```python
import torch

def _softmax(x, axis=-1):
    return torch.softmax(x, dim=axis)

def _gelu(x):
    return torch.nn.functional.gelu(x, approximate='tanh')

def _silu(x):
    return torch.nn.functional.silu(x)

def _sigmoid(x):
    return torch.sigmoid(x)

def _layernorm(x, axis=-1, eps=1e-05):
    m = x.mean(dim=axis, keepdim=True)
    v = x.var(dim=axis, keepdim=True, unbiased=False)
    return (x - m) / torch.sqrt(v + eps)

def _scatter_add(tgt, idx, src, axis=0):
    return tgt.clone().index_add_(axis, idx, src)

def _segment_sum(src, seg, n):
    out = torch.zeros((n,) + src.shape[1:], dtype=src.dtype)
    return out.index_add_(0, seg, src)

def _pad(x, pw):
    flat = tuple((v for pair in reversed(pw) for v in pair))
    return torch.nn.functional.pad(x, flat)
kernel_name = 'concat_heads__linear_attn_block__memory_aug_recurrent_mem_tr__prompt'

def setup_inputs():

    _w = lambda a: (lambda t: t.to(torch.bfloat16) if t.is_floating_point() else t)(torch.as_tensor(a))

    def _A_setup():
        B, S, D = (1, 2048, 1024)
        return {'x': _w((lambda *s: torch.randn(*s, dtype=torch.bfloat16) * 0.05)(B, S, D)), 'wqkv': _w((lambda *s: torch.randn(*s, dtype=torch.bfloat16) * 1.6)(D, 3 * D)), 'wo': _w((lambda *s: torch.randn(*s, dtype=torch.bfloat16) * 0.05)(D, D))}
    _A_in = _A_setup()

    def _B_setup():
        B, S, Dm = (1, 2048, 1024)
        H, Dh = (32, 128)
        M, seg = (8, 32)
        seg = min(seg, S)
        S = S // seg * seg
        return {'x': _w((lambda *s: torch.randn(*s, dtype=torch.bfloat16) * 0.05)(B, S, Dm)), 'mem0': _w((lambda *s: torch.randn(*s, dtype=torch.bfloat16) * 0.8)(B, M, Dm)), 'Wq': _w((lambda *s: torch.randn(*s, dtype=torch.bfloat16) * 1.6)(Dm, H, Dh) * Dm ** (-0.5)), 'Wk': _w((lambda *s: torch.randn(*s, dtype=torch.bfloat16) * 1.6)(Dm, H, Dh) * Dm ** (-0.5)), 'Wv': _w((lambda *s: torch.randn(*s, dtype=torch.bfloat16) * 0.8)(Dm, H, Dh) * Dm ** (-0.5)), 'Wo': _w((lambda *s: torch.randn(*s, dtype=torch.bfloat16) * 0.8)(H, Dh, Dm) * (H * Dh) ** (-0.5)), 'seg_len': seg}
    _B_in = _B_setup()
    return {'A_x': _A_in['x'], 'A_wqkv': _A_in['wqkv'], 'A_wo': _A_in['wo'], 'B_x': _B_in['x'], 'B_mem0': _B_in['mem0'], 'B_Wq': _B_in['Wq'], 'B_Wk': _B_in['Wk'], 'B_Wv': _B_in['Wv'], 'B_Wo': _B_in['Wo'], 'B_seg_len': _B_in['seg_len']}

def reference(A_x, A_wqkv, A_wo, B_x, B_mem0, B_Wq, B_Wk, B_Wv, B_Wo, B_seg_len):

    def _A_ref(x, wqkv, wo):
        B, S, D = x.shape
        H = 32
        Dh = D // H
        qkv = (lambda x, *d: x.permute(*d))((x @ wqkv).reshape(B, S, 3, H, Dh), 2, 0, 3, 1, 4)
        q, k, v = (qkv[0], qkv[1], qkv[2])
        phi = lambda t: torch.where(t > 0, t + 1, torch.exp(t)) + 1e-06
        pq, pk = (phi(q), phi(k))
        kv = torch.einsum('bhsd,bhse->bhde', pk, v)
        z = torch.einsum('bhsd->bhd', pk)
        num = torch.einsum('bhqd,bhde->bhqe', pq, kv)
        den = torch.einsum('bhqd,bhd->bhq', pq, z)[..., None] + 1e-06
        o = num / den
        return (lambda x, *d: x.permute(*d))(o, 0, 2, 1, 3).reshape(B, S, D) @ wo

    def _B_ref(x, mem0, Wq, Wk, Wv, Wo, seg_len):
        B, S, Dm = x.shape
        H, Dh = (Wq.shape[1], Wq.shape[2])
        M = mem0.shape[1]
        scale = Dh ** (-0.5)
        n_seg = S // seg_len
        L = M + seg_len
        idx = torch.arange(L)
        mask = (idx[:, None] < M) | (idx[:, None] >= idx[None, :])
        mem = mem0
        outs = []
        for s in range(n_seg):
            xs = x[:, s * seg_len:(s + 1) * seg_len, :].clone()
            h = torch.concatenate([mem, xs], axis=1)
            q = torch.einsum('btd,dhe->bhte', h, Wq)
            k = torch.einsum('btd,dhe->bhte', h, Wk)
            v = torch.einsum('btd,dhe->bhte', h, Wv)
            scores = torch.einsum('bhqe,bhke->bhqk', q, k) * scale
            scores = torch.where(mask[None, None], scores, -1000000000.0)
            p = _softmax(scores, axis=-1)
            o = torch.einsum('bhqk,bhke->bhqe', p, v)
            o = torch.einsum('bhte,hed->btd', o, Wo)
            mem = o[:, :M, :].clone()
            outs.append(o[:, M:, :])
        return torch.concatenate(outs, axis=1)
    a = _A_ref(A_x, A_wqkv, A_wo)
    b = _B_ref(B_x, B_mem0, B_Wq, B_Wk, B_Wv, B_Wo, B_seg_len)
    return torch.concatenate([a, b], axis=-1)
```

```asm
; @launch kernel=main_kernel grid=(256,1,1) block=(512,1,1) lds=163840
.amdgcn_target "amdgcn-amd-amdhsa--gfx950"
.text
.globl main_kernel
.p2align 8
.type main_kernel,@function
main_kernel:
    s_load_dwordx2 s[4:5], s[0:1], 96
    s_load_dwordx2 s[6:7], s[0:1], 88
    s_getreg_b32 s24, hwreg(HW_REG_XCC_ID)
    s_and_b32 s24, s24, 7
    v_lshrrev_b32 v1, 6, v0
    v_mov_b32 v3, 163584
    v_readfirstlane_b32 s26, v1
    s_waitcnt lgkmcnt(0)
    s_mov_b32 s8, s4
    s_and_b32 s9, s5, 0xffff
    s_mov_b32 s10, 0x10000000
    s_mov_b32 s11, 0x20000
    s_mov_b32 s20, s6
    s_and_b32 s21, s7, 0xffff
    s_mov_b32 s22, 0x100
    s_mov_b32 s23, 0x20000
    s_cmp_lg_u32 s26, 7
    s_cbranch_scc1 L_nocw
    s_getpc_b64 s[48:49]
L_cwpc:
    s_and_b32 s49, s49, 0xffff
    s_mov_b32 s50, W_table-L_cwpc
    s_mov_b32 s51, 0x20000
    s_bfe_u32 s3, s2, 0x50003
    s_lshl_b32 s3, s3, 12
    v_and_b32 v4, 63, v0
    v_lshlrev_b32 v4, 6, v4
    buffer_load_dword v255, v4, s[48:51], s3 offen
L_nocw:
    s_cmp_lg_u32 s26, 0
    s_cbranch_scc1 L_noticket
    s_mov_b64 exec, 1
    s_lshl_b32 s3, s24, 2
    v_mov_b32 v1, s3
    v_mov_b32 v2, 1
    buffer_atomic_add v2, v1, s[20:23], 0 offen sc0 sc1
    s_cmp_ge_u32 s24, 4
    s_cbranch_scc1 L_nocal
    s_and_b32 s3, s2, 127
    s_lshl_b32 s3, s3, 14
    s_bfe_u32 s38, s2, 0x20007
    s_lshl_b32 s38, s38, 8
    s_add_u32 s3, s3, s38
    s_add_u32 s3, s3, 75497472
    s_add_u32 s38, s3, 8192
    v_mov_b32 v4, 0
    v_mov_b32 v5, -1
    v_mov_b32 v6, 77594624
    buffer_store_dword v5, v4, s[8:11], s3 offen sc1
    buffer_store_dword v5, v4, s[8:11], s38 offen sc1
    buffer_load_dword v7, v6, s[8:11], 0 offen
    s_waitcnt vmcnt(0)
    s_memtime s[48:49]
    s_waitcnt lgkmcnt(0)
    buffer_store_dword v5, v4, s[8:11], s3 offen sc1
    s_waitcnt vmcnt(0)
    s_memtime s[50:51]
    s_waitcnt lgkmcnt(0)
    buffer_store_dword v5, v4, s[8:11], s38 offen sc1
    s_waitcnt vmcnt(0)
    s_memtime s[52:53]
    s_waitcnt lgkmcnt(0)
    s_sub_u32 s48, s50, s48
    s_sub_u32 s50, s52, s50
    s_cmp_gt_u32 s48, s50
    s_cselect_b32 s59, 0x10001, 1
L_nocal:
    s_waitcnt vmcnt(0)
    ds_write_b32 v3, v2
    s_waitcnt lgkmcnt(0)
    s_mov_b64 exec, -1
L_noticket:
    s_barrier
    ds_read_b32 v2, v3
    s_waitcnt lgkmcnt(0)
    v_readfirstlane_b32 s25, v2
    s_nop 3
    s_cmp_ge_u32 s24, 4
    s_cbranch_scc1 W_start
    s_cmp_ge_u32 s25, 32
    s_cbranch_scc1 L_end
    s_load_dwordx2 s[48:49], s[0:1], 40
    s_load_dwordx2 s[50:51], s[0:1], 48
    s_load_dwordx2 s[52:53], s[0:1], 56
    s_load_dwordx2 s[54:55], s[0:1], 64
    s_load_dwordx2 s[56:57], s[0:1], 32
    v_lshrrev_b32 v1, 6, v0
    v_and_b32 v2, 63, v0
    v_readfirstlane_b32 s26, v1
    v_and_b32 v3, 15, v2
    v_lshrrev_b32 v4, 4, v2
    v_bfe_u32 v5, v2, 3, 1
    v_and_b32 v6, 7, v2
    v_lshlrev_b32 v7, 4, v2
    s_lshr_b32 s27, s25, 2
    s_lshl_b32 s38, s24, 3
    s_add_u32 s27, s27, s38
    s_and_b32 s28, s25, 3
    s_mov_b32 s30, 0x40000
    s_mov_b32 s41, 0xfffffffe
    s_mov_b32 s42, 0x3e0293ee
    s_mov_b32 s43, 0
    s_mov_b32 s29, 0
    s_waitcnt lgkmcnt(0)
    s_mov_b32 s16, s56
    s_and_b32 s17, s57, 0xffff
    s_mov_b32 s18, 0x4000
    s_mov_b32 s19, 0x20000
    s_load_dwordx2 s[56:57], s[0:1], 80
    s_waitcnt lgkmcnt(0)
    v_mov_b32 v8, -1
    v_mov_b32 v9, -1
    v_mov_b32 v10, -1
    v_mov_b32 v11, -1
    s_xor_b32 s38, s24, 0
    s_lshl_b32 s38, s38, 5
    s_add_u32 s38, s38, s25
    s_lshl_b32 s38, s38, 14
    s_add_u32 s38, s38, s43
    s_lshl_b32 s39, s26, 10
    s_add_u32 s38, s38, s39
    s_add_u32 s38, s38, 75497472
    buffer_store_dwordx4 v[8:11], v7, s[8:11], s38 offen sc1
    s_add_u32 s38, s38, 8192
    buffer_store_dwordx4 v[8:11], v7, s[8:11], s38 offen sc1
    s_cmp_ge_u32 s26, 2
    s_cbranch_scc1 ini_1
    s_lshl_b32 s38, s26, 18
    s_lshl_b32 s39, s27, 13
    s_add_u32 s38, s38, s39
    s_add_u32 s38, s38, 77594624
    s_lshl_b32 s39, s28, 10
    s_add_u32 s39, s39, s38
    buffer_store_dwordx4 v[8:11], v7, s[8:11], s39 offen
    s_lshl_b32 s39, s28, 8
    s_add_u32 s39, s39, s38
    s_add_u32 s39, s39, 4096
    v_lshlrev_b32 v12, 2, v2
    buffer_store_dword v8, v12, s[8:11], s39 offen
    v_lshlrev_b32 v12, 3, v2
    s_lshl_b32 s38, s26, 16
    s_lshl_b32 s39, s24, 14
    s_add_u32 s38, s38, s39
    s_lshl_b32 s39, s25, 9
    s_add_u32 s38, s38, s39
    s_add_u32 s39, s38, 78643200
    buffer_store_dwordx2 v[8:9], v12, s[8:11], s39 offen
    s_add_u32 s39, s38, 78905344
    buffer_store_dwordx2 v[8:9], v12, s[8:11], s39 offen
ini_1:
    v_mov_b32 v16, 0
    v_mov_b32 v17, 0
    v_mov_b32 v18, 0
    v_mov_b32 v19, 0
    s_lshl_b32 s38, s24, 5
    s_add_u32 s38, s38, s25
    s_lshl_b32 s38, s38, 3
    s_add_u32 s38, s38, s26
    s_lshl_b32 s38, s38, 10
    s_add_u32 s38, s38, 79691776
    buffer_store_dwordx4 v[16:19], v7, s[8:11], s38 offen sc1
    s_waitcnt vmcnt(0)
    s_barrier
    s_cmp_lg_u32 s26, 0
    s_cbranch_scc1 rdy_2
    v_mov_b32 v12, 128
    v_mov_b32 v13, s59
    s_mov_b64 exec, 1
    buffer_atomic_add v13, v12, s[20:23], 0 offen sc1
    s_mov_b64 exec, -1
rdy_2:
    v_lshrrev_b32 v12, 2, v2
    v_and_b32 v13, 3, v2
    v_lshlrev_b32 v13, 4, v13
    v_bfe_u32 v14, v12, 1, 1
    v_lshlrev_b32 v14, 3, v14
    v_lshrrev_b32 v15, 2, v12
    v_lshl_add_u32 v14, v15, 1, v14
    v_and_b32 v15, 1, v12
    v_add_u32 v14, v14, v15
    v_lshl_add_u32 v14, v14, 13, v13
    s_lshl_b32 s38, s27, 8
    s_lshl_b32 s39, s28, 6
    s_add_u32 s38, s38, s39
    v_add_u32 v14, s38, v14
    v_and_b32 v15, 1, v12
    v_lshlrev_b32 v15, 4, v15
    v_lshrrev_b32 v16, 3, v2
    v_add_u32 v15, v15, v16
    v_lshl_add_u32 v15, v15, 11, v13
    s_lshl_b32 s38, s24, 21
    s_lshl_b32 s39, s25, 6
    s_add_u32 s38, s38, s39
    v_add_u32 v15, s38, v15
    s_lshr_b32 s38, s26, 1
    s_mov_b64 s[12:13], s[48:49]
    s_cmp_eq_u32 s38, 1
    s_cselect_b64 s[12:13], s[50:51], s[12:13]
    s_cmp_eq_u32 s38, 2
    s_cselect_b64 s[12:13], s[52:53], s[12:13]
    s_cmp_eq_u32 s38, 3
    s_cselect_b64 s[12:13], s[54:55], s[12:13]
    s_cselect_b32 s40, 11, 13
    s_cselect_b32 s3, 21, 11
    s_and_b32 s13, s13, 0xffff
    s_mov_b32 s14, 8388608
    s_mov_b32 s15, 0x20000
    s_lshl_b32 s3, s24, s3
    s_lshr_b32 s38, s12, 7
    s_sub_u32 s38, 3, s38
    s_and_b32 s36, s38, 7
    s_lshl_b32 s38, s36, 7
    s_add_u32 s3, s3, s38
    s_lshl_b32 s38, s25, 5
    s_and_b32 s39, s26, 1
    s_lshl_b32 s39, s39, 4
    s_add_u32 s38, s38, s39
    v_add_u32 v18, s38, v12
    v_lshlrev_b32 v18, s40, v18
    v_bfe_u32 v19, v2, 1, 1
    v_lshl_add_u32 v18, v19, 10, v18
    v_and_b32 v19, 1, v2
    v_lshl_add_u32 v18, v19, 6, v18
    buffer_load_dword v24, v18, s[12:15], s3 offen
    s_lshr_b32 s38, s12, 7
    s_lshl_b32 s39, s24, 4
    s_add_u32 s38, s38, s39
    s_sub_u32 s38, 63, s38
    s_and_b32 s35, s38, 63
    s_cmp_ge_u32 s35, 16
    s_cbranch_scc1 h2_5
    s_sub_u32 s38, s35, s36
    s_lshl_b32 s38, s38, 7
    s_add_u32 s3, s3, s38
    v_and_b32 v18, 0xfffffbff, v18
    buffer_load_dword v25, v18, s[12:15], s3 offen
    s_lshr_b32 s38, s25, 1
    s_cmp_eq_u32 s38, s35
    s_cbranch_scc1 hw_4
h2_5:
    s_bfe_u32 s38, s25, 0x30001
    s_cmp_lg_u32 s38, s36
    s_cbranch_scc1 hs_3
hw_4:
    s_waitcnt vmcnt(0)
    s_sleep 32
hs_3:
    s_cmp_ge_u32 s26, 4
    s_cbranch_scc1 w2_6
    s_mov_b32 s12, s48
    s_and_b32 s13, s49, 0xffff
    s_mov_b32 s14, 0x800000
    s_mov_b32 s15, 0x20000
    s_and_b32 s38, s26, 3
    s_lshl_b32 s39, s38, 21
    s_lshl_b32 s40, s26, 14
    s_mov_b32 m0, s40
    s_add_u32 s40, s40, 1024
    buffer_load_dwordx4 v14, s[12:15], s39 offen  lds
    s_add_u32 s39, s39, 131072
    s_mov_b32 m0, s40
    s_add_u32 s40, s40, 1024
    buffer_load_dwordx4 v14, s[12:15], s39 offen  lds
    s_add_u32 s39, s39, 131072
    s_mov_b32 m0, s40
    s_add_u32 s40, s40, 1024
    buffer_load_dwordx4 v14, s[12:15], s39 offen  lds
    s_add_u32 s39, s39, 131072
    s_mov_b32 m0, s40
    s_add_u32 s40, s40, 1024
    buffer_load_dwordx4 v14, s[12:15], s39 offen  lds
    s_add_u32 s39, s39, 131072
    s_mov_b32 m0, s40
    s_add_u32 s40, s40, 1024
    buffer_load_dwordx4 v14, s[12:15], s39 offen  lds
    s_add_u32 s39, s39, 131072
    s_mov_b32 m0, s40
    s_add_u32 s40, s40, 1024
    buffer_load_dwordx4 v14, s[12:15], s39 offen  lds
    s_add_u32 s39, s39, 131072
    s_mov_b32 m0, s40
    s_add_u32 s40, s40, 1024
    buffer_load_dwordx4 v14, s[12:15], s39 offen  lds
    s_add_u32 s39, s39, 131072
    s_mov_b32 m0, s40
    s_add_u32 s40, s40, 1024
    buffer_load_dwordx4 v14, s[12:15], s39 offen  lds
    s_add_u32 s39, s39, 131072
    s_mov_b32 m0, s40
    s_add_u32 s40, s40, 1024
    buffer_load_dwordx4 v14, s[12:15], s39 offen  lds
    s_add_u32 s39, s39, 131072
    s_mov_b32 m0, s40
    s_add_u32 s40, s40, 1024
    buffer_load_dwordx4 v14, s[12:15], s39 offen  lds
    s_add_u32 s39, s39, 131072
    s_mov_b32 m0, s40
    s_add_u32 s40, s40, 1024
    buffer_load_dwordx4 v14, s[12:15], s39 offen  lds
    s_add_u32 s39, s39, 131072
    s_mov_b32 m0, s40
    s_add_u32 s40, s40, 1024
    buffer_load_dwordx4 v14, s[12:15], s39 offen  lds
    s_add_u32 s39, s39, 131072
    s_mov_b32 m0, s40
    s_add_u32 s40, s40, 1024
    buffer_load_dwordx4 v14, s[12:15], s39 offen  lds
    s_add_u32 s39, s39, 131072
    s_mov_b32 m0, s40
    s_add_u32 s40, s40, 1024
    buffer_load_dwordx4 v14, s[12:15], s39 offen  lds
    s_add_u32 s39, s39, 131072
    s_mov_b32 m0, s40
    s_add_u32 s40, s40, 1024
    buffer_load_dwordx4 v14, s[12:15], s39 offen  lds
    s_add_u32 s39, s39, 131072
    s_mov_b32 m0, s40
    s_add_u32 s40, s40, 1024
    buffer_load_dwordx4 v14, s[12:15], s39 offen  lds
    s_add_u32 s39, s39, 131072
    s_mov_b32 s12, s52
    s_and_b32 s13, s53, 0xffff
    s_mov_b32 s14, 0x800000
    s_mov_b32 s15, 0x20000
    s_and_b32 s38, s26, 3
    s_lshl_b32 s39, s38, 21
    buffer_load_dwordx4 v[64:67], v14, s[12:15], s39 offen
    s_add_u32 s39, s39, 131072
    buffer_load_dwordx4 v[68:71], v14, s[12:15], s39 offen
    s_add_u32 s39, s39, 131072
    buffer_load_dwordx4 v[72:75], v14, s[12:15], s39 offen
    s_add_u32 s39, s39, 131072
    buffer_load_dwordx4 v[76:79], v14, s[12:15], s39 offen
    s_add_u32 s39, s39, 131072
    buffer_load_dwordx4 v[80:83], v14, s[12:15], s39 offen
    s_add_u32 s39, s39, 131072
    buffer_load_dwordx4 v[84:87], v14, s[12:15], s39 offen
    s_add_u32 s39, s39, 131072
    buffer_load_dwordx4 v[88:91], v14, s[12:15], s39 offen
    s_add_u32 s39, s39, 131072
    buffer_load_dwordx4 v[92:95], v14, s[12:15], s39 offen
    s_add_u32 s39, s39, 131072
    buffer_load_dwordx4 v[96:99], v14, s[12:15], s39 offen
    s_add_u32 s39, s39, 131072
    buffer_load_dwordx4 v[100:103], v14, s[12:15], s39 offen
    s_add_u32 s39, s39, 131072
    buffer_load_dwordx4 v[104:107], v14, s[12:15], s39 offen
    s_add_u32 s39, s39, 131072
    buffer_load_dwordx4 v[108:111], v14, s[12:15], s39 offen
    s_add_u32 s39, s39, 131072
    buffer_load_dwordx4 v[112:115], v14, s[12:15], s39 offen
    s_add_u32 s39, s39, 131072
    buffer_load_dwordx4 v[116:119], v14, s[12:15], s39 offen
    s_add_u32 s39, s39, 131072
    buffer_load_dwordx4 v[120:123], v14, s[12:15], s39 offen
    s_add_u32 s39, s39, 131072
    buffer_load_dwordx4 v[124:127], v14, s[12:15], s39 offen
    s_add_u32 s39, s39, 131072
    v_mov_b32 v26, 128
    buffer_load_dword v27, v26, s[20:23], 0 offen sc1
    s_getpc_b64 s[60:61]
lt_8:
    s_and_b32 s61, s61, 0xffff
    s_mov_b32 s62, L_rt_done-lt_8
    s_mov_b32 s63, 0x20000
    s_lshl_b32 s38, s25, 3
    s_add_u32 s38, s38, s26
    s_lshl_b32 s38, s38, 7
    v_and_b32 v26, 1, v2
    v_lshlrev_b32 v26, 6, v26
    buffer_load_dword v28, v26, s[60:63], s38 offen
    s_waitcnt vmcnt(18)
    s_branch w2e_7
w2_6:
    s_mov_b32 s12, s50
    s_and_b32 s13, s51, 0xffff
    s_mov_b32 s14, 0x800000
    s_mov_b32 s15, 0x20000
    s_and_b32 s38, s26, 3
    s_lshl_b32 s39, s38, 21
    s_lshl_b32 s40, s26, 14
    s_mov_b32 m0, s40
    s_add_u32 s40, s40, 1024
    buffer_load_dwordx4 v14, s[12:15], s39 offen  lds
    s_add_u32 s39, s39, 131072
    s_mov_b32 m0, s40
    s_add_u32 s40, s40, 1024
    buffer_load_dwordx4 v14, s[12:15], s39 offen  lds
    s_add_u32 s39, s39, 131072
    s_mov_b32 m0, s40
    s_add_u32 s40, s40, 1024
    buffer_load_dwordx4 v14, s[12:15], s39 offen  lds
    s_add_u32 s39, s39, 131072
    s_mov_b32 m0, s40
    s_add_u32 s40, s40, 1024
    buffer_load_dwordx4 v14, s[12:15], s39 offen  lds
    s_add_u32 s39, s39, 131072
    s_mov_b32 m0, s40
    s_add_u32 s40, s40, 1024
    buffer_load_dwordx4 v14, s[12:15], s39 offen  lds
    s_add_u32 s39, s39, 131072
    s_mov_b32 m0, s40
    s_add_u32 s40, s40, 1024
    buffer_load_dwordx4 v14, s[12:15], s39 offen  lds
    s_add_u32 s39, s39, 131072
    s_mov_b32 m0, s40
    s_add_u32 s40, s40, 1024
    buffer_load_dwordx4 v14, s[12:15], s39 offen  lds
    s_add_u32 s39, s39, 131072
    s_mov_b32 m0, s40
    s_add_u32 s40, s40, 1024
    buffer_load_dwordx4 v14, s[12:15], s39 offen  lds
    s_add_u32 s39, s39, 131072
    s_mov_b32 m0, s40
    s_add_u32 s40, s40, 1024
    buffer_load_dwordx4 v14, s[12:15], s39 offen  lds
    s_add_u32 s39, s39, 131072
    s_mov_b32 m0, s40
    s_add_u32 s40, s40, 1024
    buffer_load_dwordx4 v14, s[12:15], s39 offen  lds
    s_add_u32 s39, s39, 131072
    s_mov_b32 m0, s40
    s_add_u32 s40, s40, 1024
    buffer_load_dwordx4 v14, s[12:15], s39 offen  lds
    s_add_u32 s39, s39, 131072
    s_mov_b32 m0, s40
    s_add_u32 s40, s40, 1024
    buffer_load_dwordx4 v14, s[12:15], s39 offen  lds
    s_add_u32 s39, s39, 131072
    s_mov_b32 m0, s40
    s_add_u32 s40, s40, 1024
    buffer_load_dwordx4 v14, s[12:15], s39 offen  lds
    s_add_u32 s39, s39, 131072
    s_mov_b32 m0, s40
    s_add_u32 s40, s40, 1024
    buffer_load_dwordx4 v14, s[12:15], s39 offen  lds
    s_add_u32 s39, s39, 131072
    s_mov_b32 m0, s40
    s_add_u32 s40, s40, 1024
    buffer_load_dwordx4 v14, s[12:15], s39 offen  lds
    s_add_u32 s39, s39, 131072
    s_mov_b32 m0, s40
    s_add_u32 s40, s40, 1024
    buffer_load_dwordx4 v14, s[12:15], s39 offen  lds
    s_add_u32 s39, s39, 131072
    s_mov_b32 s12, s54
    s_and_b32 s13, s55, 0xffff
    s_mov_b32 s14, 0x800000
    s_mov_b32 s15, 0x20000
    s_and_b32 s38, s26, 3
    s_lshl_b32 s39, s38, 19
    buffer_load_dwordx4 v[64:67], v15, s[12:15], s39 offen
    s_add_u32 s39, s39, 16384
    buffer_load_dwordx4 v[68:71], v15, s[12:15], s39 offen
    s_add_u32 s39, s39, 49152
    buffer_load_dwordx4 v[72:75], v15, s[12:15], s39 offen
    s_add_u32 s39, s39, 16384
    buffer_load_dwordx4 v[76:79], v15, s[12:15], s39 offen
    s_add_u32 s39, s39, 49152
    buffer_load_dwordx4 v[80:83], v15, s[12:15], s39 offen
    s_add_u32 s39, s39, 16384
    buffer_load_dwordx4 v[84:87], v15, s[12:15], s39 offen
    s_add_u32 s39, s39, 49152
    buffer_load_dwordx4 v[88:91], v15, s[12:15], s39 offen
    s_add_u32 s39, s39, 16384
    buffer_load_dwordx4 v[92:95], v15, s[12:15], s39 offen
    s_add_u32 s39, s39, 49152
    buffer_load_dwordx4 v[96:99], v15, s[12:15], s39 offen
    s_add_u32 s39, s39, 16384
    buffer_load_dwordx4 v[100:103], v15, s[12:15], s39 offen
    s_add_u32 s39, s39, 49152
    buffer_load_dwordx4 v[104:107], v15, s[12:15], s39 offen
    s_add_u32 s39, s39, 16384
    buffer_load_dwordx4 v[108:111], v15, s[12:15], s39 offen
    s_add_u32 s39, s39, 49152
    buffer_load_dwordx4 v[112:115], v15, s[12:15], s39 offen
    s_add_u32 s39, s39, 16384
    buffer_load_dwordx4 v[116:119], v15, s[12:15], s39 offen
    s_add_u32 s39, s39, 49152
    buffer_load_dwordx4 v[120:123], v15, s[12:15], s39 offen
    s_add_u32 s39, s39, 16384
    buffer_load_dwordx4 v[124:127], v15, s[12:15], s39 offen
    s_add_u32 s39, s39, 49152
    v_mov_b32 v26, 128
    buffer_load_dword v27, v26, s[20:23], 0 offen sc1
    s_getpc_b64 s[60:61]
lt_9:
    s_and_b32 s61, s61, 0xffff
    s_mov_b32 s62, L_rt_done-lt_9
    s_mov_b32 s63, 0x20000
    s_lshl_b32 s38, s25, 3
    s_add_u32 s38, s38, s26
    s_lshl_b32 s38, s38, 7
    v_and_b32 v26, 1, v2
    v_lshlrev_b32 v26, 6, v26
    buffer_load_dword v28, v26, s[60:63], s38 offen
    s_waitcnt vmcnt(18)
w2e_7:
    v_bfe_u32 v16, v2, 2, 2
    v_lshl_add_u32 v16, v4, 3, v16
    v_lshlrev_b32 v16, 6, v16
    v_and_b32 v17, 3, v2
    v_lshl_add_u32 v16, v17, 3, v16
    s_barrier
    s_cmp_ge_u32 s26, 4
    s_cbranch_scc1 w1_10
    s_lshl_b32 s38, s26, 14
    v_add_u32 v17, s38, v16
    v_add_u32 v19, 65536, v17
    ds_read_b64_tr_b16 v[128:129], v17 offset:0
    ds_read_b64_tr_b16 v[136:137], v19 offset:0
    ds_read_b64_tr_b16 v[130:131], v17 offset:256
    ds_read_b64_tr_b16 v[138:139], v19 offset:256
    ds_read_b64_tr_b16 v[132:133], v17 offset:2048
    ds_read_b64_tr_b16 v[140:141], v19 offset:2048
    ds_read_b64_tr_b16 v[134:135], v17 offset:2304
    ds_read_b64_tr_b16 v[142:143], v19 offset:2304
    ds_read_b64_tr_b16 v[144:145], v17 offset:32
    ds_read_b64_tr_b16 v[152:153], v19 offset:32
    ds_read_b64_tr_b16 v[146:147], v17 offset:288
    ds_read_b64_tr_b16 v[154:155], v19 offset:288
    ds_read_b64_tr_b16 v[148:149], v17 offset:2080
    ds_read_b64_tr_b16 v[156:157], v19 offset:2080
    ds_read_b64_tr_b16 v[150:151], v17 offset:2336
    ds_read_b64_tr_b16 v[158:159], v19 offset:2336
    s_waitcnt lgkmcnt(8)
    v_swap_b32 v129, v137
    v_swap_b32 v131, v139
    v_swap_b32 v133, v141
    v_swap_b32 v135, v143
    ds_read_b64_tr_b16 v[160:161], v17 offset:4096
    ds_read_b64_tr_b16 v[168:169], v19 offset:4096
    ds_read_b64_tr_b16 v[162:163], v17 offset:4352
    ds_read_b64_tr_b16 v[170:171], v19 offset:4352
    ds_read_b64_tr_b16 v[164:165], v17 offset:6144
    ds_read_b64_tr_b16 v[172:173], v19 offset:6144
    ds_read_b64_tr_b16 v[166:167], v17 offset:6400
    ds_read_b64_tr_b16 v[174:175], v19 offset:6400
    s_waitcnt lgkmcnt(8)
    v_swap_b32 v145, v153
    v_swap_b32 v147, v155
    v_swap_b32 v149, v157
    v_swap_b32 v151, v159
    ds_read_b64_tr_b16 v[176:177], v17 offset:4128
    ds_read_b64_tr_b16 v[184:185], v19 offset:4128
    ds_read_b64_tr_b16 v[178:179], v17 offset:4384
    ds_read_b64_tr_b16 v[186:187], v19 offset:4384
    ds_read_b64_tr_b16 v[180:181], v17 offset:6176
    ds_read_b64_tr_b16 v[188:189], v19 offset:6176
    ds_read_b64_tr_b16 v[182:183], v17 offset:6432
    ds_read_b64_tr_b16 v[190:191], v19 offset:6432
    s_waitcnt lgkmcnt(8)
    v_swap_b32 v161, v169
    v_swap_b32 v163, v171
    v_swap_b32 v165, v173
    v_swap_b32 v167, v175
    ds_read_b64_tr_b16 v[192:193], v17 offset:8192
    ds_read_b64_tr_b16 v[200:201], v19 offset:8192
    ds_read_b64_tr_b16 v[194:195], v17 offset:8448
    ds_read_b64_tr_b16 v[202:203], v19 offset:8448
    ds_read_b64_tr_b16 v[196:197], v17 offset:10240
    ds_read_b64_tr_b16 v[204:205], v19 offset:10240
    ds_read_b64_tr_b16 v[198:199], v17 offset:10496
    ds_read_b64_tr_b16 v[206:207], v19 offset:10496
    s_waitcnt lgkmcnt(8)
    v_swap_b32 v177, v185
    v_swap_b32 v179, v187
    v_swap_b32 v181, v189
    v_swap_b32 v183, v191
    ds_read_b64_tr_b16 v[208:209], v17 offset:8224
    ds_read_b64_tr_b16 v[216:217], v19 offset:8224
    ds_read_b64_tr_b16 v[210:211], v17 offset:8480
    ds_read_b64_tr_b16 v[218:219], v19 offset:8480
    ds_read_b64_tr_b16 v[212:213], v17 offset:10272
    ds_read_b64_tr_b16 v[220:221], v19 offset:10272
    ds_read_b64_tr_b16 v[214:215], v17 offset:10528
    ds_read_b64_tr_b16 v[222:223], v19 offset:10528
    s_waitcnt lgkmcnt(8)
    v_swap_b32 v193, v201
    v_swap_b32 v195, v203
    v_swap_b32 v197, v205
    v_swap_b32 v199, v207
    ds_read_b64_tr_b16 v[224:225], v17 offset:12288
    ds_read_b64_tr_b16 v[232:233], v19 offset:12288
    ds_read_b64_tr_b16 v[226:227], v17 offset:12544
    ds_read_b64_tr_b16 v[234:235], v19 offset:12544
    ds_read_b64_tr_b16 v[228:229], v17 offset:14336
    ds_read_b64_tr_b16 v[236:237], v19 offset:14336
    ds_read_b64_tr_b16 v[230:231], v17 offset:14592
    ds_read_b64_tr_b16 v[238:239], v19 offset:14592
    s_waitcnt lgkmcnt(8)
    v_swap_b32 v209, v217
    v_swap_b32 v211, v219
    v_swap_b32 v213, v221
    v_swap_b32 v215, v223
    ds_read_b64_tr_b16 v[240:241], v17 offset:12320
    ds_read_b64_tr_b16 v[248:249], v19 offset:12320
    ds_read_b64_tr_b16 v[242:243], v17 offset:12576
    ds_read_b64_tr_b16 v[250:251], v19 offset:12576
    ds_read_b64_tr_b16 v[244:245], v17 offset:14368
    ds_read_b64_tr_b16 v[252:253], v19 offset:14368
    ds_read_b64_tr_b16 v[246:247], v17 offset:14624
    ds_read_b64_tr_b16 v[254:255], v19 offset:14624
    s_waitcnt lgkmcnt(8)
    v_swap_b32 v225, v233
    v_swap_b32 v227, v235
    v_swap_b32 v229, v237
    v_swap_b32 v231, v239
    s_waitcnt lgkmcnt(0)
    v_swap_b32 v241, v249
    v_swap_b32 v243, v251
    v_swap_b32 v245, v253
    v_swap_b32 v247, v255
    s_waitcnt lgkmcnt(0)
w1_10:
    s_barrier
    s_lshl_b32 s38, s26, 14
    v_add_u32 v17, s38, v7
    s_waitcnt vmcnt(0)
    ds_write_b128 v17, v[64:67] offset:0
    ds_write_b128 v17, v[68:71] offset:1024
    ds_write_b128 v17, v[72:75] offset:2048
    ds_write_b128 v17, v[76:79] offset:3072
    ds_write_b128 v17, v[80:83] offset:4096
    ds_write_b128 v17, v[84:87] offset:5120
    ds_write_b128 v17, v[88:91] offset:6144
    ds_write_b128 v17, v[92:95] offset:7168
    ds_write_b128 v17, v[96:99] offset:8192
    ds_write_b128 v17, v[100:103] offset:9216
    ds_write_b128 v17, v[104:107] offset:10240
    ds_write_b128 v17, v[108:111] offset:11264
    ds_write_b128 v17, v[112:115] offset:12288
    ds_write_b128 v17, v[116:119] offset:13312
    ds_write_b128 v17, v[120:123] offset:14336
    ds_write_b128 v17, v[124:127] offset:15360
    s_waitcnt lgkmcnt(0)
    s_lshl_b32 s38, s26, 14
    v_add_u32 v17, s38, v16
    s_cmp_lt_u32 s26, 4
    s_cbranch_scc1 w3_11
    ds_read_b64_tr_b16 v[128:129], v17 offset:0
    ds_read_b64_tr_b16 v[136:137], v17 offset:32
    ds_read_b64_tr_b16 v[130:131], v17 offset:256
    ds_read_b64_tr_b16 v[138:139], v17 offset:288
    ds_read_b64_tr_b16 v[132:133], v17 offset:2048
    ds_read_b64_tr_b16 v[140:141], v17 offset:2080
    ds_read_b64_tr_b16 v[134:135], v17 offset:2304
    ds_read_b64_tr_b16 v[142:143], v17 offset:2336
    ds_read_b64_tr_b16 v[144:145], v17 offset:4096
    ds_read_b64_tr_b16 v[152:153], v17 offset:4128
    ds_read_b64_tr_b16 v[146:147], v17 offset:4352
    ds_read_b64_tr_b16 v[154:155], v17 offset:4384
    ds_read_b64_tr_b16 v[148:149], v17 offset:6144
    ds_read_b64_tr_b16 v[156:157], v17 offset:6176
    ds_read_b64_tr_b16 v[150:151], v17 offset:6400
    ds_read_b64_tr_b16 v[158:159], v17 offset:6432
    s_waitcnt lgkmcnt(8)
    v_swap_b32 v129, v137
    v_swap_b32 v131, v139
    v_swap_b32 v133, v141
    v_swap_b32 v135, v143
    ds_read_b64_tr_b16 v[160:161], v17 offset:8192
    ds_read_b64_tr_b16 v[168:169], v17 offset:8224
    ds_read_b64_tr_b16 v[162:163], v17 offset:8448
    ds_read_b64_tr_b16 v[170:171], v17 offset:8480
    ds_read_b64_tr_b16 v[164:165], v17 offset:10240
    ds_read_b64_tr_b16 v[172:173], v17 offset:10272
    ds_read_b64_tr_b16 v[166:167], v17 offset:10496
    ds_read_b64_tr_b16 v[174:175], v17 offset:10528
    s_waitcnt lgkmcnt(8)
    v_swap_b32 v145, v153
    v_swap_b32 v147, v155
    v_swap_b32 v149, v157
    v_swap_b32 v151, v159
    ds_read_b64_tr_b16 v[176:177], v17 offset:12288
    ds_read_b64_tr_b16 v[184:185], v17 offset:12320
    ds_read_b64_tr_b16 v[178:179], v17 offset:12544
    ds_read_b64_tr_b16 v[186:187], v17 offset:12576
    ds_read_b64_tr_b16 v[180:181], v17 offset:14336
    ds_read_b64_tr_b16 v[188:189], v17 offset:14368
    ds_read_b64_tr_b16 v[182:183], v17 offset:14592
    ds_read_b64_tr_b16 v[190:191], v17 offset:14624
    s_waitcnt lgkmcnt(8)
    v_swap_b32 v161, v169
    v_swap_b32 v163, v171
    v_swap_b32 v165, v173
    v_swap_b32 v167, v175
    s_waitcnt lgkmcnt(0)
    v_swap_b32 v177, v185
    v_swap_b32 v179, v187
    v_swap_b32 v181, v189
    v_swap_b32 v183, v191
    s_branch w3e_12
w3_11:
    ds_read_b64_tr_b16 v[64:65], v17 offset:0
    ds_read_b64_tr_b16 v[72:73], v17 offset:32
    ds_read_b64_tr_b16 v[66:67], v17 offset:256
    ds_read_b64_tr_b16 v[74:75], v17 offset:288
    ds_read_b64_tr_b16 v[68:69], v17 offset:2048
    ds_read_b64_tr_b16 v[76:77], v17 offset:2080
    ds_read_b64_tr_b16 v[70:71], v17 offset:2304
    ds_read_b64_tr_b16 v[78:79], v17 offset:2336
    ds_read_b64_tr_b16 v[80:81], v17 offset:4096
    ds_read_b64_tr_b16 v[88:89], v17 offset:4128
    ds_read_b64_tr_b16 v[82:83], v17 offset:4352
    ds_read_b64_tr_b16 v[90:91], v17 offset:4384
    ds_read_b64_tr_b16 v[84:85], v17 offset:6144
    ds_read_b64_tr_b16 v[92:93], v17 offset:6176
    ds_read_b64_tr_b16 v[86:87], v17 offset:6400
    ds_read_b64_tr_b16 v[94:95], v17 offset:6432
    s_waitcnt lgkmcnt(8)
    v_swap_b32 v65, v73
    v_swap_b32 v67, v75
    v_swap_b32 v69, v77
    v_swap_b32 v71, v79
    ds_read_b64_tr_b16 v[96:97], v17 offset:8192
    ds_read_b64_tr_b16 v[104:105], v17 offset:8224
    ds_read_b64_tr_b16 v[98:99], v17 offset:8448
    ds_read_b64_tr_b16 v[106:107], v17 offset:8480
    ds_read_b64_tr_b16 v[100:101], v17 offset:10240
    ds_read_b64_tr_b16 v[108:109], v17 offset:10272
    ds_read_b64_tr_b16 v[102:103], v17 offset:10496
    ds_read_b64_tr_b16 v[110:111], v17 offset:10528
    s_waitcnt lgkmcnt(8)
    v_swap_b32 v81, v89
    v_swap_b32 v83, v91
    v_swap_b32 v85, v93
    v_swap_b32 v87, v95
    ds_read_b64_tr_b16 v[112:113], v17 offset:12288
    ds_read_b64_tr_b16 v[120:121], v17 offset:12320
    ds_read_b64_tr_b16 v[114:115], v17 offset:12544
    ds_read_b64_tr_b16 v[122:123], v17 offset:12576
    ds_read_b64_tr_b16 v[116:117], v17 offset:14336
    ds_read_b64_tr_b16 v[124:125], v17 offset:14368
    ds_read_b64_tr_b16 v[118:119], v17 offset:14592
    ds_read_b64_tr_b16 v[126:127], v17 offset:14624
    s_waitcnt lgkmcnt(8)
    v_swap_b32 v97, v105
    v_swap_b32 v99, v107
    v_swap_b32 v101, v109
    v_swap_b32 v103, v111
    s_waitcnt lgkmcnt(0)
    v_swap_b32 v113, v121
    v_swap_b32 v115, v123
    v_swap_b32 v117, v125
    v_swap_b32 v119, v127
w3e_12:
    s_waitcnt lgkmcnt(0)
    v_mov_b32 v12, 128
    s_branch L_rdy_chk
poll_13:
    s_sub_u32 s30, s30, 1
    s_cbranch_scc1 L_end
    buffer_load_dword v27, v12, s[20:23], 0 offen sc1
    s_waitcnt vmcnt(0)
L_rdy_chk:
    v_readfirstlane_b32 s38, v27
    s_nop 3
    s_and_b32 s39, s38, 0xffff
    s_cmp_lt_u32 s39, 128
    s_cbranch_scc1 poll_13
    s_add_u32 s38, s38, 4128768
    s_lshr_b32 s38, s38, 10
    s_and_b32 s43, s38, 8192
    s_barrier
    s_mov_b32 s31, 77594624
    s_mov_b32 s32, 78643200
    s_mov_b32 s33, 75497472
    s_mov_b32 s45, 78708736
    s_mov_b32 s34, 78970880
    s_mov_b32 s46, 78905344
    s_lshl_b32 s35, s24, 5
    s_add_u32 s35, s35, s25
    s_lshl_b32 s35, s35, 19
    s_add_u32 s35, s35, 134217728
    s_bfe_u32 s3, s27, 0x10000
    s_lshl_b32 s3, s3, 13
    s_xor_b32 s3, s3, s43
    s_xor_b32 s3, s3, 8192
    s_add_u32 s35, s35, s3
    s_xor_b32 s37, s43, 0
    s_add_u32 s37, s37, 104857600
    v_mov_b32 v20, 0x4444
    v_mov_b32 v12, 0xeeee
    v_cmp_eq_u32 vcc, 1, v5
    s_nop 1
    v_cndmask_b32 v20, v20, v12, vcc
    v_and_b32 v18, 1, v4
    v_lshlrev_b32 v18, 2, v18
    v_and_b32 v12, 2, v4
    v_add_u32 v18, v18, v12
    s_and_b32 s47, s26, 3
    s_mov_b32 s58, 0
    s_mov_b32 s44, 0
    s_lshl_b32 s38, s47, 12
    s_lshl_b32 s39, s24, 14
    s_add_u32 s38, s38, s39
    v_add_u32 v21, s38, v7
    v_xor_b32 v1, 0xaaaa, v20
    s_cmp_ge_u32 s26, 4
    s_cbranch_scc1 L_vo
    s_mul_i32 s38, s26, 2304
    s_add_u32 s38, s38, 16384
    v_mul_u32_u24 v22, 576, v4
    v_lshl_add_u32 v22, v3, 2, v22
    v_add_u32 v22, s38, v22
    s_lshl_b32 s38, s47, 10
    s_add_u32 s39, s38, 26624
    v_lshrrev_b32 v8, 1, v4
    v_lshl_add_u32 v8, v8, 4, v3
    v_lshlrev_b32 v8, 5, v8
    v_and_b32 v9, 1, v4
    v_lshl_add_u32 v23, v9, 4, v8
    v_add_u32 v23, s39, v23
    v_mov_b32 v12, v7
    s_lshl_b32 s38, s27, 8
    s_lshl_b32 s39, s28, 6
    s_add_u32 s38, s38, s39
    s_lshr_b32 s38, s27, 1
    s_lshl_b32 s38, s38, 14
    s_and_b32 s39, s25, 7
    s_lshl_b32 s39, s39, 10
    s_add_u32 s38, s38, s39
    s_add_u32 s38, s38, 512
    v_lshlrev_b32 v15, 4, v3
    v_lshl_add_u32 v15, v4, 2, v15
    v_add_u32 v15, s38, v15
    v_lshlrev_b32 v8, 3, v4
    v_lshl_add_u32 v14, v3, 5, v8
    v_add_u32 v14, 26624, v14
    s_lshl_b32 s38, s24, 14
    s_lshl_b32 s39, s25, 9
    s_add_u32 s38, s38, s39
    v_lshlrev_b32 v16, 3, v2
    v_add_u32 v16, s38, v16
    s_lshl_b32 s38, s27, 13
    s_lshl_b32 s39, s28, 10
    s_add_u32 s39, s38, s39
    v_add_u32 v17, s39, v7
    s_lshl_b32 s39, s28, 8
    s_add_u32 s39, s38, s39
    s_add_u32 s39, s39, 4096
    v_lshlrev_b32 v18, 2, v2
    v_add_u32 v18, s39, v18
    v_mov_b32 v4, -1
    v_mov_b32 v5, -1
    v_mov_b32 v6, -1
    v_mov_b32 v7, -1
L_qk_loop:
    v_mov_b32 v24, 0
    v_mov_b32 v25, 0
    v_mov_b32 v26, 0
    v_mov_b32 v27, 0
    v_mov_b32 v28, 0
    v_mov_b32 v29, 0
    v_mov_b32 v30, 0
    v_mov_b32 v31, 0
.p2align 6
    s_nop 0
    s_nop 0
    s_nop 0
    s_nop 0
    s_nop 0
    s_nop 0
    s_nop 0
    s_nop 0
    s_nop 0
    s_nop 0
    s_nop 0
    s_barrier
    v_mov_b32 v0, v0
    s_nop 0
    v_mov_b32 v0, v0
    s_nop 0
    v_mov_b32 v0, v0
    s_nop 0
    v_mov_b32 v0, v0
    s_nop 0
    v_mov_b32 v0, v0
    s_nop 0
    v_mov_b32 v0, v0
    s_nop 0
    v_mov_b32 v0, v0
    s_nop 0
    v_mov_b32 v0, v0
    s_nop 0
    v_mov_b32 v0, v0
    s_nop 0
    v_mov_b32 v0, v0
    s_nop 0
    v_mov_b32 v0, v0
    s_nop 0
    v_mov_b32 v0, v0
    s_nop 0
    v_mov_b32 v0, v0
    s_nop 0
    v_mov_b32 v0, v0
    s_nop 0
    v_mov_b32 v0, v0
    s_nop 0
    v_mov_b32 v0, v0
    s_nop 0
    v_mov_b32 v0, v0
    s_nop 0
    v_mov_b32 v0, v0
    s_nop 0
    buffer_load_dwordx4 v[32:35], v21, s[8:11], s34 offen offset:0 sc1
    v_mov_b32 v0, v0
    s_nop 0
    v_mov_b32 v0, v0
    s_nop 0
    v_mov_b32 v0, v0
    s_nop 0
    v_mov_b32 v0, v0
    s_nop 0
    v_mov_b32 v0, v0
    s_nop 0
    v_mov_b32 v0, v0
    s_nop 0
    v_mov_b32 v0, v0
    s_nop 0
    v_mov_b32 v0, v0
    buffer_load_dwordx4 v[36:39], v21, s[8:11], s34 offen offset:1024 sc1
    v_mov_b32 v0, v0
    s_nop 0
    v_mov_b32 v0, v0
    s_nop 0
    v_mov_b32 v0, v0
    s_nop 0
    v_mov_b32 v0, v0
    s_nop 0
    v_mov_b32 v0, v0
    s_nop 0
    v_mov_b32 v0, v0
    s_nop 0
    v_mov_b32 v0, v0
    s_nop 0
    v_mov_b32 v0, v0
    buffer_load_dwordx4 v[40:43], v21, s[8:11], s34 offen offset:2048 sc1
    v_mov_b32 v0, v0
    s_nop 0
    v_mov_b32 v0, v0
    s_nop 0
    v_mov_b32 v0, v0
    s_nop 0
    v_mov_b32 v0, v0
    s_nop 0
    v_mov_b32 v0, v0
    s_nop 0
    v_mov_b32 v0, v0
    s_nop 0
    v_mov_b32 v0, v0
    s_nop 0
    v_mov_b32 v0, v0
    buffer_load_dwordx4 v[44:47], v21, s[8:11], s34 offen offset:3072 sc1
    v_mov_b32 v0, v0
    s_nop 0
    v_mov_b32 v0, v0
    s_nop 0
    v_mov_b32 v0, v0
    s_nop 0
    v_mov_b32 v0, v0
    s_nop 0
    v_mov_b32 v0, v0
    s_nop 0
    s_waitcnt vmcnt(3)
    v_max_u32 v8, v32, v34
    v_cmp_eq_u32 vcc, -1, v8
    v_mov_b32_dpp v48, v32 row_ror:8 row_mask:0xf bank_mask:0xf
    v_mov_b32_dpp v49, v33 row_ror:8 row_mask:0xf bank_mask:0xf
    v_mov_b32_dpp v50, v34 row_ror:8 row_mask:0xf bank_mask:0xf
    v_mov_b32_dpp v51, v35 row_ror:8 row_mask:0xf bank_mask:0xf
    s_cbranch_vccnz gent_16
    v_smfmac_f32_16x16x64_bf16 v[24:27], v[32:35], v[128:135], v20
    v_smfmac_f32_16x16x64_bf16 v[28:31], v[32:35], v[144:151], v20
    s_waitcnt vmcnt(2)
    v_max_u32 v8, v36, v38
    v_cmp_eq_u32 vcc, -1, v8
    v_smfmac_f32_16x16x64_bf16 v[24:27], v[48:51], v[136:143], v1
    v_mov_b32_dpp v52, v36 row_ror:8 row_mask:0xf bank_mask:0xf
    v_smfmac_f32_16x16x64_bf16 v[28:31], v[48:51], v[152:159], v1
    v_mov_b32_dpp v53, v37 row_ror:8 row_mask:0xf bank_mask:0xf
    s_cbranch_vccnz gent_17
    v_smfmac_f32_16x16x64_bf16 v[24:27], v[36:39], v[160:167], v20
    v_mov_b32_dpp v54, v38 row_ror:8 row_mask:0xf bank_mask:0xf
    v_smfmac_f32_16x16x64_bf16 v[28:31], v[36:39], v[176:183], v20
    v_mov_b32_dpp v55, v39 row_ror:8 row_mask:0xf bank_mask:0xf
    s_waitcnt vmcnt(1)
    v_max_u32 v8, v40, v42
    v_cmp_eq_u32 vcc, -1, v8
    v_smfmac_f32_16x16x64_bf16 v[24:27], v[52:55], v[168:175], v1
    v_mov_b32_dpp v56, v40 row_ror:8 row_mask:0xf bank_mask:0xf
    v_smfmac_f32_16x16x64_bf16 v[28:31], v[52:55], v[184:191], v1
    v_mov_b32_dpp v57, v41 row_ror:8 row_mask:0xf bank_mask:0xf
    s_cbranch_vccnz gent_18
    v_smfmac_f32_16x16x64_bf16 v[24:27], v[40:43], v[192:199], v20
    v_mov_b32_dpp v58, v42 row_ror:8 row_mask:0xf bank_mask:0xf
    v_smfmac_f32_16x16x64_bf16 v[28:31], v[40:43], v[208:215], v20
    v_mov_b32_dpp v59, v43 row_ror:8 row_mask:0xf bank_mask:0xf
    s_waitcnt vmcnt(0)
    v_max_u32 v8, v44, v46
    v_cmp_eq_u32 vcc, -1, v8
    v_smfmac_f32_16x16x64_bf16 v[24:27], v[56:59], v[200:207], v1
    v_mov_b32_dpp v60, v44 row_ror:8 row_mask:0xf bank_mask:0xf
    v_smfmac_f32_16x16x64_bf16 v[28:31], v[56:59], v[216:223], v1
    v_mov_b32_dpp v61, v45 row_ror:8 row_mask:0xf bank_mask:0xf
    s_cbranch_vccnz gent_19
    v_smfmac_f32_16x16x64_bf16 v[24:27], v[44:47], v[224:231], v20
    v_mov_b32_dpp v62, v46 row_ror:8 row_mask:0xf bank_mask:0xf
    v_smfmac_f32_16x16x64_bf16 v[28:31], v[44:47], v[240:247], v20
    v_mov_b32_dpp v63, v47 row_ror:8 row_mask:0xf bank_mask:0xf
    s_nop 1
    v_smfmac_f32_16x16x64_bf16 v[24:27], v[60:63], v[232:239], v1
    v_smfmac_f32_16x16x64_bf16 v[28:31], v[60:63], v[248:255], v1
gdone_15:
    s_nop 6
    ds_write2_b32 v22, v24, v25 offset0:0 offset1:36
    ds_write2_b32 v22, v26, v27 offset0:72 offset1:108
    ds_write2_b32 v22, v28, v29 offset0:16 offset1:52
    ds_write2_b32 v22, v30, v31 offset0:88 offset1:124
    v_mov_b32 v8, 0
    v_mov_b32 v9, 0
    v_mov_b32 v10, 0
    v_mov_b32 v11, 0
    s_waitcnt lgkmcnt(0)
    s_barrier
    v_smfmac_f32_16x16x64_bf16 v[8:11], v[32:35], v[64:71], v20
    v_smfmac_f32_16x16x64_bf16 v[8:11], v[48:51], v[72:79], v1
    v_smfmac_f32_16x16x64_bf16 v[8:11], v[36:39], v[80:87], v20
    v_smfmac_f32_16x16x64_bf16 v[8:11], v[52:55], v[88:95], v1
    v_smfmac_f32_16x16x64_bf16 v[8:11], v[40:43], v[96:103], v20
    v_smfmac_f32_16x16x64_bf16 v[8:11], v[56:59], v[104:111], v1
    v_smfmac_f32_16x16x64_bf16 v[8:11], v[44:47], v[112:119], v20
    v_smfmac_f32_16x16x64_bf16 v[8:11], v[60:63], v[120:127], v1
    s_nop 7
    ds_write_b128 v23, v[8:11]
    s_waitcnt lgkmcnt(0)
    s_barrier
    s_cmp_lg_u32 s26, 3
    s_cbranch_scc1 nv_20
    s_cmp_eq_u32 s29, 63
    s_cbranch_scc1 nv_20l
    s_nop 15
    s_nop 15
    s_nop 15
    s_nop 11
nv_20l:
    ds_read_b64 v[32:33], v14 offset:0
    ds_read_b64 v[34:35], v14 offset:1024
    ds_read_b64 v[36:37], v14 offset:2048
    ds_read_b64 v[38:39], v14 offset:3072
    ds_read_b64 v[40:41], v14 offset:512
    ds_read_b64 v[42:43], v14 offset:1536
    ds_read_b64 v[44:45], v14 offset:2560
    ds_read_b64 v[46:47], v14 offset:3584
    s_waitcnt lgkmcnt(0)
    v_pk_add_f32 v[32:33], v[32:33], v[34:35]
    v_pk_add_f32 v[36:37], v[36:37], v[38:39]
    v_pk_add_f32 v[40:41], v[40:41], v[42:43]
    v_pk_add_f32 v[44:45], v[44:45], v[46:47]
    v_pk_add_f32 v[32:33], v[32:33], v[36:37]
    v_pk_add_f32 v[40:41], v[40:41], v[44:45]
    v_cvt_pk_bf16_f32 v10, v32, v33
    v_cvt_pk_bf16_f32 v11, v40, v41
    s_cmp_eq_u32 s29, 63
    s_cbranch_scc1 L_w3_last
nv_20:
    s_cmp_eq_u32 s29, 63
    s_cbranch_scc1 L_rec_done
    s_cmp_lg_u32 s26, 1
    s_cbranch_scc1 kl_21
    s_add_u32 s38, s29, 3
    s_and_b32 s39, s38, 7
    s_cbranch_scc1 kl_21
    s_lshr_b32 s38, s38, 1
    s_add_u32 s38, s38, s24
    s_lshl_b32 s38, s38, 7
    s_add_u32 s38, s38, 79720448
    s_buffer_load_dword s44, s[8:11], s38
kl_21:
    s_lshl_b32 s38, s26, 10
    s_add_u32 s38, s38, s35
    s_add_u32 s38, s38, 16384
    s_buffer_load_dword s36, s[8:11], s38 offset:0
    s_buffer_load_dword s36, s[8:11], s38 offset:64
    s_buffer_load_dword s36, s[8:11], s38 offset:128
    s_buffer_load_dword s36, s[8:11], s38 offset:192
    s_buffer_load_dword s36, s[8:11], s38 offset:256
    s_buffer_load_dword s36, s[8:11], s38 offset:320
    s_buffer_load_dword s36, s[8:11], s38 offset:384
    s_buffer_load_dword s36, s[8:11], s38 offset:448
    s_buffer_load_dword s36, s[8:11], s38 offset:512
    s_barrier
    s_lshl_b32 s38, s26, 10
    s_add_u32 s38, s38, s35
    s_add_u32 s38, s38, 16384
    s_barrier
    s_lshl_b32 s38, s26, 10
    s_add_u32 s38, s38, s35
    s_add_u32 s38, s38, 16384
    s_buffer_load_dword s36, s[8:11], s38 offset:576
    s_buffer_load_dword s36, s[8:11], s38 offset:640
    s_buffer_load_dword s36, s[8:11], s38 offset:704
    s_buffer_load_dword s36, s[8:11], s38 offset:768
    s_buffer_load_dword s36, s[8:11], s38 offset:832
    s_buffer_load_dword s36, s[8:11], s38 offset:896
    s_buffer_load_dword s36, s[8:11], s38 offset:960
    s_cmp_lg_u32 s26, 1
    s_cbranch_scc1 n1_22
    s_nop 9
    s_bitcmp1_b32 s29, 0
    s_cselect_b32 s3, 0x2000, 0
    s_add_u32 s38, s35, s3
    s_add_u32 s38, s38, 4096
    s_mov_b32 m0, 34816
    s_nop 0
    buffer_load_dwordx4 v12, s[8:11], s38 offen offset:0 sc1 lds
    buffer_load_dwordx4 v12, s[8:11], s38 offen offset:1024 sc1 lds
    buffer_load_dwordx4 v12, s[8:11], s38 offen offset:2048 sc1 lds
    buffer_load_dwordx4 v12, s[8:11], s38 offen offset:3072 sc1 lds
    s_waitcnt vmcnt(0)
    s_add_u32 s38, s29, 2
    s_and_b32 s39, s38, 7
    s_cbranch_scc1 n1_22
    s_cmp_ge_u32 s38, 64
    s_cbranch_scc1 n1_22
    s_cmp_ge_u32 s44, 32
    s_cbranch_scc1 n1_22
    s_lshr_b32 s38, s38, 3
    s_lshl_b32 s39, s38, 2
    s_add_u32 s39, s39, s24
    s_lshl_b32 s39, s39, 7
    s_add_u32 s39, s39, 79720448
    v_mov_b32 v8, s39
    s_branch kf_24
poll_25:
    s_sub_u32 s30, s30, 1
    s_cbranch_scc1 L_end
    s_sleep 4
kf_24:
    buffer_load_dword v9, v8, s[8:11], 0 offen sc1
    s_waitcnt vmcnt(0)
    v_cmp_gt_u32 vcc, 32, v9
    s_cbranch_vccnz poll_25
n1_22:
    s_cmp_lg_u32 s26, 3
    s_cbranch_scc1 n3_23
    s_cmp_ge_u32 s29, 58
    s_cbranch_scc1 sg_26
    s_cmp_ge_u32 s29, 40
    s_cselect_b32 s38, 1, 3
    s_and_b32 s38, s29, s38
    s_cbranch_scc1 ns_27
sg_26:
    s_lshl_b32 s39, s24, 5
    s_add_u32 s39, s39, s25
    s_lshl_b32 s39, s39, 14
    s_add_u32 s39, s39, s43
    s_add_u32 s39, s39, 75501568
    v_mov_b32 v8, s39
    v_mov_b32 v9, s29
    s_mov_b64 exec, 1
    buffer_store_dword v9, v8, s[8:11], 0 offen sc1
    s_mov_b64 exec, -1
ns_27:
    s_nop 15
    s_nop 15
    s_nop 15
    s_nop 15
    s_nop 15
    s_nop 15
    s_nop 15
    s_nop 15
    s_nop 15
    s_nop 15
    s_nop 9
    buffer_store_dwordx2 v[4:5], v16, s[8:11], s34 offen
    buffer_store_dwordx4 v[4:7], v17, s[8:11], s31 offen
    buffer_store_dword v4, v18, s[8:11], s31 offen
    buffer_store_dword v10, v15, s[8:11], s37 offen sc1
    buffer_store_dword v11, v15, s[8:11], s37 offen offset:256 sc1
n3_23:
    s_cmp_lg_u32 s26, 2
    s_cbranch_scc1 n2_28
    s_cmp_ge_u32 s29, 32
    s_cbranch_scc1 n2_28
    s_and_b32 s38, s29, 12
    s_cbranch_scc0 n2_28
    s_lshr_b32 s38, s29, 4
    s_lshl_b32 s38, s38, 2
    s_add_u32 s38, s38, s24
    s_cmp_ge_u32 s38, 6
    s_cbranch_scc1 n2_28
    s_nop 15
    s_nop 15
    s_nop 15
    s_nop 15
    s_nop 15
    s_nop 15
    s_nop 15
    s_nop 15
    s_nop 15
    s_nop 15
    s_nop 9
    s_lshl_b32 s38, s24, 5
    s_add_u32 s38, s38, s25
    s_lshl_b32 s38, s38, 2
    s_lshr_b32 s39, s29, 3
    s_add_u32 s38, s38, s39
    s_lshl_b32 s38, s38, 4
    s_and_b32 s39, s29, 7
    s_add_u32 s38, s38, s39
    s_lshl_b32 s38, s38, 10
    s_and_b32 s39, s24, 1
    s_lshl_b32 s39, s39, 13
    s_xor_b32 s39, s39, s43
    s_add_u32 s38, s38, s39
    s_add_u32 s38, s38, 92274688
    buffer_store_dwordx4 v[4:7], v12, s[8:11], s38 offen sc1
n2_28:
    s_xor_b32 s31, s31, 262144
    s_xor_b32 s32, s32, 65536
    s_xor_b32 s45, s45, 65536
    s_xor_b32 s33, s33, 4096
    s_xor_b32 s34, s34, 65536
    s_xor_b32 s46, s46, 65536
    s_add_u32 s37, s37, 262144
    s_and_b32 s38, s29, 7
    s_cmp_eq_u32 s38, 7
    s_cselect_b32 s38, 8192, 0
    s_xor_b32 s37, s37, s38
    s_bitcmp1_b32 s29, 0
    s_cselect_b32 s3, 0x2000, 0
    s_add_u32 s35, s35, s3
    s_add_u32 s35, s35, 4096
    s_add_u32 s29, s29, 1
    s_branch L_qk_loop
L_w3_last:
    buffer_store_dword v10, v15, s[8:11], s37 offen sc1
    buffer_store_dword v11, v15, s[8:11], s37 offen offset:256 sc1
    s_branch L_rec_done
gent_16:
    buffer_load_dwordx4 v[32:35], v21, s[8:11], s34 offen offset:0 sc1
    s_sub_u32 s30, s30, 1
    s_cbranch_scc1 L_end
    s_branch q_29_15_1
gent_17:
    buffer_load_dwordx4 v[36:39], v21, s[8:11], s34 offen offset:1024 sc1
    s_sub_u32 s30, s30, 1
    s_cbranch_scc1 L_end
    s_branch q_29_14_2
gent_18:
    buffer_load_dwordx4 v[40:43], v21, s[8:11], s34 offen offset:2048 sc1
    s_sub_u32 s30, s30, 1
    s_cbranch_scc1 L_end
    s_branch q_29_12_3
gent_19:
    buffer_load_dwordx4 v[44:47], v21, s[8:11], s34 offen offset:3072 sc1
    s_sub_u32 s30, s30, 1
    s_cbranch_scc1 L_end
    s_branch q_29_8_3
bad_30:
    buffer_load_dwordx4 v[32:35], v21, s[8:11], s34 offen offset:0 sc1
    s_sub_u32 s30, s30, 1
    s_cbranch_scc1 L_end
q_29_1_0:
    s_waitcnt vmcnt(0)
    v_max_u32 v8, v32, v34
    v_cmp_eq_u32 vcc, -1, v8
    v_mov_b32_dpp v48, v32 row_ror:8 row_mask:0xf bank_mask:0xf
    v_mov_b32_dpp v49, v33 row_ror:8 row_mask:0xf bank_mask:0xf
    v_mov_b32_dpp v50, v34 row_ror:8 row_mask:0xf bank_mask:0xf
    v_mov_b32_dpp v51, v35 row_ror:8 row_mask:0xf bank_mask:0xf
    s_cbranch_vccnz bad_30
    v_smfmac_f32_16x16x64_bf16 v[24:27], v[32:35], v[128:135], v20
    v_smfmac_f32_16x16x64_bf16 v[28:31], v[32:35], v[144:151], v20
    v_smfmac_f32_16x16x64_bf16 v[24:27], v[48:51], v[136:143], v1
    v_smfmac_f32_16x16x64_bf16 v[28:31], v[48:51], v[152:159], v1
    s_branch gdone_15
bad_31:
    buffer_load_dwordx4 v[36:39], v21, s[8:11], s34 offen offset:1024 sc1
    s_sub_u32 s30, s30, 1
    s_cbranch_scc1 L_end
q_29_2_1:
    s_waitcnt vmcnt(0)
    v_max_u32 v8, v36, v38
    v_cmp_eq_u32 vcc, -1, v8
    v_mov_b32_dpp v52, v36 row_ror:8 row_mask:0xf bank_mask:0xf
    v_mov_b32_dpp v53, v37 row_ror:8 row_mask:0xf bank_mask:0xf
    v_mov_b32_dpp v54, v38 row_ror:8 row_mask:0xf bank_mask:0xf
    v_mov_b32_dpp v55, v39 row_ror:8 row_mask:0xf bank_mask:0xf
    s_cbranch_vccnz bad_31
    v_smfmac_f32_16x16x64_bf16 v[24:27], v[36:39], v[160:167], v20
    v_smfmac_f32_16x16x64_bf16 v[28:31], v[36:39], v[176:183], v20
    v_smfmac_f32_16x16x64_bf16 v[24:27], v[52:55], v[168:175], v1
    v_smfmac_f32_16x16x64_bf16 v[28:31], v[52:55], v[184:191], v1
    s_branch gdone_15
q_29_3_0:
    s_waitcnt vmcnt(1)
    v_max_u32 v8, v32, v34
    v_cmp_eq_u32 vcc, -1, v8
    v_mov_b32_dpp v48, v32 row_ror:8 row_mask:0xf bank_mask:0xf
    v_mov_b32_dpp v49, v33 row_ror:8 row_mask:0xf bank_mask:0xf
    v_mov_b32_dpp v50, v34 row_ror:8 row_mask:0xf bank_mask:0xf
    v_mov_b32_dpp v51, v35 row_ror:8 row_mask:0xf bank_mask:0xf
    s_cbranch_vccnz bad_32
    v_smfmac_f32_16x16x64_bf16 v[24:27], v[32:35], v[128:135], v20
    v_smfmac_f32_16x16x64_bf16 v[28:31], v[32:35], v[144:151], v20
    v_smfmac_f32_16x16x64_bf16 v[24:27], v[48:51], v[136:143], v1
    v_smfmac_f32_16x16x64_bf16 v[28:31], v[48:51], v[152:159], v1
    s_branch q_29_2_1
bad_32:
    buffer_load_dwordx4 v[32:35], v21, s[8:11], s34 offen offset:0 sc1
    s_sub_u32 s30, s30, 1
    s_cbranch_scc1 L_end
    s_branch q_29_3_1
q_29_3_1:
    s_waitcnt vmcnt(1)
    v_max_u32 v8, v36, v38
    v_cmp_eq_u32 vcc, -1, v8
    v_mov_b32_dpp v52, v36 row_ror:8 row_mask:0xf bank_mask:0xf
    v_mov_b32_dpp v53, v37 row_ror:8 row_mask:0xf bank_mask:0xf
    v_mov_b32_dpp v54, v38 row_ror:8 row_mask:0xf bank_mask:0xf
    v_mov_b32_dpp v55, v39 row_ror:8 row_mask:0xf bank_mask:0xf
    s_cbranch_vccnz bad_33
    v_smfmac_f32_16x16x64_bf16 v[24:27], v[36:39], v[160:167], v20
    v_smfmac_f32_16x16x64_bf16 v[28:31], v[36:39], v[176:183], v20
    v_smfmac_f32_16x16x64_bf16 v[24:27], v[52:55], v[168:175], v1
    v_smfmac_f32_16x16x64_bf16 v[28:31], v[52:55], v[184:191], v1
    s_branch q_29_1_0
bad_33:
    buffer_load_dwordx4 v[36:39], v21, s[8:11], s34 offen offset:1024 sc1
    s_sub_u32 s30, s30, 1
    s_cbranch_scc1 L_end
    s_branch q_29_3_0
bad_34:
    buffer_load_dwordx4 v[40:43], v21, s[8:11], s34 offen offset:2048 sc1
    s_sub_u32 s30, s30, 1
    s_cbranch_scc1 L_end
q_29_4_2:
    s_waitcnt vmcnt(0)
    v_max_u32 v8, v40, v42
    v_cmp_eq_u32 vcc, -1, v8
    v_mov_b32_dpp v56, v40 row_ror:8 row_mask:0xf bank_mask:0xf
    v_mov_b32_dpp v57, v41 row_ror:8 row_mask:0xf bank_mask:0xf
    v_mov_b32_dpp v58, v42 row_ror:8 row_mask:0xf bank_mask:0xf
    v_mov_b32_dpp v59, v43 row_ror:8 row_mask:0xf bank_mask:0xf
    s_cbranch_vccnz bad_34
    v_smfmac_f32_16x16x64_bf16 v[24:27], v[40:43], v[192:199], v20
    v_smfmac_f32_16x16x64_bf16 v[28:31], v[40:43], v[208:215], v20
    v_smfmac_f32_16x16x64_bf16 v[24:27], v[56:59], v[200:207], v1
    v_smfmac_f32_16x16x64_bf16 v[28:31], v[56:59], v[216:223], v1
    s_branch gdone_15
q_29_5_0:
    s_waitcnt vmcnt(1)
    v_max_u32 v8, v32, v34
    v_cmp_eq_u32 vcc, -1, v8
    v_mov_b32_dpp v48, v32 row_ror:8 row_mask:0xf bank_mask:0xf
    v_mov_b32_dpp v49, v33 row_ror:8 row_mask:0xf bank_mask:0xf
    v_mov_b32_dpp v50, v34 row_ror:8 row_mask:0xf bank_mask:0xf
    v_mov_b32_dpp v51, v35 row_ror:8 row_mask:0xf bank_mask:0xf
    s_cbranch_vccnz bad_35
    v_smfmac_f32_16x16x64_bf16 v[24:27], v[32:35], v[128:135], v20
    v_smfmac_f32_16x16x64_bf16 v[28:31], v[32:35], v[144:151], v20
    v_smfmac_f32_16x16x64_bf16 v[24:27], v[48:51], v[136:143], v1
    v_smfmac_f32_16x16x64_bf16 v[28:31], v[48:51], v[152:159], v1
    s_branch q_29_4_2
bad_35:
    buffer_load_dwordx4 v[32:35], v21, s[8:11], s34 offen offset:0 sc1
    s_sub_u32 s30, s30, 1
    s_cbranch_scc1 L_end
    s_branch q_29_5_2
q_29_5_2:
    s_waitcnt vmcnt(1)
    v_max_u32 v8, v40, v42
    v_cmp_eq_u32 vcc, -1, v8
    v_mov_b32_dpp v56, v40 row_ror:8 row_mask:0xf bank_mask:0xf
    v_mov_b32_dpp v57, v41 row_ror:8 row_mask:0xf bank_mask:0xf
    v_mov_b32_dpp v58, v42 row_ror:8 row_mask:0xf bank_mask:0xf
    v_mov_b32_dpp v59, v43 row_ror:8 row_mask:0xf bank_mask:0xf
    s_cbranch_vccnz bad_36
    v_smfmac_f32_16x16x64_bf16 v[24:27], v[40:43], v[192:199], v20
    v_smfmac_f32_16x16x64_bf16 v[28:31], v[40:43], v[208:215], v20
    v_smfmac_f32_16x16x64_bf16 v[24:27], v[56:59], v[200:207], v1
    v_smfmac_f32_16x16x64_bf16 v[28:31], v[56:59], v[216:223], v1
    s_branch q_29_1_0
bad_36:
    buffer_load_dwordx4 v[40:43], v21, s[8:11], s34 offen offset:2048 sc1
    s_sub_u32 s30, s30, 1
    s_cbranch_scc1 L_end
    s_branch q_29_5_0
q_29_6_1:
    s_waitcnt vmcnt(1)
    v_max_u32 v8, v36, v38
    v_cmp_eq_u32 vcc, -1, v8
    v_mov_b32_dpp v52, v36 row_ror:8 row_mask:0xf bank_mask:0xf
    v_mov_b32_dpp v53, v37 row_ror:8 row_mask:0xf bank_mask:0xf
    v_mov_b32_dpp v54, v38 row_ror:8 row_mask:0xf bank_mask:0xf
    v_mov_b32_dpp v55, v39 row_ror:8 row_mask:0xf bank_mask:0xf
    s_cbranch_vccnz bad_37
    v_smfmac_f32_16x16x64_bf16 v[24:27], v[36:39], v[160:167], v20
    v_smfmac_f32_16x16x64_bf16 v[28:31], v[36:39], v[176:183], v20
    v_smfmac_f32_16x16x64_bf16 v[24:27], v[52:55], v[168:175], v1
    v_smfmac_f32_16x16x64_bf16 v[28:31], v[52:55], v[184:191], v1
    s_branch q_29_4_2
bad_37:
    buffer_load_dwordx4 v[36:39], v21, s[8:11], s34 offen offset:1024 sc1
    s_sub_u32 s30, s30, 1
    s_cbranch_scc1 L_end
    s_branch q_29_6_2
q_29_6_2:
    s_waitcnt vmcnt(1)
    v_max_u32 v8, v40, v42
    v_cmp_eq_u32 vcc, -1, v8
    v_mov_b32_dpp v56, v40 row_ror:8 row_mask:0xf bank_mask:0xf
    v_mov_b32_dpp v57, v41 row_ror:8 row_mask:0xf bank_mask:0xf
    v_mov_b32_dpp v58, v42 row_ror:8 row_mask:0xf bank_mask:0xf
    v_mov_b32_dpp v59, v43 row_ror:8 row_mask:0xf bank_mask:0xf
    s_cbranch_vccnz bad_38
    v_smfmac_f32_16x16x64_bf16 v[24:27], v[40:43], v[192:199], v20
    v_smfmac_f32_16x16x64_bf16 v[28:31], v[40:43], v[208:215], v20
    v_smfmac_f32_16x16x64_bf16 v[24:27], v[56:59], v[200:207], v1
    v_smfmac_f32_16x16x64_bf16 v[28:31], v[56:59], v[216:223], v1
    s_branch q_29_2_1
bad_38:
    buffer_load_dwordx4 v[40:43], v21, s[8:11], s34 offen offset:2048 sc1
    s_sub_u32 s30, s30, 1
    s_cbranch_scc1 L_end
    s_branch q_29_6_1
q_29_7_0:
    s_waitcnt vmcnt(2)
    v_max_u32 v8, v32, v34
    v_cmp_eq_u32 vcc, -1, v8
    v_mov_b32_dpp v48, v32 row_ror:8 row_mask:0xf bank_mask:0xf
    v_mov_b32_dpp v49, v33 row_ror:8 row_mask:0xf bank_mask:0xf
    v_mov_b32_dpp v50, v34 row_ror:8 row_mask:0xf bank_mask:0xf
    v_mov_b32_dpp v51, v35 row_ror:8 row_mask:0xf bank_mask:0xf
    s_cbranch_vccnz bad_39
    v_smfmac_f32_16x16x64_bf16 v[24:27], v[32:35], v[128:135], v20
    v_smfmac_f32_16x16x64_bf16 v[28:31], v[32:35], v[144:151], v20
    v_smfmac_f32_16x16x64_bf16 v[24:27], v[48:51], v[136:143], v1
    v_smfmac_f32_16x16x64_bf16 v[28:31], v[48:51], v[152:159], v1
    s_branch q_29_6_1
bad_39:
    buffer_load_dwordx4 v[32:35], v21, s[8:11], s34 offen offset:0 sc1
    s_sub_u32 s30, s30, 1
    s_cbranch_scc1 L_end
    s_branch q_29_7_1
q_29_7_1:
    s_waitcnt vmcnt(2)
    v_max_u32 v8, v36, v38
    v_cmp_eq_u32 vcc, -1, v8
    v_mov_b32_dpp v52, v36 row_ror:8 row_mask:0xf bank_mask:0xf
    v_mov_b32_dpp v53, v37 row_ror:8 row_mask:0xf bank_mask:0xf
    v_mov_b32_dpp v54, v38 row_ror:8 row_mask:0xf bank_mask:0xf
    v_mov_b32_dpp v55, v39 row_ror:8 row_mask:0xf bank_mask:0xf
    s_cbranch_vccnz bad_40
    v_smfmac_f32_16x16x64_bf16 v[24:27], v[36:39], v[160:167], v20
    v_smfmac_f32_16x16x64_bf16 v[28:31], v[36:39], v[176:183], v20
    v_smfmac_f32_16x16x64_bf16 v[24:27], v[52:55], v[168:175], v1
    v_smfmac_f32_16x16x64_bf16 v[28:31], v[52:55], v[184:191], v1
    s_branch q_29_5_2
bad_40:
    buffer_load_dwordx4 v[36:39], v21, s[8:11], s34 offen offset:1024 sc1
    s_sub_u32 s30, s30, 1
    s_cbranch_scc1 L_end
    s_branch q_29_7_2
q_29_7_2:
    s_waitcnt vmcnt(2)
    v_max_u32 v8, v40, v42
    v_cmp_eq_u32 vcc, -1, v8
    v_mov_b32_dpp v56, v40 row_ror:8 row_mask:0xf bank_mask:0xf
    v_mov_b32_dpp v57, v41 row_ror:8 row_mask:0xf bank_mask:0xf
    v_mov_b32_dpp v58, v42 row_ror:8 row_mask:0xf bank_mask:0xf
    v_mov_b32_dpp v59, v43 row_ror:8 row_mask:0xf bank_mask:0xf
    s_cbranch_vccnz bad_41
    v_smfmac_f32_16x16x64_bf16 v[24:27], v[40:43], v[192:199], v20
    v_smfmac_f32_16x16x64_bf16 v[28:31], v[40:43], v[208:215], v20
    v_smfmac_f32_16x16x64_bf16 v[24:27], v[56:59], v[200:207], v1
    v_smfmac_f32_16x16x64_bf16 v[28:31], v[56:59], v[216:223], v1
    s_branch q_29_3_0
bad_41:
    buffer_load_dwordx4 v[40:43], v21, s[8:11], s34 offen offset:2048 sc1
    s_sub_u32 s30, s30, 1
    s_cbranch_scc1 L_end
    s_branch q_29_7_0
bad_42:
    buffer_load_dwordx4 v[44:47], v21, s[8:11], s34 offen offset:3072 sc1
    s_sub_u32 s30, s30, 1
    s_cbranch_scc1 L_end
q_29_8_3:
    s_waitcnt vmcnt(0)
    v_max_u32 v8, v44, v46
    v_cmp_eq_u32 vcc, -1, v8
    v_mov_b32_dpp v60, v44 row_ror:8 row_mask:0xf bank_mask:0xf
    v_mov_b32_dpp v61, v45 row_ror:8 row_mask:0xf bank_mask:0xf
    v_mov_b32_dpp v62, v46 row_ror:8 row_mask:0xf bank_mask:0xf
    v_mov_b32_dpp v63, v47 row_ror:8 row_mask:0xf bank_mask:0xf
    s_cbranch_vccnz bad_42
    v_smfmac_f32_16x16x64_bf16 v[24:27], v[44:47], v[224:231], v20
    v_smfmac_f32_16x16x64_bf16 v[28:31], v[44:47], v[240:247], v20
    v_smfmac_f32_16x16x64_bf16 v[24:27], v[60:63], v[232:239], v1
    v_smfmac_f32_16x16x64_bf16 v[28:31], v[60:63], v[248:255], v1
    s_branch gdone_15
q_29_9_0:
    s_waitcnt vmcnt(1)
    v_max_u32 v8, v32, v34
    v_cmp_eq_u32 vcc, -1, v8
    v_mov_b32_dpp v48, v32 row_ror:8 row_mask:0xf bank_mask:0xf
    v_mov_b32_dpp v49, v33 row_ror:8 row_mask:0xf bank_mask:0xf
    v_mov_b32_dpp v50, v34 row_ror:8 row_mask:0xf bank_mask:0xf
    v_mov_b32_dpp v51, v35 row_ror:8 row_mask:0xf bank_mask:0xf
    s_cbranch_vccnz bad_43
    v_smfmac_f32_16x16x64_bf16 v[24:27], v[32:35], v[128:135], v20
    v_smfmac_f32_16x16x64_bf16 v[28:31], v[32:35], v[144:151], v20
    v_smfmac_f32_16x16x64_bf16 v[24:27], v[48:51], v[136:143], v1
    v_smfmac_f32_16x16x64_bf16 v[28:31], v[48:51], v[152:159], v1
    s_branch q_29_8_3
bad_43:
    buffer_load_dwordx4 v[32:35], v21, s[8:11], s34 offen offset:0 sc1
    s_sub_u32 s30, s30, 1
    s_cbranch_scc1 L_end
    s_branch q_29_9_3
q_29_9_3:
    s_waitcnt vmcnt(1)
    v_max_u32 v8, v44, v46
    v_cmp_eq_u32 vcc, -1, v8
    v_mov_b32_dpp v60, v44 row_ror:8 row_mask:0xf bank_mask:0xf
    v_mov_b32_dpp v61, v45 row_ror:8 row_mask:0xf bank_mask:0xf
    v_mov_b32_dpp v62, v46 row_ror:8 row_mask:0xf bank_mask:0xf
    v_mov_b32_dpp v63, v47 row_ror:8 row_mask:0xf bank_mask:0xf
    s_cbranch_vccnz bad_44
    v_smfmac_f32_16x16x64_bf16 v[24:27], v[44:47], v[224:231], v20
    v_smfmac_f32_16x16x64_bf16 v[28:31], v[44:47], v[240:247], v20
    v_smfmac_f32_16x16x64_bf16 v[24:27], v[60:63], v[232:239], v1
    v_smfmac_f32_16x16x64_bf16 v[28:31], v[60:63], v[248:255], v1
    s_branch q_29_1_0
bad_44:
    buffer_load_dwordx4 v[44:47], v21, s[8:11], s34 offen offset:3072 sc1
    s_sub_u32 s30, s30, 1
    s_cbranch_scc1 L_end
    s_branch q_29_9_0
q_29_10_1:
    s_waitcnt vmcnt(1)
    v_max_u32 v8, v36, v38
    v_cmp_eq_u32 vcc, -1, v8
    v_mov_b32_dpp v52, v36 row_ror:8 row_mask:0xf bank_mask:0xf
    v_mov_b32_dpp v53, v37 row_ror:8 row_mask:0xf bank_mask:0xf
    v_mov_b32_dpp v54, v38 row_ror:8 row_mask:0xf bank_mask:0xf
    v_mov_b32_dpp v55, v39 row_ror:8 row_mask:0xf bank_mask:0xf
    s_cbranch_vccnz bad_45
    v_smfmac_f32_16x16x64_bf16 v[24:27], v[36:39], v[160:167], v20
    v_smfmac_f32_16x16x64_bf16 v[28:31], v[36:39], v[176:183], v20
    v_smfmac_f32_16x16x64_bf16 v[24:27], v[52:55], v[168:175], v1
    v_smfmac_f32_16x16x64_bf16 v[28:31], v[52:55], v[184:191], v1
    s_branch q_29_8_3
bad_45:
    buffer_load_dwordx4 v[36:39], v21, s[8:11], s34 offen offset:1024 sc1
    s_sub_u32 s30, s30, 1
    s_cbranch_scc1 L_end
    s_branch q_29_10_3
q_29_10_3:
    s_waitcnt vmcnt(1)
    v_max_u32 v8, v44, v46
    v_cmp_eq_u32 vcc, -1, v8
    v_mov_b32_dpp v60, v44 row_ror:8 row_mask:0xf bank_mask:0xf
    v_mov_b32_dpp v61, v45 row_ror:8 row_mask:0xf bank_mask:0xf
    v_mov_b32_dpp v62, v46 row_ror:8 row_mask:0xf bank_mask:0xf
    v_mov_b32_dpp v63, v47 row_ror:8 row_mask:0xf bank_mask:0xf
    s_cbranch_vccnz bad_46
    v_smfmac_f32_16x16x64_bf16 v[24:27], v[44:47], v[224:231], v20
    v_smfmac_f32_16x16x64_bf16 v[28:31], v[44:47], v[240:247], v20
    v_smfmac_f32_16x16x64_bf16 v[24:27], v[60:63], v[232:239], v1
    v_smfmac_f32_16x16x64_bf16 v[28:31], v[60:63], v[248:255], v1
    s_branch q_29_2_1
bad_46:
    buffer_load_dwordx4 v[44:47], v21, s[8:11], s34 offen offset:3072 sc1
    s_sub_u32 s30, s30, 1
    s_cbranch_scc1 L_end
    s_branch q_29_10_1
q_29_11_0:
    s_waitcnt vmcnt(2)
    v_max_u32 v8, v32, v34
    v_cmp_eq_u32 vcc, -1, v8
    v_mov_b32_dpp v48, v32 row_ror:8 row_mask:0xf bank_mask:0xf
    v_mov_b32_dpp v49, v33 row_ror:8 row_mask:0xf bank_mask:0xf
    v_mov_b32_dpp v50, v34 row_ror:8 row_mask:0xf bank_mask:0xf
    v_mov_b32_dpp v51, v35 row_ror:8 row_mask:0xf bank_mask:0xf
    s_cbranch_vccnz bad_47
    v_smfmac_f32_16x16x64_bf16 v[24:27], v[32:35], v[128:135], v20
    v_smfmac_f32_16x16x64_bf16 v[28:31], v[32:35], v[144:151], v20
    v_smfmac_f32_16x16x64_bf16 v[24:27], v[48:51], v[136:143], v1
    v_smfmac_f32_16x16x64_bf16 v[28:31], v[48:51], v[152:159], v1
    s_branch q_29_10_1
bad_47:
    buffer_load_dwordx4 v[32:35], v21, s[8:11], s34 offen offset:0 sc1
    s_sub_u32 s30, s30, 1
    s_cbranch_scc1 L_end
    s_branch q_29_11_1
q_29_11_1:
    s_waitcnt vmcnt(2)
    v_max_u32 v8, v36, v38
    v_cmp_eq_u32 vcc, -1, v8
    v_mov_b32_dpp v52, v36 row_ror:8 row_mask:0xf bank_mask:0xf
    v_mov_b32_dpp v53, v37 row_ror:8 row_mask:0xf bank_mask:0xf
    v_mov_b32_dpp v54, v38 row_ror:8 row_mask:0xf bank_mask:0xf
    v_mov_b32_dpp v55, v39 row_ror:8 row_mask:0xf bank_mask:0xf
    s_cbranch_vccnz bad_48
    v_smfmac_f32_16x16x64_bf16 v[24:27], v[36:39], v[160:167], v20
    v_smfmac_f32_16x16x64_bf16 v[28:31], v[36:39], v[176:183], v20
    v_smfmac_f32_16x16x64_bf16 v[24:27], v[52:55], v[168:175], v1
    v_smfmac_f32_16x16x64_bf16 v[28:31], v[52:55], v[184:191], v1
    s_branch q_29_9_3
bad_48:
    buffer_load_dwordx4 v[36:39], v21, s[8:11], s34 offen offset:1024 sc1
    s_sub_u32 s30, s30, 1
    s_cbranch_scc1 L_end
    s_branch q_29_11_3
q_29_11_3:
    s_waitcnt vmcnt(2)
    v_max_u32 v8, v44, v46
    v_cmp_eq_u32 vcc, -1, v8
    v_mov_b32_dpp v60, v44 row_ror:8 row_mask:0xf bank_mask:0xf
    v_mov_b32_dpp v61, v45 row_ror:8 row_mask:0xf bank_mask:0xf
    v_mov_b32_dpp v62, v46 row_ror:8 row_mask:0xf bank_mask:0xf
    v_mov_b32_dpp v63, v47 row_ror:8 row_mask:0xf bank_mask:0xf
    s_cbranch_vccnz bad_49
    v_smfmac_f32_16x16x64_bf16 v[24:27], v[44:47], v[224:231], v20
    v_smfmac_f32_16x16x64_bf16 v[28:31], v[44:47], v[240:247], v20
    v_smfmac_f32_16x16x64_bf16 v[24:27], v[60:63], v[232:239], v1
    v_smfmac_f32_16x16x64_bf16 v[28:31], v[60:63], v[248:255], v1
    s_branch q_29_3_0
bad_49:
    buffer_load_dwordx4 v[44:47], v21, s[8:11], s34 offen offset:3072 sc1
    s_sub_u32 s30, s30, 1
    s_cbranch_scc1 L_end
    s_branch q_29_11_0
q_29_12_2:
    s_waitcnt vmcnt(1)
    v_max_u32 v8, v40, v42
    v_cmp_eq_u32 vcc, -1, v8
    v_mov_b32_dpp v56, v40 row_ror:8 row_mask:0xf bank_mask:0xf
    v_mov_b32_dpp v57, v41 row_ror:8 row_mask:0xf bank_mask:0xf
    v_mov_b32_dpp v58, v42 row_ror:8 row_mask:0xf bank_mask:0xf
    v_mov_b32_dpp v59, v43 row_ror:8 row_mask:0xf bank_mask:0xf
    s_cbranch_vccnz bad_50
    v_smfmac_f32_16x16x64_bf16 v[24:27], v[40:43], v[192:199], v20
    v_smfmac_f32_16x16x64_bf16 v[28:31], v[40:43], v[208:215], v20
    v_smfmac_f32_16x16x64_bf16 v[24:27], v[56:59], v[200:207], v1
    v_smfmac_f32_16x16x64_bf16 v[28:31], v[56:59], v[216:223], v1
    s_branch q_29_8_3
bad_50:
    buffer_load_dwordx4 v[40:43], v21, s[8:11], s34 offen offset:2048 sc1
    s_sub_u32 s30, s30, 1
    s_cbranch_scc1 L_end
    s_branch q_29_12_3
q_29_12_3:
    s_waitcnt vmcnt(1)
    v_max_u32 v8, v44, v46
    v_cmp_eq_u32 vcc, -1, v8
    v_mov_b32_dpp v60, v44 row_ror:8 row_mask:0xf bank_mask:0xf
    v_mov_b32_dpp v61, v45 row_ror:8 row_mask:0xf bank_mask:0xf
    v_mov_b32_dpp v62, v46 row_ror:8 row_mask:0xf bank_mask:0xf
    v_mov_b32_dpp v63, v47 row_ror:8 row_mask:0xf bank_mask:0xf
    s_cbranch_vccnz bad_51
    v_smfmac_f32_16x16x64_bf16 v[24:27], v[44:47], v[224:231], v20
    v_smfmac_f32_16x16x64_bf16 v[28:31], v[44:47], v[240:247], v20
    v_smfmac_f32_16x16x64_bf16 v[24:27], v[60:63], v[232:239], v1
    v_smfmac_f32_16x16x64_bf16 v[28:31], v[60:63], v[248:255], v1
    s_branch q_29_4_2
bad_51:
    buffer_load_dwordx4 v[44:47], v21, s[8:11], s34 offen offset:3072 sc1
    s_sub_u32 s30, s30, 1
    s_cbranch_scc1 L_end
    s_branch q_29_12_2
q_29_13_0:
    s_waitcnt vmcnt(2)
    v_max_u32 v8, v32, v34
    v_cmp_eq_u32 vcc, -1, v8
    v_mov_b32_dpp v48, v32 row_ror:8 row_mask:0xf bank_mask:0xf
    v_mov_b32_dpp v49, v33 row_ror:8 row_mask:0xf bank_mask:0xf
    v_mov_b32_dpp v50, v34 row_ror:8 row_mask:0xf bank_mask:0xf
    v_mov_b32_dpp v51, v35 row_ror:8 row_mask:0xf bank_mask:0xf
    s_cbranch_vccnz bad_52
    v_smfmac_f32_16x16x64_bf16 v[24:27], v[32:35], v[128:135], v20
    v_smfmac_f32_16x16x64_bf16 v[28:31], v[32:35], v[144:151], v20
    v_smfmac_f32_16x16x64_bf16 v[24:27], v[48:51], v[136:143], v1
    v_smfmac_f32_16x16x64_bf16 v[28:31], v[48:51], v[152:159], v1
    s_branch q_29_12_2
bad_52:
    buffer_load_dwordx4 v[32:35], v21, s[8:11], s34 offen offset:0 sc1
    s_sub_u32 s30, s30, 1
    s_cbranch_scc1 L_end
    s_branch q_29_13_2
q_29_13_2:
    s_waitcnt vmcnt(2)
    v_max_u32 v8, v40, v42
    v_cmp_eq_u32 vcc, -1, v8
    v_mov_b32_dpp v56, v40 row_ror:8 row_mask:0xf bank_mask:0xf
    v_mov_b32_dpp v57, v41 row_ror:8 row_mask:0xf bank_mask:0xf
    v_mov_b32_dpp v58, v42 row_ror:8 row_mask:0xf bank_mask:0xf
    v_mov_b32_dpp v59, v43 row_ror:8 row_mask:0xf bank_mask:0xf
    s_cbranch_vccnz bad_53
    v_smfmac_f32_16x16x64_bf16 v[24:27], v[40:43], v[192:199], v20
    v_smfmac_f32_16x16x64_bf16 v[28:31], v[40:43], v[208:215], v20
    v_smfmac_f32_16x16x64_bf16 v[24:27], v[56:59], v[200:207], v1
    v_smfmac_f32_16x16x64_bf16 v[28:31], v[56:59], v[216:223], v1
    s_branch q_29_9_3
bad_53:
    buffer_load_dwordx4 v[40:43], v21, s[8:11], s34 offen offset:2048 sc1
    s_sub_u32 s30, s30, 1
    s_cbranch_scc1 L_end
    s_branch q_29_13_3
q_29_13_3:
    s_waitcnt vmcnt(2)
    v_max_u32 v8, v44, v46
    v_cmp_eq_u32 vcc, -1, v8
    v_mov_b32_dpp v60, v44 row_ror:8 row_mask:0xf bank_mask:0xf
    v_mov_b32_dpp v61, v45 row_ror:8 row_mask:0xf bank_mask:0xf
    v_mov_b32_dpp v62, v46 row_ror:8 row_mask:0xf bank_mask:0xf
    v_mov_b32_dpp v63, v47 row_ror:8 row_mask:0xf bank_mask:0xf
    s_cbranch_vccnz bad_54
    v_smfmac_f32_16x16x64_bf16 v[24:27], v[44:47], v[224:231], v20
    v_smfmac_f32_16x16x64_bf16 v[28:31], v[44:47], v[240:247], v20
    v_smfmac_f32_16x16x64_bf16 v[24:27], v[60:63], v[232:239], v1
    v_smfmac_f32_16x16x64_bf16 v[28:31], v[60:63], v[248:255], v1
    s_branch q_29_5_0
bad_54:
    buffer_load_dwordx4 v[44:47], v21, s[8:11], s34 offen offset:3072 sc1
    s_sub_u32 s30, s30, 1
    s_cbranch_scc1 L_end
    s_branch q_29_13_0
q_29_14_1:
    s_waitcnt vmcnt(2)
    v_max_u32 v8, v36, v38
    v_cmp_eq_u32 vcc, -1, v8
    v_mov_b32_dpp v52, v36 row_ror:8 row_mask:0xf bank_mask:0xf
    v_mov_b32_dpp v53, v37 row_ror:8 row_mask:0xf bank_mask:0xf
    v_mov_b32_dpp v54, v38 row_ror:8 row_mask:0xf bank_mask:0xf
    v_mov_b32_dpp v55, v39 row_ror:8 row_mask:0xf bank_mask:0xf
    s_cbranch_vccnz bad_55
    v_smfmac_f32_16x16x64_bf16 v[24:27], v[36:39], v[160:167], v20
    v_smfmac_f32_16x16x64_bf16 v[28:31], v[36:39], v[176:183], v20
    v_smfmac_f32_16x16x64_bf16 v[24:27], v[52:55], v[168:175], v1
    v_smfmac_f32_16x16x64_bf16 v[28:31], v[52:55], v[184:191], v1
    s_branch q_29_12_2
bad_55:
    buffer_load_dwordx4 v[36:39], v21, s[8:11], s34 offen offset:1024 sc1
    s_sub_u32 s30, s30, 1
    s_cbranch_scc1 L_end
    s_branch q_29_14_2
q_29_14_2:
    s_waitcnt vmcnt(2)
    v_max_u32 v8, v40, v42
    v_cmp_eq_u32 vcc, -1, v8
    v_mov_b32_dpp v56, v40 row_ror:8 row_mask:0xf bank_mask:0xf
    v_mov_b32_dpp v57, v41 row_ror:8 row_mask:0xf bank_mask:0xf
    v_mov_b32_dpp v58, v42 row_ror:8 row_mask:0xf bank_mask:0xf
    v_mov_b32_dpp v59, v43 row_ror:8 row_mask:0xf bank_mask:0xf
    s_cbranch_vccnz bad_56
    v_smfmac_f32_16x16x64_bf16 v[24:27], v[40:43], v[192:199], v20
    v_smfmac_f32_16x16x64_bf16 v[28:31], v[40:43], v[208:215], v20
    v_smfmac_f32_16x16x64_bf16 v[24:27], v[56:59], v[200:207], v1
    v_smfmac_f32_16x16x64_bf16 v[28:31], v[56:59], v[216:223], v1
    s_branch q_29_10_3
bad_56:
    buffer_load_dwordx4 v[40:43], v21, s[8:11], s34 offen offset:2048 sc1
    s_sub_u32 s30, s30, 1
    s_cbranch_scc1 L_end
    s_branch q_29_14_3
q_29_14_3:
    s_waitcnt vmcnt(2)
    v_max_u32 v8, v44, v46
    v_cmp_eq_u32 vcc, -1, v8
    v_mov_b32_dpp v60, v44 row_ror:8 row_mask:0xf bank_mask:0xf
    v_mov_b32_dpp v61, v45 row_ror:8 row_mask:0xf bank_mask:0xf
    v_mov_b32_dpp v62, v46 row_ror:8 row_mask:0xf bank_mask:0xf
    v_mov_b32_dpp v63, v47 row_ror:8 row_mask:0xf bank_mask:0xf
    s_cbranch_vccnz bad_57
    v_smfmac_f32_16x16x64_bf16 v[24:27], v[44:47], v[224:231], v20
    v_smfmac_f32_16x16x64_bf16 v[28:31], v[44:47], v[240:247], v20
    v_smfmac_f32_16x16x64_bf16 v[24:27], v[60:63], v[232:239], v1
    v_smfmac_f32_16x16x64_bf16 v[28:31], v[60:63], v[248:255], v1
    s_branch q_29_6_1
bad_57:
    buffer_load_dwordx4 v[44:47], v21, s[8:11], s34 offen offset:3072 sc1
    s_sub_u32 s30, s30, 1
    s_cbranch_scc1 L_end
    s_branch q_29_14_1
q_29_15_0:
    s_waitcnt vmcnt(3)
    v_max_u32 v8, v32, v34
    v_cmp_eq_u32 vcc, -1, v8
    v_mov_b32_dpp v48, v32 row_ror:8 row_mask:0xf bank_mask:0xf
    v_mov_b32_dpp v49, v33 row_ror:8 row_mask:0xf bank_mask:0xf
    v_mov_b32_dpp v50, v34 row_ror:8 row_mask:0xf bank_mask:0xf
    v_mov_b32_dpp v51, v35 row_ror:8 row_mask:0xf bank_mask:0xf
    s_cbranch_vccnz bad_58
    v_smfmac_f32_16x16x64_bf16 v[24:27], v[32:35], v[128:135], v20
    v_smfmac_f32_16x16x64_bf16 v[28:31], v[32:35], v[144:151], v20
    v_smfmac_f32_16x16x64_bf16 v[24:27], v[48:51], v[136:143], v1
    v_smfmac_f32_16x16x64_bf16 v[28:31], v[48:51], v[152:159], v1
    s_branch q_29_14_1
bad_58:
    buffer_load_dwordx4 v[32:35], v21, s[8:11], s34 offen offset:0 sc1
    s_sub_u32 s30, s30, 1
    s_cbranch_scc1 L_end
    s_branch q_29_15_1
q_29_15_1:
    s_waitcnt vmcnt(3)
    v_max_u32 v8, v36, v38
    v_cmp_eq_u32 vcc, -1, v8
    v_mov_b32_dpp v52, v36 row_ror:8 row_mask:0xf bank_mask:0xf
    v_mov_b32_dpp v53, v37 row_ror:8 row_mask:0xf bank_mask:0xf
    v_mov_b32_dpp v54, v38 row_ror:8 row_mask:0xf bank_mask:0xf
    v_mov_b32_dpp v55, v39 row_ror:8 row_mask:0xf bank_mask:0xf
    s_cbranch_vccnz bad_59
    v_smfmac_f32_16x16x64_bf16 v[24:27], v[36:39], v[160:167], v20
    v_smfmac_f32_16x16x64_bf16 v[28:31], v[36:39], v[176:183], v20
    v_smfmac_f32_16x16x64_bf16 v[24:27], v[52:55], v[168:175], v1
    v_smfmac_f32_16x16x64_bf16 v[28:31], v[52:55], v[184:191], v1
    s_branch q_29_13_2
bad_59:
    buffer_load_dwordx4 v[36:39], v21, s[8:11], s34 offen offset:1024 sc1
    s_sub_u32 s30, s30, 1
    s_cbranch_scc1 L_end
    s_branch q_29_15_2
q_29_15_2:
    s_waitcnt vmcnt(3)
    v_max_u32 v8, v40, v42
    v_cmp_eq_u32 vcc, -1, v8
    v_mov_b32_dpp v56, v40 row_ror:8 row_mask:0xf bank_mask:0xf
    v_mov_b32_dpp v57, v41 row_ror:8 row_mask:0xf bank_mask:0xf
    v_mov_b32_dpp v58, v42 row_ror:8 row_mask:0xf bank_mask:0xf
    v_mov_b32_dpp v59, v43 row_ror:8 row_mask:0xf bank_mask:0xf
    s_cbranch_vccnz bad_60
    v_smfmac_f32_16x16x64_bf16 v[24:27], v[40:43], v[192:199], v20
    v_smfmac_f32_16x16x64_bf16 v[28:31], v[40:43], v[208:215], v20
    v_smfmac_f32_16x16x64_bf16 v[24:27], v[56:59], v[200:207], v1
    v_smfmac_f32_16x16x64_bf16 v[28:31], v[56:59], v[216:223], v1
    s_branch q_29_11_3
bad_60:
    buffer_load_dwordx4 v[40:43], v21, s[8:11], s34 offen offset:2048 sc1
    s_sub_u32 s30, s30, 1
    s_cbranch_scc1 L_end
    s_branch q_29_15_3
q_29_15_3:
    s_waitcnt vmcnt(3)
    v_max_u32 v8, v44, v46
    v_cmp_eq_u32 vcc, -1, v8
    v_mov_b32_dpp v60, v44 row_ror:8 row_mask:0xf bank_mask:0xf
    v_mov_b32_dpp v61, v45 row_ror:8 row_mask:0xf bank_mask:0xf
    v_mov_b32_dpp v62, v46 row_ror:8 row_mask:0xf bank_mask:0xf
    v_mov_b32_dpp v63, v47 row_ror:8 row_mask:0xf bank_mask:0xf
    s_cbranch_vccnz bad_61
    v_smfmac_f32_16x16x64_bf16 v[24:27], v[44:47], v[224:231], v20
    v_smfmac_f32_16x16x64_bf16 v[28:31], v[44:47], v[240:247], v20
    v_smfmac_f32_16x16x64_bf16 v[24:27], v[60:63], v[232:239], v1
    v_smfmac_f32_16x16x64_bf16 v[28:31], v[60:63], v[248:255], v1
    s_branch q_29_7_0
bad_61:
    buffer_load_dwordx4 v[44:47], v21, s[8:11], s34 offen offset:3072 sc1
    s_sub_u32 s30, s30, 1
    s_cbranch_scc1 L_end
    s_branch q_29_15_0
L_vo:
    s_setprio 2
    s_lshl_b32 s38, s47, 10
    s_add_u32 s39, s38, 30720
    v_lshlrev_b32 v22, 2, v2
    v_add_u32 v22, s39, v22
    s_xor_b32 s38, s24, 0
    s_lshl_b32 s38, s38, 5
    s_add_u32 s38, s38, s25
    s_lshl_b32 s38, s38, 14
    s_add_u32 s38, s38, s43
    v_add_u32 v19, s38, v7
    s_xor_b32 s38, s24, 1
    s_lshl_b32 s38, s38, 5
    s_add_u32 s38, s38, s25
    s_lshl_b32 s38, s38, 14
    s_add_u32 s38, s38, s43
    s_mov_b32 s39, 1024
    s_add_u32 s38, s38, s39
    v_add_u32 v24, s38, v7
    s_xor_b32 s38, s24, 2
    s_lshl_b32 s38, s38, 5
    s_add_u32 s38, s38, s25
    s_lshl_b32 s38, s38, 14
    s_add_u32 s38, s38, s43
    s_mov_b32 s39, 2048
    s_add_u32 s38, s38, s39
    v_add_u32 v25, s38, v7
    s_xor_b32 s38, s24, 3
    s_lshl_b32 s38, s38, 5
    s_add_u32 s38, s38, s25
    s_lshl_b32 s38, s38, 14
    s_add_u32 s38, s38, s43
    s_mov_b32 s39, 3072
    s_add_u32 s38, s38, s39
    v_add_u32 v26, s38, v7
    v_mov_b32 v113, v19
    v_mov_b32 v114, v19
    s_mov_b32 s39, 1024
    v_add_u32 v113, s39, v19
    s_mov_b32 s39, 2048
    v_add_u32 v114, s39, v19
    v_and_b32 v14, 4, v3
    v_add_u32 v14, v14, v4
    v_lshlrev_b32 v15, 4, v5
    v_add_u32 v15, v15, v14
    v_and_b32 v16, 2, v3
    v_lshl_add_u32 v15, v16, 2, v15
    v_lshlrev_b32 v15, 4, v15
    v_and_b32 v16, 1, v3
    v_lshl_add_u32 v15, v16, 3, v15
    s_lshl_b32 s38, s24, 14
    s_lshl_b32 s39, s25, 9
    s_add_u32 s38, s38, s39
    v_add_u32 v27, s38, v15
    v_mov_b32 v28, 0
    v_mov_b32 v30, 0
    v_mov_b32 v31, 0
    v_mov_b32 v12, 0
    v_lshlrev_b32 v29, 3, v2
    v_add_u32 v29, s38, v29
    v_mov_b32 v100, -1
    v_mov_b32 v101, -1
    v_mov_b32 v102, -1
    v_mov_b32 v103, -1
    v_lshlrev_b32 v14, 11, v14
    v_lshl_add_u32 v14, v5, 5, v14
    v_and_b32 v16, 3, v3
    v_lshl_add_u32 v14, v16, 3, v14
    s_lshl_b32 s39, s25, 6
    v_add_u32 v14, s39, v14
    buffer_load_dwordx2 v[64:65], v14, s[16:19], 0 offen
    s_cmp_eq_u32 s26, 6
    s_cbranch_scc1 s6_63
    s_cmp_lg_u32 s26, 4
    s_cbranch_scc1 se_64
    v_mul_u32_u24 v28, 144, v3
    v_lshl_add_u32 v28, v4, 4, v28
    v_add_u32 v28, 16384, v28
    s_lshl_b32 s38, s27, 11
    s_lshl_b32 s39, s28, 9
    s_add_u32 s38, s38, s39
    s_lshr_b32 s38, s27, 1
    s_lshl_b32 s38, s38, 14
    s_and_b32 s39, s25, 7
    s_lshl_b32 s39, s39, 10
    s_add_u32 s38, s38, s39
    v_lshl_add_u32 v31, v4, 3, v6
    v_lshlrev_b32 v31, 4, v31
    v_add_u32 v31, s38, v31
    s_lshl_b32 s38, s27, 13
    s_lshl_b32 s39, s28, 10
    s_add_u32 s39, s38, s39
    v_add_u32 v29, s39, v7
    s_lshl_b32 s39, s28, 8
    s_add_u32 s39, s38, s39
    s_add_u32 s39, s39, 4096
    v_and_b32 v16, 1, v4
    v_lshlrev_b32 v30, 5, v6
    v_lshl_add_u32 v30, v16, 4, v30
    v_add_u32 v30, s39, v30
    s_mov_b32 s60, 0xff00ff00
    s_mov_b32 s61, 0xff00ff00
    s_mov_b32 s62, 0
    s_mov_b32 s63, 0x00ff00ff
    s_branch se_64
s6_63:
    s_mov_b32 s60, 0x0000ffff
    s_mov_b32 s61, 0x0000ffff
    s_mov_b32 s62, 0xffff0000
    s_mov_b32 s63, 0xffff0000
    s_lshl_b32 s38, s27, 13
    v_add_u32 v28, s38, v7
    v_and_b32 v16, 1, v4
    v_lshlrev_b32 v16, 2, v16
    v_and_b32 v17, 2, v4
    v_add3_u32 v16, v16, v17, v5
    v_lshlrev_b32 v16, 2, v16
    v_lshl_add_u32 v16, v6, 5, v16
    s_add_u32 s38, s38, 4096
    v_add_u32 v29, s38, v16
    v_lshrrev_b32 v16, 1, v4
    v_lshlrev_b32 v16, 4, v16
    v_lshl_add_u32 v30, v3, 5, v16
    v_add_u32 v30, 26624, v30
    v_add_u32 v16, v16, v3
    v_lshlrev_b32 v16, 4, v16
    v_add_u32 v31, 36864, v16
    v_lshrrev_b32 v16, 3, v3
    v_lshl_add_u32 v16, v16, 4, v18
    v_and_b32 v17, 1, v3
    v_lshl_add_u32 v16, v17, 3, v16
    v_bfe_u32 v17, v3, 1, 2
    v_lshl_add_u32 v16, v16, 2, v17
    v_lshlrev_b32 v16, 2, v16
    s_lshl_b32 s38, s24, 14
    s_lshl_b32 s39, s25, 9
    s_add_u32 s38, s38, s39
    v_add_u32 v12, s38, v16
    v_or_b32 v16, 0x48, v5
    v_lshlrev_b32 v16, 8, v16
    v_and_b32 v17, 0xff, v20
    v_or_b32 v13, v16, v17
    v_mov_b32 v100, 0
    v_mov_b32 v101, 0
    v_mov_b32 v102, 0
    v_mov_b32 v103, 0
    v_mov_b32 v104, 0
    v_mov_b32 v105, 0
    v_mov_b32 v106, 0
    v_mov_b32 v107, 0
    v_mov_b32 v108, 0
    v_mov_b32 v109, 0
    v_mov_b32 v110, 0
    v_mov_b32 v111, 0
    v_mov_b32 v112, 0
    v_mov_b32 v113, 0
    v_mov_b32 v114, 0
    v_mov_b32 v115, 0
    v_mov_b32 v116, 0x3f803f80
    v_mov_b32 v117, 0x3f803f80
    v_mov_b32 v118, 0x3f803f80
    v_mov_b32 v119, 0x3f803f80
    v_mov_b32 v120, 0x3f803f80
    v_mov_b32 v121, 0x3f803f80
    v_mov_b32 v122, 0x3f803f80
    v_mov_b32 v123, 0x3f803f80
    v_mov_b32 v127, 0
    v_mov_b32 v14, s42
    v_mov_b32 v15, s42
se_64:
    s_waitcnt vmcnt(0)
    v_min_u32 v64, s41, v64
    v_min_u32 v65, s41, v65
    s_cmp_lg_u32 s26, 5
    s_cbranch_scc1 n5_65
    buffer_store_dwordx2 v[64:65], v27, s[8:11], s34 offen
n5_65:
    s_barrier
    s_cmp_eq_u32 s26, 4
    s_cbranch_scc1 L_w4_first
    s_cmp_lg_u32 s26, 7
    s_cbranch_scc1 f7_66
    s_nop 15
    s_nop 15
    s_nop 15
    s_nop 15
    s_nop 15
    s_nop 15
    s_nop 15
    s_nop 15
    s_nop 15
    s_nop 15
    s_nop 15
    s_nop 15
    s_nop 7
    s_lshl_b32 s39, s29, 2
    s_add_u32 s39, s39, s24
    s_lshl_b32 s39, s39, 7
    s_add_u32 s39, s39, 79720448
    v_mov_b32 v8, s39
    s_branch kf_67
poll_68:
    s_sub_u32 s30, s30, 1
    s_cbranch_scc1 L_end
    s_sleep 4
kf_67:
    buffer_load_dword v9, v8, s[8:11], 0 offen sc1
    s_waitcnt vmcnt(0)
    v_cmp_gt_u32 vcc, 32, v9
    s_cbranch_vccnz poll_68
    v_lshlrev_b32 v8, 6, v2
    s_add_u32 s38, s35, 4096
    buffer_load_dword v9, v8, s[8:11], s38 offen sc1
    s_mov_b32 m0, 34816
    s_nop 0
    buffer_load_dwordx4 v7, s[8:11], s35 offen offset:0 sc1 lds
    buffer_load_dwordx4 v7, s[8:11], s35 offen offset:1024 sc1 lds
    buffer_load_dwordx4 v7, s[8:11], s35 offen offset:2048 sc1 lds
    buffer_load_dwordx4 v7, s[8:11], s35 offen offset:3072 sc1 lds
    s_waitcnt vmcnt(0)
f7_66:
L_vo_loop:
    s_cmp_eq_u32 s26, 4
    s_cbranch_scc1 L_w4
    s_cmp_eq_u32 s26, 6
    s_cbranch_scc1 L_w6
    s_xor_b32 s38, s33, 4096
    s_cmp_eq_u32 s26, 5
    s_barrier
    s_cbranch_scc1 n7_69
    buffer_store_dwordx4 v[100:103], v19, s[8:11], s38 offen offset:1024 sc1
    buffer_store_dwordx4 v[100:103], v19, s[8:11], s38 offen offset:2048 sc1
    buffer_store_dwordx4 v[100:103], v19, s[8:11], s38 offen offset:3072 sc1
    buffer_store_dwordx2 v[100:101], v29, s[8:11], s45 offen
n7_69:
    s_barrier
    s_cmp_eq_u32 s29, 63
    s_cbranch_scc1 L_rec_done
L_vo_z:
    v_mov_b32 v96, 0
    v_mov_b32 v97, 0
    v_mov_b32 v98, 0
    v_mov_b32 v99, 0
.p2align 6
    s_nop 0
    s_nop 0
    s_nop 0
    s_nop 0
    s_nop 0
    s_barrier
L_vo_b:
    v_mov_b32 v0, v0
    s_nop 0
    v_mov_b32 v0, v0
    s_nop 0
    v_mov_b32 v0, v0
    s_nop 0
    v_mov_b32 v0, v0
    s_nop 0
    v_mov_b32 v0, v0
    s_nop 0
    v_mov_b32 v0, v0
    s_nop 0
    v_mov_b32 v0, v0
    s_nop 0
    v_mov_b32 v0, v0
    s_nop 0
    v_mov_b32 v0, v0
    s_nop 0
    v_mov_b32 v0, v0
    s_nop 0
    v_mov_b32 v0, v0
    s_nop 0
    v_mov_b32 v0, v0
    s_nop 0
    v_mov_b32 v0, v0
    s_nop 0
    v_mov_b32 v0, v0
    s_nop 0
    v_mov_b32 v0, v0
    s_nop 0
    v_mov_b32 v0, v0
    s_nop 0
    v_mov_b32 v0, v0
    s_nop 0
    v_mov_b32 v0, v0
    s_nop 0
    v_mov_b32 v0, v0
    s_nop 0
    v_mov_b32 v0, v0
    s_nop 0
    v_mov_b32 v0, v0
    s_nop 0
    v_mov_b32 v0, v0
    s_nop 0
    buffer_load_dwordx4 v[32:35], v21, s[8:11], s32 offen offset:0 sc1
    v_mov_b32 v0, v0
    s_nop 0
    v_mov_b32 v0, v0
    s_nop 0
    v_mov_b32 v0, v0
    s_nop 0
    v_mov_b32 v0, v0
    s_nop 0
    v_mov_b32 v0, v0
    s_nop 0
    v_mov_b32 v0, v0
    s_nop 0
    v_mov_b32 v0, v0
    s_nop 0
    v_mov_b32 v0, v0
    buffer_load_dwordx4 v[36:39], v21, s[8:11], s32 offen offset:1024 sc1
    v_mov_b32 v0, v0
    s_nop 0
    v_mov_b32 v0, v0
    s_nop 0
    v_mov_b32 v0, v0
    s_nop 0
    v_mov_b32 v0, v0
    s_nop 0
    v_mov_b32 v0, v0
    s_nop 0
    v_mov_b32 v0, v0
    s_nop 0
    v_mov_b32 v0, v0
    s_nop 0
    v_mov_b32 v0, v0
    buffer_load_dwordx4 v[40:43], v21, s[8:11], s32 offen offset:2048 sc1
    v_mov_b32 v0, v0
    s_nop 0
    v_mov_b32 v0, v0
    s_nop 0
    v_mov_b32 v0, v0
    s_nop 0
    v_mov_b32 v0, v0
    s_nop 0
    v_mov_b32 v0, v0
    s_nop 0
    v_mov_b32 v0, v0
    s_nop 0
    v_mov_b32 v0, v0
    s_nop 0
    v_mov_b32 v0, v0
    buffer_load_dwordx4 v[44:47], v21, s[8:11], s32 offen offset:3072 sc1
    v_mov_b32 v0, v0
    s_nop 0
    v_mov_b32 v0, v0
    s_nop 0
    v_mov_b32 v0, v0
    s_nop 0
    v_mov_b32 v0, v0
    s_nop 0
    v_mov_b32 v0, v0
    s_nop 0
    s_waitcnt vmcnt(3)
    v_max3_u32 v8, v32, v33, v34
    v_max_u32 v8, v8, v35
    v_cmp_eq_u32 vcc, -1, v8
    v_mov_b32_dpp v48, v32 row_ror:8 row_mask:0xf bank_mask:0xf
    v_mov_b32_dpp v49, v33 row_ror:8 row_mask:0xf bank_mask:0xf
    v_mov_b32_dpp v50, v34 row_ror:8 row_mask:0xf bank_mask:0xf
    v_mov_b32_dpp v51, v35 row_ror:8 row_mask:0xf bank_mask:0xf
    s_cbranch_vccnz gent_71
    v_smfmac_f32_16x16x64_bf16 v[96:99], v[32:35], v[128:135], v20
    v_smfmac_f32_16x16x64_bf16 v[96:99], v[48:51], v[136:143], v1
    s_waitcnt vmcnt(2)
    v_max3_u32 v8, v36, v37, v38
    v_max_u32 v8, v8, v39
    v_cmp_eq_u32 vcc, -1, v8
    v_mov_b32_dpp v52, v36 row_ror:8 row_mask:0xf bank_mask:0xf
    v_mov_b32_dpp v53, v37 row_ror:8 row_mask:0xf bank_mask:0xf
    v_mov_b32_dpp v54, v38 row_ror:8 row_mask:0xf bank_mask:0xf
    v_mov_b32_dpp v55, v39 row_ror:8 row_mask:0xf bank_mask:0xf
    s_cbranch_vccnz gent_72
    v_smfmac_f32_16x16x64_bf16 v[96:99], v[36:39], v[144:151], v20
    v_smfmac_f32_16x16x64_bf16 v[96:99], v[52:55], v[152:159], v1
    s_waitcnt vmcnt(1)
    v_max3_u32 v8, v40, v41, v42
    v_max_u32 v8, v8, v43
    v_cmp_eq_u32 vcc, -1, v8
    v_mov_b32_dpp v56, v40 row_ror:8 row_mask:0xf bank_mask:0xf
    v_mov_b32_dpp v57, v41 row_ror:8 row_mask:0xf bank_mask:0xf
    v_mov_b32_dpp v58, v42 row_ror:8 row_mask:0xf bank_mask:0xf
    v_mov_b32_dpp v59, v43 row_ror:8 row_mask:0xf bank_mask:0xf
    s_cbranch_vccnz gent_73
    v_smfmac_f32_16x16x64_bf16 v[96:99], v[40:43], v[160:167], v20
    v_smfmac_f32_16x16x64_bf16 v[96:99], v[56:59], v[168:175], v1
    s_waitcnt vmcnt(0)
    v_max3_u32 v8, v44, v45, v46
    v_max_u32 v8, v8, v47
    v_cmp_eq_u32 vcc, -1, v8
    v_mov_b32_dpp v60, v44 row_ror:8 row_mask:0xf bank_mask:0xf
    v_mov_b32_dpp v61, v45 row_ror:8 row_mask:0xf bank_mask:0xf
    v_mov_b32_dpp v62, v46 row_ror:8 row_mask:0xf bank_mask:0xf
    v_mov_b32_dpp v63, v47 row_ror:8 row_mask:0xf bank_mask:0xf
    s_cbranch_vccnz gent_74
    v_smfmac_f32_16x16x64_bf16 v[96:99], v[44:47], v[176:183], v20
    v_smfmac_f32_16x16x64_bf16 v[96:99], v[60:63], v[184:191], v1
gdone_70:
    s_nop 7
    ds_write2st64_b32 v22, v96, v97 offset0:0 offset1:1
    ds_write2st64_b32 v22, v98, v99 offset0:2 offset1:3
    s_waitcnt lgkmcnt(0)
    s_cmp_lg_u32 s26, 5
    s_barrier
    s_cbranch_scc1 L_vo_n5
    ds_read_b128 v[64:67], v7 offset:30720
    ds_read_b128 v[68:71], v7 offset:31744
    ds_read_b128 v[72:75], v7 offset:32768
    ds_read_b128 v[76:79], v7 offset:33792
    s_waitcnt lgkmcnt(2)
    v_pk_add_f32 v[64:65], v[64:65], v[68:69]
    v_pk_add_f32 v[66:67], v[66:67], v[70:71]
    s_waitcnt lgkmcnt(1)
    v_pk_add_f32 v[64:65], v[64:65], v[72:73]
    v_pk_add_f32 v[66:67], v[66:67], v[74:75]
    s_waitcnt lgkmcnt(0)
    v_pk_add_f32 v[64:65], v[64:65], v[76:77]
    v_pk_add_f32 v[66:67], v[66:67], v[78:79]
    buffer_store_dwordx4 v[64:67], v24, s[8:11], s33 offen sc1
    buffer_store_dwordx4 v[64:67], v25, s[8:11], s33 offen sc1
    buffer_store_dwordx4 v[64:67], v26, s[8:11], s33 offen sc1
    s_nop 15
    s_nop 15
    s_nop 15
    s_nop 15
    s_nop 15
    s_nop 15
    s_nop 15
    buffer_load_dwordx4 v[68:71], v113, s[8:11], s33 offen offset:0 sc1
    buffer_load_dwordx4 v[72:75], v114, s[8:11], s33 offen offset:0 sc1
    buffer_load_dwordx4 v[76:79], v19, s[8:11], s33 offen offset:3072 sc1
    s_nop 15
    s_nop 15
    s_nop 15
    s_nop 15
    s_nop 15
    s_nop 7
    buffer_load_dwordx4 v[80:83], v113, s[8:11], s33 offen offset:0 sc1
    buffer_load_dwordx4 v[84:87], v114, s[8:11], s33 offen offset:0 sc1
    buffer_load_dwordx4 v[88:91], v19, s[8:11], s33 offen offset:3072 sc1
.p2align 6
    s_nop 0
    s_nop 0
    s_nop 0
L_c_wait0:
    s_waitcnt vmcnt(5)
    v_pk_add_f32 v[104:105], v[64:65], v[68:69]
    v_pk_add_f32 v[106:107], v[66:67], v[70:71]
    s_waitcnt vmcnt(3)
    v_pk_add_f32 v[108:109], v[72:73], v[76:77]
    v_pk_add_f32 v[110:111], v[74:75], v[78:79]
    v_pk_add_f32 v[104:105], v[104:105], v[108:109]
    v_pk_add_f32 v[106:107], v[106:107], v[110:111]
    v_maximum3_f32 v112, v104, v105, v106
    v_cmp_u_f32 vcc, v112, v107
    v_cvt_pk_bf16_f32 v104, v104, v105
    v_cvt_pk_bf16_f32 v105, v106, v107
    v_min_u32 v104, s41, v104
    v_min_u32 v105, s41, v105
    s_cbranch_vccnz L_c_fail0
L_c_ok:
    buffer_store_dwordx2 v[104:105], v27, s[8:11], s46 offen
L_vo_b5:
    s_barrier
    s_xor_b32 s31, s31, 262144
    s_xor_b32 s32, s32, 65536
    s_xor_b32 s45, s45, 65536
    s_xor_b32 s33, s33, 4096
    s_xor_b32 s34, s34, 65536
    s_xor_b32 s46, s46, 65536
    s_add_u32 s37, s37, 262144
    s_and_b32 s38, s29, 7
    s_cmp_eq_u32 s38, 7
    s_cselect_b32 s38, 8192, 0
    s_xor_b32 s37, s37, s38
    s_bitcmp1_b32 s29, 0
    s_cselect_b32 s3, 0x2000, 0
    s_add_u32 s35, s35, s3
    s_add_u32 s35, s35, 4096
    s_add_u32 s29, s29, 1
    s_waitcnt vmcnt(0)
    s_branch L_vo_loop
L_vo_n5:
    s_cmp_lg_u32 s26, 4
    s_cbranch_scc1 L_vo_b5
    s_nop 15
    s_nop 15
    s_nop 15
    s_nop 15
    s_nop 15
    s_nop 15
    s_nop 15
    s_nop 15
    s_nop 15
    s_nop 15
    s_nop 9
    s_mov_b64 exec, s[60:61]
    buffer_store_dwordx4 v[108:111], v31, s[8:11], s37 offen sc1
    s_mov_b64 exec, -1
    s_branch L_vo_b5
L_c_fail0:
    s_sub_u32 s30, s30, 1
    s_cbranch_scc1 L_end
    s_sub_u32 s58, s58, 1
    v_max3_u32 v112, v68, v69, v70
    v_max3_u32 v112, v112, v71, v72
    v_max3_u32 v112, v112, v73, v74
    v_max3_u32 v112, v112, v75, v76
    v_max3_u32 v112, v112, v77, v78
    v_max_u32 v112, v112, v79
    v_cmp_eq_u32 vcc, -1, v112
    s_cbranch_vccz L_c_ok
    buffer_load_dwordx4 v[68:71], v113, s[8:11], s33 offen offset:0 sc1
    buffer_load_dwordx4 v[72:75], v114, s[8:11], s33 offen offset:0 sc1
    buffer_load_dwordx4 v[76:79], v19, s[8:11], s33 offen offset:3072 sc1
L_c_wait1:
    s_waitcnt vmcnt(5)
    v_pk_add_f32 v[104:105], v[64:65], v[80:81]
    v_pk_add_f32 v[106:107], v[66:67], v[82:83]
    s_waitcnt vmcnt(3)
    v_pk_add_f32 v[108:109], v[84:85], v[88:89]
    v_pk_add_f32 v[110:111], v[86:87], v[90:91]
    v_pk_add_f32 v[104:105], v[104:105], v[108:109]
    v_pk_add_f32 v[106:107], v[106:107], v[110:111]
    v_maximum3_f32 v112, v104, v105, v106
    v_cmp_u_f32 vcc, v112, v107
    v_cvt_pk_bf16_f32 v104, v104, v105
    v_cvt_pk_bf16_f32 v105, v106, v107
    v_min_u32 v104, s41, v104
    v_min_u32 v105, s41, v105
    s_cbranch_vccnz L_c_fail1
    s_branch L_c_ok
L_c_fail1:
    s_sub_u32 s30, s30, 1
    s_cbranch_scc1 L_end
    s_sub_u32 s58, s58, 1
    v_max3_u32 v112, v80, v81, v82
    v_max3_u32 v112, v112, v83, v84
    v_max3_u32 v112, v112, v85, v86
    v_max3_u32 v112, v112, v87, v88
    v_max3_u32 v112, v112, v89, v90
    v_max_u32 v112, v112, v91
    v_cmp_eq_u32 vcc, -1, v112
    s_cbranch_vccz L_c_ok
    buffer_load_dwordx4 v[80:83], v113, s[8:11], s33 offen offset:0 sc1
    buffer_load_dwordx4 v[84:87], v114, s[8:11], s33 offen offset:0 sc1
    buffer_load_dwordx4 v[88:91], v19, s[8:11], s33 offen offset:3072 sc1
    s_branch L_c_wait0
gent_71:
    buffer_load_dwordx4 v[32:35], v21, s[8:11], s32 offen offset:0 sc1
    s_sub_u32 s30, s30, 1
    s_cbranch_scc1 L_end
    s_branch q_75_15_1
gent_72:
    buffer_load_dwordx4 v[36:39], v21, s[8:11], s32 offen offset:1024 sc1
    s_sub_u32 s30, s30, 1
    s_cbranch_scc1 L_end
    s_branch q_75_14_2
gent_73:
    buffer_load_dwordx4 v[40:43], v21, s[8:11], s32 offen offset:2048 sc1
    s_sub_u32 s30, s30, 1
    s_cbranch_scc1 L_end
    s_branch q_75_12_3
gent_74:
    buffer_load_dwordx4 v[44:47], v21, s[8:11], s32 offen offset:3072 sc1
    s_sub_u32 s30, s30, 1
    s_cbranch_scc1 L_end
    s_branch q_75_8_3
bad_76:
    buffer_load_dwordx4 v[32:35], v21, s[8:11], s32 offen offset:0 sc1
    s_sub_u32 s30, s30, 1
    s_cbranch_scc1 L_end
q_75_1_0:
    s_waitcnt vmcnt(0)
    v_max3_u32 v8, v32, v33, v34
    v_max_u32 v8, v8, v35
    v_cmp_eq_u32 vcc, -1, v8
    v_mov_b32_dpp v48, v32 row_ror:8 row_mask:0xf bank_mask:0xf
    v_mov_b32_dpp v49, v33 row_ror:8 row_mask:0xf bank_mask:0xf
    v_mov_b32_dpp v50, v34 row_ror:8 row_mask:0xf bank_mask:0xf
    v_mov_b32_dpp v51, v35 row_ror:8 row_mask:0xf bank_mask:0xf
    s_cbranch_vccnz bad_76
    v_smfmac_f32_16x16x64_bf16 v[96:99], v[32:35], v[128:135], v20
    v_smfmac_f32_16x16x64_bf16 v[96:99], v[48:51], v[136:143], v1
    s_branch gdone_70
bad_77:
    buffer_load_dwordx4 v[36:39], v21, s[8:11], s32 offen offset:1024 sc1
    s_sub_u32 s30, s30, 1
    s_cbranch_scc1 L_end
q_75_2_1:
    s_waitcnt vmcnt(0)
    v_max3_u32 v8, v36, v37, v38
    v_max_u32 v8, v8, v39
    v_cmp_eq_u32 vcc, -1, v8
    v_mov_b32_dpp v52, v36 row_ror:8 row_mask:0xf bank_mask:0xf
    v_mov_b32_dpp v53, v37 row_ror:8 row_mask:0xf bank_mask:0xf
    v_mov_b32_dpp v54, v38 row_ror:8 row_mask:0xf bank_mask:0xf
    v_mov_b32_dpp v55, v39 row_ror:8 row_mask:0xf bank_mask:0xf
    s_cbranch_vccnz bad_77
    v_smfmac_f32_16x16x64_bf16 v[96:99], v[36:39], v[144:151], v20
    v_smfmac_f32_16x16x64_bf16 v[96:99], v[52:55], v[152:159], v1
    s_branch gdone_70
q_75_3_0:
    s_waitcnt vmcnt(1)
    v_max3_u32 v8, v32, v33, v34
    v_max_u32 v8, v8, v35
    v_cmp_eq_u32 vcc, -1, v8
    v_mov_b32_dpp v48, v32 row_ror:8 row_mask:0xf bank_mask:0xf
    v_mov_b32_dpp v49, v33 row_ror:8 row_mask:0xf bank_mask:0xf
    v_mov_b32_dpp v50, v34 row_ror:8 row_mask:0xf bank_mask:0xf
    v_mov_b32_dpp v51, v35 row_ror:8 row_mask:0xf bank_mask:0xf
    s_cbranch_vccnz bad_78
    v_smfmac_f32_16x16x64_bf16 v[96:99], v[32:35], v[128:135], v20
    v_smfmac_f32_16x16x64_bf16 v[96:99], v[48:51], v[136:143], v1
    s_branch q_75_2_1
bad_78:
    buffer_load_dwordx4 v[32:35], v21, s[8:11], s32 offen offset:0 sc1
    s_sub_u32 s30, s30, 1
    s_cbranch_scc1 L_end
    s_branch q_75_3_1
q_75_3_1:
    s_waitcnt vmcnt(1)
    v_max3_u32 v8, v36, v37, v38
    v_max_u32 v8, v8, v39
    v_cmp_eq_u32 vcc, -1, v8
    v_mov_b32_dpp v52, v36 row_ror:8 row_mask:0xf bank_mask:0xf
    v_mov_b32_dpp v53, v37 row_ror:8 row_mask:0xf bank_mask:0xf
    v_mov_b32_dpp v54, v38 row_ror:8 row_mask:0xf bank_mask:0xf
    v_mov_b32_dpp v55, v39 row_ror:8 row_mask:0xf bank_mask:0xf
    s_cbranch_vccnz bad_79
    v_smfmac_f32_16x16x64_bf16 v[96:99], v[36:39], v[144:151], v20
    v_smfmac_f32_16x16x64_bf16 v[96:99], v[52:55], v[152:159], v1
    s_branch q_75_1_0
bad_79:
    buffer_load_dwordx4 v[36:39], v21, s[8:11], s32 offen offset:1024 sc1
    s_sub_u32 s30, s30, 1
    s_cbranch_scc1 L_end
    s_branch q_75_3_0
bad_80:
    buffer_load_dwordx4 v[40:43], v21, s[8:11], s32 offen offset:2048 sc1
    s_sub_u32 s30, s30, 1
    s_cbranch_scc1 L_end
q_75_4_2:
    s_waitcnt vmcnt(0)
    v_max3_u32 v8, v40, v41, v42
    v_max_u32 v8, v8, v43
    v_cmp_eq_u32 vcc, -1, v8
    v_mov_b32_dpp v56, v40 row_ror:8 row_mask:0xf bank_mask:0xf
    v_mov_b32_dpp v57, v41 row_ror:8 row_mask:0xf bank_mask:0xf
    v_mov_b32_dpp v58, v42 row_ror:8 row_mask:0xf bank_mask:0xf
    v_mov_b32_dpp v59, v43 row_ror:8 row_mask:0xf bank_mask:0xf
    s_cbranch_vccnz bad_80
    v_smfmac_f32_16x16x64_bf16 v[96:99], v[40:43], v[160:167], v20
    v_smfmac_f32_16x16x64_bf16 v[96:99], v[56:59], v[168:175], v1
    s_branch gdone_70
q_75_5_0:
    s_waitcnt vmcnt(1)
    v_max3_u32 v8, v32, v33, v34
    v_max_u32 v8, v8, v35
    v_cmp_eq_u32 vcc, -1, v8
    v_mov_b32_dpp v48, v32 row_ror:8 row_mask:0xf bank_mask:0xf
    v_mov_b32_dpp v49, v33 row_ror:8 row_mask:0xf bank_mask:0xf
    v_mov_b32_dpp v50, v34 row_ror:8 row_mask:0xf bank_mask:0xf
    v_mov_b32_dpp v51, v35 row_ror:8 row_mask:0xf bank_mask:0xf
    s_cbranch_vccnz bad_81
    v_smfmac_f32_16x16x64_bf16 v[96:99], v[32:35], v[128:135], v20
    v_smfmac_f32_16x16x64_bf16 v[96:99], v[48:51], v[136:143], v1
    s_branch q_75_4_2
bad_81:
    buffer_load_dwordx4 v[32:35], v21, s[8:11], s32 offen offset:0 sc1
    s_sub_u32 s30, s30, 1
    s_cbranch_scc1 L_end
    s_branch q_75_5_2
q_75_5_2:
    s_waitcnt vmcnt(1)
    v_max3_u32 v8, v40, v41, v42
    v_max_u32 v8, v8, v43
    v_cmp_eq_u32 vcc, -1, v8
    v_mov_b32_dpp v56, v40 row_ror:8 row_mask:0xf bank_mask:0xf
    v_mov_b32_dpp v57, v41 row_ror:8 row_mask:0xf bank_mask:0xf
    v_mov_b32_dpp v58, v42 row_ror:8 row_mask:0xf bank_mask:0xf
    v_mov_b32_dpp v59, v43 row_ror:8 row_mask:0xf bank_mask:0xf
    s_cbranch_vccnz bad_82
    v_smfmac_f32_16x16x64_bf16 v[96:99], v[40:43], v[160:167], v20
    v_smfmac_f32_16x16x64_bf16 v[96:99], v[56:59], v[168:175], v1
    s_branch q_75_1_0
bad_82:
    buffer_load_dwordx4 v[40:43], v21, s[8:11], s32 offen offset:2048 sc1
    s_sub_u32 s30, s30, 1
    s_cbranch_scc1 L_end
    s_branch q_75_5_0
q_75_6_1:
    s_waitcnt vmcnt(1)
    v_max3_u32 v8, v36, v37, v38
    v_max_u32 v8, v8, v39
    v_cmp_eq_u32 vcc, -1, v8
    v_mov_b32_dpp v52, v36 row_ror:8 row_mask:0xf bank_mask:0xf
    v_mov_b32_dpp v53, v37 row_ror:8 row_mask:0xf bank_mask:0xf
    v_mov_b32_dpp v54, v38 row_ror:8 row_mask:0xf bank_mask:0xf
    v_mov_b32_dpp v55, v39 row_ror:8 row_mask:0xf bank_mask:0xf
    s_cbranch_vccnz bad_83
    v_smfmac_f32_16x16x64_bf16 v[96:99], v[36:39], v[144:151], v20
    v_smfmac_f32_16x16x64_bf16 v[96:99], v[52:55], v[152:159], v1
    s_branch q_75_4_2
bad_83:
    buffer_load_dwordx4 v[36:39], v21, s[8:11], s32 offen offset:1024 sc1
    s_sub_u32 s30, s30, 1
    s_cbranch_scc1 L_end
    s_branch q_75_6_2
q_75_6_2:
    s_waitcnt vmcnt(1)
    v_max3_u32 v8, v40, v41, v42
    v_max_u32 v8, v8, v43
    v_cmp_eq_u32 vcc, -1, v8
    v_mov_b32_dpp v56, v40 row_ror:8 row_mask:0xf bank_mask:0xf
    v_mov_b32_dpp v57, v41 row_ror:8 row_mask:0xf bank_mask:0xf
    v_mov_b32_dpp v58, v42 row_ror:8 row_mask:0xf bank_mask:0xf
    v_mov_b32_dpp v59, v43 row_ror:8 row_mask:0xf bank_mask:0xf
    s_cbranch_vccnz bad_84
    v_smfmac_f32_16x16x64_bf16 v[96:99], v[40:43], v[160:167], v20
    v_smfmac_f32_16x16x64_bf16 v[96:99], v[56:59], v[168:175], v1
    s_branch q_75_2_1
bad_84:
    buffer_load_dwordx4 v[40:43], v21, s[8:11], s32 offen offset:2048 sc1
    s_sub_u32 s30, s30, 1
    s_cbranch_scc1 L_end
    s_branch q_75_6_1
q_75_7_0:
    s_waitcnt vmcnt(2)
    v_max3_u32 v8, v32, v33, v34
    v_max_u32 v8, v8, v35
    v_cmp_eq_u32 vcc, -1, v8
    v_mov_b32_dpp v48, v32 row_ror:8 row_mask:0xf bank_mask:0xf
    v_mov_b32_dpp v49, v33 row_ror:8 row_mask:0xf bank_mask:0xf
    v_mov_b32_dpp v50, v34 row_ror:8 row_mask:0xf bank_mask:0xf
    v_mov_b32_dpp v51, v35 row_ror:8 row_mask:0xf bank_mask:0xf
    s_cbranch_vccnz bad_85
    v_smfmac_f32_16x16x64_bf16 v[96:99], v[32:35], v[128:135], v20
    v_smfmac_f32_16x16x64_bf16 v[96:99], v[48:51], v[136:143], v1
    s_branch q_75_6_1
bad_85:
    buffer_load_dwordx4 v[32:35], v21, s[8:11], s32 offen offset:0 sc1
    s_sub_u32 s30, s30, 1
    s_cbranch_scc1 L_end
    s_branch q_75_7_1
q_75_7_1:
    s_waitcnt vmcnt(2)
    v_max3_u32 v8, v36, v37, v38
    v_max_u32 v8, v8, v39
    v_cmp_eq_u32 vcc, -1, v8
    v_mov_b32_dpp v52, v36 row_ror:8 row_mask:0xf bank_mask:0xf
    v_mov_b32_dpp v53, v37 row_ror:8 row_mask:0xf bank_mask:0xf
    v_mov_b32_dpp v54, v38 row_ror:8 row_mask:0xf bank_mask:0xf
    v_mov_b32_dpp v55, v39 row_ror:8 row_mask:0xf bank_mask:0xf
    s_cbranch_vccnz bad_86
    v_smfmac_f32_16x16x64_bf16 v[96:99], v[36:39], v[144:151], v20
    v_smfmac_f32_16x16x64_bf16 v[96:99], v[52:55], v[152:159], v1
    s_branch q_75_5_2
bad_86:
    buffer_load_dwordx4 v[36:39], v21, s[8:11], s32 offen offset:1024 sc1
    s_sub_u32 s30, s30, 1
    s_cbranch_scc1 L_end
    s_branch q_75_7_2
q_75_7_2:
    s_waitcnt vmcnt(2)
    v_max3_u32 v8, v40, v41, v42
    v_max_u32 v8, v8, v43
    v_cmp_eq_u32 vcc, -1, v8
    v_mov_b32_dpp v56, v40 row_ror:8 row_mask:0xf bank_mask:0xf
    v_mov_b32_dpp v57, v41 row_ror:8 row_mask:0xf bank_mask:0xf
    v_mov_b32_dpp v58, v42 row_ror:8 row_mask:0xf bank_mask:0xf
    v_mov_b32_dpp v59, v43 row_ror:8 row_mask:0xf bank_mask:0xf
    s_cbranch_vccnz bad_87
    v_smfmac_f32_16x16x64_bf16 v[96:99], v[40:43], v[160:167], v20
    v_smfmac_f32_16x16x64_bf16 v[96:99], v[56:59], v[168:175], v1
    s_branch q_75_3_0
bad_87:
    buffer_load_dwordx4 v[40:43], v21, s[8:11], s32 offen offset:2048 sc1
    s_sub_u32 s30, s30, 1
    s_cbranch_scc1 L_end
    s_branch q_75_7_0
bad_88:
    buffer_load_dwordx4 v[44:47], v21, s[8:11], s32 offen offset:3072 sc1
    s_sub_u32 s30, s30, 1
    s_cbranch_scc1 L_end
q_75_8_3:
    s_waitcnt vmcnt(0)
    v_max3_u32 v8, v44, v45, v46
    v_max_u32 v8, v8, v47
    v_cmp_eq_u32 vcc, -1, v8
    v_mov_b32_dpp v60, v44 row_ror:8 row_mask:0xf bank_mask:0xf
    v_mov_b32_dpp v61, v45 row_ror:8 row_mask:0xf bank_mask:0xf
    v_mov_b32_dpp v62, v46 row_ror:8 row_mask:0xf bank_mask:0xf
    v_mov_b32_dpp v63, v47 row_ror:8 row_mask:0xf bank_mask:0xf
    s_cbranch_vccnz bad_88
    v_smfmac_f32_16x16x64_bf16 v[96:99], v[44:47], v[176:183], v20
    v_smfmac_f32_16x16x64_bf16 v[96:99], v[60:63], v[184:191], v1
    s_branch gdone_70
q_75_9_0:
    s_waitcnt vmcnt(1)
    v_max3_u32 v8, v32, v33, v34
    v_max_u32 v8, v8, v35
    v_cmp_eq_u32 vcc, -1, v8
    v_mov_b32_dpp v48, v32 row_ror:8 row_mask:0xf bank_mask:0xf
    v_mov_b32_dpp v49, v33 row_ror:8 row_mask:0xf bank_mask:0xf
    v_mov_b32_dpp v50, v34 row_ror:8 row_mask:0xf bank_mask:0xf
    v_mov_b32_dpp v51, v35 row_ror:8 row_mask:0xf bank_mask:0xf
    s_cbranch_vccnz bad_89
    v_smfmac_f32_16x16x64_bf16 v[96:99], v[32:35], v[128:135], v20
    v_smfmac_f32_16x16x64_bf16 v[96:99], v[48:51], v[136:143], v1
    s_branch q_75_8_3
bad_89:
    buffer_load_dwordx4 v[32:35], v21, s[8:11], s32 offen offset:0 sc1
    s_sub_u32 s30, s30, 1
    s_cbranch_scc1 L_end
    s_branch q_75_9_3
q_75_9_3:
    s_waitcnt vmcnt(1)
    v_max3_u32 v8, v44, v45, v46
    v_max_u32 v8, v8, v47
    v_cmp_eq_u32 vcc, -1, v8
    v_mov_b32_dpp v60, v44 row_ror:8 row_mask:0xf bank_mask:0xf
    v_mov_b32_dpp v61, v45 row_ror:8 row_mask:0xf bank_mask:0xf
    v_mov_b32_dpp v62, v46 row_ror:8 row_mask:0xf bank_mask:0xf
    v_mov_b32_dpp v63, v47 row_ror:8 row_mask:0xf bank_mask:0xf
    s_cbranch_vccnz bad_90
    v_smfmac_f32_16x16x64_bf16 v[96:99], v[44:47], v[176:183], v20
    v_smfmac_f32_16x16x64_bf16 v[96:99], v[60:63], v[184:191], v1
    s_branch q_75_1_0
bad_90:
    buffer_load_dwordx4 v[44:47], v21, s[8:11], s32 offen offset:3072 sc1
    s_sub_u32 s30, s30, 1
    s_cbranch_scc1 L_end
    s_branch q_75_9_0
q_75_10_1:
    s_waitcnt vmcnt(1)
    v_max3_u32 v8, v36, v37, v38
    v_max_u32 v8, v8, v39
    v_cmp_eq_u32 vcc, -1, v8
    v_mov_b32_dpp v52, v36 row_ror:8 row_mask:0xf bank_mask:0xf
    v_mov_b32_dpp v53, v37 row_ror:8 row_mask:0xf bank_mask:0xf
    v_mov_b32_dpp v54, v38 row_ror:8 row_mask:0xf bank_mask:0xf
    v_mov_b32_dpp v55, v39 row_ror:8 row_mask:0xf bank_mask:0xf
    s_cbranch_vccnz bad_91
    v_smfmac_f32_16x16x64_bf16 v[96:99], v[36:39], v[144:151], v20
    v_smfmac_f32_16x16x64_bf16 v[96:99], v[52:55], v[152:159], v1
    s_branch q_75_8_3
bad_91:
    buffer_load_dwordx4 v[36:39], v21, s[8:11], s32 offen offset:1024 sc1
    s_sub_u32 s30, s30, 1
    s_cbranch_scc1 L_end
    s_branch q_75_10_3
q_75_10_3:
    s_waitcnt vmcnt(1)
    v_max3_u32 v8, v44, v45, v46
    v_max_u32 v8, v8, v47
    v_cmp_eq_u32 vcc, -1, v8
    v_mov_b32_dpp v60, v44 row_ror:8 row_mask:0xf bank_mask:0xf
    v_mov_b32_dpp v61, v45 row_ror:8 row_mask:0xf bank_mask:0xf
    v_mov_b32_dpp v62, v46 row_ror:8 row_mask:0xf bank_mask:0xf
    v_mov_b32_dpp v63, v47 row_ror:8 row_mask:0xf bank_mask:0xf
    s_cbranch_vccnz bad_92
    v_smfmac_f32_16x16x64_bf16 v[96:99], v[44:47], v[176:183], v20
    v_smfmac_f32_16x16x64_bf16 v[96:99], v[60:63], v[184:191], v1
    s_branch q_75_2_1
bad_92:
    buffer_load_dwordx4 v[44:47], v21, s[8:11], s32 offen offset:3072 sc1
    s_sub_u32 s30, s30, 1
    s_cbranch_scc1 L_end
    s_branch q_75_10_1
q_75_11_0:
    s_waitcnt vmcnt(2)
    v_max3_u32 v8, v32, v33, v34
    v_max_u32 v8, v8, v35
    v_cmp_eq_u32 vcc, -1, v8
    v_mov_b32_dpp v48, v32 row_ror:8 row_mask:0xf bank_mask:0xf
    v_mov_b32_dpp v49, v33 row_ror:8 row_mask:0xf bank_mask:0xf
    v_mov_b32_dpp v50, v34 row_ror:8 row_mask:0xf bank_mask:0xf
    v_mov_b32_dpp v51, v35 row_ror:8 row_mask:0xf bank_mask:0xf
    s_cbranch_vccnz bad_93
    v_smfmac_f32_16x16x64_bf16 v[96:99], v[32:35], v[128:135], v20
    v_smfmac_f32_16x16x64_bf16 v[96:99], v[48:51], v[136:143], v1
    s_branch q_75_10_1
bad_93:
    buffer_load_dwordx4 v[32:35], v21, s[8:11], s32 offen offset:0 sc1
    s_sub_u32 s30, s30, 1
    s_cbranch_scc1 L_end
    s_branch q_75_11_1
q_75_11_1:
    s_waitcnt vmcnt(2)
    v_max3_u32 v8, v36, v37, v38
    v_max_u32 v8, v8, v39
    v_cmp_eq_u32 vcc, -1, v8
    v_mov_b32_dpp v52, v36 row_ror:8 row_mask:0xf bank_mask:0xf
    v_mov_b32_dpp v53, v37 row_ror:8 row_mask:0xf bank_mask:0xf
    v_mov_b32_dpp v54, v38 row_ror:8 row_mask:0xf bank_mask:0xf
    v_mov_b32_dpp v55, v39 row_ror:8 row_mask:0xf bank_mask:0xf
    s_cbranch_vccnz bad_94
    v_smfmac_f32_16x16x64_bf16 v[96:99], v[36:39], v[144:151], v20
    v_smfmac_f32_16x16x64_bf16 v[96:99], v[52:55], v[152:159], v1
    s_branch q_75_9_3
bad_94:
    buffer_load_dwordx4 v[36:39], v21, s[8:11], s32 offen offset:1024 sc1
    s_sub_u32 s30, s30, 1
    s_cbranch_scc1 L_end
    s_branch q_75_11_3
q_75_11_3:
    s_waitcnt vmcnt(2)
    v_max3_u32 v8, v44, v45, v46
    v_max_u32 v8, v8, v47
    v_cmp_eq_u32 vcc, -1, v8
    v_mov_b32_dpp v60, v44 row_ror:8 row_mask:0xf bank_mask:0xf
    v_mov_b32_dpp v61, v45 row_ror:8 row_mask:0xf bank_mask:0xf
    v_mov_b32_dpp v62, v46 row_ror:8 row_mask:0xf bank_mask:0xf
    v_mov_b32_dpp v63, v47 row_ror:8 row_mask:0xf bank_mask:0xf
    s_cbranch_vccnz bad_95
    v_smfmac_f32_16x16x64_bf16 v[96:99], v[44:47], v[176:183], v20
    v_smfmac_f32_16x16x64_bf16 v[96:99], v[60:63], v[184:191], v1
    s_branch q_75_3_0
bad_95:
    buffer_load_dwordx4 v[44:47], v21, s[8:11], s32 offen offset:3072 sc1
    s_sub_u32 s30, s30, 1
    s_cbranch_scc1 L_end
    s_branch q_75_11_0
q_75_12_2:
    s_waitcnt vmcnt(1)
    v_max3_u32 v8, v40, v41, v42
    v_max_u32 v8, v8, v43
    v_cmp_eq_u32 vcc, -1, v8
    v_mov_b32_dpp v56, v40 row_ror:8 row_mask:0xf bank_mask:0xf
    v_mov_b32_dpp v57, v41 row_ror:8 row_mask:0xf bank_mask:0xf
    v_mov_b32_dpp v58, v42 row_ror:8 row_mask:0xf bank_mask:0xf
    v_mov_b32_dpp v59, v43 row_ror:8 row_mask:0xf bank_mask:0xf
    s_cbranch_vccnz bad_96
    v_smfmac_f32_16x16x64_bf16 v[96:99], v[40:43], v[160:167], v20
    v_smfmac_f32_16x16x64_bf16 v[96:99], v[56:59], v[168:175], v1
    s_branch q_75_8_3
bad_96:
    buffer_load_dwordx4 v[40:43], v21, s[8:11], s32 offen offset:2048 sc1
    s_sub_u32 s30, s30, 1
    s_cbranch_scc1 L_end
    s_branch q_75_12_3
q_75_12_3:
    s_waitcnt vmcnt(1)
    v_max3_u32 v8, v44, v45, v46
    v_max_u32 v8, v8, v47
    v_cmp_eq_u32 vcc, -1, v8
    v_mov_b32_dpp v60, v44 row_ror:8 row_mask:0xf bank_mask:0xf
    v_mov_b32_dpp v61, v45 row_ror:8 row_mask:0xf bank_mask:0xf
    v_mov_b32_dpp v62, v46 row_ror:8 row_mask:0xf bank_mask:0xf
    v_mov_b32_dpp v63, v47 row_ror:8 row_mask:0xf bank_mask:0xf
    s_cbranch_vccnz bad_97
    v_smfmac_f32_16x16x64_bf16 v[96:99], v[44:47], v[176:183], v20
    v_smfmac_f32_16x16x64_bf16 v[96:99], v[60:63], v[184:191], v1
    s_branch q_75_4_2
bad_97:
    buffer_load_dwordx4 v[44:47], v21, s[8:11], s32 offen offset:3072 sc1
    s_sub_u32 s30, s30, 1
    s_cbranch_scc1 L_end
    s_branch q_75_12_2
q_75_13_0:
    s_waitcnt vmcnt(2)
    v_max3_u32 v8, v32, v33, v34
    v_max_u32 v8, v8, v35
    v_cmp_eq_u32 vcc, -1, v8
    v_mov_b32_dpp v48, v32 row_ror:8 row_mask:0xf bank_mask:0xf
    v_mov_b32_dpp v49, v33 row_ror:8 row_mask:0xf bank_mask:0xf
    v_mov_b32_dpp v50, v34 row_ror:8 row_mask:0xf bank_mask:0xf
    v_mov_b32_dpp v51, v35 row_ror:8 row_mask:0xf bank_mask:0xf
    s_cbranch_vccnz bad_98
    v_smfmac_f32_16x16x64_bf16 v[96:99], v[32:35], v[128:135], v20
    v_smfmac_f32_16x16x64_bf16 v[96:99], v[48:51], v[136:143], v1
    s_branch q_75_12_2
bad_98:
    buffer_load_dwordx4 v[32:35], v21, s[8:11], s32 offen offset:0 sc1
    s_sub_u32 s30, s30, 1
    s_cbranch_scc1 L_end
    s_branch q_75_13_2
q_75_13_2:
    s_waitcnt vmcnt(2)
    v_max3_u32 v8, v40, v41, v42
    v_max_u32 v8, v8, v43
    v_cmp_eq_u32 vcc, -1, v8
    v_mov_b32_dpp v56, v40 row_ror:8 row_mask:0xf bank_mask:0xf
    v_mov_b32_dpp v57, v41 row_ror:8 row_mask:0xf bank_mask:0xf
    v_mov_b32_dpp v58, v42 row_ror:8 row_mask:0xf bank_mask:0xf
    v_mov_b32_dpp v59, v43 row_ror:8 row_mask:0xf bank_mask:0xf
    s_cbranch_vccnz bad_99
    v_smfmac_f32_16x16x64_bf16 v[96:99], v[40:43], v[160:167], v20
    v_smfmac_f32_16x16x64_bf16 v[96:99], v[56:59], v[168:175], v1
    s_branch q_75_9_3
bad_99:
    buffer_load_dwordx4 v[40:43], v21, s[8:11], s32 offen offset:2048 sc1
    s_sub_u32 s30, s30, 1
    s_cbranch_scc1 L_end
    s_branch q_75_13_3
q_75_13_3:
    s_waitcnt vmcnt(2)
    v_max3_u32 v8, v44, v45, v46
    v_max_u32 v8, v8, v47
    v_cmp_eq_u32 vcc, -1, v8
    v_mov_b32_dpp v60, v44 row_ror:8 row_mask:0xf bank_mask:0xf
    v_mov_b32_dpp v61, v45 row_ror:8 row_mask:0xf bank_mask:0xf
    v_mov_b32_dpp v62, v46 row_ror:8 row_mask:0xf bank_mask:0xf
    v_mov_b32_dpp v63, v47 row_ror:8 row_mask:0xf bank_mask:0xf
    s_cbranch_vccnz bad_100
    v_smfmac_f32_16x16x64_bf16 v[96:99], v[44:47], v[176:183], v20
    v_smfmac_f32_16x16x64_bf16 v[96:99], v[60:63], v[184:191], v1
    s_branch q_75_5_0
bad_100:
    buffer_load_dwordx4 v[44:47], v21, s[8:11], s32 offen offset:3072 sc1
    s_sub_u32 s30, s30, 1
    s_cbranch_scc1 L_end
    s_branch q_75_13_0
q_75_14_1:
    s_waitcnt vmcnt(2)
    v_max3_u32 v8, v36, v37, v38
    v_max_u32 v8, v8, v39
    v_cmp_eq_u32 vcc, -1, v8
    v_mov_b32_dpp v52, v36 row_ror:8 row_mask:0xf bank_mask:0xf
    v_mov_b32_dpp v53, v37 row_ror:8 row_mask:0xf bank_mask:0xf
    v_mov_b32_dpp v54, v38 row_ror:8 row_mask:0xf bank_mask:0xf
    v_mov_b32_dpp v55, v39 row_ror:8 row_mask:0xf bank_mask:0xf
    s_cbranch_vccnz bad_101
    v_smfmac_f32_16x16x64_bf16 v[96:99], v[36:39], v[144:151], v20
    v_smfmac_f32_16x16x64_bf16 v[96:99], v[52:55], v[152:159], v1
    s_branch q_75_12_2
bad_101:
    buffer_load_dwordx4 v[36:39], v21, s[8:11], s32 offen offset:1024 sc1
    s_sub_u32 s30, s30, 1
    s_cbranch_scc1 L_end
    s_branch q_75_14_2
q_75_14_2:
    s_waitcnt vmcnt(2)
    v_max3_u32 v8, v40, v41, v42
    v_max_u32 v8, v8, v43
    v_cmp_eq_u32 vcc, -1, v8
    v_mov_b32_dpp v56, v40 row_ror:8 row_mask:0xf bank_mask:0xf
    v_mov_b32_dpp v57, v41 row_ror:8 row_mask:0xf bank_mask:0xf
    v_mov_b32_dpp v58, v42 row_ror:8 row_mask:0xf bank_mask:0xf
    v_mov_b32_dpp v59, v43 row_ror:8 row_mask:0xf bank_mask:0xf
    s_cbranch_vccnz bad_102
    v_smfmac_f32_16x16x64_bf16 v[96:99], v[40:43], v[160:167], v20
    v_smfmac_f32_16x16x64_bf16 v[96:99], v[56:59], v[168:175], v1
    s_branch q_75_10_3
bad_102:
    buffer_load_dwordx4 v[40:43], v21, s[8:11], s32 offen offset:2048 sc1
    s_sub_u32 s30, s30, 1
    s_cbranch_scc1 L_end
    s_branch q_75_14_3
q_75_14_3:
    s_waitcnt vmcnt(2)
    v_max3_u32 v8, v44, v45, v46
    v_max_u32 v8, v8, v47
    v_cmp_eq_u32 vcc, -1, v8
    v_mov_b32_dpp v60, v44 row_ror:8 row_mask:0xf bank_mask:0xf
    v_mov_b32_dpp v61, v45 row_ror:8 row_mask:0xf bank_mask:0xf
    v_mov_b32_dpp v62, v46 row_ror:8 row_mask:0xf bank_mask:0xf
    v_mov_b32_dpp v63, v47 row_ror:8 row_mask:0xf bank_mask:0xf
    s_cbranch_vccnz bad_103
    v_smfmac_f32_16x16x64_bf16 v[96:99], v[44:47], v[176:183], v20
    v_smfmac_f32_16x16x64_bf16 v[96:99], v[60:63], v[184:191], v1
    s_branch q_75_6_1
bad_103:
    buffer_load_dwordx4 v[44:47], v21, s[8:11], s32 offen offset:3072 sc1
    s_sub_u32 s30, s30, 1
    s_cbranch_scc1 L_end
    s_branch q_75_14_1
q_75_15_0:
    s_waitcnt vmcnt(3)
    v_max3_u32 v8, v32, v33, v34
    v_max_u32 v8, v8, v35
    v_cmp_eq_u32 vcc, -1, v8
    v_mov_b32_dpp v48, v32 row_ror:8 row_mask:0xf bank_mask:0xf
    v_mov_b32_dpp v49, v33 row_ror:8 row_mask:0xf bank_mask:0xf
    v_mov_b32_dpp v50, v34 row_ror:8 row_mask:0xf bank_mask:0xf
    v_mov_b32_dpp v51, v35 row_ror:8 row_mask:0xf bank_mask:0xf
    s_cbranch_vccnz bad_104
    v_smfmac_f32_16x16x64_bf16 v[96:99], v[32:35], v[128:135], v20
    v_smfmac_f32_16x16x64_bf16 v[96:99], v[48:51], v[136:143], v1
    s_branch q_75_14_1
bad_104:
    buffer_load_dwordx4 v[32:35], v21, s[8:11], s32 offen offset:0 sc1
    s_sub_u32 s30, s30, 1
    s_cbranch_scc1 L_end
    s_branch q_75_15_1
q_75_15_1:
    s_waitcnt vmcnt(3)
    v_max3_u32 v8, v36, v37, v38
    v_max_u32 v8, v8, v39
    v_cmp_eq_u32 vcc, -1, v8
    v_mov_b32_dpp v52, v36 row_ror:8 row_mask:0xf bank_mask:0xf
    v_mov_b32_dpp v53, v37 row_ror:8 row_mask:0xf bank_mask:0xf
    v_mov_b32_dpp v54, v38 row_ror:8 row_mask:0xf bank_mask:0xf
    v_mov_b32_dpp v55, v39 row_ror:8 row_mask:0xf bank_mask:0xf
    s_cbranch_vccnz bad_105
    v_smfmac_f32_16x16x64_bf16 v[96:99], v[36:39], v[144:151], v20
    v_smfmac_f32_16x16x64_bf16 v[96:99], v[52:55], v[152:159], v1
    s_branch q_75_13_2
bad_105:
    buffer_load_dwordx4 v[36:39], v21, s[8:11], s32 offen offset:1024 sc1
    s_sub_u32 s30, s30, 1
    s_cbranch_scc1 L_end
    s_branch q_75_15_2
q_75_15_2:
    s_waitcnt vmcnt(3)
    v_max3_u32 v8, v40, v41, v42
    v_max_u32 v8, v8, v43
    v_cmp_eq_u32 vcc, -1, v8
    v_mov_b32_dpp v56, v40 row_ror:8 row_mask:0xf bank_mask:0xf
    v_mov_b32_dpp v57, v41 row_ror:8 row_mask:0xf bank_mask:0xf
    v_mov_b32_dpp v58, v42 row_ror:8 row_mask:0xf bank_mask:0xf
    v_mov_b32_dpp v59, v43 row_ror:8 row_mask:0xf bank_mask:0xf
    s_cbranch_vccnz bad_106
    v_smfmac_f32_16x16x64_bf16 v[96:99], v[40:43], v[160:167], v20
    v_smfmac_f32_16x16x64_bf16 v[96:99], v[56:59], v[168:175], v1
    s_branch q_75_11_3
bad_106:
    buffer_load_dwordx4 v[40:43], v21, s[8:11], s32 offen offset:2048 sc1
    s_sub_u32 s30, s30, 1
    s_cbranch_scc1 L_end
    s_branch q_75_15_3
q_75_15_3:
    s_waitcnt vmcnt(3)
    v_max3_u32 v8, v44, v45, v46
    v_max_u32 v8, v8, v47
    v_cmp_eq_u32 vcc, -1, v8
    v_mov_b32_dpp v60, v44 row_ror:8 row_mask:0xf bank_mask:0xf
    v_mov_b32_dpp v61, v45 row_ror:8 row_mask:0xf bank_mask:0xf
    v_mov_b32_dpp v62, v46 row_ror:8 row_mask:0xf bank_mask:0xf
    v_mov_b32_dpp v63, v47 row_ror:8 row_mask:0xf bank_mask:0xf
    s_cbranch_vccnz bad_107
    v_smfmac_f32_16x16x64_bf16 v[96:99], v[44:47], v[176:183], v20
    v_smfmac_f32_16x16x64_bf16 v[96:99], v[60:63], v[184:191], v1
    s_branch q_75_7_0
bad_107:
    buffer_load_dwordx4 v[44:47], v21, s[8:11], s32 offen offset:3072 sc1
    s_sub_u32 s30, s30, 1
    s_cbranch_scc1 L_end
    s_branch q_75_15_0
L_w4_first:
    s_barrier
    ds_read_b128 v[100:103], v7 offset:34816
    ds_read_b128 v[104:107], v7 offset:35840
    s_waitcnt lgkmcnt(0)
    s_branch L_w4_go
L_w4:
    ds_read_b128 v[100:103], v7 offset:34816
    ds_read_b128 v[104:107], v7 offset:35840
    s_waitcnt lgkmcnt(0)
.p2align 6
    s_nop 0
    s_nop 0
    s_nop 0
    s_nop 0
    s_nop 0
    s_barrier
L_w4_go:
    ds_read_b128 v[48:51], v28 offset:0
    ds_read_b128 v[52:55], v28 offset:64
    ds_read_b128 v[56:59], v28 offset:2304
    ds_read_b128 v[60:63], v28 offset:2368
    ds_read_b128 v[64:67], v28 offset:4608
    ds_read_b128 v[68:71], v28 offset:4672
    ds_read_b128 v[72:75], v28 offset:6912
    ds_read_b128 v[76:79], v28 offset:6976
    s_waitcnt lgkmcnt(4)
    v_pk_add_f32 v[48:49], v[48:49], v[56:57]
    v_pk_add_f32 v[50:51], v[50:51], v[58:59]
    v_pk_add_f32 v[52:53], v[52:53], v[60:61]
    v_pk_add_f32 v[54:55], v[54:55], v[62:63]
    s_waitcnt lgkmcnt(2)
    v_pk_add_f32 v[48:49], v[48:49], v[64:65]
    v_pk_add_f32 v[50:51], v[50:51], v[66:67]
    v_pk_add_f32 v[52:53], v[52:53], v[68:69]
    v_pk_add_f32 v[54:55], v[54:55], v[70:71]
    s_waitcnt lgkmcnt(0)
    v_pk_add_f32 v[48:49], v[48:49], v[72:73]
    v_pk_add_f32 v[50:51], v[50:51], v[74:75]
    v_pk_add_f32 v[52:53], v[52:53], v[76:77]
    v_pk_add_f32 v[54:55], v[54:55], v[78:79]
    v_cvt_pk_bf16_f32 v108, v48, v49
    v_cvt_pk_bf16_f32 v109, v50, v51
    v_cvt_pk_bf16_f32 v110, v52, v53
    v_cvt_pk_bf16_f32 v111, v54, v55
    s_nop 1
    v_mfma_f32_16x16x32_bf16 v[44:47], v[108:111], v[108:111], 0
    v_mfma_f32_16x16x32_bf16 v[40:43], v[104:107], v[108:111], 0
    v_mfma_f32_16x16x32_bf16 v[36:39], v[100:103], v[108:111], 0
    s_nop 4
    s_mov_b64 exec, s[62:63]
    buffer_store_dwordx4 v[44:47], v30, s[8:11], s31 offen
    s_mov_b64 exec, -1
    v_mov_b32_dpp v36, v40 row_ror:8 row_mask:0xf bank_mask:0xc
    v_mov_b32_dpp v37, v41 row_ror:8 row_mask:0xf bank_mask:0xc
    v_mov_b32_dpp v38, v42 row_ror:8 row_mask:0xf bank_mask:0xc
    v_mov_b32_dpp v39, v43 row_ror:8 row_mask:0xf bank_mask:0xc
    buffer_store_dwordx4 v[36:39], v29, s[8:11], s31 offen
    s_barrier
    s_cmp_lg_u32 s29, 63
    s_cbranch_scc1 L_vo_z
    s_mov_b64 exec, s[60:61]
    buffer_store_dwordx4 v[108:111], v31, s[8:11], s37 offen sc1
    s_mov_b64 exec, -1
    s_branch L_rec_done
L_w6:
    s_mov_b64 exec, s[60:61]
    ds_read_b128 v[100:103], v31 offset:0
    ds_read_b128 v[104:107], v31 offset:512
    ds_read_b128 v[108:111], v31 offset:1024
    ds_read_b128 v[112:115], v31 offset:1536
    s_mov_b64 exec, -1
    v_mov_b32 v84, 0
    v_mov_b32 v85, 0
    v_mov_b32 v86, 0
    v_mov_b32 v87, 0
    v_mov_b32 v88, 0
    v_mov_b32 v89, 0
    v_mov_b32 v90, 0
    v_mov_b32 v91, 0
    v_mov_b32 v92, 0
    v_mov_b32 v93, 0
    v_mov_b32 v94, 0
    v_mov_b32 v95, 0
    v_mov_b32 v96, 0
    v_mov_b32 v97, 0
    v_mov_b32 v98, 0
    v_mov_b32 v99, 0
    s_waitcnt lgkmcnt(0)
    s_cmp_lg_u32 s29, 0
    s_barrier
    s_cbranch_scc1 f6_108
    s_mov_b64 exec, s[60:61]
    ds_read_b128 v[100:103], v31 offset:0
    ds_read_b128 v[104:107], v31 offset:512
    ds_read_b128 v[108:111], v31 offset:1024
    ds_read_b128 v[112:115], v31 offset:1536
    s_mov_b64 exec, -1
    s_waitcnt lgkmcnt(0)
f6_108:
.p2align 6
    s_nop 0
    s_nop 0
    s_nop 0
    s_nop 0
    s_nop 0
    s_nop 0
    s_barrier
    s_cmp_eq_u32 s29, 63
    s_cbranch_scc1 L_rec_done
    ds_read_b128 v[52:55], v30 offset:0
    ds_read_b128 v[56:59], v30 offset:1024
    ds_read_b128 v[60:63], v30 offset:2048
    ds_read_b128 v[64:67], v30 offset:3072
    ds_read_b128 v[68:71], v30 offset:512
    ds_read_b128 v[72:75], v30 offset:1536
    ds_read_b128 v[76:79], v30 offset:2560
    ds_read_b128 v[80:83], v30 offset:3584
    s_nop 15
    s_nop 11
    buffer_load_dword v48, v29, s[8:11], s31 offen offset:0 sc1
    buffer_load_dword v49, v29, s[8:11], s31 offen offset:256 sc1
    buffer_load_dword v50, v29, s[8:11], s31 offen offset:512 sc1
    buffer_load_dword v51, v29, s[8:11], s31 offen offset:768 sc1
    buffer_load_dwordx4 v[32:35], v28, s[8:11], s31 offen offset:0 sc1
    buffer_load_dwordx4 v[36:39], v28, s[8:11], s31 offen offset:1024 sc1
    buffer_load_dwordx4 v[40:43], v28, s[8:11], s31 offen offset:2048 sc1
    buffer_load_dwordx4 v[44:47], v28, s[8:11], s31 offen offset:3072 sc1
    s_waitcnt lgkmcnt(0)
    v_pk_add_f32 v[52:53], v[52:53], v[56:57]
    v_pk_add_f32 v[60:61], v[60:61], v[64:65]
    v_pk_add_f32 v[54:55], v[54:55], v[58:59]
    v_pk_add_f32 v[62:63], v[62:63], v[66:67]
    v_pk_add_f32 v[52:53], v[52:53], v[60:61]
    v_pk_add_f32 v[54:55], v[54:55], v[62:63]
    v_pk_add_f32 v[68:69], v[68:69], v[72:73]
    v_pk_add_f32 v[76:77], v[76:77], v[80:81]
    v_pk_add_f32 v[70:71], v[70:71], v[74:75]
    v_pk_add_f32 v[78:79], v[78:79], v[82:83]
    v_pk_add_f32 v[68:69], v[68:69], v[76:77]
    v_pk_add_f32 v[70:71], v[70:71], v[78:79]
    s_mov_b64 exec, s[62:63]
    v_cvt_pk_bf16_f32 v100, v52, v53
    v_cvt_pk_bf16_f32 v104, v54, v55
    v_cvt_pk_bf16_f32 v108, v68, v69
    v_cvt_pk_bf16_f32 v112, v70, v71
    s_mov_b64 exec, -1
    s_nop 7
    buffer_load_dword v80, v29, s[8:11], s31 offen offset:0 sc1
    buffer_load_dword v81, v29, s[8:11], s31 offen offset:256 sc1
    buffer_load_dword v82, v29, s[8:11], s31 offen offset:512 sc1
    buffer_load_dword v83, v29, s[8:11], s31 offen offset:768 sc1
    buffer_load_dwordx4 v[64:67], v28, s[8:11], s31 offen offset:0 sc1
    buffer_load_dwordx4 v[68:71], v28, s[8:11], s31 offen offset:1024 sc1
    buffer_load_dwordx4 v[72:75], v28, s[8:11], s31 offen offset:2048 sc1
    buffer_load_dwordx4 v[76:79], v28, s[8:11], s31 offen offset:3072 sc1
L_a_wait0:
    s_waitcnt vmcnt(10)
    v_pk_add_f32 v[60:61], v[48:49], v[50:51]
    v_pk_add_f32 v[56:57], v[32:33], v[36:37]
    v_pk_add_f32 v[58:59], v[34:35], v[38:39]
    v_add_f32 v60, v60, v61
    s_waitcnt vmcnt(9)
    v_pk_add_f32 v[56:57], v[56:57], v[40:41]
    v_pk_add_f32 v[58:59], v[58:59], v[42:43]
    s_waitcnt vmcnt(8)
    v_pk_add_f32 v[56:57], v[56:57], v[44:45]
    v_pk_add_f32 v[58:59], v[58:59], v[46:47]
    v_maximum3_f32 v8, v56, v57, v60
    v_maximum3_f32 v8, v8, v58, v59
    v_cmp_u_f32 vcc, v8, v8
    s_nop 0
    v_max_f32_dpp v8, v8, v8 row_ror:8 row_mask:0xf bank_mask:0xf
    v_mov_b32 v9, v8
    s_nop 1
    v_permlane16_swap_b32 v8, v9
    s_cbranch_vccnz L_a_fail0
L_a_ok:
    v_max_f32 v8, v8, v9
    v_mov_b32 v9, v8
    s_nop 1
    v_permlane32_swap_b32 v8, v9
    v_max_f32 v8, v8, v9
    v_mul_f32 v8, s42, v8
    v_pk_fma_f32 v[56:57], v[56:57], v[14:15], v[8:9] op_sel_hi:[1,1,0] neg_lo:[0,0,1] neg_hi:[0,0,1]
    v_pk_fma_f32 v[58:59], v[58:59], v[14:15], v[8:9] op_sel_hi:[1,1,0] neg_lo:[0,0,1] neg_hi:[0,0,1]
    v_fma_f32 v60, v60, s42, -v8
    v_exp_f32 v56, v56
    v_exp_f32 v57, v57
    v_exp_f32 v58, v58
    v_exp_f32 v59, v59
    v_exp_f32 v60, v60
    v_cvt_pk_bf16_f32 v124, v56, v57
    v_cvt_pk_bf16_f32 v125, v58, v59
    v_cvt_pk_bf16_f32 v126, v60, 0
    s_nop 1
    v_smfmac_f32_16x16x64_bf16 v[84:87], v[124:127], v[116:123], v13
    v_smfmac_f32_16x16x64_bf16 v[88:91], v[124:127], v[100:107], v13
    v_smfmac_f32_16x16x64_bf16 v[92:95], v[124:127], v[108:115], v13
    s_nop 5
    v_permlane32_swap_b32 v84, v86
    v_permlane32_swap_b32 v85, v87
    v_pk_add_f32 v[84:85], v[84:85], v[86:87]
    v_rcp_f32 v84, v84
    v_rcp_f32 v85, v85
    v_permlane32_swap_b32 v88, v90
    v_permlane32_swap_b32 v89, v91
    v_pk_add_f32 v[88:89], v[88:89], v[90:91]
    v_pk_mul_f32 v[88:89], v[88:89], v[84:85]
    v_permlane32_swap_b32 v92, v94
    v_permlane32_swap_b32 v93, v95
    v_pk_add_f32 v[92:93], v[92:93], v[94:95]
    v_pk_mul_f32 v[92:93], v[92:93], v[84:85]
    v_cvt_pk_bf16_f32 v10, v88, v92
    v_cvt_pk_bf16_f32 v11, v89, v93
    v_min_u32 v10, s41, v10
    buffer_store_dword v10, v12, s[8:11], s32 offen
    v_min_u32 v11, s41, v11
    buffer_store_dword v11, v12, s[8:11], s32 offen offset:16
    s_barrier
    s_branch L_vo_b
L_a_fail0:
    s_sub_u32 s30, s30, 1
    s_cbranch_scc1 L_end
    s_and_b32 s38, s30, 7
    s_cbranch_scc1 L_a_re0
    v_max3_u32 v10, v32, v33, v34
    v_max3_u32 v10, v10, v35, v36
    v_max3_u32 v10, v10, v37, v38
    v_max3_u32 v10, v10, v39, v40
    v_max3_u32 v10, v10, v41, v42
    v_max3_u32 v10, v10, v43, v44
    v_max3_u32 v10, v10, v45, v46
    v_max3_u32 v10, v10, v47, v48
    v_max3_u32 v10, v10, v49, v50
    v_max_u32 v10, v10, v51
    v_cmp_eq_u32 vcc, -1, v10
    s_cbranch_vccz L_a_ok
L_a_re0:
    buffer_load_dword v48, v29, s[8:11], s31 offen offset:0 sc1
    buffer_load_dword v49, v29, s[8:11], s31 offen offset:256 sc1
    buffer_load_dword v50, v29, s[8:11], s31 offen offset:512 sc1
    buffer_load_dword v51, v29, s[8:11], s31 offen offset:768 sc1
    buffer_load_dwordx4 v[32:35], v28, s[8:11], s31 offen offset:0 sc1
    buffer_load_dwordx4 v[36:39], v28, s[8:11], s31 offen offset:1024 sc1
    buffer_load_dwordx4 v[40:43], v28, s[8:11], s31 offen offset:2048 sc1
    buffer_load_dwordx4 v[44:47], v28, s[8:11], s31 offen offset:3072 sc1
L_a_wait1:
    s_waitcnt vmcnt(10)
    v_pk_add_f32 v[60:61], v[80:81], v[82:83]
    v_pk_add_f32 v[56:57], v[64:65], v[68:69]
    v_pk_add_f32 v[58:59], v[66:67], v[70:71]
    v_add_f32 v60, v60, v61
    s_waitcnt vmcnt(9)
    v_pk_add_f32 v[56:57], v[56:57], v[72:73]
    v_pk_add_f32 v[58:59], v[58:59], v[74:75]
    s_waitcnt vmcnt(8)
    v_pk_add_f32 v[56:57], v[56:57], v[76:77]
    v_pk_add_f32 v[58:59], v[58:59], v[78:79]
    v_maximum3_f32 v8, v56, v57, v60
    v_maximum3_f32 v8, v8, v58, v59
    v_cmp_u_f32 vcc, v8, v8
    s_nop 0
    v_max_f32_dpp v8, v8, v8 row_ror:8 row_mask:0xf bank_mask:0xf
    v_mov_b32 v9, v8
    s_nop 1
    v_permlane16_swap_b32 v8, v9
    s_cbranch_vccnz L_a_fail1
    s_branch L_a_ok
L_a_fail1:
    s_sub_u32 s30, s30, 1
    s_cbranch_scc1 L_end
    s_and_b32 s38, s30, 7
    s_cbranch_scc1 L_a_re1
    v_max3_u32 v10, v64, v65, v66
    v_max3_u32 v10, v10, v67, v68
    v_max3_u32 v10, v10, v69, v70
    v_max3_u32 v10, v10, v71, v72
    v_max3_u32 v10, v10, v73, v74
    v_max3_u32 v10, v10, v75, v76
    v_max3_u32 v10, v10, v77, v78
    v_max3_u32 v10, v10, v79, v80
    v_max3_u32 v10, v10, v81, v82
    v_max_u32 v10, v10, v83
    v_cmp_eq_u32 vcc, -1, v10
    s_cbranch_vccz L_a_ok
L_a_re1:
    buffer_load_dword v80, v29, s[8:11], s31 offen offset:0 sc1
    buffer_load_dword v81, v29, s[8:11], s31 offen offset:256 sc1
    buffer_load_dword v82, v29, s[8:11], s31 offen offset:512 sc1
    buffer_load_dword v83, v29, s[8:11], s31 offen offset:768 sc1
    buffer_load_dwordx4 v[64:67], v28, s[8:11], s31 offen offset:0 sc1
    buffer_load_dwordx4 v[68:71], v28, s[8:11], s31 offen offset:1024 sc1
    buffer_load_dwordx4 v[72:75], v28, s[8:11], s31 offen offset:2048 sc1
    buffer_load_dwordx4 v[76:79], v28, s[8:11], s31 offen offset:3072 sc1
    s_branch L_a_wait0
L_rec_done:
    s_setprio 0
    s_waitcnt vmcnt(0) lgkmcnt(0)
    s_barrier
    s_cmp_lg_u32 s26, 0
    s_cbranch_scc1 fs_109
    s_mov_b32 s38, 64
    s_lshl_b32 s39, s24, 5
    s_add_u32 s39, s39, s25
    s_lshl_b32 s39, s39, 14
    s_add_u32 s39, s39, s43
    s_add_u32 s39, s39, 75501568
    v_mov_b32 v8, s39
    v_mov_b32 v9, s38
    s_mov_b64 exec, 1
    buffer_store_dword v9, v8, s[8:11], 0 offen sc1
    s_mov_b64 exec, -1
fs_109:
    v_lshlrev_b32 v7, 4, v2
    s_cmp_lt_u32 s26, 4
    s_cbranch_scc1 L_rt_qk
    v_swap_b32 v129, v137
    v_swap_b32 v131, v139
    v_swap_b32 v133, v141
    v_swap_b32 v135, v143
    v_swap_b32 v145, v153
    v_swap_b32 v147, v155
    v_swap_b32 v149, v157
    v_swap_b32 v151, v159
    v_swap_b32 v161, v169
    v_swap_b32 v163, v171
    v_swap_b32 v165, v173
    v_swap_b32 v167, v175
    v_swap_b32 v177, v185
    v_swap_b32 v179, v187
    v_swap_b32 v181, v189
    v_swap_b32 v183, v191
    s_lshl_b32 s38, s24, 16
    s_lshl_b32 s39, s47, 14
    s_add_u32 s31, s38, s39
    s_add_u32 s31, s31, 231735296
    s_xor_b32 s3, s43, 0
    s_add_u32 s31, s31, s3
    s_xor_b32 s32, s31, 8192
    s_lshl_b32 s38, s47, 12
    v_add_u32 v8, s38, v7
    s_lshl_b32 s38, s24, 2
    s_add_u32 s38, s38, 79715584
    v_and_b32 v9, 1, v2
    v_lshlrev_b32 v9, 7, v9
    v_add_u32 v9, s38, v9
poll_110:
    s_sub_u32 s30, s30, 1
    s_cbranch_scc1 L_end
    buffer_load_dword v11, v9, s[8:11], 0 offen offset:0 sc1
    s_waitcnt vmcnt(0)
    v_cmp_gt_u32 vcc, 8, v11
    s_cbranch_vccnz poll_110
    s_add_u32 s38, s31, 0
    buffer_load_dwordx4 v[32:35], v7, s[8:11], s38 offen offset:0 sc1
    buffer_load_dwordx4 v[36:39], v7, s[8:11], s38 offen offset:1024 sc1
    buffer_load_dwordx4 v[40:43], v7, s[8:11], s38 offen offset:2048 sc1
    buffer_load_dwordx4 v[44:47], v7, s[8:11], s38 offen offset:3072 sc1
    s_add_u32 s38, s31, 4096
    buffer_load_dwordx4 v[48:51], v7, s[8:11], s38 offen offset:0 sc1
    buffer_load_dwordx4 v[52:55], v7, s[8:11], s38 offen offset:1024 sc1
    buffer_load_dwordx4 v[56:59], v7, s[8:11], s38 offen offset:2048 sc1
    buffer_load_dwordx4 v[60:63], v7, s[8:11], s38 offen offset:3072 sc1
    s_add_u32 s38, s31, 262144
    buffer_load_dwordx4 v[64:67], v7, s[8:11], s38 offen offset:0 sc1
    buffer_load_dwordx4 v[68:71], v7, s[8:11], s38 offen offset:1024 sc1
    buffer_load_dwordx4 v[72:75], v7, s[8:11], s38 offen offset:2048 sc1
    buffer_load_dwordx4 v[76:79], v7, s[8:11], s38 offen offset:3072 sc1
    s_add_u32 s38, s31, 266240
    buffer_load_dwordx4 v[80:83], v7, s[8:11], s38 offen offset:0 sc1
    buffer_load_dwordx4 v[84:87], v7, s[8:11], s38 offen offset:1024 sc1
    buffer_load_dwordx4 v[88:91], v7, s[8:11], s38 offen offset:2048 sc1
    buffer_load_dwordx4 v[92:95], v7, s[8:11], s38 offen offset:3072 sc1
    s_waitcnt vmcnt(15)
    v_mfma_f32_16x16x32_bf16 v[96:99], v[128:131], v[32:35], 0
    v_mfma_f32_16x16x32_bf16 v[100:103], v[136:139], v[32:35], 0
    s_add_u32 s38, s31, 524288
    buffer_load_dwordx4 v[192:195], v7, s[8:11], s38 offen offset:0 sc1
    s_waitcnt vmcnt(15)
    v_mfma_f32_16x16x32_bf16 v[96:99], v[132:135], v[36:39], v[96:99]
    v_mfma_f32_16x16x32_bf16 v[100:103], v[140:143], v[36:39], v[100:103]
    buffer_load_dwordx4 v[196:199], v7, s[8:11], s38 offen offset:1024 sc1
    s_waitcnt vmcnt(15)
    v_mfma_f32_16x16x32_bf16 v[96:99], v[144:147], v[40:43], v[96:99]
    v_mfma_f32_16x16x32_bf16 v[100:103], v[152:155], v[40:43], v[100:103]
    buffer_load_dwordx4 v[200:203], v7, s[8:11], s38 offen offset:2048 sc1
    s_waitcnt vmcnt(15)
    v_mfma_f32_16x16x32_bf16 v[96:99], v[148:151], v[44:47], v[96:99]
    v_mfma_f32_16x16x32_bf16 v[100:103], v[156:159], v[44:47], v[100:103]
    buffer_load_dwordx4 v[204:207], v7, s[8:11], s38 offen offset:3072 sc1
    s_waitcnt vmcnt(15)
    v_mfma_f32_16x16x32_bf16 v[96:99], v[160:163], v[48:51], v[96:99]
    v_mfma_f32_16x16x32_bf16 v[100:103], v[168:171], v[48:51], v[100:103]
    s_add_u32 s38, s31, 528384
    buffer_load_dwordx4 v[208:211], v7, s[8:11], s38 offen offset:0 sc1
    s_waitcnt vmcnt(15)
    v_mfma_f32_16x16x32_bf16 v[96:99], v[164:167], v[52:55], v[96:99]
    v_mfma_f32_16x16x32_bf16 v[100:103], v[172:175], v[52:55], v[100:103]
    buffer_load_dwordx4 v[212:215], v7, s[8:11], s38 offen offset:1024 sc1
    s_waitcnt vmcnt(15)
    v_mfma_f32_16x16x32_bf16 v[96:99], v[176:179], v[56:59], v[96:99]
    v_mfma_f32_16x16x32_bf16 v[100:103], v[184:187], v[56:59], v[100:103]
    buffer_load_dwordx4 v[216:219], v7, s[8:11], s38 offen offset:2048 sc1
    s_waitcnt vmcnt(15)
    v_mfma_f32_16x16x32_bf16 v[96:99], v[180:183], v[60:63], v[96:99]
    v_mfma_f32_16x16x32_bf16 v[100:103], v[188:191], v[60:63], v[100:103]
    buffer_load_dwordx4 v[220:223], v7, s[8:11], s38 offen offset:3072 sc1
    s_waitcnt vmcnt(15)
    v_mfma_f32_16x16x32_bf16 v[104:107], v[128:131], v[64:67], 0
    v_mfma_f32_16x16x32_bf16 v[108:111], v[136:139], v[64:67], 0
    s_add_u32 s38, s31, 786432
    buffer_load_dwordx4 v[224:227], v7, s[8:11], s38 offen offset:0 sc1
    s_waitcnt vmcnt(15)
    v_mfma_f32_16x16x32_bf16 v[104:107], v[132:135], v[68:71], v[104:107]
    v_mfma_f32_16x16x32_bf16 v[108:111], v[140:143], v[68:71], v[108:111]
    buffer_load_dwordx4 v[228:231], v7, s[8:11], s38 offen offset:1024 sc1
    s_waitcnt vmcnt(15)
    v_mfma_f32_16x16x32_bf16 v[104:107], v[144:147], v[72:75], v[104:107]
    v_mfma_f32_16x16x32_bf16 v[108:111], v[152:155], v[72:75], v[108:111]
    buffer_load_dwordx4 v[232:235], v7, s[8:11], s38 offen offset:2048 sc1
    s_waitcnt vmcnt(15)
    v_mfma_f32_16x16x32_bf16 v[104:107], v[148:151], v[76:79], v[104:107]
    v_mfma_f32_16x16x32_bf16 v[108:111], v[156:159], v[76:79], v[108:111]
    buffer_load_dwordx4 v[236:239], v7, s[8:11], s38 offen offset:3072 sc1
    s_waitcnt vmcnt(15)
    v_mfma_f32_16x16x32_bf16 v[104:107], v[160:163], v[80:83], v[104:107]
    v_mfma_f32_16x16x32_bf16 v[108:111], v[168:171], v[80:83], v[108:111]
    s_add_u32 s38, s31, 790528
    buffer_load_dwordx4 v[240:243], v7, s[8:11], s38 offen offset:0 sc1
    s_waitcnt vmcnt(15)
    v_mfma_f32_16x16x32_bf16 v[104:107], v[164:167], v[84:87], v[104:107]
    v_mfma_f32_16x16x32_bf16 v[108:111], v[172:175], v[84:87], v[108:111]
    buffer_load_dwordx4 v[244:247], v7, s[8:11], s38 offen offset:1024 sc1
    s_waitcnt vmcnt(15)
    v_mfma_f32_16x16x32_bf16 v[104:107], v[176:179], v[88:91], v[104:107]
    v_mfma_f32_16x16x32_bf16 v[108:111], v[184:187], v[88:91], v[108:111]
    buffer_load_dwordx4 v[248:251], v7, s[8:11], s38 offen offset:2048 sc1
    s_waitcnt vmcnt(15)
    v_mfma_f32_16x16x32_bf16 v[104:107], v[180:183], v[92:95], v[104:107]
    v_mfma_f32_16x16x32_bf16 v[108:111], v[188:191], v[92:95], v[108:111]
    buffer_load_dwordx4 v[252:255], v7, s[8:11], s38 offen offset:3072 sc1
    s_nop 5
    ds_write_b128 v8, v[96:99] offset:0
    ds_write_b128 v8, v[100:103] offset:1024
    ds_write_b128 v8, v[104:107] offset:2048
    ds_write_b128 v8, v[108:111] offset:3072
    s_waitcnt lgkmcnt(0)
    s_barrier
    s_waitcnt vmcnt(15)
    v_mfma_f32_16x16x32_bf16 v[96:99], v[128:131], v[192:195], 0
    v_mfma_f32_16x16x32_bf16 v[100:103], v[136:139], v[192:195], 0
    s_add_u32 s38, s32, 1048576
    buffer_load_dwordx4 v[32:35], v7, s[8:11], s38 offen offset:0 sc1
    s_waitcnt vmcnt(15)
    v_mfma_f32_16x16x32_bf16 v[96:99], v[132:135], v[196:199], v[96:99]
    v_mfma_f32_16x16x32_bf16 v[100:103], v[140:143], v[196:199], v[100:103]
    buffer_load_dwordx4 v[36:39], v7, s[8:11], s38 offen offset:1024 sc1
    s_waitcnt vmcnt(15)
    v_mfma_f32_16x16x32_bf16 v[96:99], v[144:147], v[200:203], v[96:99]
    v_mfma_f32_16x16x32_bf16 v[100:103], v[152:155], v[200:203], v[100:103]
    buffer_load_dwordx4 v[40:43], v7, s[8:11], s38 offen offset:2048 sc1
    s_waitcnt vmcnt(15)
    v_mfma_f32_16x16x32_bf16 v[96:99], v[148:151], v[204:207], v[96:99]
    v_mfma_f32_16x16x32_bf16 v[100:103], v[156:159], v[204:207], v[100:103]
    buffer_load_dwordx4 v[44:47], v7, s[8:11], s38 offen offset:3072 sc1
    s_waitcnt vmcnt(15)
    v_mfma_f32_16x16x32_bf16 v[96:99], v[160:163], v[208:211], v[96:99]
    v_mfma_f32_16x16x32_bf16 v[100:103], v[168:171], v[208:211], v[100:103]
    s_add_u32 s38, s32, 1052672
    buffer_load_dwordx4 v[48:51], v7, s[8:11], s38 offen offset:0 sc1
    s_waitcnt vmcnt(15)
    v_mfma_f32_16x16x32_bf16 v[96:99], v[164:167], v[212:215], v[96:99]
    v_mfma_f32_16x16x32_bf16 v[100:103], v[172:175], v[212:215], v[100:103]
    buffer_load_dwordx4 v[52:55], v7, s[8:11], s38 offen offset:1024 sc1
    s_waitcnt vmcnt(15)
    v_mfma_f32_16x16x32_bf16 v[96:99], v[176:179], v[216:219], v[96:99]
    v_mfma_f32_16x16x32_bf16 v[100:103], v[184:187], v[216:219], v[100:103]
    buffer_load_dwordx4 v[56:59], v7, s[8:11], s38 offen offset:2048 sc1
    s_waitcnt vmcnt(15)
    v_mfma_f32_16x16x32_bf16 v[96:99], v[180:183], v[220:223], v[96:99]
    v_mfma_f32_16x16x32_bf16 v[100:103], v[188:191], v[220:223], v[100:103]
    buffer_load_dwordx4 v[60:63], v7, s[8:11], s38 offen offset:3072 sc1
    s_waitcnt vmcnt(15)
    v_mfma_f32_16x16x32_bf16 v[104:107], v[128:131], v[224:227], 0
    v_mfma_f32_16x16x32_bf16 v[108:111], v[136:139], v[224:227], 0
    s_add_u32 s38, s32, 1310720
    buffer_load_dwordx4 v[64:67], v7, s[8:11], s38 offen offset:0 sc1
    s_waitcnt vmcnt(15)
    v_mfma_f32_16x16x32_bf16 v[104:107], v[132:135], v[228:231], v[104:107]
    v_mfma_f32_16x16x32_bf16 v[108:111], v[140:143], v[228:231], v[108:111]
    buffer_load_dwordx4 v[68:71], v7, s[8:11], s38 offen offset:1024 sc1
    s_waitcnt vmcnt(15)
    v_mfma_f32_16x16x32_bf16 v[104:107], v[144:147], v[232:235], v[104:107]
    v_mfma_f32_16x16x32_bf16 v[108:111], v[152:155], v[232:235], v[108:111]
    buffer_load_dwordx4 v[72:75], v7, s[8:11], s38 offen offset:2048 sc1
    s_waitcnt vmcnt(15)
    v_mfma_f32_16x16x32_bf16 v[104:107], v[148:151], v[236:239], v[104:107]
    v_mfma_f32_16x16x32_bf16 v[108:111], v[156:159], v[236:239], v[108:111]
    buffer_load_dwordx4 v[76:79], v7, s[8:11], s38 offen offset:3072 sc1
    s_waitcnt vmcnt(15)
    v_mfma_f32_16x16x32_bf16 v[104:107], v[160:163], v[240:243], v[104:107]
    v_mfma_f32_16x16x32_bf16 v[108:111], v[168:171], v[240:243], v[108:111]
    s_add_u32 s38, s32, 1314816
    buffer_load_dwordx4 v[80:83], v7, s[8:11], s38 offen offset:0 sc1
    s_waitcnt vmcnt(15)
    v_mfma_f32_16x16x32_bf16 v[104:107], v[164:167], v[244:247], v[104:107]
    v_mfma_f32_16x16x32_bf16 v[108:111], v[172:175], v[244:247], v[108:111]
    buffer_load_dwordx4 v[84:87], v7, s[8:11], s38 offen offset:1024 sc1
    s_waitcnt vmcnt(15)
    v_mfma_f32_16x16x32_bf16 v[104:107], v[176:179], v[248:251], v[104:107]
    v_mfma_f32_16x16x32_bf16 v[108:111], v[184:187], v[248:251], v[108:111]
    buffer_load_dwordx4 v[88:91], v7, s[8:11], s38 offen offset:2048 sc1
    s_waitcnt vmcnt(15)
    v_mfma_f32_16x16x32_bf16 v[104:107], v[180:183], v[252:255], v[104:107]
    v_mfma_f32_16x16x32_bf16 v[108:111], v[188:191], v[252:255], v[108:111]
    buffer_load_dwordx4 v[92:95], v7, s[8:11], s38 offen offset:3072 sc1
    s_nop 5
    ds_write_b128 v8, v[96:99] offset:16384
    ds_write_b128 v8, v[100:103] offset:17408
    ds_write_b128 v8, v[104:107] offset:18432
    ds_write_b128 v8, v[108:111] offset:19456
    s_waitcnt lgkmcnt(0)
    s_barrier
    s_waitcnt vmcnt(15)
    v_mfma_f32_16x16x32_bf16 v[96:99], v[128:131], v[32:35], 0
    v_mfma_f32_16x16x32_bf16 v[100:103], v[136:139], v[32:35], 0
    s_add_u32 s38, s32, 1572864
    buffer_load_dwordx4 v[192:195], v7, s[8:11], s38 offen offset:0 sc1
    s_waitcnt vmcnt(15)
    v_mfma_f32_16x16x32_bf16 v[96:99], v[132:135], v[36:39], v[96:99]
    v_mfma_f32_16x16x32_bf16 v[100:103], v[140:143], v[36:39], v[100:103]
    buffer_load_dwordx4 v[196:199], v7, s[8:11], s38 offen offset:1024 sc1
    s_waitcnt vmcnt(15)
    v_mfma_f32_16x16x32_bf16 v[96:99], v[144:147], v[40:43], v[96:99]
    v_mfma_f32_16x16x32_bf16 v[100:103], v[152:155], v[40:43], v[100:103]
    buffer_load_dwordx4 v[200:203], v7, s[8:11], s38 offen offset:2048 sc1
    s_waitcnt vmcnt(15)
    v_mfma_f32_16x16x32_bf16 v[96:99], v[148:151], v[44:47], v[96:99]
    v_mfma_f32_16x16x32_bf16 v[100:103], v[156:159], v[44:47], v[100:103]
    buffer_load_dwordx4 v[204:207], v7, s[8:11], s38 offen offset:3072 sc1
    s_waitcnt vmcnt(15)
    v_mfma_f32_16x16x32_bf16 v[96:99], v[160:163], v[48:51], v[96:99]
    v_mfma_f32_16x16x32_bf16 v[100:103], v[168:171], v[48:51], v[100:103]
    s_add_u32 s38, s32, 1576960
    buffer_load_dwordx4 v[208:211], v7, s[8:11], s38 offen offset:0 sc1
    s_waitcnt vmcnt(15)
    v_mfma_f32_16x16x32_bf16 v[96:99], v[164:167], v[52:55], v[96:99]
    v_mfma_f32_16x16x32_bf16 v[100:103], v[172:175], v[52:55], v[100:103]
    buffer_load_dwordx4 v[212:215], v7, s[8:11], s38 offen offset:1024 sc1
    s_waitcnt vmcnt(15)
    v_mfma_f32_16x16x32_bf16 v[96:99], v[176:179], v[56:59], v[96:99]
    v_mfma_f32_16x16x32_bf16 v[100:103], v[184:187], v[56:59], v[100:103]
    buffer_load_dwordx4 v[216:219], v7, s[8:11], s38 offen offset:2048 sc1
    s_waitcnt vmcnt(15)
    v_mfma_f32_16x16x32_bf16 v[96:99], v[180:183], v[60:63], v[96:99]
    v_mfma_f32_16x16x32_bf16 v[100:103], v[188:191], v[60:63], v[100:103]
    buffer_load_dwordx4 v[220:223], v7, s[8:11], s38 offen offset:3072 sc1
    s_waitcnt vmcnt(15)
    v_mfma_f32_16x16x32_bf16 v[104:107], v[128:131], v[64:67], 0
    v_mfma_f32_16x16x32_bf16 v[108:111], v[136:139], v[64:67], 0
    s_add_u32 s38, s32, 1835008
    buffer_load_dwordx4 v[224:227], v7, s[8:11], s38 offen offset:0 sc1
    s_waitcnt vmcnt(15)
    v_mfma_f32_16x16x32_bf16 v[104:107], v[132:135], v[68:71], v[104:107]
    v_mfma_f32_16x16x32_bf16 v[108:111], v[140:143], v[68:71], v[108:111]
    buffer_load_dwordx4 v[228:231], v7, s[8:11], s38 offen offset:1024 sc1
    s_waitcnt vmcnt(15)
    v_mfma_f32_16x16x32_bf16 v[104:107], v[144:147], v[72:75], v[104:107]
    v_mfma_f32_16x16x32_bf16 v[108:111], v[152:155], v[72:75], v[108:111]
    buffer_load_dwordx4 v[232:235], v7, s[8:11], s38 offen offset:2048 sc1
    s_waitcnt vmcnt(15)
    v_mfma_f32_16x16x32_bf16 v[104:107], v[148:151], v[76:79], v[104:107]
    v_mfma_f32_16x16x32_bf16 v[108:111], v[156:159], v[76:79], v[108:111]
    buffer_load_dwordx4 v[236:239], v7, s[8:11], s38 offen offset:3072 sc1
    s_waitcnt vmcnt(15)
    v_mfma_f32_16x16x32_bf16 v[104:107], v[160:163], v[80:83], v[104:107]
    v_mfma_f32_16x16x32_bf16 v[108:111], v[168:171], v[80:83], v[108:111]
    s_add_u32 s38, s32, 1839104
    buffer_load_dwordx4 v[240:243], v7, s[8:11], s38 offen offset:0 sc1
    s_waitcnt vmcnt(15)
    v_mfma_f32_16x16x32_bf16 v[104:107], v[164:167], v[84:87], v[104:107]
    v_mfma_f32_16x16x32_bf16 v[108:111], v[172:175], v[84:87], v[108:111]
    buffer_load_dwordx4 v[244:247], v7, s[8:11], s38 offen offset:1024 sc1
    s_waitcnt vmcnt(15)
    v_mfma_f32_16x16x32_bf16 v[104:107], v[176:179], v[88:91], v[104:107]
    v_mfma_f32_16x16x32_bf16 v[108:111], v[184:187], v[88:91], v[108:111]
    buffer_load_dwordx4 v[248:251], v7, s[8:11], s38 offen offset:2048 sc1
    s_waitcnt vmcnt(15)
    v_mfma_f32_16x16x32_bf16 v[104:107], v[180:183], v[92:95], v[104:107]
    v_mfma_f32_16x16x32_bf16 v[108:111], v[188:191], v[92:95], v[108:111]
    buffer_load_dwordx4 v[252:255], v7, s[8:11], s38 offen offset:3072 sc1
    s_nop 5
    ds_write_b128 v8, v[96:99] offset:0
    ds_write_b128 v8, v[100:103] offset:1024
    ds_write_b128 v8, v[104:107] offset:2048
    ds_write_b128 v8, v[108:111] offset:3072
    s_waitcnt lgkmcnt(0)
    s_barrier
    s_waitcnt vmcnt(15)
    v_mfma_f32_16x16x32_bf16 v[96:99], v[128:131], v[192:195], 0
    v_mfma_f32_16x16x32_bf16 v[100:103], v[136:139], v[192:195], 0
    s_waitcnt vmcnt(14)
    v_mfma_f32_16x16x32_bf16 v[96:99], v[132:135], v[196:199], v[96:99]
    v_mfma_f32_16x16x32_bf16 v[100:103], v[140:143], v[196:199], v[100:103]
    s_waitcnt vmcnt(13)
    v_mfma_f32_16x16x32_bf16 v[96:99], v[144:147], v[200:203], v[96:99]
    v_mfma_f32_16x16x32_bf16 v[100:103], v[152:155], v[200:203], v[100:103]
    s_waitcnt vmcnt(12)
    v_mfma_f32_16x16x32_bf16 v[96:99], v[148:151], v[204:207], v[96:99]
    v_mfma_f32_16x16x32_bf16 v[100:103], v[156:159], v[204:207], v[100:103]
    s_waitcnt vmcnt(11)
    v_mfma_f32_16x16x32_bf16 v[96:99], v[160:163], v[208:211], v[96:99]
    v_mfma_f32_16x16x32_bf16 v[100:103], v[168:171], v[208:211], v[100:103]
    s_waitcnt vmcnt(10)
    v_mfma_f32_16x16x32_bf16 v[96:99], v[164:167], v[212:215], v[96:99]
    v_mfma_f32_16x16x32_bf16 v[100:103], v[172:175], v[212:215], v[100:103]
    s_waitcnt vmcnt(9)
    v_mfma_f32_16x16x32_bf16 v[96:99], v[176:179], v[216:219], v[96:99]
    v_mfma_f32_16x16x32_bf16 v[100:103], v[184:187], v[216:219], v[100:103]
    s_waitcnt vmcnt(8)
    v_mfma_f32_16x16x32_bf16 v[96:99], v[180:183], v[220:223], v[96:99]
    v_mfma_f32_16x16x32_bf16 v[100:103], v[188:191], v[220:223], v[100:103]
    s_waitcnt vmcnt(7)
    v_mfma_f32_16x16x32_bf16 v[104:107], v[128:131], v[224:227], 0
    v_mfma_f32_16x16x32_bf16 v[108:111], v[136:139], v[224:227], 0
    s_waitcnt vmcnt(6)
    v_mfma_f32_16x16x32_bf16 v[104:107], v[132:135], v[228:231], v[104:107]
    v_mfma_f32_16x16x32_bf16 v[108:111], v[140:143], v[228:231], v[108:111]
    s_waitcnt vmcnt(5)
    v_mfma_f32_16x16x32_bf16 v[104:107], v[144:147], v[232:235], v[104:107]
    v_mfma_f32_16x16x32_bf16 v[108:111], v[152:155], v[232:235], v[108:111]
    s_waitcnt vmcnt(4)
    v_mfma_f32_16x16x32_bf16 v[104:107], v[148:151], v[236:239], v[104:107]
    v_mfma_f32_16x16x32_bf16 v[108:111], v[156:159], v[236:239], v[108:111]
    s_waitcnt vmcnt(3)
    v_mfma_f32_16x16x32_bf16 v[104:107], v[160:163], v[240:243], v[104:107]
    v_mfma_f32_16x16x32_bf16 v[108:111], v[168:171], v[240:243], v[108:111]
    s_waitcnt vmcnt(2)
    v_mfma_f32_16x16x32_bf16 v[104:107], v[164:167], v[244:247], v[104:107]
    v_mfma_f32_16x16x32_bf16 v[108:111], v[172:175], v[244:247], v[108:111]
    s_waitcnt vmcnt(1)
    v_mfma_f32_16x16x32_bf16 v[104:107], v[176:179], v[248:251], v[104:107]
    v_mfma_f32_16x16x32_bf16 v[108:111], v[184:187], v[248:251], v[108:111]
    s_waitcnt vmcnt(0)
    v_mfma_f32_16x16x32_bf16 v[104:107], v[180:183], v[252:255], v[104:107]
    v_mfma_f32_16x16x32_bf16 v[108:111], v[188:191], v[252:255], v[108:111]
    s_nop 5
    ds_write_b128 v8, v[96:99] offset:16384
    ds_write_b128 v8, v[100:103] offset:17408
    ds_write_b128 v8, v[104:107] offset:18432
    ds_write_b128 v8, v[108:111] offset:19456
    s_waitcnt lgkmcnt(0)
    s_barrier
    s_add_u32 s38, s32, 2097152
    buffer_load_dwordx4 v[32:35], v7, s[8:11], s38 offen offset:0 sc1
    buffer_load_dwordx4 v[36:39], v7, s[8:11], s38 offen offset:1024 sc1
    buffer_load_dwordx4 v[40:43], v7, s[8:11], s38 offen offset:2048 sc1
    buffer_load_dwordx4 v[44:47], v7, s[8:11], s38 offen offset:3072 sc1
    s_add_u32 s38, s32, 2101248
    buffer_load_dwordx4 v[48:51], v7, s[8:11], s38 offen offset:0 sc1
    buffer_load_dwordx4 v[52:55], v7, s[8:11], s38 offen offset:1024 sc1
    buffer_load_dwordx4 v[56:59], v7, s[8:11], s38 offen offset:2048 sc1
    buffer_load_dwordx4 v[60:63], v7, s[8:11], s38 offen offset:3072 sc1
    s_add_u32 s38, s32, 2359296
    buffer_load_dwordx4 v[64:67], v7, s[8:11], s38 offen offset:0 sc1
    buffer_load_dwordx4 v[68:71], v7, s[8:11], s38 offen offset:1024 sc1
    buffer_load_dwordx4 v[72:75], v7, s[8:11], s38 offen offset:2048 sc1
    buffer_load_dwordx4 v[76:79], v7, s[8:11], s38 offen offset:3072 sc1
    s_add_u32 s38, s32, 2363392
    buffer_load_dwordx4 v[80:83], v7, s[8:11], s38 offen offset:0 sc1
    buffer_load_dwordx4 v[84:87], v7, s[8:11], s38 offen offset:1024 sc1
    buffer_load_dwordx4 v[88:91], v7, s[8:11], s38 offen offset:2048 sc1
    buffer_load_dwordx4 v[92:95], v7, s[8:11], s38 offen offset:3072 sc1
    s_waitcnt vmcnt(15)
    v_mfma_f32_16x16x32_bf16 v[96:99], v[128:131], v[32:35], 0
    v_mfma_f32_16x16x32_bf16 v[100:103], v[136:139], v[32:35], 0
    s_add_u32 s38, s32, 2621440
    buffer_load_dwordx4 v[192:195], v7, s[8:11], s38 offen offset:0 sc1
    s_waitcnt vmcnt(15)
    v_mfma_f32_16x16x32_bf16 v[96:99], v[132:135], v[36:39], v[96:99]
    v_mfma_f32_16x16x32_bf16 v[100:103], v[140:143], v[36:39], v[100:103]
    buffer_load_dwordx4 v[196:199], v7, s[8:11], s38 offen offset:1024 sc1
    s_waitcnt vmcnt(15)
    v_mfma_f32_16x16x32_bf16 v[96:99], v[144:147], v[40:43], v[96:99]
    v_mfma_f32_16x16x32_bf16 v[100:103], v[152:155], v[40:43], v[100:103]
    buffer_load_dwordx4 v[200:203], v7, s[8:11], s38 offen offset:2048 sc1
    s_waitcnt vmcnt(15)
    v_mfma_f32_16x16x32_bf16 v[96:99], v[148:151], v[44:47], v[96:99]
    v_mfma_f32_16x16x32_bf16 v[100:103], v[156:159], v[44:47], v[100:103]
    buffer_load_dwordx4 v[204:207], v7, s[8:11], s38 offen offset:3072 sc1
    s_waitcnt vmcnt(15)
    v_mfma_f32_16x16x32_bf16 v[96:99], v[160:163], v[48:51], v[96:99]
    v_mfma_f32_16x16x32_bf16 v[100:103], v[168:171], v[48:51], v[100:103]
    s_add_u32 s38, s32, 2625536
    buffer_load_dwordx4 v[208:211], v7, s[8:11], s38 offen offset:0 sc1
    s_waitcnt vmcnt(15)
    v_mfma_f32_16x16x32_bf16 v[96:99], v[164:167], v[52:55], v[96:99]
    v_mfma_f32_16x16x32_bf16 v[100:103], v[172:175], v[52:55], v[100:103]
    buffer_load_dwordx4 v[212:215], v7, s[8:11], s38 offen offset:1024 sc1
    s_waitcnt vmcnt(15)
    v_mfma_f32_16x16x32_bf16 v[96:99], v[176:179], v[56:59], v[96:99]
    v_mfma_f32_16x16x32_bf16 v[100:103], v[184:187], v[56:59], v[100:103]
    buffer_load_dwordx4 v[216:219], v7, s[8:11], s38 offen offset:2048 sc1
    s_waitcnt vmcnt(15)
    v_mfma_f32_16x16x32_bf16 v[96:99], v[180:183], v[60:63], v[96:99]
    v_mfma_f32_16x16x32_bf16 v[100:103], v[188:191], v[60:63], v[100:103]
    buffer_load_dwordx4 v[220:223], v7, s[8:11], s38 offen offset:3072 sc1
    s_waitcnt vmcnt(15)
    v_mfma_f32_16x16x32_bf16 v[104:107], v[128:131], v[64:67], 0
    v_mfma_f32_16x16x32_bf16 v[108:111], v[136:139], v[64:67], 0
    s_add_u32 s38, s32, 2883584
    buffer_load_dwordx4 v[224:227], v7, s[8:11], s38 offen offset:0 sc1
    s_waitcnt vmcnt(15)
    v_mfma_f32_16x16x32_bf16 v[104:107], v[132:135], v[68:71], v[104:107]
    v_mfma_f32_16x16x32_bf16 v[108:111], v[140:143], v[68:71], v[108:111]
    buffer_load_dwordx4 v[228:231], v7, s[8:11], s38 offen offset:1024 sc1
    s_waitcnt vmcnt(15)
    v_mfma_f32_16x16x32_bf16 v[104:107], v[144:147], v[72:75], v[104:107]
    v_mfma_f32_16x16x32_bf16 v[108:111], v[152:155], v[72:75], v[108:111]
    buffer_load_dwordx4 v[232:235], v7, s[8:11], s38 offen offset:2048 sc1
    s_waitcnt vmcnt(15)
    v_mfma_f32_16x16x32_bf16 v[104:107], v[148:151], v[76:79], v[104:107]
    v_mfma_f32_16x16x32_bf16 v[108:111], v[156:159], v[76:79], v[108:111]
    buffer_load_dwordx4 v[236:239], v7, s[8:11], s38 offen offset:3072 sc1
    s_waitcnt vmcnt(15)
    v_mfma_f32_16x16x32_bf16 v[104:107], v[160:163], v[80:83], v[104:107]
    v_mfma_f32_16x16x32_bf16 v[108:111], v[168:171], v[80:83], v[108:111]
    s_add_u32 s38, s32, 2887680
    buffer_load_dwordx4 v[240:243], v7, s[8:11], s38 offen offset:0 sc1
    s_waitcnt vmcnt(15)
    v_mfma_f32_16x16x32_bf16 v[104:107], v[164:167], v[84:87], v[104:107]
    v_mfma_f32_16x16x32_bf16 v[108:111], v[172:175], v[84:87], v[108:111]
    buffer_load_dwordx4 v[244:247], v7, s[8:11], s38 offen offset:1024 sc1
    s_waitcnt vmcnt(15)
    v_mfma_f32_16x16x32_bf16 v[104:107], v[176:179], v[88:91], v[104:107]
    v_mfma_f32_16x16x32_bf16 v[108:111], v[184:187], v[88:91], v[108:111]
    buffer_load_dwordx4 v[248:251], v7, s[8:11], s38 offen offset:2048 sc1
    s_waitcnt vmcnt(15)
    v_mfma_f32_16x16x32_bf16 v[104:107], v[180:183], v[92:95], v[104:107]
    v_mfma_f32_16x16x32_bf16 v[108:111], v[188:191], v[92:95], v[108:111]
    buffer_load_dwordx4 v[252:255], v7, s[8:11], s38 offen offset:3072 sc1
    s_nop 5
    ds_write_b128 v8, v[96:99] offset:0
    ds_write_b128 v8, v[100:103] offset:1024
    ds_write_b128 v8, v[104:107] offset:2048
    ds_write_b128 v8, v[108:111] offset:3072
    s_waitcnt lgkmcnt(0)
    s_barrier
    s_waitcnt vmcnt(15)
    v_mfma_f32_16x16x32_bf16 v[96:99], v[128:131], v[192:195], 0
    v_mfma_f32_16x16x32_bf16 v[100:103], v[136:139], v[192:195], 0
    s_waitcnt vmcnt(14)
    v_mfma_f32_16x16x32_bf16 v[96:99], v[132:135], v[196:199], v[96:99]
    v_mfma_f32_16x16x32_bf16 v[100:103], v[140:143], v[196:199], v[100:103]
    s_waitcnt vmcnt(13)
    v_mfma_f32_16x16x32_bf16 v[96:99], v[144:147], v[200:203], v[96:99]
    v_mfma_f32_16x16x32_bf16 v[100:103], v[152:155], v[200:203], v[100:103]
    s_waitcnt vmcnt(12)
    v_mfma_f32_16x16x32_bf16 v[96:99], v[148:151], v[204:207], v[96:99]
    v_mfma_f32_16x16x32_bf16 v[100:103], v[156:159], v[204:207], v[100:103]
    s_waitcnt vmcnt(11)
    v_mfma_f32_16x16x32_bf16 v[96:99], v[160:163], v[208:211], v[96:99]
    v_mfma_f32_16x16x32_bf16 v[100:103], v[168:171], v[208:211], v[100:103]
    s_waitcnt vmcnt(10)
    v_mfma_f32_16x16x32_bf16 v[96:99], v[164:167], v[212:215], v[96:99]
    v_mfma_f32_16x16x32_bf16 v[100:103], v[172:175], v[212:215], v[100:103]
    s_waitcnt vmcnt(9)
    v_mfma_f32_16x16x32_bf16 v[96:99], v[176:179], v[216:219], v[96:99]
    v_mfma_f32_16x16x32_bf16 v[100:103], v[184:187], v[216:219], v[100:103]
    s_waitcnt vmcnt(8)
    v_mfma_f32_16x16x32_bf16 v[96:99], v[180:183], v[220:223], v[96:99]
    v_mfma_f32_16x16x32_bf16 v[100:103], v[188:191], v[220:223], v[100:103]
    s_waitcnt vmcnt(7)
    v_mfma_f32_16x16x32_bf16 v[104:107], v[128:131], v[224:227], 0
    v_mfma_f32_16x16x32_bf16 v[108:111], v[136:139], v[224:227], 0
    s_waitcnt vmcnt(6)
    v_mfma_f32_16x16x32_bf16 v[104:107], v[132:135], v[228:231], v[104:107]
    v_mfma_f32_16x16x32_bf16 v[108:111], v[140:143], v[228:231], v[108:111]
    s_waitcnt vmcnt(5)
    v_mfma_f32_16x16x32_bf16 v[104:107], v[144:147], v[232:235], v[104:107]
    v_mfma_f32_16x16x32_bf16 v[108:111], v[152:155], v[232:235], v[108:111]
    s_waitcnt vmcnt(4)
    v_mfma_f32_16x16x32_bf16 v[104:107], v[148:151], v[236:239], v[104:107]
    v_mfma_f32_16x16x32_bf16 v[108:111], v[156:159], v[236:239], v[108:111]
    s_waitcnt vmcnt(3)
    v_mfma_f32_16x16x32_bf16 v[104:107], v[160:163], v[240:243], v[104:107]
    v_mfma_f32_16x16x32_bf16 v[108:111], v[168:171], v[240:243], v[108:111]
    s_waitcnt vmcnt(2)
    v_mfma_f32_16x16x32_bf16 v[104:107], v[164:167], v[244:247], v[104:107]
    v_mfma_f32_16x16x32_bf16 v[108:111], v[172:175], v[244:247], v[108:111]
    s_waitcnt vmcnt(1)
    v_mfma_f32_16x16x32_bf16 v[104:107], v[176:179], v[248:251], v[104:107]
    v_mfma_f32_16x16x32_bf16 v[108:111], v[184:187], v[248:251], v[108:111]
    s_waitcnt vmcnt(0)
    v_mfma_f32_16x16x32_bf16 v[104:107], v[180:183], v[252:255], v[104:107]
    v_mfma_f32_16x16x32_bf16 v[108:111], v[188:191], v[252:255], v[108:111]
    s_nop 5
    ds_write_b128 v8, v[96:99] offset:16384
    ds_write_b128 v8, v[100:103] offset:17408
    ds_write_b128 v8, v[104:107] offset:18432
    ds_write_b128 v8, v[108:111] offset:19456
    s_waitcnt lgkmcnt(0)
    s_barrier
    s_branch L_rt_done
L_rt_qk:
    s_lshl_b32 s38, s26, 10
    v_add_u32 v8, s38, v7
    v_and_b32 v3, 15, v2
    v_lshrrev_b32 v4, 4, v2
    v_lshlrev_b32 v9, 12, v3
    v_lshl_add_u32 v9, v4, 3, v9
    s_lshr_b32 s38, s26, 1
    s_lshl_b32 s38, s38, 16
    s_and_b32 s39, s26, 1
    s_lshl_b32 s39, s39, 5
    s_add_u32 s38, s38, s39
    s_lshl_b32 s39, s25, 6
    s_add_u32 s38, s38, s39
    s_lshl_b32 s39, s24, 17
    s_add_u32 s38, s38, s39
    s_add_u32 s32, s38, 7604224
    s_lshl_b32 s34, s25, 16
    s_add_u32 s34, s34, 92274688
    s_add_u32 s34, s34, s43
    s_waitcnt lgkmcnt(0)
    s_mov_b32 s12, s56
    s_and_b32 s13, s57, 0xffff
    s_mov_b32 s14, 0x800000
    s_mov_b32 s15, 0x20000
    s_lshl_b32 s38, s24, 2
    s_add_u32 s38, s38, 79715584
    v_min_u32 v10, 5, v2
    v_lshlrev_b32 v10, 7, v10
    v_add_u32 v10, s38, v10
    s_mov_b32 s31, -1
    s_cmp_lg_u32 s26, 0
    s_cbranch_scc1 fo_111
    s_and_b32 s3, s31, 4
    s_cbranch_scc0 fo_111
poll_112:
    s_sub_u32 s30, s30, 1
    s_cbranch_scc1 L_end
    buffer_load_dword v11, v10, s[8:11], 0 offen sc1
    s_waitcnt vmcnt(0)
    v_cmp_gt_u32 vcc, 8, v11
    s_nop 3
    s_mov_b32 s31, vcc_lo
    s_and_b32 s3, s31, 4
    s_cbranch_scc1 poll_112
fo_111:
    s_barrier
    ds_read_b128 v[48:51], v8 offset:0
    ds_read_b128 v[52:55], v8 offset:4096
    ds_read_b128 v[56:59], v8 offset:8192
    ds_read_b128 v[60:63], v8 offset:12288
    s_waitcnt lgkmcnt(0)
    v_pk_add_f32 v[48:49], v[48:49], v[52:53]
    v_pk_add_f32 v[50:51], v[50:51], v[54:55]
    v_pk_add_f32 v[56:57], v[56:57], v[60:61]
    v_pk_add_f32 v[58:59], v[58:59], v[62:63]
    v_pk_add_f32 v[80:81], v[48:49], v[56:57]
    v_pk_add_f32 v[82:83], v[50:51], v[58:59]
    v_min_u32 v80, s41, v80
    v_min_u32 v81, s41, v81
    v_min_u32 v82, s41, v82
    v_min_u32 v83, s41, v83
    s_cmp_lg_u32 s26, 0
    s_cbranch_scc1 fo_113
    s_and_b32 s3, s31, 8
    s_cbranch_scc0 fo_113
poll_114:
    s_sub_u32 s30, s30, 1
    s_cbranch_scc1 L_end
    buffer_load_dword v11, v10, s[8:11], 0 offen sc1
    s_waitcnt vmcnt(0)
    v_cmp_gt_u32 vcc, 8, v11
    s_nop 3
    s_mov_b32 s31, vcc_lo
    s_and_b32 s3, s31, 8
    s_cbranch_scc1 poll_114
fo_113:
    s_barrier
    ds_read_b128 v[48:51], v8 offset:16384
    ds_read_b128 v[52:55], v8 offset:20480
    ds_read_b128 v[56:59], v8 offset:24576
    ds_read_b128 v[60:63], v8 offset:28672
    s_waitcnt lgkmcnt(0)
    v_pk_add_f32 v[48:49], v[48:49], v[52:53]
    v_pk_add_f32 v[50:51], v[50:51], v[54:55]
    v_pk_add_f32 v[56:57], v[56:57], v[60:61]
    v_pk_add_f32 v[58:59], v[58:59], v[62:63]
    v_pk_add_f32 v[84:85], v[48:49], v[56:57]
    v_pk_add_f32 v[86:87], v[50:51], v[58:59]
    v_min_u32 v84, s41, v84
    v_min_u32 v85, s41, v85
    v_min_u32 v86, s41, v86
    v_min_u32 v87, s41, v87
    s_barrier
    ds_read_b128 v[48:51], v8 offset:0
    ds_read_b128 v[52:55], v8 offset:4096
    ds_read_b128 v[56:59], v8 offset:8192
    ds_read_b128 v[60:63], v8 offset:12288
    s_waitcnt lgkmcnt(0)
    v_pk_add_f32 v[48:49], v[48:49], v[52:53]
    v_pk_add_f32 v[50:51], v[50:51], v[54:55]
    v_pk_add_f32 v[56:57], v[56:57], v[60:61]
    v_pk_add_f32 v[58:59], v[58:59], v[62:63]
    v_pk_add_f32 v[88:89], v[48:49], v[56:57]
    v_pk_add_f32 v[90:91], v[50:51], v[58:59]
    v_min_u32 v88, s41, v88
    v_min_u32 v89, s41, v89
    v_min_u32 v90, s41, v90
    v_min_u32 v91, s41, v91
    s_cmp_lg_u32 s26, 0
    s_cbranch_scc1 fo_115
    s_and_b32 s3, s31, 48
    s_cbranch_scc0 fo_115
poll_116:
    s_sub_u32 s30, s30, 1
    s_cbranch_scc1 L_end
    buffer_load_dword v11, v10, s[8:11], 0 offen sc1
    s_waitcnt vmcnt(0)
    v_cmp_gt_u32 vcc, 8, v11
    s_nop 3
    s_mov_b32 s31, vcc_lo
    s_and_b32 s3, s31, 48
    s_cbranch_scc1 poll_116
fo_115:
    s_barrier
    ds_read_b128 v[48:51], v8 offset:16384
    ds_read_b128 v[52:55], v8 offset:20480
    ds_read_b128 v[56:59], v8 offset:24576
    ds_read_b128 v[60:63], v8 offset:28672
    s_waitcnt lgkmcnt(0)
    v_pk_add_f32 v[48:49], v[48:49], v[52:53]
    v_pk_add_f32 v[50:51], v[50:51], v[54:55]
    v_pk_add_f32 v[56:57], v[56:57], v[60:61]
    v_pk_add_f32 v[58:59], v[58:59], v[62:63]
    v_pk_add_f32 v[92:93], v[48:49], v[56:57]
    v_pk_add_f32 v[94:95], v[50:51], v[58:59]
    v_min_u32 v92, s41, v92
    v_min_u32 v93, s41, v93
    v_min_u32 v94, s41, v94
    v_min_u32 v95, s41, v95
    s_cmp_eq_u32 s24, 0
    s_cbranch_scc1 nx_117
    s_xor_b32 s38, s24, 0
    s_and_b32 s39, s38, 1
    s_lshl_b32 s39, s39, 12
    s_lshr_b32 s38, s38, 1
    s_lshl_b32 s38, s38, 14
    s_add_u32 s38, s38, s39
    s_xor_b32 s39, s34, 0
    s_add_u32 s38, s38, s39
    s_add_u32 s38, s38, 0
    buffer_store_dwordx4 v[80:83], v8, s[8:11], s38 offen sc1
    s_branch nx_117x
nx_117:
    v_mov_b32 v32, v80
    v_mov_b32 v33, v81
    v_mov_b32 v34, v82
    v_mov_b32 v35, v83
nx_117x:
    s_cmp_eq_u32 s24, 1
    s_cbranch_scc1 nx_118
    s_xor_b32 s38, s24, 1
    s_and_b32 s39, s38, 1
    s_lshl_b32 s39, s39, 12
    s_lshr_b32 s38, s38, 1
    s_lshl_b32 s38, s38, 14
    s_add_u32 s38, s38, s39
    s_xor_b32 s39, s34, 8192
    s_add_u32 s38, s38, s39
    s_add_u32 s38, s38, 2097152
    buffer_store_dwordx4 v[84:87], v8, s[8:11], s38 offen sc1
    s_branch nx_118x
nx_118:
    v_mov_b32 v32, v84
    v_mov_b32 v33, v85
    v_mov_b32 v34, v86
    v_mov_b32 v35, v87
nx_118x:
    s_cmp_eq_u32 s24, 2
    s_cbranch_scc1 nx_119
    s_xor_b32 s38, s24, 2
    s_and_b32 s39, s38, 1
    s_lshl_b32 s39, s39, 12
    s_lshr_b32 s38, s38, 1
    s_lshl_b32 s38, s38, 14
    s_add_u32 s38, s38, s39
    s_xor_b32 s39, s34, 0
    s_add_u32 s38, s38, s39
    s_add_u32 s38, s38, 4194304
    buffer_store_dwordx4 v[88:91], v8, s[8:11], s38 offen sc1
    s_branch nx_119x
nx_119:
    v_mov_b32 v32, v88
    v_mov_b32 v33, v89
    v_mov_b32 v34, v90
    v_mov_b32 v35, v91
nx_119x:
    s_cmp_eq_u32 s24, 3
    s_cbranch_scc1 nx_120
    s_xor_b32 s38, s24, 3
    s_and_b32 s39, s38, 1
    s_lshl_b32 s39, s39, 12
    s_lshr_b32 s38, s38, 1
    s_lshl_b32 s38, s38, 14
    s_add_u32 s38, s38, s39
    s_xor_b32 s39, s34, 8192
    s_add_u32 s38, s38, s39
    s_add_u32 s38, s38, 6291456
    buffer_store_dwordx4 v[92:95], v8, s[8:11], s38 offen sc1
    s_branch nx_120x
nx_120:
    v_mov_b32 v32, v92
    v_mov_b32 v33, v93
    v_mov_b32 v34, v94
    v_mov_b32 v35, v95
nx_120x:
    s_barrier
    ds_read_b128 v[48:51], v8 offset:0
    ds_read_b128 v[52:55], v8 offset:4096
    ds_read_b128 v[56:59], v8 offset:8192
    ds_read_b128 v[60:63], v8 offset:12288
    s_waitcnt lgkmcnt(0)
    v_pk_add_f32 v[48:49], v[48:49], v[52:53]
    v_pk_add_f32 v[50:51], v[50:51], v[54:55]
    v_pk_add_f32 v[56:57], v[56:57], v[60:61]
    v_pk_add_f32 v[58:59], v[58:59], v[62:63]
    v_pk_add_f32 v[96:97], v[48:49], v[56:57]
    v_pk_add_f32 v[98:99], v[50:51], v[58:59]
    v_min_u32 v96, s41, v96
    v_min_u32 v97, s41, v97
    v_min_u32 v98, s41, v98
    v_min_u32 v99, s41, v99
    s_cmp_eq_u32 s24, 0
    s_cbranch_scc1 nx_121
    s_xor_b32 s38, s24, 0
    s_and_b32 s39, s38, 1
    s_lshl_b32 s39, s39, 12
    s_lshr_b32 s38, s38, 1
    s_lshl_b32 s38, s38, 14
    s_add_u32 s38, s38, s39
    s_xor_b32 s39, s34, 0
    s_add_u32 s38, s38, s39
    s_add_u32 s38, s38, 32768
    buffer_store_dwordx4 v[96:99], v8, s[8:11], s38 offen sc1
    s_branch nx_121x
nx_121:
    v_mov_b32 v36, v96
    v_mov_b32 v37, v97
    v_mov_b32 v38, v98
    v_mov_b32 v39, v99
nx_121x:
    s_and_b32 s38, s24, 1
    s_lshl_b32 s38, s38, 13
    s_xor_b32 s38, s38, s34
    s_lshl_b32 s39, s24, 21
    s_add_u32 s38, s38, s39
    s_add_u32 s38, s38, 4096
    s_add_u32 s39, s38, 12288
    s_add_u32 s40, s38, 16384
poll_122:
    s_sub_u32 s30, s30, 1
    s_cbranch_scc1 L_end
    buffer_load_dwordx4 v[64:67], v8, s[8:11], s38 offen sc1
    buffer_load_dwordx4 v[68:71], v8, s[8:11], s39 offen sc1
    buffer_load_dwordx4 v[72:75], v8, s[8:11], s40 offen sc1
    s_waitcnt vmcnt(0)
    v_max3_u32 v12, v64, v65, v66
    v_max3_u32 v12, v12, v67, v68
    v_max3_u32 v12, v12, v69, v70
    v_max3_u32 v12, v12, v71, v72
    v_max3_u32 v12, v12, v73, v74
    v_max_u32 v12, v12, v75
    v_cmp_eq_u32 vcc, -1, v12
    s_cbranch_vccnz poll_122
    v_pk_add_f32 v[64:65], v[32:33], v[64:65]
    v_pk_add_f32 v[66:67], v[34:35], v[66:67]
    v_pk_add_f32 v[68:69], v[68:69], v[72:73]
    v_pk_add_f32 v[70:71], v[70:71], v[74:75]
    v_pk_add_f32 v[64:65], v[64:65], v[68:69]
    v_pk_add_f32 v[66:67], v[66:67], v[70:71]
    v_cvt_pk_bf16_f32 v64, v64, v65
    v_cvt_pk_bf16_f32 v65, v66, v67
    s_add_u32 s38, s32, 0
    buffer_store_dwordx2 v[64:65], v9, s[12:15], s38 offen
    s_barrier
    ds_read_b128 v[48:51], v8 offset:16384
    ds_read_b128 v[52:55], v8 offset:20480
    ds_read_b128 v[56:59], v8 offset:24576
    ds_read_b128 v[60:63], v8 offset:28672
    s_waitcnt lgkmcnt(0)
    v_pk_add_f32 v[48:49], v[48:49], v[52:53]
    v_pk_add_f32 v[50:51], v[50:51], v[54:55]
    v_pk_add_f32 v[56:57], v[56:57], v[60:61]
    v_pk_add_f32 v[58:59], v[58:59], v[62:63]
    v_pk_add_f32 v[100:101], v[48:49], v[56:57]
    v_pk_add_f32 v[102:103], v[50:51], v[58:59]
    v_min_u32 v100, s41, v100
    v_min_u32 v101, s41, v101
    v_min_u32 v102, s41, v102
    v_min_u32 v103, s41, v103
    s_cmp_eq_u32 s24, 1
    s_cbranch_scc1 nx_123
    s_xor_b32 s38, s24, 1
    s_and_b32 s39, s38, 1
    s_lshl_b32 s39, s39, 12
    s_lshr_b32 s38, s38, 1
    s_lshl_b32 s38, s38, 14
    s_add_u32 s38, s38, s39
    s_xor_b32 s39, s34, 8192
    s_add_u32 s38, s38, s39
    s_add_u32 s38, s38, 2129920
    buffer_store_dwordx4 v[100:103], v8, s[8:11], s38 offen sc1
    s_branch nx_123x
nx_123:
    v_mov_b32 v36, v100
    v_mov_b32 v37, v101
    v_mov_b32 v38, v102
    v_mov_b32 v39, v103
nx_123x:
    s_cmp_ge_u32 s24, 2
    s_cbranch_scc1 L_rt_done
    s_and_b32 s38, s24, 1
    s_lshl_b32 s38, s38, 13
    s_xor_b32 s38, s38, s34
    s_lshl_b32 s39, s24, 21
    s_add_u32 s38, s38, s39
    s_add_u32 s38, s38, 36864
    s_add_u32 s39, s38, 12288
    s_add_u32 s40, s38, 16384
poll_124:
    s_sub_u32 s30, s30, 1
    s_cbranch_scc1 L_end
    buffer_load_dwordx4 v[64:67], v8, s[8:11], s38 offen sc1
    buffer_load_dwordx4 v[68:71], v8, s[8:11], s39 offen sc1
    buffer_load_dwordx4 v[72:75], v8, s[8:11], s40 offen sc1
    s_waitcnt vmcnt(0)
    v_max3_u32 v12, v64, v65, v66
    v_max3_u32 v12, v12, v67, v68
    v_max3_u32 v12, v12, v69, v70
    v_max3_u32 v12, v12, v71, v72
    v_max3_u32 v12, v12, v73, v74
    v_max_u32 v12, v12, v75
    v_cmp_eq_u32 vcc, -1, v12
    s_cbranch_vccnz poll_124
    v_pk_add_f32 v[64:65], v[36:37], v[64:65]
    v_pk_add_f32 v[66:67], v[38:39], v[66:67]
    v_pk_add_f32 v[68:69], v[68:69], v[72:73]
    v_pk_add_f32 v[70:71], v[70:71], v[74:75]
    v_pk_add_f32 v[64:65], v[64:65], v[68:69]
    v_pk_add_f32 v[66:67], v[66:67], v[70:71]
    v_cvt_pk_bf16_f32 v64, v64, v65
    v_cvt_pk_bf16_f32 v65, v66, v67
    s_add_u32 s38, s32, 524288
    buffer_store_dwordx2 v[64:65], v9, s[12:15], s38 offen
L_rt_done:
    s_branch L_end
W_start:
    s_load_dwordx2 s[82:83], s[0:1], 24
    s_load_dwordx2 s[84:85], s[0:1], 40
    s_load_dwordx2 s[86:87], s[0:1], 48
    s_load_dwordx2 s[88:89], s[0:1], 56
    s_load_dwordx2 s[90:91], s[0:1], 64
    s_load_dwordx2 s[92:93], s[0:1], 0
    s_load_dwordx2 s[94:95], s[0:1], 8
    s_load_dwordx2 s[96:97], s[0:1], 16
    s_load_dwordx2 s[98:99], s[0:1], 80
    s_getpc_b64 s[50:51]
W_pc:
    s_add_u32 s50, s50, W_table-W_pc
    s_addc_u32 s51, s51, 0
    v_mbcnt_lo_u32_b32 v2, -1, 0
    v_mbcnt_hi_u32_b32 v2, -1, v2
    s_and_b32 s43, s24, 3
    s_mov_b32 s30, 0x20000
    s_mov_b32 s53, 256
    s_waitcnt lgkmcnt(0)
    s_mov_b32 s64, s98
    s_and_b32 s65, s99, 0xffff
    s_mov_b32 s66, 0x800000
    s_mov_b32 s67, 0x20000
    s_mov_b32 s12, s4
    s_and_b32 s13, s5, 0xffff
    s_mov_b32 s14, 0x10000000
    s_mov_b32 s15, 0x20000
    s_mov_b32 s16, s4
    s_and_b32 s17, s5, 0xffff
    s_mov_b32 s18, 0x10000000
    s_mov_b32 s19, 0x20000
    v_mov_b32 v3, 0
    v_mov_b32 v4, 0
    v_mov_b32 v5, 0
    v_mov_b32 v6, 0
    v_mov_b32 v7, 0
    v_mov_b32 v8, 0
    v_mov_b32 v9, 0
    v_mov_b32 v10, 0
    v_mov_b32 v11, 0
    v_mov_b32 v12, 0
    v_mov_b32 v13, 0
    v_mov_b32 v14, 0
    v_mov_b32 v15, 0
    v_mov_b32 v16, 0
    v_mov_b32 v17, 0
    v_mov_b32 v18, 0
    v_mov_b32 v19, 0
    v_mov_b32 v20, 0
    v_mov_b32 v21, 0
    v_mov_b32 v22, 0
    v_mov_b32 v23, 0
    v_mov_b32 v24, 0
    v_mov_b32 v25, 0
    v_mov_b32 v26, 0
    v_mov_b32 v27, 0
    v_mov_b32 v28, 0
    v_mov_b32 v29, 0
    v_mov_b32 v30, 0
    v_mov_b32 v31, 0
    s_lshr_b32 s44, s26, 2
    s_and_b32 s45, s26, 3
    s_mov_b32 s6, 0
    s_mov_b32 s49, 0
    s_mov_b32 s37, 0
    s_lshr_b32 s2, s26, 8
    s_mov_b32 s79, -1
W_dec:
    s_min_u32 s3, s25, 204
    s_lshl_b32 s3, s3, 2
    s_load_dword s7, s[50:51], s3
    s_waitcnt lgkmcnt(0)
D_pre:
    s_sub_u32 s53, s53, 1
    s_cbranch_scc1 L_end
    s_bfe_u32 s100, s7, 0x80008
    s_lshl_b32 s100, s100, 5
    s_bfe_u32 s101, s7, 0x80010
    s_and_b32 s3, s7, 255
    s_cmp_eq_u32 s3, 0
    s_cbranch_scc1 P_K0
    s_cmp_eq_u32 s3, 1
    s_cbranch_scc1 P_V0
    s_cmp_eq_u32 s3, 2
    s_cbranch_scc1 P_K1
    s_cmp_eq_u32 s3, 3
    s_cbranch_scc1 P_V1
    s_cmp_eq_u32 s3, 4
    s_cbranch_scc1 P_K
    s_cmp_eq_u32 s3, 5
    s_cbranch_scc1 P_V
    s_cmp_eq_u32 s3, 6
    s_cbranch_scc1 P_QT
    s_cmp_eq_u32 s3, 7
    s_cbranch_scc1 P_AKV
    s_cmp_eq_u32 s3, 8
    s_cbranch_scc1 P_AQ
    s_cmp_eq_u32 s3, 9
    s_cbranch_scc1 P_T4S
    s_cmp_eq_u32 s3, 10
    s_cbranch_scc1 P_T4
    s_cmp_eq_u32 s3, 11
    s_cbranch_scc1 P_T7
    s_cmp_eq_u32 s3, 12
    s_cbranch_scc1 P_T4W
    s_cmp_eq_u32 s3, 13
    s_cbranch_scc1 P_T4Q
    s_branch P_none
P_none:
    s_cmp_eq_u32 s6, 0
    s_cbranch_scc1 P_exit
P_skip:
    s_mov_b32 s6, 0
D_epi:
    s_and_b32 s3, s49, 255
    s_cmp_eq_u32 s3, 0
    s_cbranch_scc1 E_K0
    s_cmp_eq_u32 s3, 1
    s_cbranch_scc1 E_V0
    s_cmp_eq_u32 s3, 2
    s_cbranch_scc1 E_K1
    s_cmp_eq_u32 s3, 3
    s_cbranch_scc1 E_V1
    s_cmp_eq_u32 s3, 4
    s_cbranch_scc1 E_K
    s_cmp_eq_u32 s3, 5
    s_cbranch_scc1 E_V
    s_cmp_eq_u32 s3, 6
    s_cbranch_scc1 E_QT
    s_cmp_eq_u32 s3, 7
    s_cbranch_scc1 E_AKV
    s_cmp_eq_u32 s3, 8
    s_cbranch_scc1 E_AQ
    s_cmp_eq_u32 s3, 9
    s_cbranch_scc1 E_T4S
    s_cmp_eq_u32 s3, 10
    s_cbranch_scc1 E_T4
    s_cmp_eq_u32 s3, 11
    s_cbranch_scc1 E_T7
    s_cmp_eq_u32 s3, 12
    s_cbranch_scc1 E_T4W
    s_cmp_eq_u32 s3, 13
    s_cbranch_scc1 E_T4Q
    s_branch L_end
D_main:
    s_and_b32 s3, s7, 255
    s_cmp_eq_u32 s3, 0
    s_cbranch_scc1 M_K0
    s_cmp_eq_u32 s3, 1
    s_cbranch_scc1 M_V0
    s_cmp_eq_u32 s3, 2
    s_cbranch_scc1 M_K1
    s_cmp_eq_u32 s3, 3
    s_cbranch_scc1 M_V1
    s_cmp_eq_u32 s3, 4
    s_cbranch_scc1 M_K
    s_cmp_eq_u32 s3, 5
    s_cbranch_scc1 M_V
    s_cmp_eq_u32 s3, 6
    s_cbranch_scc1 M_QT
    s_cmp_eq_u32 s3, 7
    s_cbranch_scc1 M_AKV
    s_cmp_eq_u32 s3, 8
    s_cbranch_scc1 M_AQ
    s_cmp_eq_u32 s3, 9
    s_cbranch_scc1 M_T4S
    s_cmp_eq_u32 s3, 10
    s_cbranch_scc1 M_T4
    s_cmp_eq_u32 s3, 11
    s_cbranch_scc1 M_T7
    s_cmp_eq_u32 s3, 12
    s_cbranch_scc1 M_T4W
    s_cmp_eq_u32 s3, 13
    s_cbranch_scc1 M_T4Q
    s_branch L_end
P_exit:
    s_branch L_end
P_K0:
    s_mov_b32 s12, s82
    s_and_b32 s13, s83, 0xffff
    s_mov_b32 s14, 0x400000
    s_mov_b32 s15, 0x20000
    s_mov_b32 s16, s86
    s_and_b32 s17, s87, 0xffff
    s_mov_b32 s18, 0x800000
    s_mov_b32 s19, 0x20000
    s_lshl_b32 s101, s101, 5
    s_mul_i32 s3, s43, 1024
    s_add_u32 s101, s101, s3
    s_mul_i32 s38, s26, 16
    s_add_u32 s38, s38, 0
    v_lshrrev_b32 v3, 3, v2
    v_add_u32 v3, s38, v3
    v_bfe_u32 v4, v3, 1, 3
    v_and_b32 v5, 7, v2
    v_xor_b32 v4, v4, v5
    v_mul_u32_u24 v3, 2048, v3
    v_lshl_add_u32 v3, v4, 4, v3
    v_subrev_u32 v8, 0, v3
    s_mul_i32 s38, s26, 16
    s_add_u32 s38, s38, 8
    v_lshrrev_b32 v3, 3, v2
    v_add_u32 v3, s38, v3
    v_bfe_u32 v4, v3, 1, 3
    v_and_b32 v5, 7, v2
    v_xor_b32 v4, v4, v5
    v_mul_u32_u24 v3, 2048, v3
    v_lshl_add_u32 v3, v4, 4, v3
    v_subrev_u32 v9, 1024, v3
    s_mul_i32 s38, s26, 8
    s_add_u32 s38, s38, 0
    v_lshrrev_b32 v3, 4, v2
    v_add_u32 v3, s38, v3
    v_and_b32 v4, 3, v3
    v_lshlrev_b32 v4, 1, v4
    v_bfe_u32 v5, v3, 3, 1
    v_or_b32 v4, v4, v5
    v_lshlrev_b32 v4, 1, v4
    v_and_b32 v5, 15, v2
    v_xor_b32 v4, v4, v5
    v_lshlrev_b32 v4, 4, v4
    v_mul_u32_u24 v3, 8192, v3
    v_add_u32 v3, v3, v4
    v_subrev_u32 v12, 0, v3
    s_mul_i32 s38, s26, 8
    s_add_u32 s38, s38, 4
    v_lshrrev_b32 v3, 4, v2
    v_add_u32 v3, s38, v3
    v_and_b32 v4, 3, v3
    v_lshlrev_b32 v4, 1, v4
    v_bfe_u32 v5, v3, 3, 1
    v_or_b32 v4, v4, v5
    v_lshlrev_b32 v4, 1, v4
    v_and_b32 v5, 15, v2
    v_xor_b32 v4, v4, v5
    v_lshlrev_b32 v4, 4, v4
    v_mul_u32_u24 v3, 8192, v3
    v_add_u32 v3, v3, v4
    v_subrev_u32 v13, 1024, v3
    s_mov_b32 s33, 524288
    s_lshl_b32 s31, s100, 11
    s_lshl_b32 s32, s101, 1
    s_mul_i32 s35, s26, 2048
    s_mul_i32 s36, s26, 2048
    s_add_u32 s36, s36, 16384
    s_mov_b32 m0, s35
    s_add_u32 s35, s35, 32768
    s_cmp_ge_u32 s35, 131072
    s_cselect_b32 s40, 131072, 0
    s_sub_u32 s35, s35, s40
    buffer_load_dwordx4 v8, s[12:15], s31 offen offset:0  lds
    buffer_load_dwordx4 v9, s[12:15], s31 offen offset:1024  lds
    s_mov_b32 m0, s36
    s_add_u32 s31, s31, 128
    s_add_u32 s36, s36, 32768
    s_cmp_ge_u32 s36, 131072
    s_cselect_b32 s40, 131072, 0
    s_sub_u32 s36, s36, s40
    buffer_load_dwordx4 v12, s[16:19], s32 offen offset:0  lds
    buffer_load_dwordx4 v13, s[16:19], s32 offen offset:1024  lds
    s_add_u32 s32, s32, s33
    s_mov_b32 m0, s35
    s_add_u32 s35, s35, 32768
    s_cmp_ge_u32 s35, 131072
    s_cselect_b32 s40, 131072, 0
    s_sub_u32 s35, s35, s40
    buffer_load_dwordx4 v8, s[12:15], s31 offen offset:0  lds
    buffer_load_dwordx4 v9, s[12:15], s31 offen offset:1024  lds
    s_mov_b32 m0, s36
    s_add_u32 s31, s31, 128
    s_add_u32 s36, s36, 32768
    s_cmp_ge_u32 s36, 131072
    s_cselect_b32 s40, 131072, 0
    s_sub_u32 s36, s36, s40
    buffer_load_dwordx4 v12, s[16:19], s32 offen offset:0  lds
    buffer_load_dwordx4 v13, s[16:19], s32 offen offset:1024  lds
    s_add_u32 s32, s32, s33
    s_mov_b32 m0, s35
    s_add_u32 s35, s35, 32768
    s_cmp_ge_u32 s35, 131072
    s_cselect_b32 s40, 131072, 0
    s_sub_u32 s35, s35, s40
    buffer_load_dwordx4 v8, s[12:15], s31 offen offset:0  lds
    buffer_load_dwordx4 v9, s[12:15], s31 offen offset:1024  lds
    s_mov_b32 m0, s36
    s_add_u32 s31, s31, 128
    s_add_u32 s36, s36, 32768
    s_cmp_ge_u32 s36, 131072
    s_cselect_b32 s40, 131072, 0
    s_sub_u32 s36, s36, s40
    buffer_load_dwordx4 v12, s[16:19], s32 offen offset:0  lds
    buffer_load_dwordx4 v13, s[16:19], s32 offen offset:1024  lds
    s_add_u32 s32, s32, s33
    s_mov_b32 m0, s35
    s_add_u32 s35, s35, 32768
    s_cmp_ge_u32 s35, 131072
    s_cselect_b32 s40, 131072, 0
    s_sub_u32 s35, s35, s40
    buffer_load_dwordx4 v8, s[12:15], s31 offen offset:0  lds
    buffer_load_dwordx4 v9, s[12:15], s31 offen offset:1024  lds
    s_mov_b32 m0, s36
    s_add_u32 s31, s31, 128
    s_add_u32 s36, s36, 32768
    s_cmp_ge_u32 s36, 131072
    s_cselect_b32 s40, 131072, 0
    s_sub_u32 s36, s36, s40
    buffer_load_dwordx4 v12, s[16:19], s32 offen offset:0  lds
    buffer_load_dwordx4 v13, s[16:19], s32 offen offset:1024  lds
    s_add_u32 s32, s32, s33
    s_cmp_lg_u32 s6, 0
    s_cbranch_scc1 D_epi
M_K0:
    s_mov_b32 s49, s7
    s_mov_b32 s37, s25
    s_mov_b32 s41, s100
    s_mov_b32 s42, s101
    s_lshr_b32 s44, s26, 2
    s_and_b32 s45, s26, 3
    s_mul_i32 s38, s44, 8192
    v_and_b32 v3, 15, v2
    v_lshrrev_b32 v4, 4, v2
    v_lshrrev_b32 v5, 1, v3
    v_xor_b32 v4, v4, v5
    v_lshlrev_b32 v3, 7, v3
    v_lshl_add_u32 v3, v4, 4, v3
    v_add_u32 v16, s38, v3
    v_xor_b32 v17, 64, v16
    v_and_b32 v3, 3, v2
    v_lshlrev_b32 v3, 3, v3
    s_mul_i32 s38, s45, 64
    v_add_u32 v3, s38, v3
    v_bfe_u32 v4, v2, 2, 2
    v_lshlrev_b32 v5, 6, v4
    v_xor_b32 v3, v3, v5
    v_bfe_u32 v5, v2, 4, 1
    v_lshlrev_b32 v5, 5, v5
    v_xor_b32 v3, v3, v5
    v_lshrrev_b32 v5, 4, v2
    v_lshl_add_u32 v4, v5, 3, v4
    v_mul_u32_u24 v4, 256, v4
    v_add_u32 v18, v3, v4
    v_xor_b32 v19, 32, v18
    s_branch LP_K0
P_V0:
    s_mov_b32 s12, s82
    s_and_b32 s13, s83, 0xffff
    s_mov_b32 s14, 0x400000
    s_mov_b32 s15, 0x20000
    s_mov_b32 s16, s88
    s_and_b32 s17, s89, 0xffff
    s_mov_b32 s18, 0x800000
    s_mov_b32 s19, 0x20000
    s_lshl_b32 s101, s101, 5
    s_mul_i32 s3, s43, 1024
    s_add_u32 s101, s101, s3
    s_mul_i32 s38, s26, 16
    s_add_u32 s38, s38, 0
    v_lshrrev_b32 v3, 3, v2
    v_add_u32 v3, s38, v3
    v_bfe_u32 v4, v3, 1, 3
    v_and_b32 v5, 7, v2
    v_xor_b32 v4, v4, v5
    v_mul_u32_u24 v3, 2048, v3
    v_lshl_add_u32 v3, v4, 4, v3
    v_subrev_u32 v8, 0, v3
    s_mul_i32 s38, s26, 16
    s_add_u32 s38, s38, 8
    v_lshrrev_b32 v3, 3, v2
    v_add_u32 v3, s38, v3
    v_bfe_u32 v4, v3, 1, 3
    v_and_b32 v5, 7, v2
    v_xor_b32 v4, v4, v5
    v_mul_u32_u24 v3, 2048, v3
    v_lshl_add_u32 v3, v4, 4, v3
    v_subrev_u32 v9, 1024, v3
    s_mul_i32 s38, s26, 8
    s_add_u32 s38, s38, 0
    v_lshrrev_b32 v3, 4, v2
    v_add_u32 v3, s38, v3
    v_and_b32 v4, 3, v3
    v_lshlrev_b32 v4, 1, v4
    v_bfe_u32 v5, v3, 3, 1
    v_or_b32 v4, v4, v5
    v_lshlrev_b32 v4, 1, v4
    v_and_b32 v5, 15, v2
    v_xor_b32 v4, v4, v5
    v_lshlrev_b32 v4, 4, v4
    v_mul_u32_u24 v3, 8192, v3
    v_add_u32 v3, v3, v4
    v_subrev_u32 v12, 0, v3
    s_mul_i32 s38, s26, 8
    s_add_u32 s38, s38, 4
    v_lshrrev_b32 v3, 4, v2
    v_add_u32 v3, s38, v3
    v_and_b32 v4, 3, v3
    v_lshlrev_b32 v4, 1, v4
    v_bfe_u32 v5, v3, 3, 1
    v_or_b32 v4, v4, v5
    v_lshlrev_b32 v4, 1, v4
    v_and_b32 v5, 15, v2
    v_xor_b32 v4, v4, v5
    v_lshlrev_b32 v4, 4, v4
    v_mul_u32_u24 v3, 8192, v3
    v_add_u32 v3, v3, v4
    v_subrev_u32 v13, 1024, v3
    s_mov_b32 s33, 524288
    s_lshl_b32 s31, s100, 11
    s_lshl_b32 s32, s101, 1
    s_mul_i32 s35, s26, 2048
    s_mul_i32 s36, s26, 2048
    s_add_u32 s36, s36, 16384
    s_mov_b32 m0, s35
    s_add_u32 s35, s35, 32768
    s_cmp_ge_u32 s35, 131072
    s_cselect_b32 s40, 131072, 0
    s_sub_u32 s35, s35, s40
    buffer_load_dwordx4 v8, s[12:15], s31 offen offset:0  lds
    buffer_load_dwordx4 v9, s[12:15], s31 offen offset:1024  lds
    s_mov_b32 m0, s36
    s_add_u32 s31, s31, 128
    s_add_u32 s36, s36, 32768
    s_cmp_ge_u32 s36, 131072
    s_cselect_b32 s40, 131072, 0
    s_sub_u32 s36, s36, s40
    buffer_load_dwordx4 v12, s[16:19], s32 offen offset:0  lds
    buffer_load_dwordx4 v13, s[16:19], s32 offen offset:1024  lds
    s_add_u32 s32, s32, s33
    s_mov_b32 m0, s35
    s_add_u32 s35, s35, 32768
    s_cmp_ge_u32 s35, 131072
    s_cselect_b32 s40, 131072, 0
    s_sub_u32 s35, s35, s40
    buffer_load_dwordx4 v8, s[12:15], s31 offen offset:0  lds
    buffer_load_dwordx4 v9, s[12:15], s31 offen offset:1024  lds
    s_mov_b32 m0, s36
    s_add_u32 s31, s31, 128
    s_add_u32 s36, s36, 32768
    s_cmp_ge_u32 s36, 131072
    s_cselect_b32 s40, 131072, 0
    s_sub_u32 s36, s36, s40
    buffer_load_dwordx4 v12, s[16:19], s32 offen offset:0  lds
    buffer_load_dwordx4 v13, s[16:19], s32 offen offset:1024  lds
    s_add_u32 s32, s32, s33
    s_mov_b32 m0, s35
    s_add_u32 s35, s35, 32768
    s_cmp_ge_u32 s35, 131072
    s_cselect_b32 s40, 131072, 0
    s_sub_u32 s35, s35, s40
    buffer_load_dwordx4 v8, s[12:15], s31 offen offset:0  lds
    buffer_load_dwordx4 v9, s[12:15], s31 offen offset:1024  lds
    s_mov_b32 m0, s36
    s_add_u32 s31, s31, 128
    s_add_u32 s36, s36, 32768
    s_cmp_ge_u32 s36, 131072
    s_cselect_b32 s40, 131072, 0
    s_sub_u32 s36, s36, s40
    buffer_load_dwordx4 v12, s[16:19], s32 offen offset:0  lds
    buffer_load_dwordx4 v13, s[16:19], s32 offen offset:1024  lds
    s_add_u32 s32, s32, s33
    s_mov_b32 m0, s35
    s_add_u32 s35, s35, 32768
    s_cmp_ge_u32 s35, 131072
    s_cselect_b32 s40, 131072, 0
    s_sub_u32 s35, s35, s40
    buffer_load_dwordx4 v8, s[12:15], s31 offen offset:0  lds
    buffer_load_dwordx4 v9, s[12:15], s31 offen offset:1024  lds
    s_mov_b32 m0, s36
    s_add_u32 s31, s31, 128
    s_add_u32 s36, s36, 32768
    s_cmp_ge_u32 s36, 131072
    s_cselect_b32 s40, 131072, 0
    s_sub_u32 s36, s36, s40
    buffer_load_dwordx4 v12, s[16:19], s32 offen offset:0  lds
    buffer_load_dwordx4 v13, s[16:19], s32 offen offset:1024  lds
    s_add_u32 s32, s32, s33
    s_cmp_lg_u32 s6, 0
    s_cbranch_scc1 D_epi
M_V0:
    s_mov_b32 s49, s7
    s_mov_b32 s37, s25
    s_mov_b32 s41, s100
    s_mov_b32 s42, s101
    s_lshr_b32 s44, s26, 2
    s_and_b32 s45, s26, 3
    s_mul_i32 s38, s44, 8192
    v_and_b32 v3, 15, v2
    v_lshrrev_b32 v4, 4, v2
    v_lshrrev_b32 v5, 1, v3
    v_xor_b32 v4, v4, v5
    v_lshlrev_b32 v3, 7, v3
    v_lshl_add_u32 v3, v4, 4, v3
    v_add_u32 v16, s38, v3
    v_xor_b32 v17, 64, v16
    v_and_b32 v3, 3, v2
    v_lshlrev_b32 v3, 3, v3
    s_mul_i32 s38, s45, 64
    v_add_u32 v3, s38, v3
    v_bfe_u32 v4, v2, 2, 2
    v_lshlrev_b32 v5, 6, v4
    v_xor_b32 v3, v3, v5
    v_bfe_u32 v5, v2, 4, 1
    v_lshlrev_b32 v5, 5, v5
    v_xor_b32 v3, v3, v5
    v_lshrrev_b32 v5, 4, v2
    v_lshl_add_u32 v4, v5, 3, v4
    v_mul_u32_u24 v4, 256, v4
    v_add_u32 v18, v3, v4
    v_xor_b32 v19, 32, v18
    s_branch LP_V0
P_K1:
    s_mov_b32 s12, s82
    s_and_b32 s13, s83, 0xffff
    s_mov_b32 s14, 0x400000
    s_mov_b32 s15, 0x20000
    s_mov_b32 s16, s86
    s_and_b32 s17, s87, 0xffff
    s_mov_b32 s18, 0x800000
    s_mov_b32 s19, 0x20000
    s_lshl_b32 s101, s101, 5
    s_mul_i32 s3, s43, 1024
    s_add_u32 s101, s101, s3
    s_mul_i32 s38, s26, 16
    s_add_u32 s38, s38, 0
    v_lshrrev_b32 v3, 3, v2
    v_add_u32 v3, s38, v3
    v_bfe_u32 v4, v3, 1, 3
    v_and_b32 v5, 7, v2
    v_xor_b32 v4, v4, v5
    v_mul_u32_u24 v3, 2048, v3
    v_lshl_add_u32 v3, v4, 4, v3
    v_subrev_u32 v8, 0, v3
    s_mul_i32 s38, s26, 16
    s_add_u32 s38, s38, 8
    v_lshrrev_b32 v3, 3, v2
    v_add_u32 v3, s38, v3
    v_bfe_u32 v4, v3, 1, 3
    v_and_b32 v5, 7, v2
    v_xor_b32 v4, v4, v5
    v_mul_u32_u24 v3, 2048, v3
    v_lshl_add_u32 v3, v4, 4, v3
    v_subrev_u32 v9, 1024, v3
    s_mul_i32 s38, s26, 8
    s_add_u32 s38, s38, 0
    v_lshrrev_b32 v3, 5, v2
    v_add_u32 v3, s38, v3
    v_and_b32 v4, 3, v3
    v_lshlrev_b32 v4, 1, v4
    v_bfe_u32 v5, v3, 3, 1
    v_or_b32 v4, v4, v5
    v_lshlrev_b32 v4, 1, v4
    v_and_b32 v5, 31, v2
    v_xor_b32 v4, v4, v5
    v_lshlrev_b32 v4, 4, v4
    v_mul_u32_u24 v3, 8192, v3
    v_add_u32 v3, v3, v4
    v_subrev_u32 v12, 0, v3
    s_mul_i32 s38, s26, 8
    s_add_u32 s38, s38, 2
    v_lshrrev_b32 v3, 5, v2
    v_add_u32 v3, s38, v3
    v_and_b32 v4, 3, v3
    v_lshlrev_b32 v4, 1, v4
    v_bfe_u32 v5, v3, 3, 1
    v_or_b32 v4, v4, v5
    v_lshlrev_b32 v4, 1, v4
    v_and_b32 v5, 31, v2
    v_xor_b32 v4, v4, v5
    v_lshlrev_b32 v4, 4, v4
    v_mul_u32_u24 v3, 8192, v3
    v_add_u32 v3, v3, v4
    v_subrev_u32 v13, 1024, v3
    s_mul_i32 s38, s26, 8
    s_add_u32 s38, s38, 4
    v_lshrrev_b32 v3, 5, v2
    v_add_u32 v3, s38, v3
    v_and_b32 v4, 3, v3
    v_lshlrev_b32 v4, 1, v4
    v_bfe_u32 v5, v3, 3, 1
    v_or_b32 v4, v4, v5
    v_lshlrev_b32 v4, 1, v4
    v_and_b32 v5, 31, v2
    v_xor_b32 v4, v4, v5
    v_lshlrev_b32 v4, 4, v4
    v_mul_u32_u24 v3, 8192, v3
    v_add_u32 v3, v3, v4
    v_subrev_u32 v14, 2048, v3
    s_mul_i32 s38, s26, 8
    s_add_u32 s38, s38, 6
    v_lshrrev_b32 v3, 5, v2
    v_add_u32 v3, s38, v3
    v_and_b32 v4, 3, v3
    v_lshlrev_b32 v4, 1, v4
    v_bfe_u32 v5, v3, 3, 1
    v_or_b32 v4, v4, v5
    v_lshlrev_b32 v4, 1, v4
    v_and_b32 v5, 31, v2
    v_xor_b32 v4, v4, v5
    v_lshlrev_b32 v4, 4, v4
    v_mul_u32_u24 v3, 8192, v3
    v_add_u32 v3, v3, v4
    v_subrev_u32 v15, 3072, v3
    s_mov_b32 s33, 524288
    s_lshl_b32 s31, s100, 11
    s_lshl_b32 s32, s101, 1
    s_mul_i32 s35, s26, 2048
    s_mul_i32 s36, s26, 4096
    s_add_u32 s36, s36, 16384
    s_mov_b32 m0, s35
    s_add_u32 s35, s35, 49152
    s_cmp_ge_u32 s35, 147456
    s_cselect_b32 s40, 147456, 0
    s_sub_u32 s35, s35, s40
    buffer_load_dwordx4 v8, s[12:15], s31 offen offset:0  lds
    buffer_load_dwordx4 v9, s[12:15], s31 offen offset:1024  lds
    s_mov_b32 m0, s36
    s_add_u32 s31, s31, 128
    s_add_u32 s36, s36, 49152
    s_cmp_ge_u32 s36, 147456
    s_cselect_b32 s40, 147456, 0
    s_sub_u32 s36, s36, s40
    buffer_load_dwordx4 v12, s[16:19], s32 offen offset:0  lds
    buffer_load_dwordx4 v13, s[16:19], s32 offen offset:1024  lds
    buffer_load_dwordx4 v14, s[16:19], s32 offen offset:2048  lds
    buffer_load_dwordx4 v15, s[16:19], s32 offen offset:3072  lds
    s_add_u32 s32, s32, s33
    s_mov_b32 m0, s35
    s_add_u32 s35, s35, 49152
    s_cmp_ge_u32 s35, 147456
    s_cselect_b32 s40, 147456, 0
    s_sub_u32 s35, s35, s40
    buffer_load_dwordx4 v8, s[12:15], s31 offen offset:0  lds
    buffer_load_dwordx4 v9, s[12:15], s31 offen offset:1024  lds
    s_mov_b32 m0, s36
    s_add_u32 s31, s31, 128
    s_add_u32 s36, s36, 49152
    s_cmp_ge_u32 s36, 147456
    s_cselect_b32 s40, 147456, 0
    s_sub_u32 s36, s36, s40
    buffer_load_dwordx4 v12, s[16:19], s32 offen offset:0  lds
    buffer_load_dwordx4 v13, s[16:19], s32 offen offset:1024  lds
    buffer_load_dwordx4 v14, s[16:19], s32 offen offset:2048  lds
    buffer_load_dwordx4 v15, s[16:19], s32 offen offset:3072  lds
    s_add_u32 s32, s32, s33
    s_mov_b32 m0, s35
    s_add_u32 s35, s35, 49152
    s_cmp_ge_u32 s35, 147456
    s_cselect_b32 s40, 147456, 0
    s_sub_u32 s35, s35, s40
    buffer_load_dwordx4 v8, s[12:15], s31 offen offset:0  lds
    buffer_load_dwordx4 v9, s[12:15], s31 offen offset:1024  lds
    s_mov_b32 m0, s36
    s_add_u32 s31, s31, 128
    s_add_u32 s36, s36, 49152
    s_cmp_ge_u32 s36, 147456
    s_cselect_b32 s40, 147456, 0
    s_sub_u32 s36, s36, s40
    buffer_load_dwordx4 v12, s[16:19], s32 offen offset:0  lds
    buffer_load_dwordx4 v13, s[16:19], s32 offen offset:1024  lds
    buffer_load_dwordx4 v14, s[16:19], s32 offen offset:2048  lds
    buffer_load_dwordx4 v15, s[16:19], s32 offen offset:3072  lds
    s_add_u32 s32, s32, s33
    s_cmp_lg_u32 s6, 0
    s_cbranch_scc1 D_epi
M_K1:
    s_mov_b32 s49, s7
    s_mov_b32 s37, s25
    s_mov_b32 s41, s100
    s_mov_b32 s42, s101
    s_lshr_b32 s44, s26, 2
    s_and_b32 s45, s26, 3
    s_mul_i32 s38, s44, 8192
    v_and_b32 v3, 15, v2
    v_lshrrev_b32 v4, 4, v2
    v_lshrrev_b32 v5, 1, v3
    v_xor_b32 v4, v4, v5
    v_lshlrev_b32 v3, 7, v3
    v_lshl_add_u32 v3, v4, 4, v3
    v_add_u32 v16, s38, v3
    v_xor_b32 v17, 64, v16
    v_and_b32 v3, 3, v2
    v_lshlrev_b32 v3, 3, v3
    s_mul_i32 s38, s45, 128
    v_add_u32 v3, s38, v3
    v_bfe_u32 v4, v2, 2, 2
    v_lshlrev_b32 v5, 6, v4
    v_xor_b32 v3, v3, v5
    v_bfe_u32 v5, v2, 4, 1
    v_lshlrev_b32 v5, 5, v5
    v_xor_b32 v3, v3, v5
    v_lshrrev_b32 v5, 4, v2
    v_lshl_add_u32 v4, v5, 3, v4
    v_mul_u32_u24 v4, 512, v4
    v_add_u32 v18, v3, v4
    v_xor_b32 v19, 32, v18
    v_xor_b32 v20, 64, v18
    v_xor_b32 v21, 96, v18
    s_branch LP_K1
P_V1:
    s_mov_b32 s12, s82
    s_and_b32 s13, s83, 0xffff
    s_mov_b32 s14, 0x400000
    s_mov_b32 s15, 0x20000
    s_mov_b32 s16, s88
    s_and_b32 s17, s89, 0xffff
    s_mov_b32 s18, 0x800000
    s_mov_b32 s19, 0x20000
    s_lshl_b32 s101, s101, 5
    s_mul_i32 s3, s43, 1024
    s_add_u32 s101, s101, s3
    s_mul_i32 s38, s26, 16
    s_add_u32 s38, s38, 0
    v_lshrrev_b32 v3, 3, v2
    v_add_u32 v3, s38, v3
    v_bfe_u32 v4, v3, 1, 3
    v_and_b32 v5, 7, v2
    v_xor_b32 v4, v4, v5
    v_mul_u32_u24 v3, 2048, v3
    v_lshl_add_u32 v3, v4, 4, v3
    v_subrev_u32 v8, 0, v3
    s_mul_i32 s38, s26, 16
    s_add_u32 s38, s38, 8
    v_lshrrev_b32 v3, 3, v2
    v_add_u32 v3, s38, v3
    v_bfe_u32 v4, v3, 1, 3
    v_and_b32 v5, 7, v2
    v_xor_b32 v4, v4, v5
    v_mul_u32_u24 v3, 2048, v3
    v_lshl_add_u32 v3, v4, 4, v3
    v_subrev_u32 v9, 1024, v3
    s_mul_i32 s38, s26, 8
    s_add_u32 s38, s38, 0
    v_lshrrev_b32 v3, 5, v2
    v_add_u32 v3, s38, v3
    v_and_b32 v4, 3, v3
    v_lshlrev_b32 v4, 1, v4
    v_bfe_u32 v5, v3, 3, 1
    v_or_b32 v4, v4, v5
    v_lshlrev_b32 v4, 1, v4
    v_and_b32 v5, 31, v2
    v_xor_b32 v4, v4, v5
    v_lshlrev_b32 v4, 4, v4
    v_mul_u32_u24 v3, 8192, v3
    v_add_u32 v3, v3, v4
    v_subrev_u32 v12, 0, v3
    s_mul_i32 s38, s26, 8
    s_add_u32 s38, s38, 2
    v_lshrrev_b32 v3, 5, v2
    v_add_u32 v3, s38, v3
    v_and_b32 v4, 3, v3
    v_lshlrev_b32 v4, 1, v4
    v_bfe_u32 v5, v3, 3, 1
    v_or_b32 v4, v4, v5
    v_lshlrev_b32 v4, 1, v4
    v_and_b32 v5, 31, v2
    v_xor_b32 v4, v4, v5
    v_lshlrev_b32 v4, 4, v4
    v_mul_u32_u24 v3, 8192, v3
    v_add_u32 v3, v3, v4
    v_subrev_u32 v13, 1024, v3
    s_mul_i32 s38, s26, 8
    s_add_u32 s38, s38, 4
    v_lshrrev_b32 v3, 5, v2
    v_add_u32 v3, s38, v3
    v_and_b32 v4, 3, v3
    v_lshlrev_b32 v4, 1, v4
    v_bfe_u32 v5, v3, 3, 1
    v_or_b32 v4, v4, v5
    v_lshlrev_b32 v4, 1, v4
    v_and_b32 v5, 31, v2
    v_xor_b32 v4, v4, v5
    v_lshlrev_b32 v4, 4, v4
    v_mul_u32_u24 v3, 8192, v3
    v_add_u32 v3, v3, v4
    v_subrev_u32 v14, 2048, v3
    s_mul_i32 s38, s26, 8
    s_add_u32 s38, s38, 6
    v_lshrrev_b32 v3, 5, v2
    v_add_u32 v3, s38, v3
    v_and_b32 v4, 3, v3
    v_lshlrev_b32 v4, 1, v4
    v_bfe_u32 v5, v3, 3, 1
    v_or_b32 v4, v4, v5
    v_lshlrev_b32 v4, 1, v4
    v_and_b32 v5, 31, v2
    v_xor_b32 v4, v4, v5
    v_lshlrev_b32 v4, 4, v4
    v_mul_u32_u24 v3, 8192, v3
    v_add_u32 v3, v3, v4
    v_subrev_u32 v15, 3072, v3
    s_mov_b32 s33, 524288
    s_lshl_b32 s31, s100, 11
    s_lshl_b32 s32, s101, 1
    s_mul_i32 s35, s26, 2048
    s_mul_i32 s36, s26, 4096
    s_add_u32 s36, s36, 16384
    s_mov_b32 m0, s35
    s_add_u32 s35, s35, 49152
    s_cmp_ge_u32 s35, 147456
    s_cselect_b32 s40, 147456, 0
    s_sub_u32 s35, s35, s40
    buffer_load_dwordx4 v8, s[12:15], s31 offen offset:0  lds
    buffer_load_dwordx4 v9, s[12:15], s31 offen offset:1024  lds
    s_mov_b32 m0, s36
    s_add_u32 s31, s31, 128
    s_add_u32 s36, s36, 49152
    s_cmp_ge_u32 s36, 147456
    s_cselect_b32 s40, 147456, 0
    s_sub_u32 s36, s36, s40
    buffer_load_dwordx4 v12, s[16:19], s32 offen offset:0  lds
    buffer_load_dwordx4 v13, s[16:19], s32 offen offset:1024  lds
    buffer_load_dwordx4 v14, s[16:19], s32 offen offset:2048  lds
    buffer_load_dwordx4 v15, s[16:19], s32 offen offset:3072  lds
    s_add_u32 s32, s32, s33
    s_mov_b32 m0, s35
    s_add_u32 s35, s35, 49152
    s_cmp_ge_u32 s35, 147456
    s_cselect_b32 s40, 147456, 0
    s_sub_u32 s35, s35, s40
    buffer_load_dwordx4 v8, s[12:15], s31 offen offset:0  lds
    buffer_load_dwordx4 v9, s[12:15], s31 offen offset:1024  lds
    s_mov_b32 m0, s36
    s_add_u32 s31, s31, 128
    s_add_u32 s36, s36, 49152
    s_cmp_ge_u32 s36, 147456
    s_cselect_b32 s40, 147456, 0
    s_sub_u32 s36, s36, s40
    buffer_load_dwordx4 v12, s[16:19], s32 offen offset:0  lds
    buffer_load_dwordx4 v13, s[16:19], s32 offen offset:1024  lds
    buffer_load_dwordx4 v14, s[16:19], s32 offen offset:2048  lds
    buffer_load_dwordx4 v15, s[16:19], s32 offen offset:3072  lds
    s_add_u32 s32, s32, s33
    s_mov_b32 m0, s35
    s_add_u32 s35, s35, 49152
    s_cmp_ge_u32 s35, 147456
    s_cselect_b32 s40, 147456, 0
    s_sub_u32 s35, s35, s40
    buffer_load_dwordx4 v8, s[12:15], s31 offen offset:0  lds
    buffer_load_dwordx4 v9, s[12:15], s31 offen offset:1024  lds
    s_mov_b32 m0, s36
    s_add_u32 s31, s31, 128
    s_add_u32 s36, s36, 49152
    s_cmp_ge_u32 s36, 147456
    s_cselect_b32 s40, 147456, 0
    s_sub_u32 s36, s36, s40
    buffer_load_dwordx4 v12, s[16:19], s32 offen offset:0  lds
    buffer_load_dwordx4 v13, s[16:19], s32 offen offset:1024  lds
    buffer_load_dwordx4 v14, s[16:19], s32 offen offset:2048  lds
    buffer_load_dwordx4 v15, s[16:19], s32 offen offset:3072  lds
    s_add_u32 s32, s32, s33
    s_cmp_lg_u32 s6, 0
    s_cbranch_scc1 D_epi
M_V1:
    s_mov_b32 s49, s7
    s_mov_b32 s37, s25
    s_mov_b32 s41, s100
    s_mov_b32 s42, s101
    s_lshr_b32 s44, s26, 2
    s_and_b32 s45, s26, 3
    s_mul_i32 s38, s44, 8192
    v_and_b32 v3, 15, v2
    v_lshrrev_b32 v4, 4, v2
    v_lshrrev_b32 v5, 1, v3
    v_xor_b32 v4, v4, v5
    v_lshlrev_b32 v3, 7, v3
    v_lshl_add_u32 v3, v4, 4, v3
    v_add_u32 v16, s38, v3
    v_xor_b32 v17, 64, v16
    v_and_b32 v3, 3, v2
    v_lshlrev_b32 v3, 3, v3
    s_mul_i32 s38, s45, 128
    v_add_u32 v3, s38, v3
    v_bfe_u32 v4, v2, 2, 2
    v_lshlrev_b32 v5, 6, v4
    v_xor_b32 v3, v3, v5
    v_bfe_u32 v5, v2, 4, 1
    v_lshlrev_b32 v5, 5, v5
    v_xor_b32 v3, v3, v5
    v_lshrrev_b32 v5, 4, v2
    v_lshl_add_u32 v4, v5, 3, v4
    v_mul_u32_u24 v4, 512, v4
    v_add_u32 v18, v3, v4
    v_xor_b32 v19, 32, v18
    v_xor_b32 v20, 64, v18
    v_xor_b32 v21, 96, v18
    s_branch LP_V1
P_K:
    s_mov_b32 s12, s82
    s_and_b32 s13, s83, 0xffff
    s_mov_b32 s14, 0x400000
    s_mov_b32 s15, 0x20000
    s_mov_b32 s16, s86
    s_and_b32 s17, s87, 0xffff
    s_mov_b32 s18, 0x800000
    s_mov_b32 s19, 0x20000
    s_lshl_b32 s101, s101, 5
    s_mul_i32 s3, s43, 1024
    s_add_u32 s101, s101, s3
    s_mul_i32 s38, s26, 32
    s_add_u32 s38, s38, 0
    v_lshrrev_b32 v3, 3, v2
    v_add_u32 v3, s38, v3
    v_bfe_u32 v4, v3, 1, 3
    v_and_b32 v5, 7, v2
    v_xor_b32 v4, v4, v5
    v_mul_u32_u24 v3, 2048, v3
    v_lshl_add_u32 v3, v4, 4, v3
    v_subrev_u32 v8, 0, v3
    s_mul_i32 s38, s26, 32
    s_add_u32 s38, s38, 8
    v_lshrrev_b32 v3, 3, v2
    v_add_u32 v3, s38, v3
    v_bfe_u32 v4, v3, 1, 3
    v_and_b32 v5, 7, v2
    v_xor_b32 v4, v4, v5
    v_mul_u32_u24 v3, 2048, v3
    v_lshl_add_u32 v3, v4, 4, v3
    v_subrev_u32 v9, 1024, v3
    s_mul_i32 s38, s26, 32
    s_add_u32 s38, s38, 16
    v_lshrrev_b32 v3, 3, v2
    v_add_u32 v3, s38, v3
    v_bfe_u32 v4, v3, 1, 3
    v_and_b32 v5, 7, v2
    v_xor_b32 v4, v4, v5
    v_mul_u32_u24 v3, 2048, v3
    v_lshl_add_u32 v3, v4, 4, v3
    v_subrev_u32 v10, 2048, v3
    s_mul_i32 s38, s26, 32
    s_add_u32 s38, s38, 24
    v_lshrrev_b32 v3, 3, v2
    v_add_u32 v3, s38, v3
    v_bfe_u32 v4, v3, 1, 3
    v_and_b32 v5, 7, v2
    v_xor_b32 v4, v4, v5
    v_mul_u32_u24 v3, 2048, v3
    v_lshl_add_u32 v3, v4, 4, v3
    v_subrev_u32 v11, 3072, v3
    s_mul_i32 s38, s26, 8
    s_add_u32 s38, s38, 0
    v_lshrrev_b32 v3, 5, v2
    v_add_u32 v3, s38, v3
    v_and_b32 v4, 3, v3
    v_lshlrev_b32 v4, 1, v4
    v_bfe_u32 v5, v3, 3, 1
    v_or_b32 v4, v4, v5
    v_lshlrev_b32 v4, 1, v4
    v_and_b32 v5, 31, v2
    v_xor_b32 v4, v4, v5
    v_lshlrev_b32 v4, 4, v4
    v_mul_u32_u24 v3, 8192, v3
    v_add_u32 v3, v3, v4
    v_subrev_u32 v12, 0, v3
    s_mul_i32 s38, s26, 8
    s_add_u32 s38, s38, 2
    v_lshrrev_b32 v3, 5, v2
    v_add_u32 v3, s38, v3
    v_and_b32 v4, 3, v3
    v_lshlrev_b32 v4, 1, v4
    v_bfe_u32 v5, v3, 3, 1
    v_or_b32 v4, v4, v5
    v_lshlrev_b32 v4, 1, v4
    v_and_b32 v5, 31, v2
    v_xor_b32 v4, v4, v5
    v_lshlrev_b32 v4, 4, v4
    v_mul_u32_u24 v3, 8192, v3
    v_add_u32 v3, v3, v4
    v_subrev_u32 v13, 1024, v3
    s_mul_i32 s38, s26, 8
    s_add_u32 s38, s38, 4
    v_lshrrev_b32 v3, 5, v2
    v_add_u32 v3, s38, v3
    v_and_b32 v4, 3, v3
    v_lshlrev_b32 v4, 1, v4
    v_bfe_u32 v5, v3, 3, 1
    v_or_b32 v4, v4, v5
    v_lshlrev_b32 v4, 1, v4
    v_and_b32 v5, 31, v2
    v_xor_b32 v4, v4, v5
    v_lshlrev_b32 v4, 4, v4
    v_mul_u32_u24 v3, 8192, v3
    v_add_u32 v3, v3, v4
    v_subrev_u32 v14, 2048, v3
    s_mul_i32 s38, s26, 8
    s_add_u32 s38, s38, 6
    v_lshrrev_b32 v3, 5, v2
    v_add_u32 v3, s38, v3
    v_and_b32 v4, 3, v3
    v_lshlrev_b32 v4, 1, v4
    v_bfe_u32 v5, v3, 3, 1
    v_or_b32 v4, v4, v5
    v_lshlrev_b32 v4, 1, v4
    v_and_b32 v5, 31, v2
    v_xor_b32 v4, v4, v5
    v_lshlrev_b32 v4, 4, v4
    v_mul_u32_u24 v3, 8192, v3
    v_add_u32 v3, v3, v4
    v_subrev_u32 v15, 3072, v3
    s_mov_b32 s33, 524288
    s_lshl_b32 s31, s100, 11
    s_lshl_b32 s32, s101, 1
    s_mul_i32 s35, s26, 4096
    s_mul_i32 s36, s26, 4096
    s_add_u32 s36, s36, 32768
    s_mov_b32 m0, s35
    s_xor_b32 s35, s35, 65536
    buffer_load_dwordx4 v8, s[12:15], s31 offen offset:0  lds
    buffer_load_dwordx4 v9, s[12:15], s31 offen offset:1024  lds
    buffer_load_dwordx4 v10, s[12:15], s31 offen offset:2048  lds
    buffer_load_dwordx4 v11, s[12:15], s31 offen offset:3072  lds
    s_mov_b32 m0, s36
    s_add_u32 s31, s31, 128
    s_xor_b32 s36, s36, 65536
    buffer_load_dwordx4 v12, s[16:19], s32 offen offset:0  lds
    buffer_load_dwordx4 v13, s[16:19], s32 offen offset:1024  lds
    buffer_load_dwordx4 v14, s[16:19], s32 offen offset:2048  lds
    buffer_load_dwordx4 v15, s[16:19], s32 offen offset:3072  lds
    s_add_u32 s32, s32, s33
    s_mov_b32 m0, s35
    s_xor_b32 s35, s35, 65536
    buffer_load_dwordx4 v8, s[12:15], s31 offen offset:0  lds
    buffer_load_dwordx4 v9, s[12:15], s31 offen offset:1024  lds
    buffer_load_dwordx4 v10, s[12:15], s31 offen offset:2048  lds
    buffer_load_dwordx4 v11, s[12:15], s31 offen offset:3072  lds
    s_mov_b32 m0, s36
    s_add_u32 s31, s31, 128
    s_xor_b32 s36, s36, 65536
    buffer_load_dwordx4 v12, s[16:19], s32 offen offset:0  lds
    buffer_load_dwordx4 v13, s[16:19], s32 offen offset:1024  lds
    buffer_load_dwordx4 v14, s[16:19], s32 offen offset:2048  lds
    buffer_load_dwordx4 v15, s[16:19], s32 offen offset:3072  lds
    s_add_u32 s32, s32, s33
    s_cmp_lg_u32 s6, 0
    s_cbranch_scc1 D_epi
M_K:
    s_mov_b32 s49, s7
    s_mov_b32 s37, s25
    s_mov_b32 s41, s100
    s_mov_b32 s42, s101
    s_lshr_b32 s44, s26, 2
    s_and_b32 s45, s26, 3
    s_mul_i32 s38, s44, 16384
    v_and_b32 v3, 15, v2
    v_lshrrev_b32 v4, 4, v2
    v_lshrrev_b32 v5, 1, v3
    v_xor_b32 v4, v4, v5
    v_lshlrev_b32 v3, 7, v3
    v_lshl_add_u32 v3, v4, 4, v3
    v_add_u32 v16, s38, v3
    v_xor_b32 v17, 64, v16
    v_and_b32 v3, 3, v2
    v_lshlrev_b32 v3, 3, v3
    s_mul_i32 s38, s45, 128
    v_add_u32 v3, s38, v3
    v_bfe_u32 v4, v2, 2, 2
    v_lshlrev_b32 v5, 6, v4
    v_xor_b32 v3, v3, v5
    v_bfe_u32 v5, v2, 4, 1
    v_lshlrev_b32 v5, 5, v5
    v_xor_b32 v3, v3, v5
    v_lshrrev_b32 v5, 4, v2
    v_lshl_add_u32 v4, v5, 3, v4
    v_mul_u32_u24 v4, 512, v4
    v_add_u32 v18, v3, v4
    v_xor_b32 v19, 32, v18
    v_xor_b32 v20, 64, v18
    v_xor_b32 v21, 96, v18
    s_branch LP_K
P_V:
    s_mov_b32 s12, s82
    s_and_b32 s13, s83, 0xffff
    s_mov_b32 s14, 0x400000
    s_mov_b32 s15, 0x20000
    s_mov_b32 s16, s88
    s_and_b32 s17, s89, 0xffff
    s_mov_b32 s18, 0x800000
    s_mov_b32 s19, 0x20000
    s_lshl_b32 s101, s101, 5
    s_mul_i32 s3, s43, 1024
    s_add_u32 s101, s101, s3
    s_mul_i32 s38, s26, 32
    s_add_u32 s38, s38, 0
    v_lshrrev_b32 v3, 3, v2
    v_add_u32 v3, s38, v3
    v_bfe_u32 v4, v3, 1, 3
    v_and_b32 v5, 7, v2
    v_xor_b32 v4, v4, v5
    v_mul_u32_u24 v3, 2048, v3
    v_lshl_add_u32 v3, v4, 4, v3
    v_subrev_u32 v8, 0, v3
    s_mul_i32 s38, s26, 32
    s_add_u32 s38, s38, 8
    v_lshrrev_b32 v3, 3, v2
    v_add_u32 v3, s38, v3
    v_bfe_u32 v4, v3, 1, 3
    v_and_b32 v5, 7, v2
    v_xor_b32 v4, v4, v5
    v_mul_u32_u24 v3, 2048, v3
    v_lshl_add_u32 v3, v4, 4, v3
    v_subrev_u32 v9, 1024, v3
    s_mul_i32 s38, s26, 32
    s_add_u32 s38, s38, 16
    v_lshrrev_b32 v3, 3, v2
    v_add_u32 v3, s38, v3
    v_bfe_u32 v4, v3, 1, 3
    v_and_b32 v5, 7, v2
    v_xor_b32 v4, v4, v5
    v_mul_u32_u24 v3, 2048, v3
    v_lshl_add_u32 v3, v4, 4, v3
    v_subrev_u32 v10, 2048, v3
    s_mul_i32 s38, s26, 32
    s_add_u32 s38, s38, 24
    v_lshrrev_b32 v3, 3, v2
    v_add_u32 v3, s38, v3
    v_bfe_u32 v4, v3, 1, 3
    v_and_b32 v5, 7, v2
    v_xor_b32 v4, v4, v5
    v_mul_u32_u24 v3, 2048, v3
    v_lshl_add_u32 v3, v4, 4, v3
    v_subrev_u32 v11, 3072, v3
    s_mul_i32 s38, s26, 8
    s_add_u32 s38, s38, 0
    v_lshrrev_b32 v3, 5, v2
    v_add_u32 v3, s38, v3
    v_and_b32 v4, 3, v3
    v_lshlrev_b32 v4, 1, v4
    v_bfe_u32 v5, v3, 3, 1
    v_or_b32 v4, v4, v5
    v_lshlrev_b32 v4, 1, v4
    v_and_b32 v5, 31, v2
    v_xor_b32 v4, v4, v5
    v_lshlrev_b32 v4, 4, v4
    v_mul_u32_u24 v3, 8192, v3
    v_add_u32 v3, v3, v4
    v_subrev_u32 v12, 0, v3
    s_mul_i32 s38, s26, 8
    s_add_u32 s38, s38, 2
    v_lshrrev_b32 v3, 5, v2
    v_add_u32 v3, s38, v3
    v_and_b32 v4, 3, v3
    v_lshlrev_b32 v4, 1, v4
    v_bfe_u32 v5, v3, 3, 1
    v_or_b32 v4, v4, v5
    v_lshlrev_b32 v4, 1, v4
    v_and_b32 v5, 31, v2
    v_xor_b32 v4, v4, v5
    v_lshlrev_b32 v4, 4, v4
    v_mul_u32_u24 v3, 8192, v3
    v_add_u32 v3, v3, v4
    v_subrev_u32 v13, 1024, v3
    s_mul_i32 s38, s26, 8
    s_add_u32 s38, s38, 4
    v_lshrrev_b32 v3, 5, v2
    v_add_u32 v3, s38, v3
    v_and_b32 v4, 3, v3
    v_lshlrev_b32 v4, 1, v4
    v_bfe_u32 v5, v3, 3, 1
    v_or_b32 v4, v4, v5
    v_lshlrev_b32 v4, 1, v4
    v_and_b32 v5, 31, v2
    v_xor_b32 v4, v4, v5
    v_lshlrev_b32 v4, 4, v4
    v_mul_u32_u24 v3, 8192, v3
    v_add_u32 v3, v3, v4
    v_subrev_u32 v14, 2048, v3
    s_mul_i32 s38, s26, 8
    s_add_u32 s38, s38, 6
    v_lshrrev_b32 v3, 5, v2
    v_add_u32 v3, s38, v3
    v_and_b32 v4, 3, v3
    v_lshlrev_b32 v4, 1, v4
    v_bfe_u32 v5, v3, 3, 1
    v_or_b32 v4, v4, v5
    v_lshlrev_b32 v4, 1, v4
    v_and_b32 v5, 31, v2
    v_xor_b32 v4, v4, v5
    v_lshlrev_b32 v4, 4, v4
    v_mul_u32_u24 v3, 8192, v3
    v_add_u32 v3, v3, v4
    v_subrev_u32 v15, 3072, v3
    s_mov_b32 s33, 524288
    s_lshl_b32 s31, s100, 11
    s_lshl_b32 s32, s101, 1
    s_mul_i32 s35, s26, 4096
    s_mul_i32 s36, s26, 4096
    s_add_u32 s36, s36, 32768
    s_mov_b32 m0, s35
    s_xor_b32 s35, s35, 65536
    buffer_load_dwordx4 v8, s[12:15], s31 offen offset:0  lds
    buffer_load_dwordx4 v9, s[12:15], s31 offen offset:1024  lds
    buffer_load_dwordx4 v10, s[12:15], s31 offen offset:2048  lds
    buffer_load_dwordx4 v11, s[12:15], s31 offen offset:3072  lds
    s_mov_b32 m0, s36
    s_add_u32 s31, s31, 128
    s_xor_b32 s36, s36, 65536
    buffer_load_dwordx4 v12, s[16:19], s32 offen offset:0  lds
    buffer_load_dwordx4 v13, s[16:19], s32 offen offset:1024  lds
    buffer_load_dwordx4 v14, s[16:19], s32 offen offset:2048  lds
    buffer_load_dwordx4 v15, s[16:19], s32 offen offset:3072  lds
    s_add_u32 s32, s32, s33
    s_mov_b32 m0, s35
    s_xor_b32 s35, s35, 65536
    buffer_load_dwordx4 v8, s[12:15], s31 offen offset:0  lds
    buffer_load_dwordx4 v9, s[12:15], s31 offen offset:1024  lds
    buffer_load_dwordx4 v10, s[12:15], s31 offen offset:2048  lds
    buffer_load_dwordx4 v11, s[12:15], s31 offen offset:3072  lds
    s_mov_b32 m0, s36
    s_add_u32 s31, s31, 128
    s_xor_b32 s36, s36, 65536
    buffer_load_dwordx4 v12, s[16:19], s32 offen offset:0  lds
    buffer_load_dwordx4 v13, s[16:19], s32 offen offset:1024  lds
    buffer_load_dwordx4 v14, s[16:19], s32 offen offset:2048  lds
    buffer_load_dwordx4 v15, s[16:19], s32 offen offset:3072  lds
    s_add_u32 s32, s32, s33
    s_cmp_lg_u32 s6, 0
    s_cbranch_scc1 D_epi
M_V:
    s_mov_b32 s49, s7
    s_mov_b32 s37, s25
    s_mov_b32 s41, s100
    s_mov_b32 s42, s101
    s_lshr_b32 s44, s26, 2
    s_and_b32 s45, s26, 3
    s_mul_i32 s38, s44, 16384
    v_and_b32 v3, 15, v2
    v_lshrrev_b32 v4, 4, v2
    v_lshrrev_b32 v5, 1, v3
    v_xor_b32 v4, v4, v5
    v_lshlrev_b32 v3, 7, v3
    v_lshl_add_u32 v3, v4, 4, v3
    v_add_u32 v16, s38, v3
    v_xor_b32 v17, 64, v16
    v_and_b32 v3, 3, v2
    v_lshlrev_b32 v3, 3, v3
    s_mul_i32 s38, s45, 128
    v_add_u32 v3, s38, v3
    v_bfe_u32 v4, v2, 2, 2
    v_lshlrev_b32 v5, 6, v4
    v_xor_b32 v3, v3, v5
    v_bfe_u32 v5, v2, 4, 1
    v_lshlrev_b32 v5, 5, v5
    v_xor_b32 v3, v3, v5
    v_lshrrev_b32 v5, 4, v2
    v_lshl_add_u32 v4, v5, 3, v4
    v_mul_u32_u24 v4, 512, v4
    v_add_u32 v18, v3, v4
    v_xor_b32 v19, 32, v18
    v_xor_b32 v20, 64, v18
    v_xor_b32 v21, 96, v18
    s_branch LP_V
P_AKV:
    s_mov_b32 s12, s92
    s_and_b32 s13, s93, 0xffff
    s_mov_b32 s14, 0x400000
    s_mov_b32 s15, 0x20000
    s_mov_b32 s16, s94
    s_and_b32 s17, s95, 0xffff
    s_mov_b32 s18, 0x600000
    s_mov_b32 s19, 0x20000
    s_lshl_b32 s3, s43, 3
    s_add_u32 s101, s101, s3
    s_mul_i32 s38, s26, 32
    s_add_u32 s38, s38, 0
    v_lshrrev_b32 v3, 3, v2
    v_add_u32 v3, s38, v3
    v_bfe_u32 v4, v3, 1, 3
    v_and_b32 v5, 7, v2
    v_xor_b32 v4, v4, v5
    v_mul_u32_u24 v3, 2048, v3
    v_lshl_add_u32 v3, v4, 4, v3
    v_subrev_u32 v8, 0, v3
    s_mul_i32 s38, s26, 32
    s_add_u32 s38, s38, 8
    v_lshrrev_b32 v3, 3, v2
    v_add_u32 v3, s38, v3
    v_bfe_u32 v4, v3, 1, 3
    v_and_b32 v5, 7, v2
    v_xor_b32 v4, v4, v5
    v_mul_u32_u24 v3, 2048, v3
    v_lshl_add_u32 v3, v4, 4, v3
    v_subrev_u32 v9, 1024, v3
    s_mul_i32 s38, s26, 32
    s_add_u32 s38, s38, 16
    v_lshrrev_b32 v3, 3, v2
    v_add_u32 v3, s38, v3
    v_bfe_u32 v4, v3, 1, 3
    v_and_b32 v5, 7, v2
    v_xor_b32 v4, v4, v5
    v_mul_u32_u24 v3, 2048, v3
    v_lshl_add_u32 v3, v4, 4, v3
    v_subrev_u32 v10, 2048, v3
    s_mul_i32 s38, s26, 32
    s_add_u32 s38, s38, 24
    v_lshrrev_b32 v3, 3, v2
    v_add_u32 v3, s38, v3
    v_bfe_u32 v4, v3, 1, 3
    v_and_b32 v5, 7, v2
    v_xor_b32 v4, v4, v5
    v_mul_u32_u24 v3, 2048, v3
    v_lshl_add_u32 v3, v4, 4, v3
    v_subrev_u32 v11, 3072, v3
    s_mul_i32 s38, s26, 8
    s_add_u32 s38, s38, 0
    v_lshrrev_b32 v3, 5, v2
    v_add_u32 v3, s38, v3
    v_and_b32 v4, 3, v3
    v_lshlrev_b32 v4, 1, v4
    v_bfe_u32 v5, v3, 3, 1
    v_or_b32 v4, v4, v5
    v_lshlrev_b32 v4, 1, v4
    v_and_b32 v5, 31, v2
    v_xor_b32 v4, v4, v5
    v_bfe_u32 v5, v4, 2, 1
    v_lshlrev_b32 v5, 11, v5
    v_add_u32 v5, 2048, v5
    v_lshrrev_b32 v6, 3, v4
    v_lshl_add_u32 v5, v6, 6, v5
    v_and_b32 v4, 3, v4
    v_lshl_add_u32 v4, v4, 4, v5
    v_mul_u32_u24 v3, 6144, v3
    v_add_u32 v3, v3, v4
    v_subrev_u32 v12, 0, v3
    s_mul_i32 s38, s26, 8
    s_add_u32 s38, s38, 2
    v_lshrrev_b32 v3, 5, v2
    v_add_u32 v3, s38, v3
    v_and_b32 v4, 3, v3
    v_lshlrev_b32 v4, 1, v4
    v_bfe_u32 v5, v3, 3, 1
    v_or_b32 v4, v4, v5
    v_lshlrev_b32 v4, 1, v4
    v_and_b32 v5, 31, v2
    v_xor_b32 v4, v4, v5
    v_bfe_u32 v5, v4, 2, 1
    v_lshlrev_b32 v5, 11, v5
    v_add_u32 v5, 2048, v5
    v_lshrrev_b32 v6, 3, v4
    v_lshl_add_u32 v5, v6, 6, v5
    v_and_b32 v4, 3, v4
    v_lshl_add_u32 v4, v4, 4, v5
    v_mul_u32_u24 v3, 6144, v3
    v_add_u32 v3, v3, v4
    v_subrev_u32 v13, 1024, v3
    s_mul_i32 s38, s26, 8
    s_add_u32 s38, s38, 4
    v_lshrrev_b32 v3, 5, v2
    v_add_u32 v3, s38, v3
    v_and_b32 v4, 3, v3
    v_lshlrev_b32 v4, 1, v4
    v_bfe_u32 v5, v3, 3, 1
    v_or_b32 v4, v4, v5
    v_lshlrev_b32 v4, 1, v4
    v_and_b32 v5, 31, v2
    v_xor_b32 v4, v4, v5
    v_bfe_u32 v5, v4, 2, 1
    v_lshlrev_b32 v5, 11, v5
    v_add_u32 v5, 2048, v5
    v_lshrrev_b32 v6, 3, v4
    v_lshl_add_u32 v5, v6, 6, v5
    v_and_b32 v4, 3, v4
    v_lshl_add_u32 v4, v4, 4, v5
    v_mul_u32_u24 v3, 6144, v3
    v_add_u32 v3, v3, v4
    v_subrev_u32 v14, 2048, v3
    s_mul_i32 s38, s26, 8
    s_add_u32 s38, s38, 6
    v_lshrrev_b32 v3, 5, v2
    v_add_u32 v3, s38, v3
    v_and_b32 v4, 3, v3
    v_lshlrev_b32 v4, 1, v4
    v_bfe_u32 v5, v3, 3, 1
    v_or_b32 v4, v4, v5
    v_lshlrev_b32 v4, 1, v4
    v_and_b32 v5, 31, v2
    v_xor_b32 v4, v4, v5
    v_bfe_u32 v5, v4, 2, 1
    v_lshlrev_b32 v5, 11, v5
    v_add_u32 v5, 2048, v5
    v_lshrrev_b32 v6, 3, v4
    v_lshl_add_u32 v5, v6, 6, v5
    v_and_b32 v4, 3, v4
    v_lshl_add_u32 v4, v4, 4, v5
    v_mul_u32_u24 v3, 6144, v3
    v_add_u32 v3, v3, v4
    v_subrev_u32 v15, 3072, v3
    s_mov_b32 s33, 393216
    s_lshl_b32 s31, s100, 11
    s_lshl_b32 s32, s101, 6
    s_mul_i32 s35, s26, 4096
    s_mul_i32 s36, s26, 4096
    s_add_u32 s36, s36, 32768
    s_mov_b32 m0, s35
    s_xor_b32 s35, s35, 65536
    buffer_load_dwordx4 v8, s[12:15], s31 offen offset:0  lds
    buffer_load_dwordx4 v9, s[12:15], s31 offen offset:1024  lds
    buffer_load_dwordx4 v10, s[12:15], s31 offen offset:2048  lds
    buffer_load_dwordx4 v11, s[12:15], s31 offen offset:3072  lds
    s_mov_b32 m0, s36
    s_add_u32 s31, s31, 128
    s_xor_b32 s36, s36, 65536
    buffer_load_dwordx4 v12, s[16:19], s32 offen offset:0  lds
    buffer_load_dwordx4 v13, s[16:19], s32 offen offset:1024  lds
    buffer_load_dwordx4 v14, s[16:19], s32 offen offset:2048  lds
    buffer_load_dwordx4 v15, s[16:19], s32 offen offset:3072  lds
    s_add_u32 s32, s32, s33
    s_mov_b32 m0, s35
    s_xor_b32 s35, s35, 65536
    buffer_load_dwordx4 v8, s[12:15], s31 offen offset:0  lds
    buffer_load_dwordx4 v9, s[12:15], s31 offen offset:1024  lds
    buffer_load_dwordx4 v10, s[12:15], s31 offen offset:2048  lds
    buffer_load_dwordx4 v11, s[12:15], s31 offen offset:3072  lds
    s_mov_b32 m0, s36
    s_add_u32 s31, s31, 128
    s_xor_b32 s36, s36, 65536
    buffer_load_dwordx4 v12, s[16:19], s32 offen offset:0  lds
    buffer_load_dwordx4 v13, s[16:19], s32 offen offset:1024  lds
    buffer_load_dwordx4 v14, s[16:19], s32 offen offset:2048  lds
    buffer_load_dwordx4 v15, s[16:19], s32 offen offset:3072  lds
    s_add_u32 s32, s32, s33
    s_cmp_lg_u32 s6, 0
    s_cbranch_scc1 D_epi
M_AKV:
    s_mov_b32 s49, s7
    s_mov_b32 s37, s25
    s_mov_b32 s41, s100
    s_mov_b32 s42, s101
    s_lshr_b32 s44, s26, 2
    s_and_b32 s45, s26, 3
    s_mul_i32 s38, s44, 16384
    v_and_b32 v3, 15, v2
    v_lshrrev_b32 v4, 4, v2
    v_lshrrev_b32 v5, 1, v3
    v_xor_b32 v4, v4, v5
    v_lshlrev_b32 v3, 7, v3
    v_lshl_add_u32 v3, v4, 4, v3
    v_add_u32 v16, s38, v3
    v_xor_b32 v17, 64, v16
    v_and_b32 v3, 3, v2
    v_lshlrev_b32 v3, 3, v3
    s_mul_i32 s38, s45, 128
    v_add_u32 v3, s38, v3
    v_bfe_u32 v4, v2, 2, 2
    v_lshlrev_b32 v5, 6, v4
    v_xor_b32 v3, v3, v5
    v_bfe_u32 v5, v2, 4, 1
    v_lshlrev_b32 v5, 5, v5
    v_xor_b32 v3, v3, v5
    v_lshrrev_b32 v5, 4, v2
    v_lshl_add_u32 v4, v5, 3, v4
    v_mul_u32_u24 v4, 512, v4
    v_add_u32 v18, v3, v4
    v_xor_b32 v19, 32, v18
    v_xor_b32 v20, 64, v18
    v_xor_b32 v21, 96, v18
    s_branch LP_AKV
P_AQ:
    s_mov_b32 s12, s92
    s_and_b32 s13, s93, 0xffff
    s_mov_b32 s14, 0x400000
    s_mov_b32 s15, 0x20000
    s_mov_b32 s16, s94
    s_and_b32 s17, s95, 0xffff
    s_mov_b32 s18, 0x600000
    s_mov_b32 s19, 0x20000
    s_lshl_b32 s101, s101, 5
    s_mul_i32 s3, s43, 256
    s_add_u32 s101, s101, s3
    s_mul_i32 s38, s26, 32
    s_add_u32 s38, s38, 0
    v_lshrrev_b32 v3, 3, v2
    v_add_u32 v3, s38, v3
    v_bfe_u32 v4, v3, 1, 3
    v_and_b32 v5, 7, v2
    v_xor_b32 v4, v4, v5
    v_mul_u32_u24 v3, 2048, v3
    v_lshl_add_u32 v3, v4, 4, v3
    v_subrev_u32 v8, 0, v3
    s_mul_i32 s38, s26, 32
    s_add_u32 s38, s38, 8
    v_lshrrev_b32 v3, 3, v2
    v_add_u32 v3, s38, v3
    v_bfe_u32 v4, v3, 1, 3
    v_and_b32 v5, 7, v2
    v_xor_b32 v4, v4, v5
    v_mul_u32_u24 v3, 2048, v3
    v_lshl_add_u32 v3, v4, 4, v3
    v_subrev_u32 v9, 1024, v3
    s_mul_i32 s38, s26, 32
    s_add_u32 s38, s38, 16
    v_lshrrev_b32 v3, 3, v2
    v_add_u32 v3, s38, v3
    v_bfe_u32 v4, v3, 1, 3
    v_and_b32 v5, 7, v2
    v_xor_b32 v4, v4, v5
    v_mul_u32_u24 v3, 2048, v3
    v_lshl_add_u32 v3, v4, 4, v3
    v_subrev_u32 v10, 2048, v3
    s_mul_i32 s38, s26, 32
    s_add_u32 s38, s38, 24
    v_lshrrev_b32 v3, 3, v2
    v_add_u32 v3, s38, v3
    v_bfe_u32 v4, v3, 1, 3
    v_and_b32 v5, 7, v2
    v_xor_b32 v4, v4, v5
    v_mul_u32_u24 v3, 2048, v3
    v_lshl_add_u32 v3, v4, 4, v3
    v_subrev_u32 v11, 3072, v3
    s_mul_i32 s38, s26, 8
    s_add_u32 s38, s38, 0
    v_lshrrev_b32 v3, 5, v2
    v_add_u32 v3, s38, v3
    v_and_b32 v4, 3, v3
    v_lshlrev_b32 v4, 1, v4
    v_bfe_u32 v5, v3, 3, 1
    v_or_b32 v4, v4, v5
    v_lshlrev_b32 v4, 1, v4
    v_and_b32 v5, 31, v2
    v_xor_b32 v4, v4, v5
    v_lshlrev_b32 v4, 4, v4
    v_mul_u32_u24 v3, 6144, v3
    v_add_u32 v3, v3, v4
    v_subrev_u32 v12, 0, v3
    s_mul_i32 s38, s26, 8
    s_add_u32 s38, s38, 2
    v_lshrrev_b32 v3, 5, v2
    v_add_u32 v3, s38, v3
    v_and_b32 v4, 3, v3
    v_lshlrev_b32 v4, 1, v4
    v_bfe_u32 v5, v3, 3, 1
    v_or_b32 v4, v4, v5
    v_lshlrev_b32 v4, 1, v4
    v_and_b32 v5, 31, v2
    v_xor_b32 v4, v4, v5
    v_lshlrev_b32 v4, 4, v4
    v_mul_u32_u24 v3, 6144, v3
    v_add_u32 v3, v3, v4
    v_subrev_u32 v13, 1024, v3
    s_mul_i32 s38, s26, 8
    s_add_u32 s38, s38, 4
    v_lshrrev_b32 v3, 5, v2
    v_add_u32 v3, s38, v3
    v_and_b32 v4, 3, v3
    v_lshlrev_b32 v4, 1, v4
    v_bfe_u32 v5, v3, 3, 1
    v_or_b32 v4, v4, v5
    v_lshlrev_b32 v4, 1, v4
    v_and_b32 v5, 31, v2
    v_xor_b32 v4, v4, v5
    v_lshlrev_b32 v4, 4, v4
    v_mul_u32_u24 v3, 6144, v3
    v_add_u32 v3, v3, v4
    v_subrev_u32 v14, 2048, v3
    s_mul_i32 s38, s26, 8
    s_add_u32 s38, s38, 6
    v_lshrrev_b32 v3, 5, v2
    v_add_u32 v3, s38, v3
    v_and_b32 v4, 3, v3
    v_lshlrev_b32 v4, 1, v4
    v_bfe_u32 v5, v3, 3, 1
    v_or_b32 v4, v4, v5
    v_lshlrev_b32 v4, 1, v4
    v_and_b32 v5, 31, v2
    v_xor_b32 v4, v4, v5
    v_lshlrev_b32 v4, 4, v4
    v_mul_u32_u24 v3, 6144, v3
    v_add_u32 v3, v3, v4
    v_subrev_u32 v15, 3072, v3
    s_mov_b32 s33, 393216
    s_lshl_b32 s31, s100, 11
    s_lshl_b32 s32, s101, 1
    s_mul_i32 s35, s26, 4096
    s_mul_i32 s36, s26, 4096
    s_add_u32 s36, s36, 32768
    s_mov_b32 m0, s35
    s_xor_b32 s35, s35, 65536
    buffer_load_dwordx4 v8, s[12:15], s31 offen offset:0  lds
    buffer_load_dwordx4 v9, s[12:15], s31 offen offset:1024  lds
    buffer_load_dwordx4 v10, s[12:15], s31 offen offset:2048  lds
    buffer_load_dwordx4 v11, s[12:15], s31 offen offset:3072  lds
    s_mov_b32 m0, s36
    s_add_u32 s31, s31, 128
    s_xor_b32 s36, s36, 65536
    buffer_load_dwordx4 v12, s[16:19], s32 offen offset:0  lds
    buffer_load_dwordx4 v13, s[16:19], s32 offen offset:1024  lds
    buffer_load_dwordx4 v14, s[16:19], s32 offen offset:2048  lds
    buffer_load_dwordx4 v15, s[16:19], s32 offen offset:3072  lds
    s_add_u32 s32, s32, s33
    s_mov_b32 m0, s35
    s_xor_b32 s35, s35, 65536
    buffer_load_dwordx4 v8, s[12:15], s31 offen offset:0  lds
    buffer_load_dwordx4 v9, s[12:15], s31 offen offset:1024  lds
    buffer_load_dwordx4 v10, s[12:15], s31 offen offset:2048  lds
    buffer_load_dwordx4 v11, s[12:15], s31 offen offset:3072  lds
    s_mov_b32 m0, s36
    s_add_u32 s31, s31, 128
    s_xor_b32 s36, s36, 65536
    buffer_load_dwordx4 v12, s[16:19], s32 offen offset:0  lds
    buffer_load_dwordx4 v13, s[16:19], s32 offen offset:1024  lds
    buffer_load_dwordx4 v14, s[16:19], s32 offen offset:2048  lds
    buffer_load_dwordx4 v15, s[16:19], s32 offen offset:3072  lds
    s_add_u32 s32, s32, s33
    s_cmp_lg_u32 s6, 0
    s_cbranch_scc1 D_epi
M_AQ:
    s_mov_b32 s49, s7
    s_mov_b32 s37, s25
    s_mov_b32 s41, s100
    s_mov_b32 s42, s101
    s_lshr_b32 s44, s26, 2
    s_and_b32 s45, s26, 3
    s_mul_i32 s38, s44, 16384
    v_and_b32 v3, 15, v2
    v_lshrrev_b32 v4, 4, v2
    v_lshrrev_b32 v5, 1, v3
    v_xor_b32 v4, v4, v5
    v_lshlrev_b32 v3, 7, v3
    v_lshl_add_u32 v3, v4, 4, v3
    v_add_u32 v16, s38, v3
    v_xor_b32 v17, 64, v16
    v_and_b32 v3, 3, v2
    v_lshlrev_b32 v3, 3, v3
    s_mul_i32 s38, s45, 128
    v_add_u32 v3, s38, v3
    v_bfe_u32 v4, v2, 2, 2
    v_lshlrev_b32 v5, 6, v4
    v_xor_b32 v3, v3, v5
    v_bfe_u32 v5, v2, 4, 1
    v_lshlrev_b32 v5, 5, v5
    v_xor_b32 v3, v3, v5
    v_lshrrev_b32 v5, 4, v2
    v_lshl_add_u32 v4, v5, 3, v4
    v_mul_u32_u24 v4, 512, v4
    v_add_u32 v18, v3, v4
    v_xor_b32 v19, 32, v18
    v_xor_b32 v20, 64, v18
    v_xor_b32 v21, 96, v18
    s_branch LP_AQ
P_T4:
    s_cmp_lg_u32 s79, -1
    s_cbranch_scc1 hp_189
ht_190:
    s_sub_u32 s30, s30, 1
    s_cbranch_scc1 L_end
    v_mov_b32 v30, 128
    buffer_load_dword v31, v30, s[20:23], 0 offen sc1
hc_191:
    s_waitcnt vmcnt(0)
    v_readfirstlane_b32 s3, v31
    s_nop 3
    s_and_b32 s40, s3, 0xffff
    s_cmp_lt_u32 s40, 128
    s_cbranch_scc1 ht_190
    s_add_u32 s3, s3, 4128768
    s_lshr_b32 s3, s3, 10
    s_and_b32 s79, s3, 8192
hp_189:
    s_lshr_b32 s40, s100, 5
    s_lshl_b32 s40, s40, 7
    s_add_u32 s40, s40, 79708160
    s_cmp_lg_u32 s6, 0
    s_cbranch_scc1 re_192
    s_cmp_lg_u32 s26, 0
    s_cbranch_scc1 wf_195
    v_mov_b32 v3, s40
    v_bfe_u32 v5, v2, 2, 2
    v_lshlrev_b32 v5, 7, v5
    v_and_b32 v6, 3, v2
    v_lshl_add_u32 v5, v6, 2, v5
    v_add_u32 v3, v3, v5
wt_196:
    buffer_load_dword v4, v3, s[8:11], 0 offen sc1
    s_sub_u32 s30, s30, 1
    s_cbranch_scc1 L_end
    s_waitcnt vmcnt(0)
    v_cmp_gt_u32 vcc, 8, v4
    s_cbranch_vccz wf_195
    s_sleep 8
    s_branch wt_196
wf_195:
    s_barrier
    s_branch rd_193
re_192:
    v_mov_b32 v7, 163588
    s_cmp_lg_u32 s26, 0
    s_cbranch_scc1 rl_194
    v_mov_b32 v3, s40
    v_bfe_u32 v5, v2, 2, 2
    v_lshlrev_b32 v5, 7, v5
    v_and_b32 v6, 3, v2
    v_lshl_add_u32 v5, v6, 2, v5
    v_add_u32 v3, v3, v5
    buffer_load_dword v4, v3, s[8:11], 0 offen sc1
    s_waitcnt vmcnt(0)
    v_cmp_gt_u32 vcc, 8, v4
    s_nop 3
    s_or_b32 s3, vcc_lo, vcc_hi
    v_mov_b32 v4, s3
    ds_write_b32 v7, v4
    s_waitcnt lgkmcnt(0)
rl_194:
    s_barrier
    ds_read_b32 v4, v7
    s_waitcnt lgkmcnt(0)
    v_readfirstlane_b32 s3, v4
    s_nop 3
    s_cmp_lg_u32 s3, 0
    s_cbranch_scc1 P_skip
rd_193:
    s_mov_b32 s12, s4
    s_and_b32 s13, s5, 0xffff
    s_mov_b32 s14, 0x10000000
    s_mov_b32 s15, 0x20000
    s_mov_b32 s16, s90
    s_and_b32 s17, s91, 0xffff
    s_mov_b32 s18, 0x800000
    s_mov_b32 s19, 0x20000
    s_lshl_b32 s101, s101, 5
    s_mul_i32 s3, s43, 256
    s_add_u32 s101, s101, s3
    s_mul_i32 s38, s26, 2
    s_add_u32 s38, s38, 0
    s_lshr_b32 s39, s38, 1
    s_mul_i32 s39, s39, 262144
    s_and_b32 s38, s38, 1
    s_lshl_b32 s38, s38, 10
    s_add_u32 s38, s38, s39
    s_sub_u32 s38, s38, 0
    v_lshlrev_b32 v3, 4, v2
    v_add_u32 v8, s38, v3
    s_mul_i32 s38, s26, 2
    s_add_u32 s38, s38, 1
    s_lshr_b32 s39, s38, 1
    s_mul_i32 s39, s39, 262144
    s_and_b32 s38, s38, 1
    s_lshl_b32 s38, s38, 10
    s_add_u32 s38, s38, s39
    s_sub_u32 s38, s38, 1024
    v_lshlrev_b32 v3, 4, v2
    v_add_u32 v9, s38, v3
    s_mul_i32 s38, s26, 8
    s_add_u32 s38, s38, 0
    v_lshrrev_b32 v3, 4, v2
    v_add_u32 v3, s38, v3
    v_and_b32 v4, 3, v3
    v_lshlrev_b32 v4, 1, v4
    v_bfe_u32 v5, v3, 3, 1
    v_or_b32 v4, v4, v5
    v_lshlrev_b32 v4, 1, v4
    v_and_b32 v5, 15, v2
    v_xor_b32 v4, v4, v5
    v_lshlrev_b32 v4, 4, v4
    v_and_b32 v5, 32, v3
    v_and_b32 v6, 1, v3
    v_lshl_add_u32 v5, v6, 4, v5
    v_bfe_u32 v6, v3, 1, 4
    v_add_u32 v3, v6, v5
    v_mul_u32_u24 v3, 2048, v3
    v_add_u32 v3, v3, v4
    v_subrev_u32 v12, 0, v3
    s_mul_i32 s38, s26, 8
    s_add_u32 s38, s38, 4
    v_lshrrev_b32 v3, 4, v2
    v_add_u32 v3, s38, v3
    v_and_b32 v4, 3, v3
    v_lshlrev_b32 v4, 1, v4
    v_bfe_u32 v5, v3, 3, 1
    v_or_b32 v4, v4, v5
    v_lshlrev_b32 v4, 1, v4
    v_and_b32 v5, 15, v2
    v_xor_b32 v4, v4, v5
    v_lshlrev_b32 v4, 4, v4
    v_and_b32 v5, 32, v3
    v_and_b32 v6, 1, v3
    v_lshl_add_u32 v5, v6, 4, v5
    v_bfe_u32 v6, v3, 1, 4
    v_add_u32 v3, v6, v5
    v_mul_u32_u24 v3, 2048, v3
    v_add_u32 v3, v3, v4
    v_subrev_u32 v13, 1024, v3
    s_mov_b32 s33, 131072
    s_lshl_b32 s31, s100, 14
    s_add_u32 s31, s31, 201326592
    s_bfe_u32 s3, s100, 0x10007
    s_lshl_b32 s3, s3, 13
    s_xor_b32 s3, s3, s79
    s_xor_b32 s3, s3, 8192
    s_add_u32 s31, s31, s3
    s_lshl_b32 s32, s101, 1
    s_mul_i32 s35, s26, 2048
    s_mul_i32 s36, s26, 2048
    s_add_u32 s36, s36, 16384
    s_mov_b32 m0, s35
    s_add_u32 s35, s35, 32768
    s_cmp_ge_u32 s35, 131072
    s_cselect_b32 s40, 131072, 0
    s_sub_u32 s35, s35, s40
    buffer_load_dwordx4 v8, s[12:15], s31 offen offset:0 sc1 lds
    buffer_load_dwordx4 v9, s[12:15], s31 offen offset:1024 sc1 lds
    s_mov_b32 m0, s36
    s_add_u32 s31, s31, 2048
    s_and_b32 s40, s31, 0x1fff
    s_cselect_b32 s40, 0, 0x2000
    s_add_u32 s31, s31, s40
    s_add_u32 s36, s36, 32768
    s_cmp_ge_u32 s36, 131072
    s_cselect_b32 s40, 131072, 0
    s_sub_u32 s36, s36, s40
    buffer_load_dwordx4 v12, s[16:19], s32 offen offset:0  lds
    buffer_load_dwordx4 v13, s[16:19], s32 offen offset:1024  lds
    s_add_u32 s32, s32, s33
    s_mov_b32 m0, s35
    s_add_u32 s35, s35, 32768
    s_cmp_ge_u32 s35, 131072
    s_cselect_b32 s40, 131072, 0
    s_sub_u32 s35, s35, s40
    buffer_load_dwordx4 v8, s[12:15], s31 offen offset:0 sc1 lds
    buffer_load_dwordx4 v9, s[12:15], s31 offen offset:1024 sc1 lds
    s_mov_b32 m0, s36
    s_add_u32 s31, s31, 2048
    s_and_b32 s40, s31, 0x1fff
    s_cselect_b32 s40, 0, 0x2000
    s_add_u32 s31, s31, s40
    s_add_u32 s36, s36, 32768
    s_cmp_ge_u32 s36, 131072
    s_cselect_b32 s40, 131072, 0
    s_sub_u32 s36, s36, s40
    buffer_load_dwordx4 v12, s[16:19], s32 offen offset:0  lds
    buffer_load_dwordx4 v13, s[16:19], s32 offen offset:1024  lds
    s_add_u32 s32, s32, s33
    s_mov_b32 m0, s35
    s_add_u32 s35, s35, 32768
    s_cmp_ge_u32 s35, 131072
    s_cselect_b32 s40, 131072, 0
    s_sub_u32 s35, s35, s40
    buffer_load_dwordx4 v8, s[12:15], s31 offen offset:0 sc1 lds
    buffer_load_dwordx4 v9, s[12:15], s31 offen offset:1024 sc1 lds
    s_mov_b32 m0, s36
    s_add_u32 s31, s31, 2048
    s_and_b32 s40, s31, 0x1fff
    s_cselect_b32 s40, 0, 0x2000
    s_add_u32 s31, s31, s40
    s_add_u32 s36, s36, 32768
    s_cmp_ge_u32 s36, 131072
    s_cselect_b32 s40, 131072, 0
    s_sub_u32 s36, s36, s40
    buffer_load_dwordx4 v12, s[16:19], s32 offen offset:0  lds
    buffer_load_dwordx4 v13, s[16:19], s32 offen offset:1024  lds
    s_add_u32 s32, s32, s33
    s_mov_b32 m0, s35
    s_add_u32 s35, s35, 32768
    s_cmp_ge_u32 s35, 131072
    s_cselect_b32 s40, 131072, 0
    s_sub_u32 s35, s35, s40
    buffer_load_dwordx4 v8, s[12:15], s31 offen offset:0 sc1 lds
    buffer_load_dwordx4 v9, s[12:15], s31 offen offset:1024 sc1 lds
    s_mov_b32 m0, s36
    s_add_u32 s31, s31, 2048
    s_and_b32 s40, s31, 0x1fff
    s_cselect_b32 s40, 0, 0x2000
    s_add_u32 s31, s31, s40
    s_add_u32 s36, s36, 32768
    s_cmp_ge_u32 s36, 131072
    s_cselect_b32 s40, 131072, 0
    s_sub_u32 s36, s36, s40
    buffer_load_dwordx4 v12, s[16:19], s32 offen offset:0  lds
    buffer_load_dwordx4 v13, s[16:19], s32 offen offset:1024  lds
    s_add_u32 s32, s32, s33
    s_cmp_lg_u32 s6, 0
    s_cbranch_scc1 D_epi
M_T4:
    s_mov_b32 s49, s7
    s_mov_b32 s37, s25
    s_mov_b32 s41, s100
    s_mov_b32 s42, s101
    s_lshr_b32 s44, s26, 2
    s_and_b32 s45, s26, 3
    s_mul_i32 s38, s44, 8192
    v_lshlrev_b32 v3, 4, v2
    v_add_u32 v16, s38, v3
    v_add_u32 v17, 1024, v16
    v_and_b32 v3, 3, v2
    v_lshlrev_b32 v3, 4, v3
    s_mul_i32 s38, s45, 64
    v_add_u32 v3, s38, v3
    v_bfe_u32 v4, v2, 2, 2
    v_lshlrev_b32 v5, 6, v4
    v_xor_b32 v3, v3, v5
    v_bfe_u32 v5, v2, 4, 1
    v_lshlrev_b32 v5, 5, v5
    v_xor_b32 v3, v3, v5
    v_lshrrev_b32 v5, 4, v2
    v_lshl_add_u32 v4, v5, 3, v4
    v_mul_u32_u24 v4, 256, v4
    v_add_u32 v18, v3, v4
    v_xor_b32 v19, 8, v18
    s_branch LP_T4
P_T4S:
    s_cmp_lg_u32 s79, -1
    s_cbranch_scc1 hp_201
ht_202:
    s_sub_u32 s30, s30, 1
    s_cbranch_scc1 L_end
    v_mov_b32 v30, 128
    buffer_load_dword v31, v30, s[20:23], 0 offen sc1
hc_203:
    s_waitcnt vmcnt(0)
    v_readfirstlane_b32 s3, v31
    s_nop 3
    s_and_b32 s40, s3, 0xffff
    s_cmp_lt_u32 s40, 128
    s_cbranch_scc1 ht_202
    s_add_u32 s3, s3, 4128768
    s_lshr_b32 s3, s3, 10
    s_and_b32 s79, s3, 8192
hp_201:
    s_lshr_b32 s40, s100, 5
    s_lshl_b32 s40, s40, 7
    s_add_u32 s40, s40, 79708160
    s_cmp_lg_u32 s6, 0
    s_cbranch_scc1 re_204
    s_cmp_lg_u32 s26, 0
    s_cbranch_scc1 wf_207
    v_mov_b32 v3, s40
    v_bfe_u32 v5, v2, 2, 1
    v_lshlrev_b32 v5, 7, v5
    v_and_b32 v6, 3, v2
    v_lshl_add_u32 v5, v6, 2, v5
    v_add_u32 v3, v3, v5
wt_208:
    buffer_load_dword v4, v3, s[8:11], 0 offen sc1
    s_sub_u32 s30, s30, 1
    s_cbranch_scc1 L_end
    s_waitcnt vmcnt(0)
    v_cmp_gt_u32 vcc, 8, v4
    s_cbranch_vccz wf_207
    s_sleep 8
    s_branch wt_208
wf_207:
    s_barrier
    s_branch rd_205
re_204:
    v_mov_b32 v7, 163588
    s_cmp_lg_u32 s26, 0
    s_cbranch_scc1 rl_206
    v_mov_b32 v3, s40
    v_bfe_u32 v5, v2, 2, 1
    v_lshlrev_b32 v5, 7, v5
    v_and_b32 v6, 3, v2
    v_lshl_add_u32 v5, v6, 2, v5
    v_add_u32 v3, v3, v5
    buffer_load_dword v4, v3, s[8:11], 0 offen sc1
    s_waitcnt vmcnt(0)
    v_cmp_gt_u32 vcc, 8, v4
    s_nop 3
    s_or_b32 s3, vcc_lo, vcc_hi
    v_mov_b32 v4, s3
    ds_write_b32 v7, v4
    s_waitcnt lgkmcnt(0)
rl_206:
    s_barrier
    ds_read_b32 v4, v7
    s_waitcnt lgkmcnt(0)
    v_readfirstlane_b32 s3, v4
    s_nop 3
    s_cmp_lg_u32 s3, 0
    s_cbranch_scc1 P_skip
rd_205:
    s_mov_b32 s12, s4
    s_and_b32 s13, s5, 0xffff
    s_mov_b32 s14, 0x10000000
    s_mov_b32 s15, 0x20000
    s_mov_b32 s16, s90
    s_and_b32 s17, s91, 0xffff
    s_mov_b32 s18, 0x800000
    s_mov_b32 s19, 0x20000
    s_lshl_b32 s101, s101, 5
    s_mul_i32 s3, s43, 256
    s_add_u32 s101, s101, s3
    s_mul_i32 s38, s26, 1
    s_add_u32 s38, s38, 0
    s_lshr_b32 s39, s38, 1
    s_mul_i32 s39, s39, 262144
    s_and_b32 s38, s38, 1
    s_lshl_b32 s38, s38, 10
    s_add_u32 s38, s38, s39
    s_sub_u32 s38, s38, 0
    v_lshlrev_b32 v3, 4, v2
    v_add_u32 v8, s38, v3
    s_mul_i32 s38, s26, 8
    s_add_u32 s38, s38, 0
    v_lshrrev_b32 v3, 4, v2
    v_add_u32 v3, s38, v3
    v_and_b32 v4, 3, v3
    v_lshlrev_b32 v4, 1, v4
    v_bfe_u32 v5, v3, 3, 1
    v_or_b32 v4, v4, v5
    v_lshlrev_b32 v4, 1, v4
    v_and_b32 v5, 15, v2
    v_xor_b32 v4, v4, v5
    v_lshlrev_b32 v4, 4, v4
    v_and_b32 v5, 32, v3
    v_and_b32 v6, 1, v3
    v_lshl_add_u32 v5, v6, 4, v5
    v_bfe_u32 v6, v3, 1, 4
    v_add_u32 v3, v6, v5
    v_mul_u32_u24 v3, 2048, v3
    v_add_u32 v3, v3, v4
    v_subrev_u32 v12, 0, v3
    s_mul_i32 s38, s26, 8
    s_add_u32 s38, s38, 4
    v_lshrrev_b32 v3, 4, v2
    v_add_u32 v3, s38, v3
    v_and_b32 v4, 3, v3
    v_lshlrev_b32 v4, 1, v4
    v_bfe_u32 v5, v3, 3, 1
    v_or_b32 v4, v4, v5
    v_lshlrev_b32 v4, 1, v4
    v_and_b32 v5, 15, v2
    v_xor_b32 v4, v4, v5
    v_lshlrev_b32 v4, 4, v4
    v_and_b32 v5, 32, v3
    v_and_b32 v6, 1, v3
    v_lshl_add_u32 v5, v6, 4, v5
    v_bfe_u32 v6, v3, 1, 4
    v_add_u32 v3, v6, v5
    v_mul_u32_u24 v3, 2048, v3
    v_add_u32 v3, v3, v4
    v_subrev_u32 v13, 1024, v3
    s_mov_b32 s33, 131072
    s_lshl_b32 s31, s100, 14
    s_add_u32 s31, s31, 201326592
    s_bfe_u32 s3, s100, 0x10007
    s_lshl_b32 s3, s3, 13
    s_xor_b32 s3, s3, s79
    s_xor_b32 s3, s3, 8192
    s_add_u32 s31, s31, s3
    s_lshl_b32 s32, s101, 1
    s_mul_i32 s35, s26, 1024
    s_mul_i32 s36, s26, 2048
    s_add_u32 s36, s36, 8192
    s_mov_b32 m0, s35
    s_add_u32 s35, s35, 24576
    s_cmp_ge_u32 s35, 122880
    s_cselect_b32 s40, 122880, 0
    s_sub_u32 s35, s35, s40
    buffer_load_dwordx4 v8, s[12:15], s31 offen offset:0 sc1 lds
    s_mov_b32 m0, s36
    s_add_u32 s31, s31, 2048
    s_and_b32 s40, s31, 0x1fff
    s_cselect_b32 s40, 0, 0x2000
    s_add_u32 s31, s31, s40
    s_add_u32 s36, s36, 24576
    s_cmp_ge_u32 s36, 122880
    s_cselect_b32 s40, 122880, 0
    s_sub_u32 s36, s36, s40
    buffer_load_dwordx4 v12, s[16:19], s32 offen offset:0  lds
    buffer_load_dwordx4 v13, s[16:19], s32 offen offset:1024  lds
    s_add_u32 s32, s32, s33
    s_mov_b32 m0, s35
    s_add_u32 s35, s35, 24576
    s_cmp_ge_u32 s35, 122880
    s_cselect_b32 s40, 122880, 0
    s_sub_u32 s35, s35, s40
    buffer_load_dwordx4 v8, s[12:15], s31 offen offset:0 sc1 lds
    s_mov_b32 m0, s36
    s_add_u32 s31, s31, 2048
    s_and_b32 s40, s31, 0x1fff
    s_cselect_b32 s40, 0, 0x2000
    s_add_u32 s31, s31, s40
    s_add_u32 s36, s36, 24576
    s_cmp_ge_u32 s36, 122880
    s_cselect_b32 s40, 122880, 0
    s_sub_u32 s36, s36, s40
    buffer_load_dwordx4 v12, s[16:19], s32 offen offset:0  lds
    buffer_load_dwordx4 v13, s[16:19], s32 offen offset:1024  lds
    s_add_u32 s32, s32, s33
    s_mov_b32 m0, s35
    s_add_u32 s35, s35, 24576
    s_cmp_ge_u32 s35, 122880
    s_cselect_b32 s40, 122880, 0
    s_sub_u32 s35, s35, s40
    buffer_load_dwordx4 v8, s[12:15], s31 offen offset:0 sc1 lds
    s_mov_b32 m0, s36
    s_add_u32 s31, s31, 2048
    s_and_b32 s40, s31, 0x1fff
    s_cselect_b32 s40, 0, 0x2000
    s_add_u32 s31, s31, s40
    s_add_u32 s36, s36, 24576
    s_cmp_ge_u32 s36, 122880
    s_cselect_b32 s40, 122880, 0
    s_sub_u32 s36, s36, s40
    buffer_load_dwordx4 v12, s[16:19], s32 offen offset:0  lds
    buffer_load_dwordx4 v13, s[16:19], s32 offen offset:1024  lds
    s_add_u32 s32, s32, s33
    s_mov_b32 m0, s35
    s_add_u32 s35, s35, 24576
    s_cmp_ge_u32 s35, 122880
    s_cselect_b32 s40, 122880, 0
    s_sub_u32 s35, s35, s40
    buffer_load_dwordx4 v8, s[12:15], s31 offen offset:0 sc1 lds
    s_mov_b32 m0, s36
    s_add_u32 s31, s31, 2048
    s_and_b32 s40, s31, 0x1fff
    s_cselect_b32 s40, 0, 0x2000
    s_add_u32 s31, s31, s40
    s_add_u32 s36, s36, 24576
    s_cmp_ge_u32 s36, 122880
    s_cselect_b32 s40, 122880, 0
    s_sub_u32 s36, s36, s40
    buffer_load_dwordx4 v12, s[16:19], s32 offen offset:0  lds
    buffer_load_dwordx4 v13, s[16:19], s32 offen offset:1024  lds
    s_add_u32 s32, s32, s33
    s_mov_b32 m0, s35
    s_add_u32 s35, s35, 24576
    s_cmp_ge_u32 s35, 122880
    s_cselect_b32 s40, 122880, 0
    s_sub_u32 s35, s35, s40
    buffer_load_dwordx4 v8, s[12:15], s31 offen offset:0 sc1 lds
    s_mov_b32 m0, s36
    s_add_u32 s31, s31, 2048
    s_and_b32 s40, s31, 0x1fff
    s_cselect_b32 s40, 0, 0x2000
    s_add_u32 s31, s31, s40
    s_add_u32 s36, s36, 24576
    s_cmp_ge_u32 s36, 122880
    s_cselect_b32 s40, 122880, 0
    s_sub_u32 s36, s36, s40
    buffer_load_dwordx4 v12, s[16:19], s32 offen offset:0  lds
    buffer_load_dwordx4 v13, s[16:19], s32 offen offset:1024  lds
    s_add_u32 s32, s32, s33
    s_cmp_lg_u32 s6, 0
    s_cbranch_scc1 D_epi
M_T4S:
    s_mov_b32 s49, s7
    s_mov_b32 s37, s25
    s_mov_b32 s41, s100
    s_mov_b32 s42, s101
    s_lshr_b32 s44, s26, 2
    s_and_b32 s45, s26, 3
    s_mul_i32 s38, s44, 4096
    v_lshlrev_b32 v3, 4, v2
    v_add_u32 v16, s38, v3
    v_add_u32 v17, 1024, v16
    v_and_b32 v3, 3, v2
    v_lshlrev_b32 v3, 4, v3
    s_mul_i32 s38, s45, 64
    v_add_u32 v3, s38, v3
    v_bfe_u32 v4, v2, 2, 2
    v_lshlrev_b32 v5, 6, v4
    v_xor_b32 v3, v3, v5
    v_bfe_u32 v5, v2, 4, 1
    v_lshlrev_b32 v5, 5, v5
    v_xor_b32 v3, v3, v5
    v_lshrrev_b32 v5, 4, v2
    v_lshl_add_u32 v4, v5, 3, v4
    v_mul_u32_u24 v4, 256, v4
    v_add_u32 v18, v3, v4
    v_xor_b32 v19, 8, v18
    s_branch LP_T4S
P_T4W:
    s_cmp_lg_u32 s79, -1
    s_cbranch_scc1 hp_213
ht_214:
    s_sub_u32 s30, s30, 1
    s_cbranch_scc1 L_end
    v_mov_b32 v30, 128
    buffer_load_dword v31, v30, s[20:23], 0 offen sc1
hc_215:
    s_waitcnt vmcnt(0)
    v_readfirstlane_b32 s3, v31
    s_nop 3
    s_and_b32 s40, s3, 0xffff
    s_cmp_lt_u32 s40, 128
    s_cbranch_scc1 ht_214
    s_add_u32 s3, s3, 4128768
    s_lshr_b32 s3, s3, 10
    s_and_b32 s79, s3, 8192
hp_213:
    s_lshr_b32 s40, s100, 5
    s_lshl_b32 s40, s40, 7
    s_add_u32 s40, s40, 79708160
    s_cmp_lg_u32 s6, 0
    s_cbranch_scc1 re_216
    s_cmp_lg_u32 s26, 0
    s_cbranch_scc1 wf_219
    v_mov_b32 v3, s40
    v_bfe_u32 v5, v2, 2, 2
    v_lshlrev_b32 v5, 7, v5
    v_and_b32 v6, 3, v2
    v_lshl_add_u32 v5, v6, 2, v5
    v_add_u32 v3, v3, v5
wt_220:
    buffer_load_dword v4, v3, s[8:11], 0 offen sc1
    s_sub_u32 s30, s30, 1
    s_cbranch_scc1 L_end
    s_waitcnt vmcnt(0)
    v_cmp_gt_u32 vcc, 8, v4
    s_cbranch_vccz wf_219
    s_sleep 8
    s_branch wt_220
wf_219:
    s_barrier
    s_branch rd_217
re_216:
    v_mov_b32 v7, 163588
    s_cmp_lg_u32 s26, 0
    s_cbranch_scc1 rl_218
    v_mov_b32 v3, s40
    v_bfe_u32 v5, v2, 2, 2
    v_lshlrev_b32 v5, 7, v5
    v_and_b32 v6, 3, v2
    v_lshl_add_u32 v5, v6, 2, v5
    v_add_u32 v3, v3, v5
    buffer_load_dword v4, v3, s[8:11], 0 offen sc1
    s_waitcnt vmcnt(0)
    v_cmp_gt_u32 vcc, 8, v4
    s_nop 3
    s_or_b32 s3, vcc_lo, vcc_hi
    v_mov_b32 v4, s3
    ds_write_b32 v7, v4
    s_waitcnt lgkmcnt(0)
rl_218:
    s_barrier
    ds_read_b32 v4, v7
    s_waitcnt lgkmcnt(0)
    v_readfirstlane_b32 s3, v4
    s_nop 3
    s_cmp_lg_u32 s3, 0
    s_cbranch_scc1 P_skip
rd_217:
    s_mov_b32 s12, s4
    s_and_b32 s13, s5, 0xffff
    s_mov_b32 s14, 0x10000000
    s_mov_b32 s15, 0x20000
    s_mov_b32 s16, s90
    s_and_b32 s17, s91, 0xffff
    s_mov_b32 s18, 0x800000
    s_mov_b32 s19, 0x20000
    s_lshl_b32 s101, s101, 5
    s_mul_i32 s3, s43, 256
    s_add_u32 s101, s101, s3
    s_mul_i32 s38, s26, 2
    s_add_u32 s38, s38, 0
    s_lshr_b32 s39, s38, 1
    s_mul_i32 s39, s39, 262144
    s_and_b32 s38, s38, 1
    s_lshl_b32 s38, s38, 10
    s_add_u32 s38, s38, s39
    s_sub_u32 s38, s38, 0
    v_lshlrev_b32 v3, 4, v2
    v_add_u32 v8, s38, v3
    s_mul_i32 s38, s26, 2
    s_add_u32 s38, s38, 1
    s_lshr_b32 s39, s38, 1
    s_mul_i32 s39, s39, 262144
    s_and_b32 s38, s38, 1
    s_lshl_b32 s38, s38, 10
    s_add_u32 s38, s38, s39
    s_sub_u32 s38, s38, 1024
    v_lshlrev_b32 v3, 4, v2
    v_add_u32 v9, s38, v3
    s_mul_i32 s38, s26, 8
    s_add_u32 s38, s38, 0
    v_lshrrev_b32 v3, 5, v2
    v_add_u32 v3, s38, v3
    v_and_b32 v4, 3, v3
    v_lshlrev_b32 v4, 1, v4
    v_bfe_u32 v5, v3, 3, 1
    v_or_b32 v4, v4, v5
    v_lshlrev_b32 v4, 1, v4
    v_and_b32 v5, 31, v2
    v_xor_b32 v4, v4, v5
    v_lshlrev_b32 v4, 4, v4
    v_and_b32 v5, 32, v3
    v_and_b32 v6, 1, v3
    v_lshl_add_u32 v5, v6, 4, v5
    v_bfe_u32 v6, v3, 1, 4
    v_add_u32 v3, v6, v5
    v_mul_u32_u24 v3, 2048, v3
    v_add_u32 v3, v3, v4
    v_subrev_u32 v12, 0, v3
    s_mul_i32 s38, s26, 8
    s_add_u32 s38, s38, 2
    v_lshrrev_b32 v3, 5, v2
    v_add_u32 v3, s38, v3
    v_and_b32 v4, 3, v3
    v_lshlrev_b32 v4, 1, v4
    v_bfe_u32 v5, v3, 3, 1
    v_or_b32 v4, v4, v5
    v_lshlrev_b32 v4, 1, v4
    v_and_b32 v5, 31, v2
    v_xor_b32 v4, v4, v5
    v_lshlrev_b32 v4, 4, v4
    v_and_b32 v5, 32, v3
    v_and_b32 v6, 1, v3
    v_lshl_add_u32 v5, v6, 4, v5
    v_bfe_u32 v6, v3, 1, 4
    v_add_u32 v3, v6, v5
    v_mul_u32_u24 v3, 2048, v3
    v_add_u32 v3, v3, v4
    v_subrev_u32 v13, 1024, v3
    s_mul_i32 s38, s26, 8
    s_add_u32 s38, s38, 4
    v_lshrrev_b32 v3, 5, v2
    v_add_u32 v3, s38, v3
    v_and_b32 v4, 3, v3
    v_lshlrev_b32 v4, 1, v4
    v_bfe_u32 v5, v3, 3, 1
    v_or_b32 v4, v4, v5
    v_lshlrev_b32 v4, 1, v4
    v_and_b32 v5, 31, v2
    v_xor_b32 v4, v4, v5
    v_lshlrev_b32 v4, 4, v4
    v_and_b32 v5, 32, v3
    v_and_b32 v6, 1, v3
    v_lshl_add_u32 v5, v6, 4, v5
    v_bfe_u32 v6, v3, 1, 4
    v_add_u32 v3, v6, v5
    v_mul_u32_u24 v3, 2048, v3
    v_add_u32 v3, v3, v4
    v_subrev_u32 v14, 2048, v3
    s_mul_i32 s38, s26, 8
    s_add_u32 s38, s38, 6
    v_lshrrev_b32 v3, 5, v2
    v_add_u32 v3, s38, v3
    v_and_b32 v4, 3, v3
    v_lshlrev_b32 v4, 1, v4
    v_bfe_u32 v5, v3, 3, 1
    v_or_b32 v4, v4, v5
    v_lshlrev_b32 v4, 1, v4
    v_and_b32 v5, 31, v2
    v_xor_b32 v4, v4, v5
    v_lshlrev_b32 v4, 4, v4
    v_and_b32 v5, 32, v3
    v_and_b32 v6, 1, v3
    v_lshl_add_u32 v5, v6, 4, v5
    v_bfe_u32 v6, v3, 1, 4
    v_add_u32 v3, v6, v5
    v_mul_u32_u24 v3, 2048, v3
    v_add_u32 v3, v3, v4
    v_subrev_u32 v15, 3072, v3
    s_mov_b32 s33, 131072
    s_lshl_b32 s31, s100, 14
    s_add_u32 s31, s31, 201326592
    s_bfe_u32 s3, s100, 0x10007
    s_lshl_b32 s3, s3, 13
    s_xor_b32 s3, s3, s79
    s_xor_b32 s3, s3, 8192
    s_add_u32 s31, s31, s3
    s_lshl_b32 s32, s101, 1
    s_mul_i32 s35, s26, 2048
    s_mul_i32 s36, s26, 4096
    s_add_u32 s36, s36, 16384
    s_mov_b32 m0, s35
    s_add_u32 s35, s35, 49152
    s_cmp_ge_u32 s35, 147456
    s_cselect_b32 s40, 147456, 0
    s_sub_u32 s35, s35, s40
    buffer_load_dwordx4 v8, s[12:15], s31 offen offset:0 sc1 lds
    buffer_load_dwordx4 v9, s[12:15], s31 offen offset:1024 sc1 lds
    s_mov_b32 m0, s36
    s_add_u32 s31, s31, 2048
    s_and_b32 s40, s31, 0x1fff
    s_cselect_b32 s40, 0, 0x2000
    s_add_u32 s31, s31, s40
    s_add_u32 s36, s36, 49152
    s_cmp_ge_u32 s36, 147456
    s_cselect_b32 s40, 147456, 0
    s_sub_u32 s36, s36, s40
    buffer_load_dwordx4 v12, s[16:19], s32 offen offset:0  lds
    buffer_load_dwordx4 v13, s[16:19], s32 offen offset:1024  lds
    buffer_load_dwordx4 v14, s[16:19], s32 offen offset:2048  lds
    buffer_load_dwordx4 v15, s[16:19], s32 offen offset:3072  lds
    s_add_u32 s32, s32, s33
    s_mov_b32 m0, s35
    s_add_u32 s35, s35, 49152
    s_cmp_ge_u32 s35, 147456
    s_cselect_b32 s40, 147456, 0
    s_sub_u32 s35, s35, s40
    buffer_load_dwordx4 v8, s[12:15], s31 offen offset:0 sc1 lds
    buffer_load_dwordx4 v9, s[12:15], s31 offen offset:1024 sc1 lds
    s_mov_b32 m0, s36
    s_add_u32 s31, s31, 2048
    s_and_b32 s40, s31, 0x1fff
    s_cselect_b32 s40, 0, 0x2000
    s_add_u32 s31, s31, s40
    s_add_u32 s36, s36, 49152
    s_cmp_ge_u32 s36, 147456
    s_cselect_b32 s40, 147456, 0
    s_sub_u32 s36, s36, s40
    buffer_load_dwordx4 v12, s[16:19], s32 offen offset:0  lds
    buffer_load_dwordx4 v13, s[16:19], s32 offen offset:1024  lds
    buffer_load_dwordx4 v14, s[16:19], s32 offen offset:2048  lds
    buffer_load_dwordx4 v15, s[16:19], s32 offen offset:3072  lds
    s_add_u32 s32, s32, s33
    s_mov_b32 m0, s35
    s_add_u32 s35, s35, 49152
    s_cmp_ge_u32 s35, 147456
    s_cselect_b32 s40, 147456, 0
    s_sub_u32 s35, s35, s40
    buffer_load_dwordx4 v8, s[12:15], s31 offen offset:0 sc1 lds
    buffer_load_dwordx4 v9, s[12:15], s31 offen offset:1024 sc1 lds
    s_mov_b32 m0, s36
    s_add_u32 s31, s31, 2048
    s_and_b32 s40, s31, 0x1fff
    s_cselect_b32 s40, 0, 0x2000
    s_add_u32 s31, s31, s40
    s_add_u32 s36, s36, 49152
    s_cmp_ge_u32 s36, 147456
    s_cselect_b32 s40, 147456, 0
    s_sub_u32 s36, s36, s40
    buffer_load_dwordx4 v12, s[16:19], s32 offen offset:0  lds
    buffer_load_dwordx4 v13, s[16:19], s32 offen offset:1024  lds
    buffer_load_dwordx4 v14, s[16:19], s32 offen offset:2048  lds
    buffer_load_dwordx4 v15, s[16:19], s32 offen offset:3072  lds
    s_add_u32 s32, s32, s33
    s_cmp_lg_u32 s6, 0
    s_cbranch_scc1 D_epi
M_T4W:
    s_mov_b32 s49, s7
    s_mov_b32 s37, s25
    s_mov_b32 s41, s100
    s_mov_b32 s42, s101
    s_lshr_b32 s44, s26, 2
    s_and_b32 s45, s26, 3
    s_mul_i32 s38, s44, 8192
    v_lshlrev_b32 v3, 4, v2
    v_add_u32 v16, s38, v3
    v_add_u32 v17, 1024, v16
    v_and_b32 v3, 3, v2
    v_lshlrev_b32 v3, 4, v3
    s_mul_i32 s38, s45, 128
    v_add_u32 v3, s38, v3
    v_bfe_u32 v4, v2, 2, 2
    v_lshlrev_b32 v5, 6, v4
    v_xor_b32 v3, v3, v5
    v_bfe_u32 v5, v2, 4, 1
    v_lshlrev_b32 v5, 5, v5
    v_xor_b32 v3, v3, v5
    v_lshrrev_b32 v5, 4, v2
    v_lshl_add_u32 v4, v5, 3, v4
    v_mul_u32_u24 v4, 512, v4
    v_add_u32 v18, v3, v4
    v_xor_b32 v19, 8, v18
    v_xor_b32 v20, 64, v18
    v_xor_b32 v21, 72, v18
    s_branch LP_T4W
P_T4Q:
    s_lshr_b32 s40, s100, 5
    s_lshl_b32 s40, s40, 7
    s_add_u32 s40, s40, 79708160
    s_lshl_b32 s3, s43, 2
    s_add_u32 s40, s40, s3
    s_mov_b32 s12, s4
    s_and_b32 s13, s5, 0xffff
    s_mov_b32 s14, 0x10000000
    s_mov_b32 s15, 0x20000
    s_mov_b32 s16, s90
    s_and_b32 s17, s91, 0xffff
    s_mov_b32 s18, 0x800000
    s_mov_b32 s19, 0x20000
    s_mov_b32 s27, s40
    s_lshl_b32 s101, s101, 5
    s_mul_i32 s38, s26, 1
    s_add_u32 s38, s38, 0
    s_lshr_b32 s39, s38, 1
    s_mul_i32 s39, s39, 262144
    s_and_b32 s38, s38, 1
    s_lshl_b32 s38, s38, 10
    s_add_u32 s38, s38, s39
    s_sub_u32 s38, s38, 0
    v_lshlrev_b32 v3, 4, v2
    v_add_u32 v8, s38, v3
    s_mul_i32 s38, s26, 8
    s_add_u32 s38, s38, 0
    v_lshrrev_b32 v3, 4, v2
    v_add_u32 v3, s38, v3
    v_and_b32 v4, 3, v3
    v_lshlrev_b32 v4, 1, v4
    v_bfe_u32 v5, v3, 3, 1
    v_or_b32 v4, v4, v5
    v_lshlrev_b32 v4, 1, v4
    v_and_b32 v5, 15, v2
    v_xor_b32 v4, v4, v5
    v_lshlrev_b32 v4, 4, v4
    v_and_b32 v5, 32, v3
    v_and_b32 v6, 1, v3
    v_lshl_add_u32 v5, v6, 4, v5
    v_bfe_u32 v6, v3, 1, 4
    v_add_u32 v3, v6, v5
    v_mul_u32_u24 v3, 2048, v3
    v_add_u32 v3, v3, v4
    v_subrev_u32 v12, 0, v3
    s_mul_i32 s38, s26, 8
    s_add_u32 s38, s38, 4
    v_lshrrev_b32 v3, 4, v2
    v_add_u32 v3, s38, v3
    v_and_b32 v4, 3, v3
    v_lshlrev_b32 v4, 1, v4
    v_bfe_u32 v5, v3, 3, 1
    v_or_b32 v4, v4, v5
    v_lshlrev_b32 v4, 1, v4
    v_and_b32 v5, 15, v2
    v_xor_b32 v4, v4, v5
    v_lshlrev_b32 v4, 4, v4
    v_and_b32 v5, 32, v3
    v_and_b32 v6, 1, v3
    v_lshl_add_u32 v5, v6, 4, v5
    v_bfe_u32 v6, v3, 1, 4
    v_add_u32 v3, v6, v5
    v_mul_u32_u24 v3, 2048, v3
    v_add_u32 v3, v3, v4
    v_subrev_u32 v13, 1024, v3
    s_mov_b32 s33, 131072
    s_cmp_lg_u32 s79, -1
    s_cbranch_scc1 hp_225
ht_226:
    s_sub_u32 s30, s30, 1
    s_cbranch_scc1 L_end
    v_mov_b32 v30, 128
    buffer_load_dword v31, v30, s[20:23], 0 offen sc1
hc_227:
    s_waitcnt vmcnt(0)
    v_readfirstlane_b32 s3, v31
    s_nop 3
    s_and_b32 s40, s3, 0xffff
    s_cmp_lt_u32 s40, 128
    s_cbranch_scc1 ht_226
    s_add_u32 s3, s3, 4128768
    s_lshr_b32 s3, s3, 10
    s_and_b32 s79, s3, 8192
hp_225:
    s_lshl_b32 s31, s100, 14
    s_add_u32 s31, s31, 201326592
    s_bfe_u32 s3, s100, 0x10007
    s_lshl_b32 s3, s3, 13
    s_xor_b32 s3, s3, s79
    s_xor_b32 s3, s3, 8192
    s_add_u32 s31, s31, s3
    s_lshl_b32 s3, s43, 16
    s_add_u32 s31, s31, s3
    s_lshl_b32 s32, s101, 1
    s_lshl_b32 s3, s43, 21
    s_add_u32 s32, s32, s3
    s_mov_b32 s40, s27
    s_cmp_lg_u32 s6, 0
    s_cbranch_scc1 re_228
    s_cmp_lg_u32 s26, 0
    s_cbranch_scc1 wf_231
    v_mov_b32 v3, s40
    v_and_b32 v5, 1, v2
    v_lshlrev_b32 v5, 7, v5
    v_add_u32 v3, v3, v5
wt_232:
    buffer_load_dword v4, v3, s[8:11], 0 offen sc1
    s_sub_u32 s30, s30, 1
    s_cbranch_scc1 L_end
    s_waitcnt vmcnt(0)
    v_cmp_gt_u32 vcc, 8, v4
    s_cbranch_vccz wf_231
    s_sleep 2
    s_branch wt_232
wf_231:
    s_barrier
    s_branch rd_229
re_228:
    v_mov_b32 v7, 163588
    s_cmp_lg_u32 s26, 0
    s_cbranch_scc1 rl_230
    v_mov_b32 v3, s40
    v_and_b32 v5, 1, v2
    v_lshlrev_b32 v5, 7, v5
    v_add_u32 v3, v3, v5
    buffer_load_dword v4, v3, s[8:11], 0 offen sc1
    s_waitcnt vmcnt(0)
    v_cmp_gt_u32 vcc, 8, v4
    s_nop 3
    s_or_b32 s3, vcc_lo, vcc_hi
    v_mov_b32 v4, s3
    ds_write_b32 v7, v4
    s_waitcnt lgkmcnt(0)
rl_230:
    s_barrier
    ds_read_b32 v4, v7
    s_waitcnt lgkmcnt(0)
    v_readfirstlane_b32 s3, v4
    s_nop 3
    s_cmp_lg_u32 s3, 0
    s_cbranch_scc1 P_skip
rd_229:
    s_mul_i32 s35, s26, 1024
    s_mul_i32 s36, s26, 2048
    s_add_u32 s36, s36, 8192
    s_mov_b32 m0, s35
    s_add_u32 s35, s35, 24576
    s_cmp_ge_u32 s35, 122880
    s_cselect_b32 s40, 122880, 0
    s_sub_u32 s35, s35, s40
    buffer_load_dwordx4 v8, s[12:15], s31 offen offset:0 sc1 lds
    s_mov_b32 m0, s36
    s_add_u32 s31, s31, 2048
    s_and_b32 s40, s31, 0x1fff
    s_cselect_b32 s40, 0, 0x2000
    s_add_u32 s31, s31, s40
    s_add_u32 s36, s36, 24576
    s_cmp_ge_u32 s36, 122880
    s_cselect_b32 s40, 122880, 0
    s_sub_u32 s36, s36, s40
    buffer_load_dwordx4 v12, s[16:19], s32 offen offset:0  lds
    buffer_load_dwordx4 v13, s[16:19], s32 offen offset:1024  lds
    s_add_u32 s32, s32, s33
    s_mov_b32 m0, s35
    s_add_u32 s35, s35, 24576
    s_cmp_ge_u32 s35, 122880
    s_cselect_b32 s40, 122880, 0
    s_sub_u32 s35, s35, s40
    buffer_load_dwordx4 v8, s[12:15], s31 offen offset:0 sc1 lds
    s_mov_b32 m0, s36
    s_add_u32 s31, s31, 2048
    s_and_b32 s40, s31, 0x1fff
    s_cselect_b32 s40, 0, 0x2000
    s_add_u32 s31, s31, s40
    s_add_u32 s36, s36, 24576
    s_cmp_ge_u32 s36, 122880
    s_cselect_b32 s40, 122880, 0
    s_sub_u32 s36, s36, s40
    buffer_load_dwordx4 v12, s[16:19], s32 offen offset:0  lds
    buffer_load_dwordx4 v13, s[16:19], s32 offen offset:1024  lds
    s_add_u32 s32, s32, s33
    s_mov_b32 m0, s35
    s_add_u32 s35, s35, 24576
    s_cmp_ge_u32 s35, 122880
    s_cselect_b32 s40, 122880, 0
    s_sub_u32 s35, s35, s40
    buffer_load_dwordx4 v8, s[12:15], s31 offen offset:0 sc1 lds
    s_mov_b32 m0, s36
    s_add_u32 s31, s31, 2048
    s_and_b32 s40, s31, 0x1fff
    s_cselect_b32 s40, 0, 0x2000
    s_add_u32 s31, s31, s40
    s_add_u32 s36, s36, 24576
    s_cmp_ge_u32 s36, 122880
    s_cselect_b32 s40, 122880, 0
    s_sub_u32 s36, s36, s40
    buffer_load_dwordx4 v12, s[16:19], s32 offen offset:0  lds
    buffer_load_dwordx4 v13, s[16:19], s32 offen offset:1024  lds
    s_add_u32 s32, s32, s33
    s_mov_b32 m0, s35
    s_add_u32 s35, s35, 24576
    s_cmp_ge_u32 s35, 122880
    s_cselect_b32 s40, 122880, 0
    s_sub_u32 s35, s35, s40
    buffer_load_dwordx4 v8, s[12:15], s31 offen offset:0 sc1 lds
    s_mov_b32 m0, s36
    s_add_u32 s31, s31, 2048
    s_and_b32 s40, s31, 0x1fff
    s_cselect_b32 s40, 0, 0x2000
    s_add_u32 s31, s31, s40
    s_add_u32 s36, s36, 24576
    s_cmp_ge_u32 s36, 122880
    s_cselect_b32 s40, 122880, 0
    s_sub_u32 s36, s36, s40
    buffer_load_dwordx4 v12, s[16:19], s32 offen offset:0  lds
    buffer_load_dwordx4 v13, s[16:19], s32 offen offset:1024  lds
    s_add_u32 s32, s32, s33
    s_mov_b32 m0, s35
    s_add_u32 s35, s35, 24576
    s_cmp_ge_u32 s35, 122880
    s_cselect_b32 s40, 122880, 0
    s_sub_u32 s35, s35, s40
    buffer_load_dwordx4 v8, s[12:15], s31 offen offset:0 sc1 lds
    s_mov_b32 m0, s36
    s_add_u32 s31, s31, 2048
    s_and_b32 s40, s31, 0x1fff
    s_cselect_b32 s40, 0, 0x2000
    s_add_u32 s31, s31, s40
    s_add_u32 s36, s36, 24576
    s_cmp_ge_u32 s36, 122880
    s_cselect_b32 s40, 122880, 0
    s_sub_u32 s36, s36, s40
    buffer_load_dwordx4 v12, s[16:19], s32 offen offset:0  lds
    buffer_load_dwordx4 v13, s[16:19], s32 offen offset:1024  lds
    s_add_u32 s32, s32, s33
    s_cmp_lg_u32 s6, 0
    s_cbranch_scc1 D_epi
M_T4Q:
    s_mov_b32 s49, s7
    s_mov_b32 s37, s25
    s_mov_b32 s41, s100
    s_mov_b32 s42, s101
    s_lshr_b32 s44, s26, 2
    s_and_b32 s45, s26, 3
    s_mul_i32 s38, s44, 4096
    v_lshlrev_b32 v3, 4, v2
    v_add_u32 v16, s38, v3
    v_add_u32 v17, 1024, v16
    v_and_b32 v3, 3, v2
    v_lshlrev_b32 v3, 4, v3
    s_mul_i32 s38, s45, 64
    v_add_u32 v3, s38, v3
    v_bfe_u32 v4, v2, 2, 2
    v_lshlrev_b32 v5, 6, v4
    v_xor_b32 v3, v3, v5
    v_bfe_u32 v5, v2, 4, 1
    v_lshlrev_b32 v5, 5, v5
    v_xor_b32 v3, v3, v5
    v_lshrrev_b32 v5, 4, v2
    v_lshl_add_u32 v4, v5, 3, v4
    v_mul_u32_u24 v4, 256, v4
    v_add_u32 v18, v3, v4
    v_xor_b32 v19, 8, v18
    s_branch LP_T4Q
P_T7:
    s_cmp_lg_u32 s79, -1
    s_cbranch_scc1 hp_241
ht_242:
    s_sub_u32 s30, s30, 1
    s_cbranch_scc1 L_end
    v_mov_b32 v30, 128
    buffer_load_dword v31, v30, s[20:23], 0 offen sc1
hc_243:
    s_waitcnt vmcnt(0)
    v_readfirstlane_b32 s3, v31
    s_nop 3
    s_and_b32 s40, s3, 0xffff
    s_cmp_lt_u32 s40, 128
    s_cbranch_scc1 ht_242
    s_add_u32 s3, s3, 4128768
    s_lshr_b32 s3, s3, 10
    s_and_b32 s79, s3, 8192
hp_241:
    s_lshr_b32 s40, s100, 8
    s_lshl_b32 s40, s40, 7
    s_add_u32 s40, s40, 79725568
    s_cmp_lg_u32 s6, 0
    s_cbranch_scc1 re_244
    s_cmp_lg_u32 s26, 0
    s_cbranch_scc1 wf_247
    v_mov_b32 v3, s40
wt_248:
    buffer_load_dword v4, v3, s[8:11], 0 offen sc1
    s_sub_u32 s30, s30, 1
    s_cbranch_scc1 L_end
    s_waitcnt vmcnt(0)
    v_cmp_gt_u32 vcc, 4, v4
    s_cbranch_vccz wf_247
    s_sleep 8
    s_branch wt_248
wf_247:
    s_barrier
    s_branch rd_245
re_244:
    v_mov_b32 v7, 163588
    s_cmp_lg_u32 s26, 0
    s_cbranch_scc1 rl_246
    v_mov_b32 v3, s40
    buffer_load_dword v4, v3, s[8:11], 0 offen sc1
    s_waitcnt vmcnt(0)
    v_cmp_gt_u32 vcc, 4, v4
    s_nop 3
    s_or_b32 s3, vcc_lo, vcc_hi
    v_mov_b32 v4, s3
    ds_write_b32 v7, v4
    s_waitcnt lgkmcnt(0)
rl_246:
    s_barrier
    ds_read_b32 v4, v7
    s_waitcnt lgkmcnt(0)
    v_readfirstlane_b32 s3, v4
    s_nop 3
    s_cmp_lg_u32 s3, 0
    s_cbranch_scc1 P_skip
rd_245:
    s_mov_b32 s12, s4
    s_and_b32 s13, s5, 0xffff
    s_mov_b32 s14, 0x10000000
    s_mov_b32 s15, 0x20000
    s_mov_b32 s16, s96
    s_and_b32 s17, s97, 0xffff
    s_mov_b32 s18, 0x200000
    s_mov_b32 s19, 0x20000
    s_lshl_b32 s101, s101, 5
    s_mul_i32 s3, s43, 256
    s_add_u32 s101, s101, s3
    s_mul_i32 s38, s26, 4
    s_add_u32 s38, s38, 0
    s_lshr_b32 s39, s38, 1
    s_mul_i32 s39, s39, 65536
    s_and_b32 s38, s38, 1
    s_lshl_b32 s38, s38, 10
    s_add_u32 s38, s38, s39
    s_sub_u32 s38, s38, 0
    v_lshlrev_b32 v3, 4, v2
    v_add_u32 v8, s38, v3
    s_mul_i32 s38, s26, 4
    s_add_u32 s38, s38, 1
    s_lshr_b32 s39, s38, 1
    s_mul_i32 s39, s39, 65536
    s_and_b32 s38, s38, 1
    s_lshl_b32 s38, s38, 10
    s_add_u32 s38, s38, s39
    s_sub_u32 s38, s38, 1024
    v_lshlrev_b32 v3, 4, v2
    v_add_u32 v9, s38, v3
    s_mul_i32 s38, s26, 4
    s_add_u32 s38, s38, 2
    s_lshr_b32 s39, s38, 1
    s_mul_i32 s39, s39, 65536
    s_and_b32 s38, s38, 1
    s_lshl_b32 s38, s38, 10
    s_add_u32 s38, s38, s39
    s_sub_u32 s38, s38, 2048
    v_lshlrev_b32 v3, 4, v2
    v_add_u32 v10, s38, v3
    s_mul_i32 s38, s26, 4
    s_add_u32 s38, s38, 3
    s_lshr_b32 s39, s38, 1
    s_mul_i32 s39, s39, 65536
    s_and_b32 s38, s38, 1
    s_lshl_b32 s38, s38, 10
    s_add_u32 s38, s38, s39
    s_sub_u32 s38, s38, 3072
    v_lshlrev_b32 v3, 4, v2
    v_add_u32 v11, s38, v3
    s_mul_i32 s38, s26, 8
    s_add_u32 s38, s38, 0
    v_lshrrev_b32 v3, 5, v2
    v_add_u32 v3, s38, v3
    v_and_b32 v4, 3, v3
    v_lshlrev_b32 v4, 1, v4
    v_bfe_u32 v5, v3, 3, 1
    v_or_b32 v4, v4, v5
    v_lshlrev_b32 v4, 1, v4
    v_and_b32 v5, 31, v2
    v_xor_b32 v4, v4, v5
    v_lshlrev_b32 v4, 4, v4
    v_and_b32 v5, 32, v3
    v_and_b32 v6, 1, v3
    v_lshl_add_u32 v5, v6, 4, v5
    v_bfe_u32 v6, v3, 1, 4
    v_add_u32 v3, v6, v5
    v_mul_u32_u24 v3, 2048, v3
    v_add_u32 v3, v3, v4
    v_subrev_u32 v12, 0, v3
    s_mul_i32 s38, s26, 8
    s_add_u32 s38, s38, 2
    v_lshrrev_b32 v3, 5, v2
    v_add_u32 v3, s38, v3
    v_and_b32 v4, 3, v3
    v_lshlrev_b32 v4, 1, v4
    v_bfe_u32 v5, v3, 3, 1
    v_or_b32 v4, v4, v5
    v_lshlrev_b32 v4, 1, v4
    v_and_b32 v5, 31, v2
    v_xor_b32 v4, v4, v5
    v_lshlrev_b32 v4, 4, v4
    v_and_b32 v5, 32, v3
    v_and_b32 v6, 1, v3
    v_lshl_add_u32 v5, v6, 4, v5
    v_bfe_u32 v6, v3, 1, 4
    v_add_u32 v3, v6, v5
    v_mul_u32_u24 v3, 2048, v3
    v_add_u32 v3, v3, v4
    v_subrev_u32 v13, 1024, v3
    s_mul_i32 s38, s26, 8
    s_add_u32 s38, s38, 4
    v_lshrrev_b32 v3, 5, v2
    v_add_u32 v3, s38, v3
    v_and_b32 v4, 3, v3
    v_lshlrev_b32 v4, 1, v4
    v_bfe_u32 v5, v3, 3, 1
    v_or_b32 v4, v4, v5
    v_lshlrev_b32 v4, 1, v4
    v_and_b32 v5, 31, v2
    v_xor_b32 v4, v4, v5
    v_lshlrev_b32 v4, 4, v4
    v_and_b32 v5, 32, v3
    v_and_b32 v6, 1, v3
    v_lshl_add_u32 v5, v6, 4, v5
    v_bfe_u32 v6, v3, 1, 4
    v_add_u32 v3, v6, v5
    v_mul_u32_u24 v3, 2048, v3
    v_add_u32 v3, v3, v4
    v_subrev_u32 v14, 2048, v3
    s_mul_i32 s38, s26, 8
    s_add_u32 s38, s38, 6
    v_lshrrev_b32 v3, 5, v2
    v_add_u32 v3, s38, v3
    v_and_b32 v4, 3, v3
    v_lshlrev_b32 v4, 1, v4
    v_bfe_u32 v5, v3, 3, 1
    v_or_b32 v4, v4, v5
    v_lshlrev_b32 v4, 1, v4
    v_and_b32 v5, 31, v2
    v_xor_b32 v4, v4, v5
    v_lshlrev_b32 v4, 4, v4
    v_and_b32 v5, 32, v3
    v_and_b32 v6, 1, v3
    v_lshl_add_u32 v5, v6, 4, v5
    v_bfe_u32 v6, v3, 1, 4
    v_add_u32 v3, v6, v5
    v_mul_u32_u24 v3, 2048, v3
    v_add_u32 v3, v3, v4
    v_subrev_u32 v15, 3072, v3
    s_mov_b32 s33, 131072
    s_lshl_b32 s31, s100, 12
    s_add_u32 s31, s31, 234881024
    s_bfe_u32 s3, s100, 0x10009
    s_lshl_b32 s3, s3, 13
    s_xor_b32 s3, s3, s79
    s_xor_b32 s3, s3, 8192
    s_add_u32 s31, s31, s3
    s_lshl_b32 s32, s101, 1
    s_mul_i32 s35, s26, 4096
    s_mul_i32 s36, s26, 4096
    s_add_u32 s36, s36, 32768
    s_mov_b32 m0, s35
    s_xor_b32 s35, s35, 65536
    buffer_load_dwordx4 v8, s[12:15], s31 offen offset:0 sc1 lds
    buffer_load_dwordx4 v9, s[12:15], s31 offen offset:1024 sc1 lds
    buffer_load_dwordx4 v10, s[12:15], s31 offen offset:2048 sc1 lds
    buffer_load_dwordx4 v11, s[12:15], s31 offen offset:3072 sc1 lds
    s_mov_b32 m0, s36
    s_add_u32 s31, s31, 2048
    s_and_b32 s40, s31, 0x1fff
    s_cselect_b32 s40, 0, 0x2000
    s_add_u32 s31, s31, s40
    s_xor_b32 s36, s36, 65536
    buffer_load_dwordx4 v12, s[16:19], s32 offen offset:0  lds
    buffer_load_dwordx4 v13, s[16:19], s32 offen offset:1024  lds
    buffer_load_dwordx4 v14, s[16:19], s32 offen offset:2048  lds
    buffer_load_dwordx4 v15, s[16:19], s32 offen offset:3072  lds
    s_add_u32 s32, s32, s33
    s_mov_b32 m0, s35
    s_xor_b32 s35, s35, 65536
    buffer_load_dwordx4 v8, s[12:15], s31 offen offset:0 sc1 lds
    buffer_load_dwordx4 v9, s[12:15], s31 offen offset:1024 sc1 lds
    buffer_load_dwordx4 v10, s[12:15], s31 offen offset:2048 sc1 lds
    buffer_load_dwordx4 v11, s[12:15], s31 offen offset:3072 sc1 lds
    s_mov_b32 m0, s36
    s_add_u32 s31, s31, 2048
    s_and_b32 s40, s31, 0x1fff
    s_cselect_b32 s40, 0, 0x2000
    s_add_u32 s31, s31, s40
    s_xor_b32 s36, s36, 65536
    buffer_load_dwordx4 v12, s[16:19], s32 offen offset:0  lds
    buffer_load_dwordx4 v13, s[16:19], s32 offen offset:1024  lds
    buffer_load_dwordx4 v14, s[16:19], s32 offen offset:2048  lds
    buffer_load_dwordx4 v15, s[16:19], s32 offen offset:3072  lds
    s_add_u32 s32, s32, s33
    s_cmp_lg_u32 s6, 0
    s_cbranch_scc1 D_epi
M_T7:
    s_mov_b32 s49, s7
    s_mov_b32 s37, s25
    s_mov_b32 s41, s100
    s_mov_b32 s42, s101
    s_lshr_b32 s44, s26, 2
    s_and_b32 s45, s26, 3
    s_mul_i32 s38, s44, 16384
    v_lshlrev_b32 v3, 4, v2
    v_add_u32 v16, s38, v3
    v_add_u32 v17, 1024, v16
    v_and_b32 v3, 3, v2
    v_lshlrev_b32 v3, 4, v3
    s_mul_i32 s38, s45, 128
    v_add_u32 v3, s38, v3
    v_bfe_u32 v4, v2, 2, 2
    v_lshlrev_b32 v5, 6, v4
    v_xor_b32 v3, v3, v5
    v_bfe_u32 v5, v2, 4, 1
    v_lshlrev_b32 v5, 5, v5
    v_xor_b32 v3, v3, v5
    v_lshrrev_b32 v5, 4, v2
    v_lshl_add_u32 v4, v5, 3, v4
    v_mul_u32_u24 v4, 512, v4
    v_add_u32 v18, v3, v4
    v_xor_b32 v19, 8, v18
    v_xor_b32 v20, 64, v18
    v_xor_b32 v21, 72, v18
    s_branch LP_T7
P_QT:
    s_mov_b32 s12, s82
    s_and_b32 s13, s83, 0xffff
    s_mov_b32 s14, 0x400000
    s_mov_b32 s15, 0x20000
    s_mov_b32 s16, s84
    s_and_b32 s17, s85, 0xffff
    s_mov_b32 s18, 0x800000
    s_mov_b32 s19, 0x20000
    s_lshl_b32 s101, s101, 5
    s_mul_i32 s3, s43, 1024
    s_add_u32 s101, s101, s3
    s_mul_i32 s38, s26, 32
    s_add_u32 s38, s38, 0
    v_lshrrev_b32 v3, 3, v2
    v_add_u32 v3, s38, v3
    v_bfe_u32 v4, v3, 1, 3
    v_and_b32 v5, 7, v2
    v_xor_b32 v4, v4, v5
    v_mul_u32_u24 v3, 2048, v3
    v_lshl_add_u32 v3, v4, 4, v3
    v_subrev_u32 v8, 0, v3
    s_mul_i32 s38, s26, 32
    s_add_u32 s38, s38, 8
    v_lshrrev_b32 v3, 3, v2
    v_add_u32 v3, s38, v3
    v_bfe_u32 v4, v3, 1, 3
    v_and_b32 v5, 7, v2
    v_xor_b32 v4, v4, v5
    v_mul_u32_u24 v3, 2048, v3
    v_lshl_add_u32 v3, v4, 4, v3
    v_subrev_u32 v9, 1024, v3
    s_mul_i32 s38, s26, 32
    s_add_u32 s38, s38, 16
    v_lshrrev_b32 v3, 3, v2
    v_add_u32 v3, s38, v3
    v_bfe_u32 v4, v3, 1, 3
    v_and_b32 v5, 7, v2
    v_xor_b32 v4, v4, v5
    v_mul_u32_u24 v3, 2048, v3
    v_lshl_add_u32 v3, v4, 4, v3
    v_subrev_u32 v10, 2048, v3
    s_mul_i32 s38, s26, 32
    s_add_u32 s38, s38, 24
    v_lshrrev_b32 v3, 3, v2
    v_add_u32 v3, s38, v3
    v_bfe_u32 v4, v3, 1, 3
    v_and_b32 v5, 7, v2
    v_xor_b32 v4, v4, v5
    v_mul_u32_u24 v3, 2048, v3
    v_lshl_add_u32 v3, v4, 4, v3
    v_subrev_u32 v11, 3072, v3
    s_mul_i32 s38, s26, 8
    s_add_u32 s38, s38, 0
    v_lshrrev_b32 v3, 5, v2
    v_add_u32 v3, s38, v3
    v_and_b32 v4, 3, v3
    v_lshlrev_b32 v4, 1, v4
    v_bfe_u32 v5, v3, 3, 1
    v_or_b32 v4, v4, v5
    v_lshlrev_b32 v4, 1, v4
    v_and_b32 v5, 31, v2
    v_xor_b32 v4, v4, v5
    v_lshlrev_b32 v4, 4, v4
    v_mul_u32_u24 v3, 8192, v3
    v_add_u32 v3, v3, v4
    v_subrev_u32 v12, 0, v3
    s_mul_i32 s38, s26, 8
    s_add_u32 s38, s38, 2
    v_lshrrev_b32 v3, 5, v2
    v_add_u32 v3, s38, v3
    v_and_b32 v4, 3, v3
    v_lshlrev_b32 v4, 1, v4
    v_bfe_u32 v5, v3, 3, 1
    v_or_b32 v4, v4, v5
    v_lshlrev_b32 v4, 1, v4
    v_and_b32 v5, 31, v2
    v_xor_b32 v4, v4, v5
    v_lshlrev_b32 v4, 4, v4
    v_mul_u32_u24 v3, 8192, v3
    v_add_u32 v3, v3, v4
    v_subrev_u32 v13, 1024, v3
    s_mul_i32 s38, s26, 8
    s_add_u32 s38, s38, 4
    v_lshrrev_b32 v3, 5, v2
    v_add_u32 v3, s38, v3
    v_and_b32 v4, 3, v3
    v_lshlrev_b32 v4, 1, v4
    v_bfe_u32 v5, v3, 3, 1
    v_or_b32 v4, v4, v5
    v_lshlrev_b32 v4, 1, v4
    v_and_b32 v5, 31, v2
    v_xor_b32 v4, v4, v5
    v_lshlrev_b32 v4, 4, v4
    v_mul_u32_u24 v3, 8192, v3
    v_add_u32 v3, v3, v4
    v_subrev_u32 v14, 2048, v3
    s_mul_i32 s38, s26, 8
    s_add_u32 s38, s38, 6
    v_lshrrev_b32 v3, 5, v2
    v_add_u32 v3, s38, v3
    v_and_b32 v4, 3, v3
    v_lshlrev_b32 v4, 1, v4
    v_bfe_u32 v5, v3, 3, 1
    v_or_b32 v4, v4, v5
    v_lshlrev_b32 v4, 1, v4
    v_and_b32 v5, 31, v2
    v_xor_b32 v4, v4, v5
    v_lshlrev_b32 v4, 4, v4
    v_mul_u32_u24 v3, 8192, v3
    v_add_u32 v3, v3, v4
    v_subrev_u32 v15, 3072, v3
    s_mov_b32 s33, 524288
    s_lshl_b32 s31, s100, 11
    s_lshl_b32 s32, s101, 1
    s_mul_i32 s35, s26, 4096
    s_mul_i32 s36, s26, 4096
    s_add_u32 s36, s36, 32768
    s_mov_b32 m0, s35
    s_xor_b32 s35, s35, 65536
    buffer_load_dwordx4 v8, s[12:15], s31 offen offset:0  lds
    buffer_load_dwordx4 v9, s[12:15], s31 offen offset:1024  lds
    buffer_load_dwordx4 v10, s[12:15], s31 offen offset:2048  lds
    buffer_load_dwordx4 v11, s[12:15], s31 offen offset:3072  lds
    s_mov_b32 m0, s36
    s_add_u32 s31, s31, 128
    s_xor_b32 s36, s36, 65536
    buffer_load_dwordx4 v12, s[16:19], s32 offen offset:0  lds
    buffer_load_dwordx4 v13, s[16:19], s32 offen offset:1024  lds
    buffer_load_dwordx4 v14, s[16:19], s32 offen offset:2048  lds
    buffer_load_dwordx4 v15, s[16:19], s32 offen offset:3072  lds
    s_add_u32 s32, s32, s33
    s_mov_b32 m0, s35
    s_xor_b32 s35, s35, 65536
    buffer_load_dwordx4 v8, s[12:15], s31 offen offset:0  lds
    buffer_load_dwordx4 v9, s[12:15], s31 offen offset:1024  lds
    buffer_load_dwordx4 v10, s[12:15], s31 offen offset:2048  lds
    buffer_load_dwordx4 v11, s[12:15], s31 offen offset:3072  lds
    s_mov_b32 m0, s36
    s_add_u32 s31, s31, 128
    s_xor_b32 s36, s36, 65536
    buffer_load_dwordx4 v12, s[16:19], s32 offen offset:0  lds
    buffer_load_dwordx4 v13, s[16:19], s32 offen offset:1024  lds
    buffer_load_dwordx4 v14, s[16:19], s32 offen offset:2048  lds
    buffer_load_dwordx4 v15, s[16:19], s32 offen offset:3072  lds
    s_add_u32 s32, s32, s33
    s_cmp_lg_u32 s6, 0
    s_cbranch_scc1 D_epi
M_QT:
    s_mov_b32 s49, s7
    s_mov_b32 s37, s25
    s_mov_b32 s41, s100
    s_mov_b32 s42, s101
    s_lshr_b32 s44, s26, 1
    s_and_b32 s45, s26, 1
    s_mul_i32 s38, s44, 4096
    v_and_b32 v3, 15, v2
    v_lshrrev_b32 v4, 4, v2
    v_lshrrev_b32 v5, 1, v3
    v_xor_b32 v4, v4, v5
    v_lshlrev_b32 v3, 7, v3
    v_lshl_add_u32 v3, v4, 4, v3
    v_add_u32 v16, s38, v3
    v_xor_b32 v17, 64, v16
    v_and_b32 v3, 3, v2
    v_lshlrev_b32 v3, 3, v3
    s_mul_i32 s38, s45, 256
    v_add_u32 v3, s38, v3
    v_bfe_u32 v4, v2, 2, 2
    v_lshlrev_b32 v5, 6, v4
    v_xor_b32 v3, v3, v5
    v_bfe_u32 v5, v2, 4, 1
    v_lshlrev_b32 v5, 5, v5
    v_xor_b32 v3, v3, v5
    v_lshrrev_b32 v5, 4, v2
    v_lshl_add_u32 v4, v5, 3, v4
    v_mul_u32_u24 v4, 512, v4
    v_add_u32 v18, v3, v4
    v_xor_b32 v19, 32, v18
    v_xor_b32 v20, 64, v18
    v_xor_b32 v21, 96, v18
    v_xor_b32 v22, 128, v18
    v_xor_b32 v23, 160, v18
    v_xor_b32 v24, 192, v18
    v_xor_b32 v25, 224, v18
    s_cmp_lg_u32 s79, -1
    s_cbranch_scc1 hp_253
ht_254:
    s_sub_u32 s30, s30, 1
    s_cbranch_scc1 L_end
    v_mov_b32 v30, 128
    buffer_load_dword v31, v30, s[20:23], 0 offen sc1
hc_255:
    s_waitcnt vmcnt(0)
    v_readfirstlane_b32 s3, v31
    s_nop 3
    s_and_b32 s40, s3, 0xffff
    s_cmp_lt_u32 s40, 128
    s_cbranch_scc1 ht_254
    s_add_u32 s3, s3, 4128768
    s_lshr_b32 s3, s3, 10
    s_and_b32 s79, s3, 8192
hp_253:
    s_lshr_b32 s80, s41, 5
    s_add_u32 s80, s80, s44
    s_lshr_b32 s81, s42, 7
    s_add_u32 s81, s81, s45
    s_lshl_b32 s38, s81, 16
    s_add_u32 s38, s38, 75501568
    s_add_u32 s38, s38, s79
    v_and_b32 v30, 3, v2
    v_lshlrev_b32 v30, 14, v30
    v_add_u32 v30, s38, v30
    s_lshr_b32 s38, s41, 8
    s_lshl_b32 s38, s38, 2
    s_add_u32 s38, s38, s43
    s_lshl_b32 s38, s38, 7
    s_add_u32 s38, s38, 79720448
    s_mov_b32 exec_lo, 0xf0f0f0f0
    s_mov_b32 exec_hi, 0xf0f0f0f0
    v_mov_b32 v30, s38
    s_mov_b64 exec, -1
    buffer_load_dword v29, v30, s[8:11], 0 offen sc1
    s_branch LP_QT
LP_K0:
    s_mov_b32 s34, 11
    s_mov_b32 s27, 0
    s_mov_b32 s29, 32768
    s_waitcnt vmcnt(12)
    s_barrier
    ds_read_b64_tr_b16 v[48:49], v18 offset:16384
    ds_read_b64_tr_b16 v[50:51], v18 offset:17408
    ds_read_b64_tr_b16 v[52:53], v19 offset:16384
    ds_read_b64_tr_b16 v[54:55], v19 offset:17408
    ds_read_b128 v[32:35], v16 offset:0
    ds_read_b128 v[36:39], v16 offset:2048
    ds_read_b128 v[40:43], v16 offset:4096
    ds_read_b128 v[44:47], v16 offset:6144
    s_waitcnt lgkmcnt(0)
    v_mfma_f32_16x16x32_bf16 v[128:131], v[48:51], v[32:35], 0
    ds_read_b64_tr_b16 v[96:97], v18 offset:24576
    ds_read_b64_tr_b16 v[98:99], v18 offset:25600
    v_mfma_f32_16x16x32_bf16 v[132:135], v[52:55], v[32:35], 0
    ds_read_b64_tr_b16 v[100:101], v19 offset:24576
    ds_read_b64_tr_b16 v[102:103], v19 offset:25600
    v_mfma_f32_16x16x32_bf16 v[136:139], v[48:51], v[36:39], 0
    ds_read_b128 v[80:83], v17 offset:0
    v_mfma_f32_16x16x32_bf16 v[140:143], v[52:55], v[36:39], 0
    ds_read_b128 v[84:87], v17 offset:2048
    ds_read_b128 v[88:91], v17 offset:4096
    v_mfma_f32_16x16x32_bf16 v[144:147], v[48:51], v[40:43], 0
    ds_read_b128 v[92:95], v17 offset:6144
    s_add_u32 s27, s27, 1
    s_cmp_eq_u32 s27, 4
    s_cselect_b32 s28, -98304, s29
    s_cselect_b32 s27, 0, s27
    v_mfma_f32_16x16x32_bf16 v[148:151], v[52:55], v[40:43], 0
    v_add_u32 v16, s28, v16
    v_mfma_f32_16x16x32_bf16 v[152:155], v[48:51], v[44:47], 0
    v_add_u32 v17, s28, v17
    v_add_u32 v18, s28, v18
    v_mfma_f32_16x16x32_bf16 v[156:159], v[52:55], v[44:47], 0
    v_add_u32 v19, s28, v19
    s_waitcnt vmcnt(8) lgkmcnt(0)
    s_barrier
    v_mfma_f32_16x16x32_bf16 v[128:131], v[96:99], v[80:83], v[128:131]
    ds_read_b64_tr_b16 v[48:49], v18 offset:16384
    ds_read_b64_tr_b16 v[50:51], v18 offset:17408
    v_mfma_f32_16x16x32_bf16 v[132:135], v[100:103], v[80:83], v[132:135]
    ds_read_b64_tr_b16 v[52:53], v19 offset:16384
    ds_read_b64_tr_b16 v[54:55], v19 offset:17408
    v_mfma_f32_16x16x32_bf16 v[136:139], v[96:99], v[84:87], v[136:139]
    ds_read_b128 v[32:35], v16 offset:0
    ds_read_b128 v[36:39], v16 offset:2048
    v_mfma_f32_16x16x32_bf16 v[140:143], v[100:103], v[84:87], v[140:143]
    ds_read_b128 v[40:43], v16 offset:4096
    ds_read_b128 v[44:47], v16 offset:6144
    v_mfma_f32_16x16x32_bf16 v[144:147], v[96:99], v[88:91], v[144:147]
    s_mov_b32 m0, s35
    s_add_u32 s35, s35, 32768
    s_cmp_ge_u32 s35, 131072
    s_cselect_b32 s40, 131072, 0
    s_sub_u32 s35, s35, s40
    buffer_load_dwordx4 v8, s[12:15], s31 offen offset:0  lds
    v_mfma_f32_16x16x32_bf16 v[148:151], v[100:103], v[88:91], v[148:151]
    buffer_load_dwordx4 v9, s[12:15], s31 offen offset:1024  lds
    s_mov_b32 m0, s36
    s_add_u32 s31, s31, 128
    s_add_u32 s36, s36, 32768
    s_cmp_ge_u32 s36, 131072
    s_cselect_b32 s40, 131072, 0
    s_sub_u32 s36, s36, s40
    v_mfma_f32_16x16x32_bf16 v[152:155], v[96:99], v[92:95], v[152:155]
    buffer_load_dwordx4 v12, s[16:19], s32 offen offset:0  lds
    buffer_load_dwordx4 v13, s[16:19], s32 offen offset:1024  lds
    v_mfma_f32_16x16x32_bf16 v[156:159], v[100:103], v[92:95], v[156:159]
    s_add_u32 s32, s32, s33
gl_125:
    s_waitcnt lgkmcnt(0)
    v_mfma_f32_16x16x32_bf16 v[128:131], v[48:51], v[32:35], v[128:131]
    ds_read_b64_tr_b16 v[96:97], v18 offset:24576
    ds_read_b64_tr_b16 v[98:99], v18 offset:25600
    v_mfma_f32_16x16x32_bf16 v[132:135], v[52:55], v[32:35], v[132:135]
    ds_read_b64_tr_b16 v[100:101], v19 offset:24576
    ds_read_b64_tr_b16 v[102:103], v19 offset:25600
    v_mfma_f32_16x16x32_bf16 v[136:139], v[48:51], v[36:39], v[136:139]
    ds_read_b128 v[80:83], v17 offset:0
    v_mfma_f32_16x16x32_bf16 v[140:143], v[52:55], v[36:39], v[140:143]
    ds_read_b128 v[84:87], v17 offset:2048
    ds_read_b128 v[88:91], v17 offset:4096
    v_mfma_f32_16x16x32_bf16 v[144:147], v[48:51], v[40:43], v[144:147]
    ds_read_b128 v[92:95], v17 offset:6144
    s_add_u32 s27, s27, 1
    s_cmp_eq_u32 s27, 4
    s_cselect_b32 s28, -98304, s29
    s_cselect_b32 s27, 0, s27
    v_mfma_f32_16x16x32_bf16 v[148:151], v[52:55], v[40:43], v[148:151]
    v_add_u32 v16, s28, v16
    v_mfma_f32_16x16x32_bf16 v[152:155], v[48:51], v[44:47], v[152:155]
    v_add_u32 v17, s28, v17
    v_add_u32 v18, s28, v18
    v_mfma_f32_16x16x32_bf16 v[156:159], v[52:55], v[44:47], v[156:159]
    v_add_u32 v19, s28, v19
    s_waitcnt vmcnt(8) lgkmcnt(0)
    s_barrier
    v_mfma_f32_16x16x32_bf16 v[128:131], v[96:99], v[80:83], v[128:131]
    ds_read_b64_tr_b16 v[48:49], v18 offset:16384
    ds_read_b64_tr_b16 v[50:51], v18 offset:17408
    v_mfma_f32_16x16x32_bf16 v[132:135], v[100:103], v[80:83], v[132:135]
    ds_read_b64_tr_b16 v[52:53], v19 offset:16384
    ds_read_b64_tr_b16 v[54:55], v19 offset:17408
    v_mfma_f32_16x16x32_bf16 v[136:139], v[96:99], v[84:87], v[136:139]
    ds_read_b128 v[32:35], v16 offset:0
    ds_read_b128 v[36:39], v16 offset:2048
    v_mfma_f32_16x16x32_bf16 v[140:143], v[100:103], v[84:87], v[140:143]
    ds_read_b128 v[40:43], v16 offset:4096
    ds_read_b128 v[44:47], v16 offset:6144
    v_mfma_f32_16x16x32_bf16 v[144:147], v[96:99], v[88:91], v[144:147]
    s_mov_b32 m0, s35
    s_add_u32 s35, s35, 32768
    s_cmp_ge_u32 s35, 131072
    s_cselect_b32 s40, 131072, 0
    s_sub_u32 s35, s35, s40
    buffer_load_dwordx4 v8, s[12:15], s31 offen offset:0  lds
    v_mfma_f32_16x16x32_bf16 v[148:151], v[100:103], v[88:91], v[148:151]
    buffer_load_dwordx4 v9, s[12:15], s31 offen offset:1024  lds
    s_mov_b32 m0, s36
    s_add_u32 s31, s31, 128
    s_add_u32 s36, s36, 32768
    s_cmp_ge_u32 s36, 131072
    s_cselect_b32 s40, 131072, 0
    s_sub_u32 s36, s36, s40
    v_mfma_f32_16x16x32_bf16 v[152:155], v[96:99], v[92:95], v[152:155]
    buffer_load_dwordx4 v12, s[16:19], s32 offen offset:0  lds
    buffer_load_dwordx4 v13, s[16:19], s32 offen offset:1024  lds
    v_mfma_f32_16x16x32_bf16 v[156:159], v[100:103], v[92:95], v[156:159]
    s_add_u32 s32, s32, s33
    s_sub_u32 s34, s34, 1
    s_cmp_lg_u32 s34, 0
    s_cbranch_scc1 gl_125
    s_cmp_lg_u32 s26, 0
    s_cbranch_scc1 ti_126
    s_lshl_b32 s3, s43, 2
    s_add_u32 s3, s3, 16
    v_mov_b32 v27, s3
    v_mov_b32 v28, 1
    s_mov_b64 exec, 1
    buffer_atomic_add v28, v27, s[20:23], 0 offen sc0 sc1
    s_mov_b64 exec, -1
ti_126:
    v_mov_b32 v30, 128
    buffer_load_dword v31, v30, s[20:23], 0 offen sc1
    s_waitcnt lgkmcnt(0)
    v_mfma_f32_16x16x32_bf16 v[128:131], v[48:51], v[32:35], v[128:131]
    ds_read_b64_tr_b16 v[96:97], v18 offset:24576
    ds_read_b64_tr_b16 v[98:99], v18 offset:25600
    v_mfma_f32_16x16x32_bf16 v[132:135], v[52:55], v[32:35], v[132:135]
    ds_read_b64_tr_b16 v[100:101], v19 offset:24576
    ds_read_b64_tr_b16 v[102:103], v19 offset:25600
    v_mfma_f32_16x16x32_bf16 v[136:139], v[48:51], v[36:39], v[136:139]
    ds_read_b128 v[80:83], v17 offset:0
    v_mfma_f32_16x16x32_bf16 v[140:143], v[52:55], v[36:39], v[140:143]
    ds_read_b128 v[84:87], v17 offset:2048
    ds_read_b128 v[88:91], v17 offset:4096
    v_mfma_f32_16x16x32_bf16 v[144:147], v[48:51], v[40:43], v[144:147]
    ds_read_b128 v[92:95], v17 offset:6144
    s_add_u32 s27, s27, 1
    s_cmp_eq_u32 s27, 4
    s_cselect_b32 s28, -98304, s29
    s_cselect_b32 s27, 0, s27
    v_mfma_f32_16x16x32_bf16 v[148:151], v[52:55], v[40:43], v[148:151]
    v_add_u32 v16, s28, v16
    v_mfma_f32_16x16x32_bf16 v[152:155], v[48:51], v[44:47], v[152:155]
    v_add_u32 v17, s28, v17
    v_add_u32 v18, s28, v18
    v_mfma_f32_16x16x32_bf16 v[156:159], v[52:55], v[44:47], v[156:159]
    v_add_u32 v19, s28, v19
    s_waitcnt vmcnt(8) lgkmcnt(0)
    s_barrier
    v_mfma_f32_16x16x32_bf16 v[128:131], v[96:99], v[80:83], v[128:131]
    ds_read_b64_tr_b16 v[48:49], v18 offset:16384
    v_mfma_f32_16x16x32_bf16 v[132:135], v[100:103], v[80:83], v[132:135]
    ds_read_b64_tr_b16 v[50:51], v18 offset:17408
    v_mfma_f32_16x16x32_bf16 v[136:139], v[96:99], v[84:87], v[136:139]
    ds_read_b64_tr_b16 v[52:53], v19 offset:16384
    v_mfma_f32_16x16x32_bf16 v[140:143], v[100:103], v[84:87], v[140:143]
    ds_read_b64_tr_b16 v[54:55], v19 offset:17408
    v_mfma_f32_16x16x32_bf16 v[144:147], v[96:99], v[88:91], v[144:147]
    ds_read_b128 v[32:35], v16 offset:0
    v_mfma_f32_16x16x32_bf16 v[148:151], v[100:103], v[88:91], v[148:151]
    ds_read_b128 v[36:39], v16 offset:2048
    v_mfma_f32_16x16x32_bf16 v[152:155], v[96:99], v[92:95], v[152:155]
    ds_read_b128 v[40:43], v16 offset:4096
    v_mfma_f32_16x16x32_bf16 v[156:159], v[100:103], v[92:95], v[156:159]
    ds_read_b128 v[44:47], v16 offset:6144
    s_waitcnt lgkmcnt(0)
    v_mfma_f32_16x16x32_bf16 v[128:131], v[48:51], v[32:35], v[128:131]
    ds_read_b64_tr_b16 v[96:97], v18 offset:24576
    ds_read_b64_tr_b16 v[98:99], v18 offset:25600
    v_mfma_f32_16x16x32_bf16 v[132:135], v[52:55], v[32:35], v[132:135]
    ds_read_b64_tr_b16 v[100:101], v19 offset:24576
    ds_read_b64_tr_b16 v[102:103], v19 offset:25600
    v_mfma_f32_16x16x32_bf16 v[136:139], v[48:51], v[36:39], v[136:139]
    ds_read_b128 v[80:83], v17 offset:0
    v_mfma_f32_16x16x32_bf16 v[140:143], v[52:55], v[36:39], v[140:143]
    ds_read_b128 v[84:87], v17 offset:2048
    ds_read_b128 v[88:91], v17 offset:4096
    v_mfma_f32_16x16x32_bf16 v[144:147], v[48:51], v[40:43], v[144:147]
    ds_read_b128 v[92:95], v17 offset:6144
    s_add_u32 s27, s27, 1
    s_cmp_eq_u32 s27, 4
    s_cselect_b32 s28, -98304, s29
    s_cselect_b32 s27, 0, s27
    v_mfma_f32_16x16x32_bf16 v[148:151], v[52:55], v[40:43], v[148:151]
    v_add_u32 v16, s28, v16
    v_mfma_f32_16x16x32_bf16 v[152:155], v[48:51], v[44:47], v[152:155]
    v_add_u32 v17, s28, v17
    v_add_u32 v18, s28, v18
    v_mfma_f32_16x16x32_bf16 v[156:159], v[52:55], v[44:47], v[156:159]
    v_add_u32 v19, s28, v19
    s_waitcnt vmcnt(4) lgkmcnt(0)
    s_barrier
    v_mfma_f32_16x16x32_bf16 v[128:131], v[96:99], v[80:83], v[128:131]
    ds_read_b64_tr_b16 v[48:49], v18 offset:16384
    v_mfma_f32_16x16x32_bf16 v[132:135], v[100:103], v[80:83], v[132:135]
    ds_read_b64_tr_b16 v[50:51], v18 offset:17408
    v_mfma_f32_16x16x32_bf16 v[136:139], v[96:99], v[84:87], v[136:139]
    ds_read_b64_tr_b16 v[52:53], v19 offset:16384
    v_mfma_f32_16x16x32_bf16 v[140:143], v[100:103], v[84:87], v[140:143]
    ds_read_b64_tr_b16 v[54:55], v19 offset:17408
    v_mfma_f32_16x16x32_bf16 v[144:147], v[96:99], v[88:91], v[144:147]
    ds_read_b128 v[32:35], v16 offset:0
    v_mfma_f32_16x16x32_bf16 v[148:151], v[100:103], v[88:91], v[148:151]
    ds_read_b128 v[36:39], v16 offset:2048
    v_mfma_f32_16x16x32_bf16 v[152:155], v[96:99], v[92:95], v[152:155]
    ds_read_b128 v[40:43], v16 offset:4096
    v_mfma_f32_16x16x32_bf16 v[156:159], v[100:103], v[92:95], v[156:159]
    ds_read_b128 v[44:47], v16 offset:6144
    s_waitcnt lgkmcnt(0)
    v_mfma_f32_16x16x32_bf16 v[128:131], v[48:51], v[32:35], v[128:131]
    ds_read_b64_tr_b16 v[96:97], v18 offset:24576
    ds_read_b64_tr_b16 v[98:99], v18 offset:25600
    v_mfma_f32_16x16x32_bf16 v[132:135], v[52:55], v[32:35], v[132:135]
    ds_read_b64_tr_b16 v[100:101], v19 offset:24576
    ds_read_b64_tr_b16 v[102:103], v19 offset:25600
    v_mfma_f32_16x16x32_bf16 v[136:139], v[48:51], v[36:39], v[136:139]
    ds_read_b128 v[80:83], v17 offset:0
    v_mfma_f32_16x16x32_bf16 v[140:143], v[52:55], v[36:39], v[140:143]
    ds_read_b128 v[84:87], v17 offset:2048
    ds_read_b128 v[88:91], v17 offset:4096
    v_mfma_f32_16x16x32_bf16 v[144:147], v[48:51], v[40:43], v[144:147]
    ds_read_b128 v[92:95], v17 offset:6144
    s_add_u32 s27, s27, 1
    s_cmp_eq_u32 s27, 4
    s_cselect_b32 s28, -98304, s29
    s_cselect_b32 s27, 0, s27
    v_mfma_f32_16x16x32_bf16 v[148:151], v[52:55], v[40:43], v[148:151]
    v_add_u32 v16, s28, v16
    v_mfma_f32_16x16x32_bf16 v[152:155], v[48:51], v[44:47], v[152:155]
    v_add_u32 v17, s28, v17
    v_add_u32 v18, s28, v18
    v_mfma_f32_16x16x32_bf16 v[156:159], v[52:55], v[44:47], v[156:159]
    v_add_u32 v19, s28, v19
    s_waitcnt vmcnt(0) lgkmcnt(0)
    s_barrier
    v_mfma_f32_16x16x32_bf16 v[128:131], v[96:99], v[80:83], v[128:131]
    ds_read_b64_tr_b16 v[48:49], v18 offset:16384
    v_mfma_f32_16x16x32_bf16 v[132:135], v[100:103], v[80:83], v[132:135]
    ds_read_b64_tr_b16 v[50:51], v18 offset:17408
    v_mfma_f32_16x16x32_bf16 v[136:139], v[96:99], v[84:87], v[136:139]
    ds_read_b64_tr_b16 v[52:53], v19 offset:16384
    v_mfma_f32_16x16x32_bf16 v[140:143], v[100:103], v[84:87], v[140:143]
    ds_read_b64_tr_b16 v[54:55], v19 offset:17408
    v_mfma_f32_16x16x32_bf16 v[144:147], v[96:99], v[88:91], v[144:147]
    ds_read_b128 v[32:35], v16 offset:0
    v_mfma_f32_16x16x32_bf16 v[148:151], v[100:103], v[88:91], v[148:151]
    ds_read_b128 v[36:39], v16 offset:2048
    v_mfma_f32_16x16x32_bf16 v[152:155], v[96:99], v[92:95], v[152:155]
    ds_read_b128 v[40:43], v16 offset:4096
    v_mfma_f32_16x16x32_bf16 v[156:159], v[100:103], v[92:95], v[156:159]
    ds_read_b128 v[44:47], v16 offset:6144
    s_waitcnt lgkmcnt(0)
    v_mfma_f32_16x16x32_bf16 v[128:131], v[48:51], v[32:35], v[128:131]
    ds_read_b64_tr_b16 v[96:97], v18 offset:24576
    ds_read_b64_tr_b16 v[98:99], v18 offset:25600
    v_mfma_f32_16x16x32_bf16 v[132:135], v[52:55], v[32:35], v[132:135]
    ds_read_b64_tr_b16 v[100:101], v19 offset:24576
    ds_read_b64_tr_b16 v[102:103], v19 offset:25600
    v_mfma_f32_16x16x32_bf16 v[136:139], v[48:51], v[36:39], v[136:139]
    ds_read_b128 v[80:83], v17 offset:0
    v_mfma_f32_16x16x32_bf16 v[140:143], v[52:55], v[36:39], v[140:143]
    ds_read_b128 v[84:87], v17 offset:2048
    ds_read_b128 v[88:91], v17 offset:4096
    v_mfma_f32_16x16x32_bf16 v[144:147], v[48:51], v[40:43], v[144:147]
    ds_read_b128 v[92:95], v17 offset:6144
    s_add_u32 s27, s27, 1
    s_cmp_eq_u32 s27, 4
    s_cselect_b32 s28, -98304, s29
    s_cselect_b32 s27, 0, s27
    v_mfma_f32_16x16x32_bf16 v[148:151], v[52:55], v[40:43], v[148:151]
    v_add_u32 v16, s28, v16
    v_mfma_f32_16x16x32_bf16 v[152:155], v[48:51], v[44:47], v[152:155]
    v_add_u32 v17, s28, v17
    v_add_u32 v18, s28, v18
    v_mfma_f32_16x16x32_bf16 v[156:159], v[52:55], v[44:47], v[156:159]
    v_add_u32 v19, s28, v19
    s_waitcnt lgkmcnt(0)
    v_mfma_f32_16x16x32_bf16 v[128:131], v[96:99], v[80:83], v[128:131]
    v_mfma_f32_16x16x32_bf16 v[132:135], v[100:103], v[80:83], v[132:135]
    v_mfma_f32_16x16x32_bf16 v[136:139], v[96:99], v[84:87], v[136:139]
    v_mfma_f32_16x16x32_bf16 v[140:143], v[100:103], v[84:87], v[140:143]
    v_mfma_f32_16x16x32_bf16 v[144:147], v[96:99], v[88:91], v[144:147]
    v_mfma_f32_16x16x32_bf16 v[148:151], v[100:103], v[88:91], v[148:151]
    v_mfma_f32_16x16x32_bf16 v[152:155], v[96:99], v[92:95], v[152:155]
    v_mfma_f32_16x16x32_bf16 v[156:159], v[100:103], v[92:95], v[156:159]
    s_nop 7
LE_K0:
    v_mov_b32 v3, 163584
    s_cmp_lg_u32 s26, 0
    s_cbranch_scc1 tt_127
    s_waitcnt vmcnt(0)
    s_mov_b64 exec, 1
    ds_write_b32 v3, v28
    s_waitcnt lgkmcnt(0)
    s_mov_b64 exec, -1
tt_127:
    s_barrier
    ds_read_b32 v5, v3
    s_waitcnt lgkmcnt(0)
    v_readfirstlane_b32 s25, v5
    s_nop 3
    s_min_u32 s3, s25, 204
    s_lshl_b32 s3, s3, 2
    s_load_dword s7, s[50:51], s3
    s_waitcnt lgkmcnt(0)
E_K0:
    s_cmp_lg_u32 s79, -1
    s_cbranch_scc1 hp_128
    s_branch hc_130
ht_129:
    s_sub_u32 s30, s30, 1
    s_cbranch_scc1 L_end
    v_mov_b32 v30, 128
    buffer_load_dword v31, v30, s[20:23], 0 offen sc1
hc_130:
    s_waitcnt vmcnt(0)
    v_readfirstlane_b32 s3, v31
    s_nop 3
    s_and_b32 s40, s3, 0xffff
    s_cmp_lt_u32 s40, 128
    s_cbranch_scc1 ht_129
    s_add_u32 s3, s3, 4128768
    s_lshr_b32 s3, s3, 10
    s_and_b32 s79, s3, 8192
hp_128:
    v_lshlrev_b32 v7, 4, v2
    s_lshr_b32 s38, s42, 5
    s_mul_i32 s39, s45, 1
    s_add_u32 s38, s38, s39
    s_lshl_b32 s38, s38, 6
    s_lshr_b32 s39, s41, 5
    s_add_u32 s38, s38, s39
    s_mul_i32 s39, s44, 2
    s_add_u32 s38, s38, s39
    s_mov_b32 s39, s38
    s_lshl_b32 s38, s38, 13
    s_add_u32 s38, s38, 134217728
    s_bfe_u32 s3, s39, 0x10008
    s_lshl_b32 s3, s3, 13
    s_xor_b32 s3, s3, s79
    s_xor_b32 s3, s3, 8192
    s_add_u32 s38, s38, s3
    s_add_u32 s39, s38, 0
    v_cvt_pk_bf16_f32 v32, v128, v129
    v_cvt_pk_bf16_f32 v33, v130, v131
    v_cvt_pk_bf16_f32 v34, v132, v133
    v_cvt_pk_bf16_f32 v35, v134, v135
    buffer_store_dwordx4 v[32:35], v7, s[8:11], s39 offen offset:0 sc1
    v_cvt_pk_bf16_f32 v36, v136, v137
    v_cvt_pk_bf16_f32 v37, v138, v139
    v_cvt_pk_bf16_f32 v38, v140, v141
    v_cvt_pk_bf16_f32 v39, v142, v143
    buffer_store_dwordx4 v[36:39], v7, s[8:11], s39 offen offset:1024 sc1
    s_add_u32 s39, s38, 4096
    v_cvt_pk_bf16_f32 v40, v144, v145
    v_cvt_pk_bf16_f32 v41, v146, v147
    v_cvt_pk_bf16_f32 v42, v148, v149
    v_cvt_pk_bf16_f32 v43, v150, v151
    buffer_store_dwordx4 v[40:43], v7, s[8:11], s39 offen offset:0 sc1
    v_cvt_pk_bf16_f32 v44, v152, v153
    v_cvt_pk_bf16_f32 v45, v154, v155
    v_cvt_pk_bf16_f32 v46, v156, v157
    v_cvt_pk_bf16_f32 v47, v158, v159
    buffer_store_dwordx4 v[44:47], v7, s[8:11], s39 offen offset:1024 sc1
    s_waitcnt vmcnt(0)
    s_lshr_b32 s37, s49, 24
    v_lshlrev_b32 v26, 6, v2
    s_cmp_ge_u32 s37, 128
    s_cbranch_scc1 to_131
    s_add_u32 s38, s37, 0
    s_lshl_b32 s38, s38, 2
    s_add_u32 s38, s38, s43
    s_lshl_b32 s38, s38, 3
    s_add_u32 s38, s38, s26
    s_lshl_b32 s38, s38, 12
    s_mov_b64 s[60:61], s[82:83]
    s_mov_b32 s39, 0
    s_cmp_ge_u32 s38, 4194304
    s_cselect_b64 s[60:61], s[92:93], s[60:61]
    s_cselect_b32 s39, 4194304, s39
    s_cmp_ge_u32 s38, 8388608
    s_cselect_b64 s[60:61], s[94:95], s[60:61]
    s_cselect_b32 s39, 8388608, s39
    s_cmp_ge_u32 s38, 14680064
    s_cselect_b64 s[60:61], s[96:97], s[60:61]
    s_cselect_b32 s39, 14680064, s39
    s_sub_u32 s38, s38, s39
    s_and_b32 s61, s61, 0xffff
    s_add_u32 s62, s38, 4096
    s_mov_b32 s63, 0x20000
    buffer_load_dword v1, v26, s[60:63], s38 offen
to_131:
    s_lshr_b32 s40, s41, 8
    s_lshl_b32 s40, s40, 2
    s_add_u32 s40, s40, s43
    s_lshl_b32 s40, s40, 7
    s_add_u32 s40, s40, 79720448
    s_waitcnt vmcnt(1)
    s_barrier
    s_cmp_lg_u32 s26, 1
    s_cbranch_scc1 sg_132
    v_mov_b32 v4, s40
    v_mov_b32 v5, 1
    s_mov_b64 exec, 1
    buffer_atomic_add v5, v4, s[8:11], 0 offen sc1
    s_mov_b64 exec, -1
sg_132:
    s_cmp_eq_u32 s6, 0
    s_cbranch_scc1 D_pre
    s_mov_b32 s6, 0
    s_branch D_main
LP_V0:
    s_mov_b32 s34, 11
    s_mov_b32 s27, 0
    s_mov_b32 s29, 32768
    s_waitcnt vmcnt(12)
    s_barrier
    ds_read_b64_tr_b16 v[48:49], v18 offset:16384
    ds_read_b64_tr_b16 v[50:51], v18 offset:17408
    ds_read_b64_tr_b16 v[52:53], v19 offset:16384
    ds_read_b64_tr_b16 v[54:55], v19 offset:17408
    ds_read_b128 v[32:35], v16 offset:0
    ds_read_b128 v[36:39], v16 offset:2048
    ds_read_b128 v[40:43], v16 offset:4096
    ds_read_b128 v[44:47], v16 offset:6144
    s_waitcnt lgkmcnt(0)
    v_mfma_f32_16x16x32_bf16 v[128:131], v[32:35], v[48:51], 0
    ds_read_b64_tr_b16 v[96:97], v18 offset:24576
    ds_read_b64_tr_b16 v[98:99], v18 offset:25600
    v_mfma_f32_16x16x32_bf16 v[132:135], v[32:35], v[52:55], 0
    ds_read_b64_tr_b16 v[100:101], v19 offset:24576
    ds_read_b64_tr_b16 v[102:103], v19 offset:25600
    v_mfma_f32_16x16x32_bf16 v[136:139], v[36:39], v[48:51], 0
    ds_read_b128 v[80:83], v17 offset:0
    v_mfma_f32_16x16x32_bf16 v[140:143], v[36:39], v[52:55], 0
    ds_read_b128 v[84:87], v17 offset:2048
    ds_read_b128 v[88:91], v17 offset:4096
    v_mfma_f32_16x16x32_bf16 v[144:147], v[40:43], v[48:51], 0
    ds_read_b128 v[92:95], v17 offset:6144
    s_add_u32 s27, s27, 1
    s_cmp_eq_u32 s27, 4
    s_cselect_b32 s28, -98304, s29
    s_cselect_b32 s27, 0, s27
    v_mfma_f32_16x16x32_bf16 v[148:151], v[40:43], v[52:55], 0
    v_add_u32 v16, s28, v16
    v_mfma_f32_16x16x32_bf16 v[152:155], v[44:47], v[48:51], 0
    v_add_u32 v17, s28, v17
    v_add_u32 v18, s28, v18
    v_mfma_f32_16x16x32_bf16 v[156:159], v[44:47], v[52:55], 0
    v_add_u32 v19, s28, v19
    s_waitcnt vmcnt(8) lgkmcnt(0)
    s_barrier
    v_mfma_f32_16x16x32_bf16 v[128:131], v[80:83], v[96:99], v[128:131]
    ds_read_b64_tr_b16 v[48:49], v18 offset:16384
    ds_read_b64_tr_b16 v[50:51], v18 offset:17408
    v_mfma_f32_16x16x32_bf16 v[132:135], v[80:83], v[100:103], v[132:135]
    ds_read_b64_tr_b16 v[52:53], v19 offset:16384
    ds_read_b64_tr_b16 v[54:55], v19 offset:17408
    v_mfma_f32_16x16x32_bf16 v[136:139], v[84:87], v[96:99], v[136:139]
    ds_read_b128 v[32:35], v16 offset:0
    ds_read_b128 v[36:39], v16 offset:2048
    v_mfma_f32_16x16x32_bf16 v[140:143], v[84:87], v[100:103], v[140:143]
    ds_read_b128 v[40:43], v16 offset:4096
    ds_read_b128 v[44:47], v16 offset:6144
    v_mfma_f32_16x16x32_bf16 v[144:147], v[88:91], v[96:99], v[144:147]
    s_mov_b32 m0, s35
    s_add_u32 s35, s35, 32768
    s_cmp_ge_u32 s35, 131072
    s_cselect_b32 s40, 131072, 0
    s_sub_u32 s35, s35, s40
    buffer_load_dwordx4 v8, s[12:15], s31 offen offset:0  lds
    v_mfma_f32_16x16x32_bf16 v[148:151], v[88:91], v[100:103], v[148:151]
    buffer_load_dwordx4 v9, s[12:15], s31 offen offset:1024  lds
    s_mov_b32 m0, s36
    s_add_u32 s31, s31, 128
    s_add_u32 s36, s36, 32768
    s_cmp_ge_u32 s36, 131072
    s_cselect_b32 s40, 131072, 0
    s_sub_u32 s36, s36, s40
    v_mfma_f32_16x16x32_bf16 v[152:155], v[92:95], v[96:99], v[152:155]
    buffer_load_dwordx4 v12, s[16:19], s32 offen offset:0  lds
    buffer_load_dwordx4 v13, s[16:19], s32 offen offset:1024  lds
    v_mfma_f32_16x16x32_bf16 v[156:159], v[92:95], v[100:103], v[156:159]
    s_add_u32 s32, s32, s33
gl_133:
    s_waitcnt lgkmcnt(0)
    v_mfma_f32_16x16x32_bf16 v[128:131], v[32:35], v[48:51], v[128:131]
    ds_read_b64_tr_b16 v[96:97], v18 offset:24576
    ds_read_b64_tr_b16 v[98:99], v18 offset:25600
    v_mfma_f32_16x16x32_bf16 v[132:135], v[32:35], v[52:55], v[132:135]
    ds_read_b64_tr_b16 v[100:101], v19 offset:24576
    ds_read_b64_tr_b16 v[102:103], v19 offset:25600
    v_mfma_f32_16x16x32_bf16 v[136:139], v[36:39], v[48:51], v[136:139]
    ds_read_b128 v[80:83], v17 offset:0
    v_mfma_f32_16x16x32_bf16 v[140:143], v[36:39], v[52:55], v[140:143]
    ds_read_b128 v[84:87], v17 offset:2048
    ds_read_b128 v[88:91], v17 offset:4096
    v_mfma_f32_16x16x32_bf16 v[144:147], v[40:43], v[48:51], v[144:147]
    ds_read_b128 v[92:95], v17 offset:6144
    s_add_u32 s27, s27, 1
    s_cmp_eq_u32 s27, 4
    s_cselect_b32 s28, -98304, s29
    s_cselect_b32 s27, 0, s27
    v_mfma_f32_16x16x32_bf16 v[148:151], v[40:43], v[52:55], v[148:151]
    v_add_u32 v16, s28, v16
    v_mfma_f32_16x16x32_bf16 v[152:155], v[44:47], v[48:51], v[152:155]
    v_add_u32 v17, s28, v17
    v_add_u32 v18, s28, v18
    v_mfma_f32_16x16x32_bf16 v[156:159], v[44:47], v[52:55], v[156:159]
    v_add_u32 v19, s28, v19
    s_waitcnt vmcnt(8) lgkmcnt(0)
    s_barrier
    v_mfma_f32_16x16x32_bf16 v[128:131], v[80:83], v[96:99], v[128:131]
    ds_read_b64_tr_b16 v[48:49], v18 offset:16384
    ds_read_b64_tr_b16 v[50:51], v18 offset:17408
    v_mfma_f32_16x16x32_bf16 v[132:135], v[80:83], v[100:103], v[132:135]
    ds_read_b64_tr_b16 v[52:53], v19 offset:16384
    ds_read_b64_tr_b16 v[54:55], v19 offset:17408
    v_mfma_f32_16x16x32_bf16 v[136:139], v[84:87], v[96:99], v[136:139]
    ds_read_b128 v[32:35], v16 offset:0
    ds_read_b128 v[36:39], v16 offset:2048
    v_mfma_f32_16x16x32_bf16 v[140:143], v[84:87], v[100:103], v[140:143]
    ds_read_b128 v[40:43], v16 offset:4096
    ds_read_b128 v[44:47], v16 offset:6144
    v_mfma_f32_16x16x32_bf16 v[144:147], v[88:91], v[96:99], v[144:147]
    s_mov_b32 m0, s35
    s_add_u32 s35, s35, 32768
    s_cmp_ge_u32 s35, 131072
    s_cselect_b32 s40, 131072, 0
    s_sub_u32 s35, s35, s40
    buffer_load_dwordx4 v8, s[12:15], s31 offen offset:0  lds
    v_mfma_f32_16x16x32_bf16 v[148:151], v[88:91], v[100:103], v[148:151]
    buffer_load_dwordx4 v9, s[12:15], s31 offen offset:1024  lds
    s_mov_b32 m0, s36
    s_add_u32 s31, s31, 128
    s_add_u32 s36, s36, 32768
    s_cmp_ge_u32 s36, 131072
    s_cselect_b32 s40, 131072, 0
    s_sub_u32 s36, s36, s40
    v_mfma_f32_16x16x32_bf16 v[152:155], v[92:95], v[96:99], v[152:155]
    buffer_load_dwordx4 v12, s[16:19], s32 offen offset:0  lds
    buffer_load_dwordx4 v13, s[16:19], s32 offen offset:1024  lds
    v_mfma_f32_16x16x32_bf16 v[156:159], v[92:95], v[100:103], v[156:159]
    s_add_u32 s32, s32, s33
    s_sub_u32 s34, s34, 1
    s_cmp_lg_u32 s34, 0
    s_cbranch_scc1 gl_133
    s_cmp_lg_u32 s26, 0
    s_cbranch_scc1 ti_134
    s_lshl_b32 s3, s43, 2
    s_add_u32 s3, s3, 16
    v_mov_b32 v27, s3
    v_mov_b32 v28, 1
    s_mov_b64 exec, 1
    buffer_atomic_add v28, v27, s[20:23], 0 offen sc0 sc1
    s_mov_b64 exec, -1
ti_134:
    v_mov_b32 v30, 128
    buffer_load_dword v31, v30, s[20:23], 0 offen sc1
    s_waitcnt lgkmcnt(0)
    v_mfma_f32_16x16x32_bf16 v[128:131], v[32:35], v[48:51], v[128:131]
    ds_read_b64_tr_b16 v[96:97], v18 offset:24576
    ds_read_b64_tr_b16 v[98:99], v18 offset:25600
    v_mfma_f32_16x16x32_bf16 v[132:135], v[32:35], v[52:55], v[132:135]
    ds_read_b64_tr_b16 v[100:101], v19 offset:24576
    ds_read_b64_tr_b16 v[102:103], v19 offset:25600
    v_mfma_f32_16x16x32_bf16 v[136:139], v[36:39], v[48:51], v[136:139]
    ds_read_b128 v[80:83], v17 offset:0
    v_mfma_f32_16x16x32_bf16 v[140:143], v[36:39], v[52:55], v[140:143]
    ds_read_b128 v[84:87], v17 offset:2048
    ds_read_b128 v[88:91], v17 offset:4096
    v_mfma_f32_16x16x32_bf16 v[144:147], v[40:43], v[48:51], v[144:147]
    ds_read_b128 v[92:95], v17 offset:6144
    s_add_u32 s27, s27, 1
    s_cmp_eq_u32 s27, 4
    s_cselect_b32 s28, -98304, s29
    s_cselect_b32 s27, 0, s27
    v_mfma_f32_16x16x32_bf16 v[148:151], v[40:43], v[52:55], v[148:151]
    v_add_u32 v16, s28, v16
    v_mfma_f32_16x16x32_bf16 v[152:155], v[44:47], v[48:51], v[152:155]
    v_add_u32 v17, s28, v17
    v_add_u32 v18, s28, v18
    v_mfma_f32_16x16x32_bf16 v[156:159], v[44:47], v[52:55], v[156:159]
    v_add_u32 v19, s28, v19
    s_waitcnt vmcnt(8) lgkmcnt(0)
    s_barrier
    v_mfma_f32_16x16x32_bf16 v[128:131], v[80:83], v[96:99], v[128:131]
    ds_read_b64_tr_b16 v[48:49], v18 offset:16384
    v_mfma_f32_16x16x32_bf16 v[132:135], v[80:83], v[100:103], v[132:135]
    ds_read_b64_tr_b16 v[50:51], v18 offset:17408
    v_mfma_f32_16x16x32_bf16 v[136:139], v[84:87], v[96:99], v[136:139]
    ds_read_b64_tr_b16 v[52:53], v19 offset:16384
    v_mfma_f32_16x16x32_bf16 v[140:143], v[84:87], v[100:103], v[140:143]
    ds_read_b64_tr_b16 v[54:55], v19 offset:17408
    v_mfma_f32_16x16x32_bf16 v[144:147], v[88:91], v[96:99], v[144:147]
    ds_read_b128 v[32:35], v16 offset:0
    v_mfma_f32_16x16x32_bf16 v[148:151], v[88:91], v[100:103], v[148:151]
    ds_read_b128 v[36:39], v16 offset:2048
    v_mfma_f32_16x16x32_bf16 v[152:155], v[92:95], v[96:99], v[152:155]
    ds_read_b128 v[40:43], v16 offset:4096
    v_mfma_f32_16x16x32_bf16 v[156:159], v[92:95], v[100:103], v[156:159]
    ds_read_b128 v[44:47], v16 offset:6144
    s_waitcnt lgkmcnt(0)
    v_mfma_f32_16x16x32_bf16 v[128:131], v[32:35], v[48:51], v[128:131]
    ds_read_b64_tr_b16 v[96:97], v18 offset:24576
    ds_read_b64_tr_b16 v[98:99], v18 offset:25600
    v_mfma_f32_16x16x32_bf16 v[132:135], v[32:35], v[52:55], v[132:135]
    ds_read_b64_tr_b16 v[100:101], v19 offset:24576
    ds_read_b64_tr_b16 v[102:103], v19 offset:25600
    v_mfma_f32_16x16x32_bf16 v[136:139], v[36:39], v[48:51], v[136:139]
    ds_read_b128 v[80:83], v17 offset:0
    v_mfma_f32_16x16x32_bf16 v[140:143], v[36:39], v[52:55], v[140:143]
    ds_read_b128 v[84:87], v17 offset:2048
    ds_read_b128 v[88:91], v17 offset:4096
    v_mfma_f32_16x16x32_bf16 v[144:147], v[40:43], v[48:51], v[144:147]
    ds_read_b128 v[92:95], v17 offset:6144
    s_add_u32 s27, s27, 1
    s_cmp_eq_u32 s27, 4
    s_cselect_b32 s28, -98304, s29
    s_cselect_b32 s27, 0, s27
    v_mfma_f32_16x16x32_bf16 v[148:151], v[40:43], v[52:55], v[148:151]
    v_add_u32 v16, s28, v16
    v_mfma_f32_16x16x32_bf16 v[152:155], v[44:47], v[48:51], v[152:155]
    v_add_u32 v17, s28, v17
    v_add_u32 v18, s28, v18
    v_mfma_f32_16x16x32_bf16 v[156:159], v[44:47], v[52:55], v[156:159]
    v_add_u32 v19, s28, v19
    s_waitcnt vmcnt(4) lgkmcnt(0)
    s_barrier
    v_mfma_f32_16x16x32_bf16 v[128:131], v[80:83], v[96:99], v[128:131]
    ds_read_b64_tr_b16 v[48:49], v18 offset:16384
    v_mfma_f32_16x16x32_bf16 v[132:135], v[80:83], v[100:103], v[132:135]
    ds_read_b64_tr_b16 v[50:51], v18 offset:17408
    v_mfma_f32_16x16x32_bf16 v[136:139], v[84:87], v[96:99], v[136:139]
    ds_read_b64_tr_b16 v[52:53], v19 offset:16384
    v_mfma_f32_16x16x32_bf16 v[140:143], v[84:87], v[100:103], v[140:143]
    ds_read_b64_tr_b16 v[54:55], v19 offset:17408
    v_mfma_f32_16x16x32_bf16 v[144:147], v[88:91], v[96:99], v[144:147]
    ds_read_b128 v[32:35], v16 offset:0
    v_mfma_f32_16x16x32_bf16 v[148:151], v[88:91], v[100:103], v[148:151]
    ds_read_b128 v[36:39], v16 offset:2048
    v_mfma_f32_16x16x32_bf16 v[152:155], v[92:95], v[96:99], v[152:155]
    ds_read_b128 v[40:43], v16 offset:4096
    v_mfma_f32_16x16x32_bf16 v[156:159], v[92:95], v[100:103], v[156:159]
    ds_read_b128 v[44:47], v16 offset:6144
    s_waitcnt lgkmcnt(0)
    v_mfma_f32_16x16x32_bf16 v[128:131], v[32:35], v[48:51], v[128:131]
    ds_read_b64_tr_b16 v[96:97], v18 offset:24576
    ds_read_b64_tr_b16 v[98:99], v18 offset:25600
    v_mfma_f32_16x16x32_bf16 v[132:135], v[32:35], v[52:55], v[132:135]
    ds_read_b64_tr_b16 v[100:101], v19 offset:24576
    ds_read_b64_tr_b16 v[102:103], v19 offset:25600
    v_mfma_f32_16x16x32_bf16 v[136:139], v[36:39], v[48:51], v[136:139]
    ds_read_b128 v[80:83], v17 offset:0
    v_mfma_f32_16x16x32_bf16 v[140:143], v[36:39], v[52:55], v[140:143]
    ds_read_b128 v[84:87], v17 offset:2048
    ds_read_b128 v[88:91], v17 offset:4096
    v_mfma_f32_16x16x32_bf16 v[144:147], v[40:43], v[48:51], v[144:147]
    ds_read_b128 v[92:95], v17 offset:6144
    s_add_u32 s27, s27, 1
    s_cmp_eq_u32 s27, 4
    s_cselect_b32 s28, -98304, s29
    s_cselect_b32 s27, 0, s27
    v_mfma_f32_16x16x32_bf16 v[148:151], v[40:43], v[52:55], v[148:151]
    v_add_u32 v16, s28, v16
    v_mfma_f32_16x16x32_bf16 v[152:155], v[44:47], v[48:51], v[152:155]
    v_add_u32 v17, s28, v17
    v_add_u32 v18, s28, v18
    v_mfma_f32_16x16x32_bf16 v[156:159], v[44:47], v[52:55], v[156:159]
    v_add_u32 v19, s28, v19
    s_waitcnt vmcnt(0) lgkmcnt(0)
    s_barrier
    v_mfma_f32_16x16x32_bf16 v[128:131], v[80:83], v[96:99], v[128:131]
    ds_read_b64_tr_b16 v[48:49], v18 offset:16384
    v_mfma_f32_16x16x32_bf16 v[132:135], v[80:83], v[100:103], v[132:135]
    ds_read_b64_tr_b16 v[50:51], v18 offset:17408
    v_mfma_f32_16x16x32_bf16 v[136:139], v[84:87], v[96:99], v[136:139]
    ds_read_b64_tr_b16 v[52:53], v19 offset:16384
    v_mfma_f32_16x16x32_bf16 v[140:143], v[84:87], v[100:103], v[140:143]
    ds_read_b64_tr_b16 v[54:55], v19 offset:17408
    v_mfma_f32_16x16x32_bf16 v[144:147], v[88:91], v[96:99], v[144:147]
    ds_read_b128 v[32:35], v16 offset:0
    v_mfma_f32_16x16x32_bf16 v[148:151], v[88:91], v[100:103], v[148:151]
    ds_read_b128 v[36:39], v16 offset:2048
    v_mfma_f32_16x16x32_bf16 v[152:155], v[92:95], v[96:99], v[152:155]
    ds_read_b128 v[40:43], v16 offset:4096
    v_mfma_f32_16x16x32_bf16 v[156:159], v[92:95], v[100:103], v[156:159]
    ds_read_b128 v[44:47], v16 offset:6144
    s_waitcnt lgkmcnt(0)
    v_mfma_f32_16x16x32_bf16 v[128:131], v[32:35], v[48:51], v[128:131]
    ds_read_b64_tr_b16 v[96:97], v18 offset:24576
    ds_read_b64_tr_b16 v[98:99], v18 offset:25600
    v_mfma_f32_16x16x32_bf16 v[132:135], v[32:35], v[52:55], v[132:135]
    ds_read_b64_tr_b16 v[100:101], v19 offset:24576
    ds_read_b64_tr_b16 v[102:103], v19 offset:25600
    v_mfma_f32_16x16x32_bf16 v[136:139], v[36:39], v[48:51], v[136:139]
    ds_read_b128 v[80:83], v17 offset:0
    v_mfma_f32_16x16x32_bf16 v[140:143], v[36:39], v[52:55], v[140:143]
    ds_read_b128 v[84:87], v17 offset:2048
    ds_read_b128 v[88:91], v17 offset:4096
    v_mfma_f32_16x16x32_bf16 v[144:147], v[40:43], v[48:51], v[144:147]
    ds_read_b128 v[92:95], v17 offset:6144
    s_add_u32 s27, s27, 1
    s_cmp_eq_u32 s27, 4
    s_cselect_b32 s28, -98304, s29
    s_cselect_b32 s27, 0, s27
    v_mfma_f32_16x16x32_bf16 v[148:151], v[40:43], v[52:55], v[148:151]
    v_add_u32 v16, s28, v16
    v_mfma_f32_16x16x32_bf16 v[152:155], v[44:47], v[48:51], v[152:155]
    v_add_u32 v17, s28, v17
    v_add_u32 v18, s28, v18
    v_mfma_f32_16x16x32_bf16 v[156:159], v[44:47], v[52:55], v[156:159]
    v_add_u32 v19, s28, v19
    s_waitcnt lgkmcnt(0)
    v_mfma_f32_16x16x32_bf16 v[128:131], v[80:83], v[96:99], v[128:131]
    v_mfma_f32_16x16x32_bf16 v[132:135], v[80:83], v[100:103], v[132:135]
    v_mfma_f32_16x16x32_bf16 v[136:139], v[84:87], v[96:99], v[136:139]
    v_mfma_f32_16x16x32_bf16 v[140:143], v[84:87], v[100:103], v[140:143]
    v_mfma_f32_16x16x32_bf16 v[144:147], v[88:91], v[96:99], v[144:147]
    v_mfma_f32_16x16x32_bf16 v[148:151], v[88:91], v[100:103], v[148:151]
    v_mfma_f32_16x16x32_bf16 v[152:155], v[92:95], v[96:99], v[152:155]
    v_mfma_f32_16x16x32_bf16 v[156:159], v[92:95], v[100:103], v[156:159]
    s_nop 7
LE_V0:
    v_mov_b32 v3, 163584
    s_cmp_lg_u32 s26, 0
    s_cbranch_scc1 tt_135
    s_waitcnt vmcnt(0)
    s_mov_b64 exec, 1
    ds_write_b32 v3, v28
    s_waitcnt lgkmcnt(0)
    s_mov_b64 exec, -1
tt_135:
    s_barrier
    ds_read_b32 v5, v3
    s_waitcnt lgkmcnt(0)
    v_readfirstlane_b32 s25, v5
    s_nop 3
    s_min_u32 s3, s25, 204
    s_lshl_b32 s3, s3, 2
    s_load_dword s7, s[50:51], s3
    s_waitcnt lgkmcnt(0)
E_V0:
    s_cmp_lg_u32 s79, -1
    s_cbranch_scc1 hp_136
    s_branch hc_138
ht_137:
    s_sub_u32 s30, s30, 1
    s_cbranch_scc1 L_end
    v_mov_b32 v30, 128
    buffer_load_dword v31, v30, s[20:23], 0 offen sc1
hc_138:
    s_waitcnt vmcnt(0)
    v_readfirstlane_b32 s3, v31
    s_nop 3
    s_and_b32 s40, s3, 0xffff
    s_cmp_lt_u32 s40, 128
    s_cbranch_scc1 ht_137
    s_add_u32 s3, s3, 4128768
    s_lshr_b32 s3, s3, 10
    s_and_b32 s79, s3, 8192
hp_136:
    v_lshlrev_b32 v7, 4, v2
    s_lshr_b32 s38, s42, 5
    s_mul_i32 s39, s45, 1
    s_add_u32 s38, s38, s39
    s_lshl_b32 s38, s38, 6
    s_lshr_b32 s39, s41, 5
    s_add_u32 s38, s38, s39
    s_mul_i32 s39, s44, 2
    s_add_u32 s38, s38, s39
    s_mov_b32 s39, s38
    s_lshl_b32 s38, s38, 13
    s_add_u32 s38, s38, 134219776
    s_bfe_u32 s3, s39, 0x10008
    s_lshl_b32 s3, s3, 13
    s_xor_b32 s3, s3, s79
    s_xor_b32 s3, s3, 8192
    s_add_u32 s38, s38, s3
    s_add_u32 s39, s38, 0
    v_cvt_pk_bf16_f32 v32, v128, v129
    v_cvt_pk_bf16_f32 v33, v136, v137
    v_cvt_pk_bf16_f32 v34, v130, v131
    v_cvt_pk_bf16_f32 v35, v138, v139
    buffer_store_dwordx4 v[32:35], v7, s[8:11], s39 offen offset:0 sc1
    v_cvt_pk_bf16_f32 v36, v132, v133
    v_cvt_pk_bf16_f32 v37, v140, v141
    v_cvt_pk_bf16_f32 v38, v134, v135
    v_cvt_pk_bf16_f32 v39, v142, v143
    buffer_store_dwordx4 v[36:39], v7, s[8:11], s39 offen offset:1024 sc1
    s_add_u32 s39, s38, 4096
    v_cvt_pk_bf16_f32 v40, v144, v145
    v_cvt_pk_bf16_f32 v41, v152, v153
    v_cvt_pk_bf16_f32 v42, v146, v147
    v_cvt_pk_bf16_f32 v43, v154, v155
    buffer_store_dwordx4 v[40:43], v7, s[8:11], s39 offen offset:0 sc1
    v_cvt_pk_bf16_f32 v44, v148, v149
    v_cvt_pk_bf16_f32 v45, v156, v157
    v_cvt_pk_bf16_f32 v46, v150, v151
    v_cvt_pk_bf16_f32 v47, v158, v159
    buffer_store_dwordx4 v[44:47], v7, s[8:11], s39 offen offset:1024 sc1
    s_waitcnt vmcnt(0)
    s_lshr_b32 s37, s49, 24
    v_lshlrev_b32 v26, 6, v2
    s_cmp_ge_u32 s37, 128
    s_cbranch_scc1 to_139
    s_add_u32 s38, s37, 0
    s_lshl_b32 s38, s38, 2
    s_add_u32 s38, s38, s43
    s_lshl_b32 s38, s38, 3
    s_add_u32 s38, s38, s26
    s_lshl_b32 s38, s38, 12
    s_mov_b64 s[60:61], s[82:83]
    s_mov_b32 s39, 0
    s_cmp_ge_u32 s38, 4194304
    s_cselect_b64 s[60:61], s[92:93], s[60:61]
    s_cselect_b32 s39, 4194304, s39
    s_cmp_ge_u32 s38, 8388608
    s_cselect_b64 s[60:61], s[94:95], s[60:61]
    s_cselect_b32 s39, 8388608, s39
    s_cmp_ge_u32 s38, 14680064
    s_cselect_b64 s[60:61], s[96:97], s[60:61]
    s_cselect_b32 s39, 14680064, s39
    s_sub_u32 s38, s38, s39
    s_and_b32 s61, s61, 0xffff
    s_add_u32 s62, s38, 4096
    s_mov_b32 s63, 0x20000
    buffer_load_dword v1, v26, s[60:63], s38 offen
to_139:
    s_lshr_b32 s40, s41, 8
    s_lshl_b32 s40, s40, 2
    s_add_u32 s40, s40, s43
    s_lshl_b32 s40, s40, 7
    s_add_u32 s40, s40, 79720448
    s_waitcnt vmcnt(1)
    s_barrier
    s_cmp_lg_u32 s26, 1
    s_cbranch_scc1 sg_140
    v_mov_b32 v4, s40
    v_mov_b32 v5, 1
    s_mov_b64 exec, 1
    buffer_atomic_add v5, v4, s[8:11], 0 offen sc1
    s_mov_b64 exec, -1
sg_140:
    s_cmp_eq_u32 s6, 0
    s_cbranch_scc1 D_pre
    s_mov_b32 s6, 0
    s_branch D_main
LP_K1:
    s_mov_b32 s34, 12
    s_mov_b32 s27, 0
    s_mov_b32 s29, 49152
    s_waitcnt vmcnt(12)
    s_barrier
    ds_read_b64_tr_b16 v[48:49], v18 offset:16384
    ds_read_b64_tr_b16 v[50:51], v18 offset:18432
    ds_read_b64_tr_b16 v[52:53], v19 offset:16384
    ds_read_b64_tr_b16 v[54:55], v19 offset:18432
    ds_read_b64_tr_b16 v[56:57], v20 offset:16384
    ds_read_b64_tr_b16 v[58:59], v20 offset:18432
    ds_read_b64_tr_b16 v[60:61], v21 offset:16384
    ds_read_b64_tr_b16 v[62:63], v21 offset:18432
    ds_read_b128 v[32:35], v16 offset:0
    ds_read_b128 v[36:39], v16 offset:2048
    ds_read_b128 v[40:43], v16 offset:4096
    ds_read_b128 v[44:47], v16 offset:6144
    s_waitcnt lgkmcnt(0)
    v_mfma_f32_16x16x32_bf16 v[128:131], v[48:51], v[32:35], 0
    ds_read_b64_tr_b16 v[96:97], v18 offset:32768
    ds_read_b64_tr_b16 v[98:99], v18 offset:34816
    v_mfma_f32_16x16x32_bf16 v[132:135], v[52:55], v[32:35], 0
    ds_read_b64_tr_b16 v[100:101], v19 offset:32768
    v_mfma_f32_16x16x32_bf16 v[136:139], v[56:59], v[32:35], 0
    ds_read_b64_tr_b16 v[102:103], v19 offset:34816
    v_mfma_f32_16x16x32_bf16 v[140:143], v[60:63], v[32:35], 0
    ds_read_b64_tr_b16 v[104:105], v20 offset:32768
    v_mfma_f32_16x16x32_bf16 v[144:147], v[48:51], v[36:39], 0
    ds_read_b64_tr_b16 v[106:107], v20 offset:34816
    v_mfma_f32_16x16x32_bf16 v[148:151], v[52:55], v[36:39], 0
    ds_read_b64_tr_b16 v[108:109], v21 offset:32768
    ds_read_b64_tr_b16 v[110:111], v21 offset:34816
    v_mfma_f32_16x16x32_bf16 v[152:155], v[56:59], v[36:39], 0
    ds_read_b128 v[80:83], v17 offset:0
    v_mfma_f32_16x16x32_bf16 v[156:159], v[60:63], v[36:39], 0
    ds_read_b128 v[84:87], v17 offset:2048
    v_mfma_f32_16x16x32_bf16 v[160:163], v[48:51], v[40:43], 0
    ds_read_b128 v[88:91], v17 offset:4096
    v_mfma_f32_16x16x32_bf16 v[164:167], v[52:55], v[40:43], 0
    ds_read_b128 v[92:95], v17 offset:6144
    v_mfma_f32_16x16x32_bf16 v[168:171], v[56:59], v[40:43], 0
    s_add_u32 s27, s27, 1
    s_cmp_eq_u32 s27, 3
    s_cselect_b32 s28, -98304, s29
    s_cselect_b32 s27, 0, s27
    v_add_u32 v16, s28, v16
    v_mfma_f32_16x16x32_bf16 v[172:175], v[60:63], v[40:43], 0
    v_add_u32 v17, s28, v17
    v_mfma_f32_16x16x32_bf16 v[176:179], v[48:51], v[44:47], 0
    v_add_u32 v18, s28, v18
    v_mfma_f32_16x16x32_bf16 v[180:183], v[52:55], v[44:47], 0
    v_add_u32 v19, s28, v19
    v_mfma_f32_16x16x32_bf16 v[184:187], v[56:59], v[44:47], 0
    v_add_u32 v20, s28, v20
    v_mfma_f32_16x16x32_bf16 v[188:191], v[60:63], v[44:47], 0
    v_add_u32 v21, s28, v21
    s_waitcnt vmcnt(6) lgkmcnt(0)
    s_barrier
    v_mfma_f32_16x16x32_bf16 v[128:131], v[96:99], v[80:83], v[128:131]
    ds_read_b64_tr_b16 v[48:49], v18 offset:16384
    ds_read_b64_tr_b16 v[50:51], v18 offset:18432
    v_mfma_f32_16x16x32_bf16 v[132:135], v[100:103], v[80:83], v[132:135]
    ds_read_b64_tr_b16 v[52:53], v19 offset:16384
    v_mfma_f32_16x16x32_bf16 v[136:139], v[104:107], v[80:83], v[136:139]
    ds_read_b64_tr_b16 v[54:55], v19 offset:18432
    v_mfma_f32_16x16x32_bf16 v[140:143], v[108:111], v[80:83], v[140:143]
    ds_read_b64_tr_b16 v[56:57], v20 offset:16384
    ds_read_b64_tr_b16 v[58:59], v20 offset:18432
    v_mfma_f32_16x16x32_bf16 v[144:147], v[96:99], v[84:87], v[144:147]
    ds_read_b64_tr_b16 v[60:61], v21 offset:16384
    v_mfma_f32_16x16x32_bf16 v[148:151], v[100:103], v[84:87], v[148:151]
    ds_read_b64_tr_b16 v[62:63], v21 offset:18432
    v_mfma_f32_16x16x32_bf16 v[152:155], v[104:107], v[84:87], v[152:155]
    ds_read_b128 v[32:35], v16 offset:0
    ds_read_b128 v[36:39], v16 offset:2048
    v_mfma_f32_16x16x32_bf16 v[156:159], v[108:111], v[84:87], v[156:159]
    ds_read_b128 v[40:43], v16 offset:4096
    v_mfma_f32_16x16x32_bf16 v[160:163], v[96:99], v[88:91], v[160:163]
    ds_read_b128 v[44:47], v16 offset:6144
    v_mfma_f32_16x16x32_bf16 v[164:167], v[100:103], v[88:91], v[164:167]
    s_mov_b32 m0, s35
    s_add_u32 s35, s35, 49152
    s_cmp_ge_u32 s35, 147456
    s_cselect_b32 s40, 147456, 0
    s_sub_u32 s35, s35, s40
    buffer_load_dwordx4 v8, s[12:15], s31 offen offset:0  lds
    v_mfma_f32_16x16x32_bf16 v[168:171], v[104:107], v[88:91], v[168:171]
    buffer_load_dwordx4 v9, s[12:15], s31 offen offset:1024  lds
    v_mfma_f32_16x16x32_bf16 v[172:175], v[108:111], v[88:91], v[172:175]
    s_mov_b32 m0, s36
    s_add_u32 s31, s31, 128
    s_add_u32 s36, s36, 49152
    s_cmp_ge_u32 s36, 147456
    s_cselect_b32 s40, 147456, 0
    s_sub_u32 s36, s36, s40
    v_mfma_f32_16x16x32_bf16 v[176:179], v[96:99], v[92:95], v[176:179]
    buffer_load_dwordx4 v12, s[16:19], s32 offen offset:0  lds
    buffer_load_dwordx4 v13, s[16:19], s32 offen offset:1024  lds
    v_mfma_f32_16x16x32_bf16 v[180:183], v[100:103], v[92:95], v[180:183]
    buffer_load_dwordx4 v14, s[16:19], s32 offen offset:2048  lds
    v_mfma_f32_16x16x32_bf16 v[184:187], v[104:107], v[92:95], v[184:187]
    buffer_load_dwordx4 v15, s[16:19], s32 offen offset:3072  lds
    v_mfma_f32_16x16x32_bf16 v[188:191], v[108:111], v[92:95], v[188:191]
    s_add_u32 s32, s32, s33
gl_141:
    s_waitcnt lgkmcnt(0)
    v_mfma_f32_16x16x32_bf16 v[128:131], v[48:51], v[32:35], v[128:131]
    ds_read_b64_tr_b16 v[96:97], v18 offset:32768
    ds_read_b64_tr_b16 v[98:99], v18 offset:34816
    v_mfma_f32_16x16x32_bf16 v[132:135], v[52:55], v[32:35], v[132:135]
    ds_read_b64_tr_b16 v[100:101], v19 offset:32768
    v_mfma_f32_16x16x32_bf16 v[136:139], v[56:59], v[32:35], v[136:139]
    ds_read_b64_tr_b16 v[102:103], v19 offset:34816
    v_mfma_f32_16x16x32_bf16 v[140:143], v[60:63], v[32:35], v[140:143]
    ds_read_b64_tr_b16 v[104:105], v20 offset:32768
    v_mfma_f32_16x16x32_bf16 v[144:147], v[48:51], v[36:39], v[144:147]
    ds_read_b64_tr_b16 v[106:107], v20 offset:34816
    v_mfma_f32_16x16x32_bf16 v[148:151], v[52:55], v[36:39], v[148:151]
    ds_read_b64_tr_b16 v[108:109], v21 offset:32768
    ds_read_b64_tr_b16 v[110:111], v21 offset:34816
    v_mfma_f32_16x16x32_bf16 v[152:155], v[56:59], v[36:39], v[152:155]
    ds_read_b128 v[80:83], v17 offset:0
    v_mfma_f32_16x16x32_bf16 v[156:159], v[60:63], v[36:39], v[156:159]
    ds_read_b128 v[84:87], v17 offset:2048
    v_mfma_f32_16x16x32_bf16 v[160:163], v[48:51], v[40:43], v[160:163]
    ds_read_b128 v[88:91], v17 offset:4096
    v_mfma_f32_16x16x32_bf16 v[164:167], v[52:55], v[40:43], v[164:167]
    ds_read_b128 v[92:95], v17 offset:6144
    v_mfma_f32_16x16x32_bf16 v[168:171], v[56:59], v[40:43], v[168:171]
    s_add_u32 s27, s27, 1
    s_cmp_eq_u32 s27, 3
    s_cselect_b32 s28, -98304, s29
    s_cselect_b32 s27, 0, s27
    v_add_u32 v16, s28, v16
    v_mfma_f32_16x16x32_bf16 v[172:175], v[60:63], v[40:43], v[172:175]
    v_add_u32 v17, s28, v17
    v_mfma_f32_16x16x32_bf16 v[176:179], v[48:51], v[44:47], v[176:179]
    v_add_u32 v18, s28, v18
    v_mfma_f32_16x16x32_bf16 v[180:183], v[52:55], v[44:47], v[180:183]
    v_add_u32 v19, s28, v19
    v_mfma_f32_16x16x32_bf16 v[184:187], v[56:59], v[44:47], v[184:187]
    v_add_u32 v20, s28, v20
    v_mfma_f32_16x16x32_bf16 v[188:191], v[60:63], v[44:47], v[188:191]
    v_add_u32 v21, s28, v21
    s_waitcnt vmcnt(6) lgkmcnt(0)
    s_barrier
    v_mfma_f32_16x16x32_bf16 v[128:131], v[96:99], v[80:83], v[128:131]
    ds_read_b64_tr_b16 v[48:49], v18 offset:16384
    ds_read_b64_tr_b16 v[50:51], v18 offset:18432
    v_mfma_f32_16x16x32_bf16 v[132:135], v[100:103], v[80:83], v[132:135]
    ds_read_b64_tr_b16 v[52:53], v19 offset:16384
    v_mfma_f32_16x16x32_bf16 v[136:139], v[104:107], v[80:83], v[136:139]
    ds_read_b64_tr_b16 v[54:55], v19 offset:18432
    v_mfma_f32_16x16x32_bf16 v[140:143], v[108:111], v[80:83], v[140:143]
    ds_read_b64_tr_b16 v[56:57], v20 offset:16384
    ds_read_b64_tr_b16 v[58:59], v20 offset:18432
    v_mfma_f32_16x16x32_bf16 v[144:147], v[96:99], v[84:87], v[144:147]
    ds_read_b64_tr_b16 v[60:61], v21 offset:16384
    v_mfma_f32_16x16x32_bf16 v[148:151], v[100:103], v[84:87], v[148:151]
    ds_read_b64_tr_b16 v[62:63], v21 offset:18432
    v_mfma_f32_16x16x32_bf16 v[152:155], v[104:107], v[84:87], v[152:155]
    ds_read_b128 v[32:35], v16 offset:0
    ds_read_b128 v[36:39], v16 offset:2048
    v_mfma_f32_16x16x32_bf16 v[156:159], v[108:111], v[84:87], v[156:159]
    ds_read_b128 v[40:43], v16 offset:4096
    v_mfma_f32_16x16x32_bf16 v[160:163], v[96:99], v[88:91], v[160:163]
    ds_read_b128 v[44:47], v16 offset:6144
    v_mfma_f32_16x16x32_bf16 v[164:167], v[100:103], v[88:91], v[164:167]
    s_mov_b32 m0, s35
    s_add_u32 s35, s35, 49152
    s_cmp_ge_u32 s35, 147456
    s_cselect_b32 s40, 147456, 0
    s_sub_u32 s35, s35, s40
    buffer_load_dwordx4 v8, s[12:15], s31 offen offset:0  lds
    v_mfma_f32_16x16x32_bf16 v[168:171], v[104:107], v[88:91], v[168:171]
    buffer_load_dwordx4 v9, s[12:15], s31 offen offset:1024  lds
    v_mfma_f32_16x16x32_bf16 v[172:175], v[108:111], v[88:91], v[172:175]
    s_mov_b32 m0, s36
    s_add_u32 s31, s31, 128
    s_add_u32 s36, s36, 49152
    s_cmp_ge_u32 s36, 147456
    s_cselect_b32 s40, 147456, 0
    s_sub_u32 s36, s36, s40
    v_mfma_f32_16x16x32_bf16 v[176:179], v[96:99], v[92:95], v[176:179]
    buffer_load_dwordx4 v12, s[16:19], s32 offen offset:0  lds
    buffer_load_dwordx4 v13, s[16:19], s32 offen offset:1024  lds
    v_mfma_f32_16x16x32_bf16 v[180:183], v[100:103], v[92:95], v[180:183]
    buffer_load_dwordx4 v14, s[16:19], s32 offen offset:2048  lds
    v_mfma_f32_16x16x32_bf16 v[184:187], v[104:107], v[92:95], v[184:187]
    buffer_load_dwordx4 v15, s[16:19], s32 offen offset:3072  lds
    v_mfma_f32_16x16x32_bf16 v[188:191], v[108:111], v[92:95], v[188:191]
    s_add_u32 s32, s32, s33
    s_sub_u32 s34, s34, 1
    s_cmp_lg_u32 s34, 0
    s_cbranch_scc1 gl_141
    s_cmp_lg_u32 s26, 0
    s_cbranch_scc1 ti_142
    s_lshl_b32 s3, s43, 2
    s_add_u32 s3, s3, 16
    v_mov_b32 v27, s3
    v_mov_b32 v28, 1
    s_mov_b64 exec, 1
    buffer_atomic_add v28, v27, s[20:23], 0 offen sc0 sc1
    s_mov_b64 exec, -1
ti_142:
    v_mov_b32 v30, 128
    buffer_load_dword v31, v30, s[20:23], 0 offen sc1
    s_waitcnt lgkmcnt(0)
    v_mfma_f32_16x16x32_bf16 v[128:131], v[48:51], v[32:35], v[128:131]
    ds_read_b64_tr_b16 v[96:97], v18 offset:32768
    ds_read_b64_tr_b16 v[98:99], v18 offset:34816
    v_mfma_f32_16x16x32_bf16 v[132:135], v[52:55], v[32:35], v[132:135]
    ds_read_b64_tr_b16 v[100:101], v19 offset:32768
    v_mfma_f32_16x16x32_bf16 v[136:139], v[56:59], v[32:35], v[136:139]
    ds_read_b64_tr_b16 v[102:103], v19 offset:34816
    v_mfma_f32_16x16x32_bf16 v[140:143], v[60:63], v[32:35], v[140:143]
    ds_read_b64_tr_b16 v[104:105], v20 offset:32768
    v_mfma_f32_16x16x32_bf16 v[144:147], v[48:51], v[36:39], v[144:147]
    ds_read_b64_tr_b16 v[106:107], v20 offset:34816
    v_mfma_f32_16x16x32_bf16 v[148:151], v[52:55], v[36:39], v[148:151]
    ds_read_b64_tr_b16 v[108:109], v21 offset:32768
    ds_read_b64_tr_b16 v[110:111], v21 offset:34816
    v_mfma_f32_16x16x32_bf16 v[152:155], v[56:59], v[36:39], v[152:155]
    ds_read_b128 v[80:83], v17 offset:0
    v_mfma_f32_16x16x32_bf16 v[156:159], v[60:63], v[36:39], v[156:159]
    ds_read_b128 v[84:87], v17 offset:2048
    v_mfma_f32_16x16x32_bf16 v[160:163], v[48:51], v[40:43], v[160:163]
    ds_read_b128 v[88:91], v17 offset:4096
    v_mfma_f32_16x16x32_bf16 v[164:167], v[52:55], v[40:43], v[164:167]
    ds_read_b128 v[92:95], v17 offset:6144
    v_mfma_f32_16x16x32_bf16 v[168:171], v[56:59], v[40:43], v[168:171]
    s_add_u32 s27, s27, 1
    s_cmp_eq_u32 s27, 3
    s_cselect_b32 s28, -98304, s29
    s_cselect_b32 s27, 0, s27
    v_add_u32 v16, s28, v16
    v_mfma_f32_16x16x32_bf16 v[172:175], v[60:63], v[40:43], v[172:175]
    v_add_u32 v17, s28, v17
    v_mfma_f32_16x16x32_bf16 v[176:179], v[48:51], v[44:47], v[176:179]
    v_add_u32 v18, s28, v18
    v_mfma_f32_16x16x32_bf16 v[180:183], v[52:55], v[44:47], v[180:183]
    v_add_u32 v19, s28, v19
    v_mfma_f32_16x16x32_bf16 v[184:187], v[56:59], v[44:47], v[184:187]
    v_add_u32 v20, s28, v20
    v_mfma_f32_16x16x32_bf16 v[188:191], v[60:63], v[44:47], v[188:191]
    v_add_u32 v21, s28, v21
    s_waitcnt vmcnt(6) lgkmcnt(0)
    s_barrier
    v_mfma_f32_16x16x32_bf16 v[128:131], v[96:99], v[80:83], v[128:131]
    ds_read_b64_tr_b16 v[48:49], v18 offset:16384
    v_mfma_f32_16x16x32_bf16 v[132:135], v[100:103], v[80:83], v[132:135]
    ds_read_b64_tr_b16 v[50:51], v18 offset:18432
    v_mfma_f32_16x16x32_bf16 v[136:139], v[104:107], v[80:83], v[136:139]
    ds_read_b64_tr_b16 v[52:53], v19 offset:16384
    v_mfma_f32_16x16x32_bf16 v[140:143], v[108:111], v[80:83], v[140:143]
    v_mfma_f32_16x16x32_bf16 v[144:147], v[96:99], v[84:87], v[144:147]
    ds_read_b64_tr_b16 v[54:55], v19 offset:18432
    v_mfma_f32_16x16x32_bf16 v[148:151], v[100:103], v[84:87], v[148:151]
    ds_read_b64_tr_b16 v[56:57], v20 offset:16384
    v_mfma_f32_16x16x32_bf16 v[152:155], v[104:107], v[84:87], v[152:155]
    ds_read_b64_tr_b16 v[58:59], v20 offset:18432
    v_mfma_f32_16x16x32_bf16 v[156:159], v[108:111], v[84:87], v[156:159]
    v_mfma_f32_16x16x32_bf16 v[160:163], v[96:99], v[88:91], v[160:163]
    ds_read_b64_tr_b16 v[60:61], v21 offset:16384
    v_mfma_f32_16x16x32_bf16 v[164:167], v[100:103], v[88:91], v[164:167]
    ds_read_b64_tr_b16 v[62:63], v21 offset:18432
    v_mfma_f32_16x16x32_bf16 v[168:171], v[104:107], v[88:91], v[168:171]
    ds_read_b128 v[32:35], v16 offset:0
    v_mfma_f32_16x16x32_bf16 v[172:175], v[108:111], v[88:91], v[172:175]
    v_mfma_f32_16x16x32_bf16 v[176:179], v[96:99], v[92:95], v[176:179]
    ds_read_b128 v[36:39], v16 offset:2048
    v_mfma_f32_16x16x32_bf16 v[180:183], v[100:103], v[92:95], v[180:183]
    ds_read_b128 v[40:43], v16 offset:4096
    v_mfma_f32_16x16x32_bf16 v[184:187], v[104:107], v[92:95], v[184:187]
    ds_read_b128 v[44:47], v16 offset:6144
    v_mfma_f32_16x16x32_bf16 v[188:191], v[108:111], v[92:95], v[188:191]
    s_waitcnt lgkmcnt(0)
    v_mfma_f32_16x16x32_bf16 v[128:131], v[48:51], v[32:35], v[128:131]
    ds_read_b64_tr_b16 v[96:97], v18 offset:32768
    ds_read_b64_tr_b16 v[98:99], v18 offset:34816
    v_mfma_f32_16x16x32_bf16 v[132:135], v[52:55], v[32:35], v[132:135]
    ds_read_b64_tr_b16 v[100:101], v19 offset:32768
    v_mfma_f32_16x16x32_bf16 v[136:139], v[56:59], v[32:35], v[136:139]
    ds_read_b64_tr_b16 v[102:103], v19 offset:34816
    v_mfma_f32_16x16x32_bf16 v[140:143], v[60:63], v[32:35], v[140:143]
    ds_read_b64_tr_b16 v[104:105], v20 offset:32768
    v_mfma_f32_16x16x32_bf16 v[144:147], v[48:51], v[36:39], v[144:147]
    ds_read_b64_tr_b16 v[106:107], v20 offset:34816
    v_mfma_f32_16x16x32_bf16 v[148:151], v[52:55], v[36:39], v[148:151]
    ds_read_b64_tr_b16 v[108:109], v21 offset:32768
    ds_read_b64_tr_b16 v[110:111], v21 offset:34816
    v_mfma_f32_16x16x32_bf16 v[152:155], v[56:59], v[36:39], v[152:155]
    ds_read_b128 v[80:83], v17 offset:0
    v_mfma_f32_16x16x32_bf16 v[156:159], v[60:63], v[36:39], v[156:159]
    ds_read_b128 v[84:87], v17 offset:2048
    v_mfma_f32_16x16x32_bf16 v[160:163], v[48:51], v[40:43], v[160:163]
    ds_read_b128 v[88:91], v17 offset:4096
    v_mfma_f32_16x16x32_bf16 v[164:167], v[52:55], v[40:43], v[164:167]
    ds_read_b128 v[92:95], v17 offset:6144
    v_mfma_f32_16x16x32_bf16 v[168:171], v[56:59], v[40:43], v[168:171]
    s_add_u32 s27, s27, 1
    s_cmp_eq_u32 s27, 3
    s_cselect_b32 s28, -98304, s29
    s_cselect_b32 s27, 0, s27
    v_add_u32 v16, s28, v16
    v_mfma_f32_16x16x32_bf16 v[172:175], v[60:63], v[40:43], v[172:175]
    v_add_u32 v17, s28, v17
    v_mfma_f32_16x16x32_bf16 v[176:179], v[48:51], v[44:47], v[176:179]
    v_add_u32 v18, s28, v18
    v_mfma_f32_16x16x32_bf16 v[180:183], v[52:55], v[44:47], v[180:183]
    v_add_u32 v19, s28, v19
    v_mfma_f32_16x16x32_bf16 v[184:187], v[56:59], v[44:47], v[184:187]
    v_add_u32 v20, s28, v20
    v_mfma_f32_16x16x32_bf16 v[188:191], v[60:63], v[44:47], v[188:191]
    v_add_u32 v21, s28, v21
    s_waitcnt vmcnt(0) lgkmcnt(0)
    s_barrier
    v_mfma_f32_16x16x32_bf16 v[128:131], v[96:99], v[80:83], v[128:131]
    ds_read_b64_tr_b16 v[48:49], v18 offset:16384
    v_mfma_f32_16x16x32_bf16 v[132:135], v[100:103], v[80:83], v[132:135]
    ds_read_b64_tr_b16 v[50:51], v18 offset:18432
    v_mfma_f32_16x16x32_bf16 v[136:139], v[104:107], v[80:83], v[136:139]
    ds_read_b64_tr_b16 v[52:53], v19 offset:16384
    v_mfma_f32_16x16x32_bf16 v[140:143], v[108:111], v[80:83], v[140:143]
    v_mfma_f32_16x16x32_bf16 v[144:147], v[96:99], v[84:87], v[144:147]
    ds_read_b64_tr_b16 v[54:55], v19 offset:18432
    v_mfma_f32_16x16x32_bf16 v[148:151], v[100:103], v[84:87], v[148:151]
    ds_read_b64_tr_b16 v[56:57], v20 offset:16384
    v_mfma_f32_16x16x32_bf16 v[152:155], v[104:107], v[84:87], v[152:155]
    ds_read_b64_tr_b16 v[58:59], v20 offset:18432
    v_mfma_f32_16x16x32_bf16 v[156:159], v[108:111], v[84:87], v[156:159]
    v_mfma_f32_16x16x32_bf16 v[160:163], v[96:99], v[88:91], v[160:163]
    ds_read_b64_tr_b16 v[60:61], v21 offset:16384
    v_mfma_f32_16x16x32_bf16 v[164:167], v[100:103], v[88:91], v[164:167]
    ds_read_b64_tr_b16 v[62:63], v21 offset:18432
    v_mfma_f32_16x16x32_bf16 v[168:171], v[104:107], v[88:91], v[168:171]
    ds_read_b128 v[32:35], v16 offset:0
    v_mfma_f32_16x16x32_bf16 v[172:175], v[108:111], v[88:91], v[172:175]
    v_mfma_f32_16x16x32_bf16 v[176:179], v[96:99], v[92:95], v[176:179]
    ds_read_b128 v[36:39], v16 offset:2048
    v_mfma_f32_16x16x32_bf16 v[180:183], v[100:103], v[92:95], v[180:183]
    ds_read_b128 v[40:43], v16 offset:4096
    v_mfma_f32_16x16x32_bf16 v[184:187], v[104:107], v[92:95], v[184:187]
    ds_read_b128 v[44:47], v16 offset:6144
    v_mfma_f32_16x16x32_bf16 v[188:191], v[108:111], v[92:95], v[188:191]
    s_waitcnt lgkmcnt(0)
    v_mfma_f32_16x16x32_bf16 v[128:131], v[48:51], v[32:35], v[128:131]
    ds_read_b64_tr_b16 v[96:97], v18 offset:32768
    ds_read_b64_tr_b16 v[98:99], v18 offset:34816
    v_mfma_f32_16x16x32_bf16 v[132:135], v[52:55], v[32:35], v[132:135]
    ds_read_b64_tr_b16 v[100:101], v19 offset:32768
    v_mfma_f32_16x16x32_bf16 v[136:139], v[56:59], v[32:35], v[136:139]
    ds_read_b64_tr_b16 v[102:103], v19 offset:34816
    v_mfma_f32_16x16x32_bf16 v[140:143], v[60:63], v[32:35], v[140:143]
    ds_read_b64_tr_b16 v[104:105], v20 offset:32768
    v_mfma_f32_16x16x32_bf16 v[144:147], v[48:51], v[36:39], v[144:147]
    ds_read_b64_tr_b16 v[106:107], v20 offset:34816
    v_mfma_f32_16x16x32_bf16 v[148:151], v[52:55], v[36:39], v[148:151]
    ds_read_b64_tr_b16 v[108:109], v21 offset:32768
    ds_read_b64_tr_b16 v[110:111], v21 offset:34816
    v_mfma_f32_16x16x32_bf16 v[152:155], v[56:59], v[36:39], v[152:155]
    ds_read_b128 v[80:83], v17 offset:0
    v_mfma_f32_16x16x32_bf16 v[156:159], v[60:63], v[36:39], v[156:159]
    ds_read_b128 v[84:87], v17 offset:2048
    v_mfma_f32_16x16x32_bf16 v[160:163], v[48:51], v[40:43], v[160:163]
    ds_read_b128 v[88:91], v17 offset:4096
    v_mfma_f32_16x16x32_bf16 v[164:167], v[52:55], v[40:43], v[164:167]
    ds_read_b128 v[92:95], v17 offset:6144
    v_mfma_f32_16x16x32_bf16 v[168:171], v[56:59], v[40:43], v[168:171]
    s_add_u32 s27, s27, 1
    s_cmp_eq_u32 s27, 3
    s_cselect_b32 s28, -98304, s29
    s_cselect_b32 s27, 0, s27
    v_add_u32 v16, s28, v16
    v_mfma_f32_16x16x32_bf16 v[172:175], v[60:63], v[40:43], v[172:175]
    v_add_u32 v17, s28, v17
    v_mfma_f32_16x16x32_bf16 v[176:179], v[48:51], v[44:47], v[176:179]
    v_add_u32 v18, s28, v18
    v_mfma_f32_16x16x32_bf16 v[180:183], v[52:55], v[44:47], v[180:183]
    v_add_u32 v19, s28, v19
    v_mfma_f32_16x16x32_bf16 v[184:187], v[56:59], v[44:47], v[184:187]
    v_add_u32 v20, s28, v20
    v_mfma_f32_16x16x32_bf16 v[188:191], v[60:63], v[44:47], v[188:191]
    v_add_u32 v21, s28, v21
    s_waitcnt lgkmcnt(0)
    v_mfma_f32_16x16x32_bf16 v[128:131], v[96:99], v[80:83], v[128:131]
    v_mfma_f32_16x16x32_bf16 v[132:135], v[100:103], v[80:83], v[132:135]
    v_mfma_f32_16x16x32_bf16 v[136:139], v[104:107], v[80:83], v[136:139]
    v_mfma_f32_16x16x32_bf16 v[140:143], v[108:111], v[80:83], v[140:143]
    v_mfma_f32_16x16x32_bf16 v[144:147], v[96:99], v[84:87], v[144:147]
    v_mfma_f32_16x16x32_bf16 v[148:151], v[100:103], v[84:87], v[148:151]
    v_mfma_f32_16x16x32_bf16 v[152:155], v[104:107], v[84:87], v[152:155]
    v_mfma_f32_16x16x32_bf16 v[156:159], v[108:111], v[84:87], v[156:159]
    v_mfma_f32_16x16x32_bf16 v[160:163], v[96:99], v[88:91], v[160:163]
    v_mfma_f32_16x16x32_bf16 v[164:167], v[100:103], v[88:91], v[164:167]
    v_mfma_f32_16x16x32_bf16 v[168:171], v[104:107], v[88:91], v[168:171]
    v_mfma_f32_16x16x32_bf16 v[172:175], v[108:111], v[88:91], v[172:175]
    v_mfma_f32_16x16x32_bf16 v[176:179], v[96:99], v[92:95], v[176:179]
    v_mfma_f32_16x16x32_bf16 v[180:183], v[100:103], v[92:95], v[180:183]
    v_mfma_f32_16x16x32_bf16 v[184:187], v[104:107], v[92:95], v[184:187]
    v_mfma_f32_16x16x32_bf16 v[188:191], v[108:111], v[92:95], v[188:191]
    s_nop 7
LE_K1:
    v_mov_b32 v3, 163584
    s_cmp_lg_u32 s26, 0
    s_cbranch_scc1 tt_143
    s_waitcnt vmcnt(0)
    s_mov_b64 exec, 1
    ds_write_b32 v3, v28
    s_waitcnt lgkmcnt(0)
    s_mov_b64 exec, -1
tt_143:
    s_barrier
    ds_read_b32 v5, v3
    s_waitcnt lgkmcnt(0)
    v_readfirstlane_b32 s25, v5
    s_nop 3
    s_min_u32 s3, s25, 204
    s_lshl_b32 s3, s3, 2
    s_load_dword s7, s[50:51], s3
    s_waitcnt lgkmcnt(0)
E_K1:
    s_cmp_lg_u32 s79, -1
    s_cbranch_scc1 hp_144
    s_branch hc_146
ht_145:
    s_sub_u32 s30, s30, 1
    s_cbranch_scc1 L_end
    v_mov_b32 v30, 128
    buffer_load_dword v31, v30, s[20:23], 0 offen sc1
hc_146:
    s_waitcnt vmcnt(0)
    v_readfirstlane_b32 s3, v31
    s_nop 3
    s_and_b32 s40, s3, 0xffff
    s_cmp_lt_u32 s40, 128
    s_cbranch_scc1 ht_145
    s_add_u32 s3, s3, 4128768
    s_lshr_b32 s3, s3, 10
    s_and_b32 s79, s3, 8192
hp_144:
    v_lshlrev_b32 v7, 4, v2
    s_lshr_b32 s38, s42, 5
    s_mul_i32 s39, s45, 2
    s_add_u32 s38, s38, s39
    s_lshl_b32 s38, s38, 6
    s_lshr_b32 s39, s41, 5
    s_add_u32 s38, s38, s39
    s_mul_i32 s39, s44, 2
    s_add_u32 s38, s38, s39
    s_mov_b32 s39, s38
    s_lshl_b32 s38, s38, 13
    s_add_u32 s38, s38, 134217728
    s_bfe_u32 s3, s39, 0x10008
    s_lshl_b32 s3, s3, 13
    s_xor_b32 s3, s3, s79
    s_xor_b32 s3, s3, 8192
    s_add_u32 s38, s38, s3
    s_add_u32 s39, s38, 0
    v_cvt_pk_bf16_f32 v32, v128, v129
    v_cvt_pk_bf16_f32 v33, v130, v131
    v_cvt_pk_bf16_f32 v34, v132, v133
    v_cvt_pk_bf16_f32 v35, v134, v135
    buffer_store_dwordx4 v[32:35], v7, s[8:11], s39 offen offset:0 sc1
    v_cvt_pk_bf16_f32 v36, v144, v145
    v_cvt_pk_bf16_f32 v37, v146, v147
    v_cvt_pk_bf16_f32 v38, v148, v149
    v_cvt_pk_bf16_f32 v39, v150, v151
    buffer_store_dwordx4 v[36:39], v7, s[8:11], s39 offen offset:1024 sc1
    s_add_u32 s39, s38, 4096
    v_cvt_pk_bf16_f32 v40, v160, v161
    v_cvt_pk_bf16_f32 v41, v162, v163
    v_cvt_pk_bf16_f32 v42, v164, v165
    v_cvt_pk_bf16_f32 v43, v166, v167
    buffer_store_dwordx4 v[40:43], v7, s[8:11], s39 offen offset:0 sc1
    v_cvt_pk_bf16_f32 v44, v176, v177
    v_cvt_pk_bf16_f32 v45, v178, v179
    v_cvt_pk_bf16_f32 v46, v180, v181
    v_cvt_pk_bf16_f32 v47, v182, v183
    buffer_store_dwordx4 v[44:47], v7, s[8:11], s39 offen offset:1024 sc1
    s_add_u32 s39, s38, 524288
    v_cvt_pk_bf16_f32 v48, v136, v137
    v_cvt_pk_bf16_f32 v49, v138, v139
    v_cvt_pk_bf16_f32 v50, v140, v141
    v_cvt_pk_bf16_f32 v51, v142, v143
    buffer_store_dwordx4 v[48:51], v7, s[8:11], s39 offen offset:0 sc1
    v_cvt_pk_bf16_f32 v52, v152, v153
    v_cvt_pk_bf16_f32 v53, v154, v155
    v_cvt_pk_bf16_f32 v54, v156, v157
    v_cvt_pk_bf16_f32 v55, v158, v159
    buffer_store_dwordx4 v[52:55], v7, s[8:11], s39 offen offset:1024 sc1
    s_add_u32 s39, s38, 528384
    v_cvt_pk_bf16_f32 v56, v168, v169
    v_cvt_pk_bf16_f32 v57, v170, v171
    v_cvt_pk_bf16_f32 v58, v172, v173
    v_cvt_pk_bf16_f32 v59, v174, v175
    buffer_store_dwordx4 v[56:59], v7, s[8:11], s39 offen offset:0 sc1
    v_cvt_pk_bf16_f32 v60, v184, v185
    v_cvt_pk_bf16_f32 v61, v186, v187
    v_cvt_pk_bf16_f32 v62, v188, v189
    v_cvt_pk_bf16_f32 v63, v190, v191
    buffer_store_dwordx4 v[60:63], v7, s[8:11], s39 offen offset:1024 sc1
    s_waitcnt vmcnt(0)
    s_lshr_b32 s37, s49, 24
    v_lshlrev_b32 v26, 6, v2
    s_cmp_ge_u32 s37, 128
    s_cbranch_scc1 to_147
    s_add_u32 s38, s37, 0
    s_lshl_b32 s38, s38, 2
    s_add_u32 s38, s38, s43
    s_lshl_b32 s38, s38, 3
    s_add_u32 s38, s38, s26
    s_lshl_b32 s38, s38, 12
    s_mov_b64 s[60:61], s[82:83]
    s_mov_b32 s39, 0
    s_cmp_ge_u32 s38, 4194304
    s_cselect_b64 s[60:61], s[92:93], s[60:61]
    s_cselect_b32 s39, 4194304, s39
    s_cmp_ge_u32 s38, 8388608
    s_cselect_b64 s[60:61], s[94:95], s[60:61]
    s_cselect_b32 s39, 8388608, s39
    s_cmp_ge_u32 s38, 14680064
    s_cselect_b64 s[60:61], s[96:97], s[60:61]
    s_cselect_b32 s39, 14680064, s39
    s_sub_u32 s38, s38, s39
    s_and_b32 s61, s61, 0xffff
    s_add_u32 s62, s38, 4096
    s_mov_b32 s63, 0x20000
    buffer_load_dword v1, v26, s[60:63], s38 offen
    s_cmp_ge_u32 s37, 127
    s_cbranch_scc1 to_147
    s_add_u32 s38, s37, 1
    s_lshl_b32 s38, s38, 2
    s_add_u32 s38, s38, s43
    s_lshl_b32 s38, s38, 3
    s_add_u32 s38, s38, s26
    s_lshl_b32 s38, s38, 12
    s_mov_b64 s[60:61], s[82:83]
    s_mov_b32 s39, 0
    s_cmp_ge_u32 s38, 4194304
    s_cselect_b64 s[60:61], s[92:93], s[60:61]
    s_cselect_b32 s39, 4194304, s39
    s_cmp_ge_u32 s38, 8388608
    s_cselect_b64 s[60:61], s[94:95], s[60:61]
    s_cselect_b32 s39, 8388608, s39
    s_cmp_ge_u32 s38, 14680064
    s_cselect_b64 s[60:61], s[96:97], s[60:61]
    s_cselect_b32 s39, 14680064, s39
    s_sub_u32 s38, s38, s39
    s_and_b32 s61, s61, 0xffff
    s_add_u32 s62, s38, 4096
    s_mov_b32 s63, 0x20000
    buffer_load_dword v1, v26, s[60:63], s38 offen
to_147:
    s_lshr_b32 s40, s41, 8
    s_lshl_b32 s40, s40, 2
    s_add_u32 s40, s40, s43
    s_lshl_b32 s40, s40, 7
    s_add_u32 s40, s40, 79720448
    s_waitcnt vmcnt(2)
    s_barrier
    s_cmp_lg_u32 s26, 1
    s_cbranch_scc1 sg_148
    v_mov_b32 v4, s40
    v_mov_b32 v5, 2
    s_mov_b64 exec, 1
    buffer_atomic_add v5, v4, s[8:11], 0 offen sc1
    s_mov_b64 exec, -1
sg_148:
    s_cmp_eq_u32 s6, 0
    s_cbranch_scc1 D_pre
    s_mov_b32 s6, 0
    s_branch D_main
LP_V1:
    s_mov_b32 s34, 12
    s_mov_b32 s27, 0
    s_mov_b32 s29, 49152
    s_waitcnt vmcnt(12)
    s_barrier
    ds_read_b64_tr_b16 v[48:49], v18 offset:16384
    ds_read_b64_tr_b16 v[50:51], v18 offset:18432
    ds_read_b64_tr_b16 v[52:53], v19 offset:16384
    ds_read_b64_tr_b16 v[54:55], v19 offset:18432
    ds_read_b64_tr_b16 v[56:57], v20 offset:16384
    ds_read_b64_tr_b16 v[58:59], v20 offset:18432
    ds_read_b64_tr_b16 v[60:61], v21 offset:16384
    ds_read_b64_tr_b16 v[62:63], v21 offset:18432
    ds_read_b128 v[32:35], v16 offset:0
    ds_read_b128 v[36:39], v16 offset:2048
    ds_read_b128 v[40:43], v16 offset:4096
    ds_read_b128 v[44:47], v16 offset:6144
    s_waitcnt lgkmcnt(0)
    v_mfma_f32_16x16x32_bf16 v[128:131], v[32:35], v[48:51], 0
    ds_read_b64_tr_b16 v[96:97], v18 offset:32768
    ds_read_b64_tr_b16 v[98:99], v18 offset:34816
    v_mfma_f32_16x16x32_bf16 v[132:135], v[32:35], v[52:55], 0
    ds_read_b64_tr_b16 v[100:101], v19 offset:32768
    v_mfma_f32_16x16x32_bf16 v[136:139], v[32:35], v[56:59], 0
    ds_read_b64_tr_b16 v[102:103], v19 offset:34816
    v_mfma_f32_16x16x32_bf16 v[140:143], v[32:35], v[60:63], 0
    ds_read_b64_tr_b16 v[104:105], v20 offset:32768
    v_mfma_f32_16x16x32_bf16 v[144:147], v[36:39], v[48:51], 0
    ds_read_b64_tr_b16 v[106:107], v20 offset:34816
    v_mfma_f32_16x16x32_bf16 v[148:151], v[36:39], v[52:55], 0
    ds_read_b64_tr_b16 v[108:109], v21 offset:32768
    ds_read_b64_tr_b16 v[110:111], v21 offset:34816
    v_mfma_f32_16x16x32_bf16 v[152:155], v[36:39], v[56:59], 0
    ds_read_b128 v[80:83], v17 offset:0
    v_mfma_f32_16x16x32_bf16 v[156:159], v[36:39], v[60:63], 0
    ds_read_b128 v[84:87], v17 offset:2048
    v_mfma_f32_16x16x32_bf16 v[160:163], v[40:43], v[48:51], 0
    ds_read_b128 v[88:91], v17 offset:4096
    v_mfma_f32_16x16x32_bf16 v[164:167], v[40:43], v[52:55], 0
    ds_read_b128 v[92:95], v17 offset:6144
    v_mfma_f32_16x16x32_bf16 v[168:171], v[40:43], v[56:59], 0
    s_add_u32 s27, s27, 1
    s_cmp_eq_u32 s27, 3
    s_cselect_b32 s28, -98304, s29
    s_cselect_b32 s27, 0, s27
    v_add_u32 v16, s28, v16
    v_mfma_f32_16x16x32_bf16 v[172:175], v[40:43], v[60:63], 0
    v_add_u32 v17, s28, v17
    v_mfma_f32_16x16x32_bf16 v[176:179], v[44:47], v[48:51], 0
    v_add_u32 v18, s28, v18
    v_mfma_f32_16x16x32_bf16 v[180:183], v[44:47], v[52:55], 0
    v_add_u32 v19, s28, v19
    v_mfma_f32_16x16x32_bf16 v[184:187], v[44:47], v[56:59], 0
    v_add_u32 v20, s28, v20
    v_mfma_f32_16x16x32_bf16 v[188:191], v[44:47], v[60:63], 0
    v_add_u32 v21, s28, v21
    s_waitcnt vmcnt(6) lgkmcnt(0)
    s_barrier
    v_mfma_f32_16x16x32_bf16 v[128:131], v[80:83], v[96:99], v[128:131]
    ds_read_b64_tr_b16 v[48:49], v18 offset:16384
    ds_read_b64_tr_b16 v[50:51], v18 offset:18432
    v_mfma_f32_16x16x32_bf16 v[132:135], v[80:83], v[100:103], v[132:135]
    ds_read_b64_tr_b16 v[52:53], v19 offset:16384
    v_mfma_f32_16x16x32_bf16 v[136:139], v[80:83], v[104:107], v[136:139]
    ds_read_b64_tr_b16 v[54:55], v19 offset:18432
    v_mfma_f32_16x16x32_bf16 v[140:143], v[80:83], v[108:111], v[140:143]
    ds_read_b64_tr_b16 v[56:57], v20 offset:16384
    ds_read_b64_tr_b16 v[58:59], v20 offset:18432
    v_mfma_f32_16x16x32_bf16 v[144:147], v[84:87], v[96:99], v[144:147]
    ds_read_b64_tr_b16 v[60:61], v21 offset:16384
    v_mfma_f32_16x16x32_bf16 v[148:151], v[84:87], v[100:103], v[148:151]
    ds_read_b64_tr_b16 v[62:63], v21 offset:18432
    v_mfma_f32_16x16x32_bf16 v[152:155], v[84:87], v[104:107], v[152:155]
    ds_read_b128 v[32:35], v16 offset:0
    ds_read_b128 v[36:39], v16 offset:2048
    v_mfma_f32_16x16x32_bf16 v[156:159], v[84:87], v[108:111], v[156:159]
    ds_read_b128 v[40:43], v16 offset:4096
    v_mfma_f32_16x16x32_bf16 v[160:163], v[88:91], v[96:99], v[160:163]
    ds_read_b128 v[44:47], v16 offset:6144
    v_mfma_f32_16x16x32_bf16 v[164:167], v[88:91], v[100:103], v[164:167]
    s_mov_b32 m0, s35
    s_add_u32 s35, s35, 49152
    s_cmp_ge_u32 s35, 147456
    s_cselect_b32 s40, 147456, 0
    s_sub_u32 s35, s35, s40
    buffer_load_dwordx4 v8, s[12:15], s31 offen offset:0  lds
    v_mfma_f32_16x16x32_bf16 v[168:171], v[88:91], v[104:107], v[168:171]
    buffer_load_dwordx4 v9, s[12:15], s31 offen offset:1024  lds
    v_mfma_f32_16x16x32_bf16 v[172:175], v[88:91], v[108:111], v[172:175]
    s_mov_b32 m0, s36
    s_add_u32 s31, s31, 128
    s_add_u32 s36, s36, 49152
    s_cmp_ge_u32 s36, 147456
    s_cselect_b32 s40, 147456, 0
    s_sub_u32 s36, s36, s40
    v_mfma_f32_16x16x32_bf16 v[176:179], v[92:95], v[96:99], v[176:179]
    buffer_load_dwordx4 v12, s[16:19], s32 offen offset:0  lds
    buffer_load_dwordx4 v13, s[16:19], s32 offen offset:1024  lds
    v_mfma_f32_16x16x32_bf16 v[180:183], v[92:95], v[100:103], v[180:183]
    buffer_load_dwordx4 v14, s[16:19], s32 offen offset:2048  lds
    v_mfma_f32_16x16x32_bf16 v[184:187], v[92:95], v[104:107], v[184:187]
    buffer_load_dwordx4 v15, s[16:19], s32 offen offset:3072  lds
    v_mfma_f32_16x16x32_bf16 v[188:191], v[92:95], v[108:111], v[188:191]
    s_add_u32 s32, s32, s33
gl_149:
    s_waitcnt lgkmcnt(0)
    v_mfma_f32_16x16x32_bf16 v[128:131], v[32:35], v[48:51], v[128:131]
    ds_read_b64_tr_b16 v[96:97], v18 offset:32768
    ds_read_b64_tr_b16 v[98:99], v18 offset:34816
    v_mfma_f32_16x16x32_bf16 v[132:135], v[32:35], v[52:55], v[132:135]
    ds_read_b64_tr_b16 v[100:101], v19 offset:32768
    v_mfma_f32_16x16x32_bf16 v[136:139], v[32:35], v[56:59], v[136:139]
    ds_read_b64_tr_b16 v[102:103], v19 offset:34816
    v_mfma_f32_16x16x32_bf16 v[140:143], v[32:35], v[60:63], v[140:143]
    ds_read_b64_tr_b16 v[104:105], v20 offset:32768
    v_mfma_f32_16x16x32_bf16 v[144:147], v[36:39], v[48:51], v[144:147]
    ds_read_b64_tr_b16 v[106:107], v20 offset:34816
    v_mfma_f32_16x16x32_bf16 v[148:151], v[36:39], v[52:55], v[148:151]
    ds_read_b64_tr_b16 v[108:109], v21 offset:32768
    ds_read_b64_tr_b16 v[110:111], v21 offset:34816
    v_mfma_f32_16x16x32_bf16 v[152:155], v[36:39], v[56:59], v[152:155]
    ds_read_b128 v[80:83], v17 offset:0
    v_mfma_f32_16x16x32_bf16 v[156:159], v[36:39], v[60:63], v[156:159]
    ds_read_b128 v[84:87], v17 offset:2048
    v_mfma_f32_16x16x32_bf16 v[160:163], v[40:43], v[48:51], v[160:163]
    ds_read_b128 v[88:91], v17 offset:4096
    v_mfma_f32_16x16x32_bf16 v[164:167], v[40:43], v[52:55], v[164:167]
    ds_read_b128 v[92:95], v17 offset:6144
    v_mfma_f32_16x16x32_bf16 v[168:171], v[40:43], v[56:59], v[168:171]
    s_add_u32 s27, s27, 1
    s_cmp_eq_u32 s27, 3
    s_cselect_b32 s28, -98304, s29
    s_cselect_b32 s27, 0, s27
    v_add_u32 v16, s28, v16
    v_mfma_f32_16x16x32_bf16 v[172:175], v[40:43], v[60:63], v[172:175]
    v_add_u32 v17, s28, v17
    v_mfma_f32_16x16x32_bf16 v[176:179], v[44:47], v[48:51], v[176:179]
    v_add_u32 v18, s28, v18
    v_mfma_f32_16x16x32_bf16 v[180:183], v[44:47], v[52:55], v[180:183]
    v_add_u32 v19, s28, v19
    v_mfma_f32_16x16x32_bf16 v[184:187], v[44:47], v[56:59], v[184:187]
    v_add_u32 v20, s28, v20
    v_mfma_f32_16x16x32_bf16 v[188:191], v[44:47], v[60:63], v[188:191]
    v_add_u32 v21, s28, v21
    s_waitcnt vmcnt(6) lgkmcnt(0)
    s_barrier
    v_mfma_f32_16x16x32_bf16 v[128:131], v[80:83], v[96:99], v[128:131]
    ds_read_b64_tr_b16 v[48:49], v18 offset:16384
    ds_read_b64_tr_b16 v[50:51], v18 offset:18432
    v_mfma_f32_16x16x32_bf16 v[132:135], v[80:83], v[100:103], v[132:135]
    ds_read_b64_tr_b16 v[52:53], v19 offset:16384
    v_mfma_f32_16x16x32_bf16 v[136:139], v[80:83], v[104:107], v[136:139]
    ds_read_b64_tr_b16 v[54:55], v19 offset:18432
    v_mfma_f32_16x16x32_bf16 v[140:143], v[80:83], v[108:111], v[140:143]
    ds_read_b64_tr_b16 v[56:57], v20 offset:16384
    ds_read_b64_tr_b16 v[58:59], v20 offset:18432
    v_mfma_f32_16x16x32_bf16 v[144:147], v[84:87], v[96:99], v[144:147]
    ds_read_b64_tr_b16 v[60:61], v21 offset:16384
    v_mfma_f32_16x16x32_bf16 v[148:151], v[84:87], v[100:103], v[148:151]
    ds_read_b64_tr_b16 v[62:63], v21 offset:18432
    v_mfma_f32_16x16x32_bf16 v[152:155], v[84:87], v[104:107], v[152:155]
    ds_read_b128 v[32:35], v16 offset:0
    ds_read_b128 v[36:39], v16 offset:2048
    v_mfma_f32_16x16x32_bf16 v[156:159], v[84:87], v[108:111], v[156:159]
    ds_read_b128 v[40:43], v16 offset:4096
    v_mfma_f32_16x16x32_bf16 v[160:163], v[88:91], v[96:99], v[160:163]
    ds_read_b128 v[44:47], v16 offset:6144
    v_mfma_f32_16x16x32_bf16 v[164:167], v[88:91], v[100:103], v[164:167]
    s_mov_b32 m0, s35
    s_add_u32 s35, s35, 49152
    s_cmp_ge_u32 s35, 147456
    s_cselect_b32 s40, 147456, 0
    s_sub_u32 s35, s35, s40
    buffer_load_dwordx4 v8, s[12:15], s31 offen offset:0  lds
    v_mfma_f32_16x16x32_bf16 v[168:171], v[88:91], v[104:107], v[168:171]
    buffer_load_dwordx4 v9, s[12:15], s31 offen offset:1024  lds
    v_mfma_f32_16x16x32_bf16 v[172:175], v[88:91], v[108:111], v[172:175]
    s_mov_b32 m0, s36
    s_add_u32 s31, s31, 128
    s_add_u32 s36, s36, 49152
    s_cmp_ge_u32 s36, 147456
    s_cselect_b32 s40, 147456, 0
    s_sub_u32 s36, s36, s40
    v_mfma_f32_16x16x32_bf16 v[176:179], v[92:95], v[96:99], v[176:179]
    buffer_load_dwordx4 v12, s[16:19], s32 offen offset:0  lds
    buffer_load_dwordx4 v13, s[16:19], s32 offen offset:1024  lds
    v_mfma_f32_16x16x32_bf16 v[180:183], v[92:95], v[100:103], v[180:183]
    buffer_load_dwordx4 v14, s[16:19], s32 offen offset:2048  lds
    v_mfma_f32_16x16x32_bf16 v[184:187], v[92:95], v[104:107], v[184:187]
    buffer_load_dwordx4 v15, s[16:19], s32 offen offset:3072  lds
    v_mfma_f32_16x16x32_bf16 v[188:191], v[92:95], v[108:111], v[188:191]
    s_add_u32 s32, s32, s33
    s_sub_u32 s34, s34, 1
    s_cmp_lg_u32 s34, 0
    s_cbranch_scc1 gl_149
    s_cmp_lg_u32 s26, 0
    s_cbranch_scc1 ti_150
    s_lshl_b32 s3, s43, 2
    s_add_u32 s3, s3, 16
    v_mov_b32 v27, s3
    v_mov_b32 v28, 1
    s_mov_b64 exec, 1
    buffer_atomic_add v28, v27, s[20:23], 0 offen sc0 sc1
    s_mov_b64 exec, -1
ti_150:
    v_mov_b32 v30, 128
    buffer_load_dword v31, v30, s[20:23], 0 offen sc1
    s_waitcnt lgkmcnt(0)
    v_mfma_f32_16x16x32_bf16 v[128:131], v[32:35], v[48:51], v[128:131]
    ds_read_b64_tr_b16 v[96:97], v18 offset:32768
    ds_read_b64_tr_b16 v[98:99], v18 offset:34816
    v_mfma_f32_16x16x32_bf16 v[132:135], v[32:35], v[52:55], v[132:135]
    ds_read_b64_tr_b16 v[100:101], v19 offset:32768
    v_mfma_f32_16x16x32_bf16 v[136:139], v[32:35], v[56:59], v[136:139]
    ds_read_b64_tr_b16 v[102:103], v19 offset:34816
    v_mfma_f32_16x16x32_bf16 v[140:143], v[32:35], v[60:63], v[140:143]
    ds_read_b64_tr_b16 v[104:105], v20 offset:32768
    v_mfma_f32_16x16x32_bf16 v[144:147], v[36:39], v[48:51], v[144:147]
    ds_read_b64_tr_b16 v[106:107], v20 offset:34816
    v_mfma_f32_16x16x32_bf16 v[148:151], v[36:39], v[52:55], v[148:151]
    ds_read_b64_tr_b16 v[108:109], v21 offset:32768
    ds_read_b64_tr_b16 v[110:111], v21 offset:34816
    v_mfma_f32_16x16x32_bf16 v[152:155], v[36:39], v[56:59], v[152:155]
    ds_read_b128 v[80:83], v17 offset:0
    v_mfma_f32_16x16x32_bf16 v[156:159], v[36:39], v[60:63], v[156:159]
    ds_read_b128 v[84:87], v17 offset:2048
    v_mfma_f32_16x16x32_bf16 v[160:163], v[40:43], v[48:51], v[160:163]
    ds_read_b128 v[88:91], v17 offset:4096
    v_mfma_f32_16x16x32_bf16 v[164:167], v[40:43], v[52:55], v[164:167]
    ds_read_b128 v[92:95], v17 offset:6144
    v_mfma_f32_16x16x32_bf16 v[168:171], v[40:43], v[56:59], v[168:171]
    s_add_u32 s27, s27, 1
    s_cmp_eq_u32 s27, 3
    s_cselect_b32 s28, -98304, s29
    s_cselect_b32 s27, 0, s27
    v_add_u32 v16, s28, v16
    v_mfma_f32_16x16x32_bf16 v[172:175], v[40:43], v[60:63], v[172:175]
    v_add_u32 v17, s28, v17
    v_mfma_f32_16x16x32_bf16 v[176:179], v[44:47], v[48:51], v[176:179]
    v_add_u32 v18, s28, v18
    v_mfma_f32_16x16x32_bf16 v[180:183], v[44:47], v[52:55], v[180:183]
    v_add_u32 v19, s28, v19
    v_mfma_f32_16x16x32_bf16 v[184:187], v[44:47], v[56:59], v[184:187]
    v_add_u32 v20, s28, v20
    v_mfma_f32_16x16x32_bf16 v[188:191], v[44:47], v[60:63], v[188:191]
    v_add_u32 v21, s28, v21
    s_waitcnt vmcnt(6) lgkmcnt(0)
    s_barrier
    v_mfma_f32_16x16x32_bf16 v[128:131], v[80:83], v[96:99], v[128:131]
    ds_read_b64_tr_b16 v[48:49], v18 offset:16384
    v_mfma_f32_16x16x32_bf16 v[132:135], v[80:83], v[100:103], v[132:135]
    ds_read_b64_tr_b16 v[50:51], v18 offset:18432
    v_mfma_f32_16x16x32_bf16 v[136:139], v[80:83], v[104:107], v[136:139]
    ds_read_b64_tr_b16 v[52:53], v19 offset:16384
    v_mfma_f32_16x16x32_bf16 v[140:143], v[80:83], v[108:111], v[140:143]
    v_mfma_f32_16x16x32_bf16 v[144:147], v[84:87], v[96:99], v[144:147]
    ds_read_b64_tr_b16 v[54:55], v19 offset:18432
    v_mfma_f32_16x16x32_bf16 v[148:151], v[84:87], v[100:103], v[148:151]
    ds_read_b64_tr_b16 v[56:57], v20 offset:16384
    v_mfma_f32_16x16x32_bf16 v[152:155], v[84:87], v[104:107], v[152:155]
    ds_read_b64_tr_b16 v[58:59], v20 offset:18432
    v_mfma_f32_16x16x32_bf16 v[156:159], v[84:87], v[108:111], v[156:159]
    v_mfma_f32_16x16x32_bf16 v[160:163], v[88:91], v[96:99], v[160:163]
    ds_read_b64_tr_b16 v[60:61], v21 offset:16384
    v_mfma_f32_16x16x32_bf16 v[164:167], v[88:91], v[100:103], v[164:167]
    ds_read_b64_tr_b16 v[62:63], v21 offset:18432
    v_mfma_f32_16x16x32_bf16 v[168:171], v[88:91], v[104:107], v[168:171]
    ds_read_b128 v[32:35], v16 offset:0
    v_mfma_f32_16x16x32_bf16 v[172:175], v[88:91], v[108:111], v[172:175]
    v_mfma_f32_16x16x32_bf16 v[176:179], v[92:95], v[96:99], v[176:179]
    ds_read_b128 v[36:39], v16 offset:2048
    v_mfma_f32_16x16x32_bf16 v[180:183], v[92:95], v[100:103], v[180:183]
    ds_read_b128 v[40:43], v16 offset:4096
    v_mfma_f32_16x16x32_bf16 v[184:187], v[92:95], v[104:107], v[184:187]
    ds_read_b128 v[44:47], v16 offset:6144
    v_mfma_f32_16x16x32_bf16 v[188:191], v[92:95], v[108:111], v[188:191]
    s_waitcnt lgkmcnt(0)
    v_mfma_f32_16x16x32_bf16 v[128:131], v[32:35], v[48:51], v[128:131]
    ds_read_b64_tr_b16 v[96:97], v18 offset:32768
    ds_read_b64_tr_b16 v[98:99], v18 offset:34816
    v_mfma_f32_16x16x32_bf16 v[132:135], v[32:35], v[52:55], v[132:135]
    ds_read_b64_tr_b16 v[100:101], v19 offset:32768
    v_mfma_f32_16x16x32_bf16 v[136:139], v[32:35], v[56:59], v[136:139]
    ds_read_b64_tr_b16 v[102:103], v19 offset:34816
    v_mfma_f32_16x16x32_bf16 v[140:143], v[32:35], v[60:63], v[140:143]
    ds_read_b64_tr_b16 v[104:105], v20 offset:32768
    v_mfma_f32_16x16x32_bf16 v[144:147], v[36:39], v[48:51], v[144:147]
    ds_read_b64_tr_b16 v[106:107], v20 offset:34816
    v_mfma_f32_16x16x32_bf16 v[148:151], v[36:39], v[52:55], v[148:151]
    ds_read_b64_tr_b16 v[108:109], v21 offset:32768
    ds_read_b64_tr_b16 v[110:111], v21 offset:34816
    v_mfma_f32_16x16x32_bf16 v[152:155], v[36:39], v[56:59], v[152:155]
    ds_read_b128 v[80:83], v17 offset:0
    v_mfma_f32_16x16x32_bf16 v[156:159], v[36:39], v[60:63], v[156:159]
    ds_read_b128 v[84:87], v17 offset:2048
    v_mfma_f32_16x16x32_bf16 v[160:163], v[40:43], v[48:51], v[160:163]
    ds_read_b128 v[88:91], v17 offset:4096
    v_mfma_f32_16x16x32_bf16 v[164:167], v[40:43], v[52:55], v[164:167]
    ds_read_b128 v[92:95], v17 offset:6144
    v_mfma_f32_16x16x32_bf16 v[168:171], v[40:43], v[56:59], v[168:171]
    s_add_u32 s27, s27, 1
    s_cmp_eq_u32 s27, 3
    s_cselect_b32 s28, -98304, s29
    s_cselect_b32 s27, 0, s27
    v_add_u32 v16, s28, v16
    v_mfma_f32_16x16x32_bf16 v[172:175], v[40:43], v[60:63], v[172:175]
    v_add_u32 v17, s28, v17
    v_mfma_f32_16x16x32_bf16 v[176:179], v[44:47], v[48:51], v[176:179]
    v_add_u32 v18, s28, v18
    v_mfma_f32_16x16x32_bf16 v[180:183], v[44:47], v[52:55], v[180:183]
    v_add_u32 v19, s28, v19
    v_mfma_f32_16x16x32_bf16 v[184:187], v[44:47], v[56:59], v[184:187]
    v_add_u32 v20, s28, v20
    v_mfma_f32_16x16x32_bf16 v[188:191], v[44:47], v[60:63], v[188:191]
    v_add_u32 v21, s28, v21
    s_waitcnt vmcnt(0) lgkmcnt(0)
    s_barrier
    v_mfma_f32_16x16x32_bf16 v[128:131], v[80:83], v[96:99], v[128:131]
    ds_read_b64_tr_b16 v[48:49], v18 offset:16384
    v_mfma_f32_16x16x32_bf16 v[132:135], v[80:83], v[100:103], v[132:135]
    ds_read_b64_tr_b16 v[50:51], v18 offset:18432
    v_mfma_f32_16x16x32_bf16 v[136:139], v[80:83], v[104:107], v[136:139]
    ds_read_b64_tr_b16 v[52:53], v19 offset:16384
    v_mfma_f32_16x16x32_bf16 v[140:143], v[80:83], v[108:111], v[140:143]
    v_mfma_f32_16x16x32_bf16 v[144:147], v[84:87], v[96:99], v[144:147]
    ds_read_b64_tr_b16 v[54:55], v19 offset:18432
    v_mfma_f32_16x16x32_bf16 v[148:151], v[84:87], v[100:103], v[148:151]
    ds_read_b64_tr_b16 v[56:57], v20 offset:16384
    v_mfma_f32_16x16x32_bf16 v[152:155], v[84:87], v[104:107], v[152:155]
    ds_read_b64_tr_b16 v[58:59], v20 offset:18432
    v_mfma_f32_16x16x32_bf16 v[156:159], v[84:87], v[108:111], v[156:159]
    v_mfma_f32_16x16x32_bf16 v[160:163], v[88:91], v[96:99], v[160:163]
    ds_read_b64_tr_b16 v[60:61], v21 offset:16384
    v_mfma_f32_16x16x32_bf16 v[164:167], v[88:91], v[100:103], v[164:167]
    ds_read_b64_tr_b16 v[62:63], v21 offset:18432
    v_mfma_f32_16x16x32_bf16 v[168:171], v[88:91], v[104:107], v[168:171]
    ds_read_b128 v[32:35], v16 offset:0
    v_mfma_f32_16x16x32_bf16 v[172:175], v[88:91], v[108:111], v[172:175]
    v_mfma_f32_16x16x32_bf16 v[176:179], v[92:95], v[96:99], v[176:179]
    ds_read_b128 v[36:39], v16 offset:2048
    v_mfma_f32_16x16x32_bf16 v[180:183], v[92:95], v[100:103], v[180:183]
    ds_read_b128 v[40:43], v16 offset:4096
    v_mfma_f32_16x16x32_bf16 v[184:187], v[92:95], v[104:107], v[184:187]
    ds_read_b128 v[44:47], v16 offset:6144
    v_mfma_f32_16x16x32_bf16 v[188:191], v[92:95], v[108:111], v[188:191]
    s_waitcnt lgkmcnt(0)
    v_mfma_f32_16x16x32_bf16 v[128:131], v[32:35], v[48:51], v[128:131]
    ds_read_b64_tr_b16 v[96:97], v18 offset:32768
    ds_read_b64_tr_b16 v[98:99], v18 offset:34816
    v_mfma_f32_16x16x32_bf16 v[132:135], v[32:35], v[52:55], v[132:135]
    ds_read_b64_tr_b16 v[100:101], v19 offset:32768
    v_mfma_f32_16x16x32_bf16 v[136:139], v[32:35], v[56:59], v[136:139]
    ds_read_b64_tr_b16 v[102:103], v19 offset:34816
    v_mfma_f32_16x16x32_bf16 v[140:143], v[32:35], v[60:63], v[140:143]
    ds_read_b64_tr_b16 v[104:105], v20 offset:32768
    v_mfma_f32_16x16x32_bf16 v[144:147], v[36:39], v[48:51], v[144:147]
    ds_read_b64_tr_b16 v[106:107], v20 offset:34816
    v_mfma_f32_16x16x32_bf16 v[148:151], v[36:39], v[52:55], v[148:151]
    ds_read_b64_tr_b16 v[108:109], v21 offset:32768
    ds_read_b64_tr_b16 v[110:111], v21 offset:34816
    v_mfma_f32_16x16x32_bf16 v[152:155], v[36:39], v[56:59], v[152:155]
    ds_read_b128 v[80:83], v17 offset:0
    v_mfma_f32_16x16x32_bf16 v[156:159], v[36:39], v[60:63], v[156:159]
    ds_read_b128 v[84:87], v17 offset:2048
    v_mfma_f32_16x16x32_bf16 v[160:163], v[40:43], v[48:51], v[160:163]
    ds_read_b128 v[88:91], v17 offset:4096
    v_mfma_f32_16x16x32_bf16 v[164:167], v[40:43], v[52:55], v[164:167]
    ds_read_b128 v[92:95], v17 offset:6144
    v_mfma_f32_16x16x32_bf16 v[168:171], v[40:43], v[56:59], v[168:171]
    s_add_u32 s27, s27, 1
    s_cmp_eq_u32 s27, 3
    s_cselect_b32 s28, -98304, s29
    s_cselect_b32 s27, 0, s27
    v_add_u32 v16, s28, v16
    v_mfma_f32_16x16x32_bf16 v[172:175], v[40:43], v[60:63], v[172:175]
    v_add_u32 v17, s28, v17
    v_mfma_f32_16x16x32_bf16 v[176:179], v[44:47], v[48:51], v[176:179]
    v_add_u32 v18, s28, v18
    v_mfma_f32_16x16x32_bf16 v[180:183], v[44:47], v[52:55], v[180:183]
    v_add_u32 v19, s28, v19
    v_mfma_f32_16x16x32_bf16 v[184:187], v[44:47], v[56:59], v[184:187]
    v_add_u32 v20, s28, v20
    v_mfma_f32_16x16x32_bf16 v[188:191], v[44:47], v[60:63], v[188:191]
    v_add_u32 v21, s28, v21
    s_waitcnt lgkmcnt(0)
    v_mfma_f32_16x16x32_bf16 v[128:131], v[80:83], v[96:99], v[128:131]
    v_mfma_f32_16x16x32_bf16 v[132:135], v[80:83], v[100:103], v[132:135]
    v_mfma_f32_16x16x32_bf16 v[136:139], v[80:83], v[104:107], v[136:139]
    v_mfma_f32_16x16x32_bf16 v[140:143], v[80:83], v[108:111], v[140:143]
    v_mfma_f32_16x16x32_bf16 v[144:147], v[84:87], v[96:99], v[144:147]
    v_mfma_f32_16x16x32_bf16 v[148:151], v[84:87], v[100:103], v[148:151]
    v_mfma_f32_16x16x32_bf16 v[152:155], v[84:87], v[104:107], v[152:155]
    v_mfma_f32_16x16x32_bf16 v[156:159], v[84:87], v[108:111], v[156:159]
    v_mfma_f32_16x16x32_bf16 v[160:163], v[88:91], v[96:99], v[160:163]
    v_mfma_f32_16x16x32_bf16 v[164:167], v[88:91], v[100:103], v[164:167]
    v_mfma_f32_16x16x32_bf16 v[168:171], v[88:91], v[104:107], v[168:171]
    v_mfma_f32_16x16x32_bf16 v[172:175], v[88:91], v[108:111], v[172:175]
    v_mfma_f32_16x16x32_bf16 v[176:179], v[92:95], v[96:99], v[176:179]
    v_mfma_f32_16x16x32_bf16 v[180:183], v[92:95], v[100:103], v[180:183]
    v_mfma_f32_16x16x32_bf16 v[184:187], v[92:95], v[104:107], v[184:187]
    v_mfma_f32_16x16x32_bf16 v[188:191], v[92:95], v[108:111], v[188:191]
    s_nop 7
LE_V1:
    v_mov_b32 v3, 163584
    s_cmp_lg_u32 s26, 0
    s_cbranch_scc1 tt_151
    s_waitcnt vmcnt(0)
    s_mov_b64 exec, 1
    ds_write_b32 v3, v28
    s_waitcnt lgkmcnt(0)
    s_mov_b64 exec, -1
tt_151:
    s_barrier
    ds_read_b32 v5, v3
    s_waitcnt lgkmcnt(0)
    v_readfirstlane_b32 s25, v5
    s_nop 3
    s_min_u32 s3, s25, 204
    s_lshl_b32 s3, s3, 2
    s_load_dword s7, s[50:51], s3
    s_waitcnt lgkmcnt(0)
E_V1:
    s_cmp_lg_u32 s79, -1
    s_cbranch_scc1 hp_152
    s_branch hc_154
ht_153:
    s_sub_u32 s30, s30, 1
    s_cbranch_scc1 L_end
    v_mov_b32 v30, 128
    buffer_load_dword v31, v30, s[20:23], 0 offen sc1
hc_154:
    s_waitcnt vmcnt(0)
    v_readfirstlane_b32 s3, v31
    s_nop 3
    s_and_b32 s40, s3, 0xffff
    s_cmp_lt_u32 s40, 128
    s_cbranch_scc1 ht_153
    s_add_u32 s3, s3, 4128768
    s_lshr_b32 s3, s3, 10
    s_and_b32 s79, s3, 8192
hp_152:
    v_lshlrev_b32 v7, 4, v2
    s_lshr_b32 s38, s42, 5
    s_mul_i32 s39, s45, 2
    s_add_u32 s38, s38, s39
    s_lshl_b32 s38, s38, 6
    s_lshr_b32 s39, s41, 5
    s_add_u32 s38, s38, s39
    s_mul_i32 s39, s44, 2
    s_add_u32 s38, s38, s39
    s_mov_b32 s39, s38
    s_lshl_b32 s38, s38, 13
    s_add_u32 s38, s38, 134219776
    s_bfe_u32 s3, s39, 0x10008
    s_lshl_b32 s3, s3, 13
    s_xor_b32 s3, s3, s79
    s_xor_b32 s3, s3, 8192
    s_add_u32 s38, s38, s3
    s_add_u32 s39, s38, 0
    v_cvt_pk_bf16_f32 v32, v128, v129
    v_cvt_pk_bf16_f32 v33, v144, v145
    v_cvt_pk_bf16_f32 v34, v130, v131
    v_cvt_pk_bf16_f32 v35, v146, v147
    buffer_store_dwordx4 v[32:35], v7, s[8:11], s39 offen offset:0 sc1
    v_cvt_pk_bf16_f32 v36, v132, v133
    v_cvt_pk_bf16_f32 v37, v148, v149
    v_cvt_pk_bf16_f32 v38, v134, v135
    v_cvt_pk_bf16_f32 v39, v150, v151
    buffer_store_dwordx4 v[36:39], v7, s[8:11], s39 offen offset:1024 sc1
    s_add_u32 s39, s38, 4096
    v_cvt_pk_bf16_f32 v40, v160, v161
    v_cvt_pk_bf16_f32 v41, v176, v177
    v_cvt_pk_bf16_f32 v42, v162, v163
    v_cvt_pk_bf16_f32 v43, v178, v179
    buffer_store_dwordx4 v[40:43], v7, s[8:11], s39 offen offset:0 sc1
    v_cvt_pk_bf16_f32 v44, v164, v165
    v_cvt_pk_bf16_f32 v45, v180, v181
    v_cvt_pk_bf16_f32 v46, v166, v167
    v_cvt_pk_bf16_f32 v47, v182, v183
    buffer_store_dwordx4 v[44:47], v7, s[8:11], s39 offen offset:1024 sc1
    s_add_u32 s39, s38, 524288
    v_cvt_pk_bf16_f32 v48, v136, v137
    v_cvt_pk_bf16_f32 v49, v152, v153
    v_cvt_pk_bf16_f32 v50, v138, v139
    v_cvt_pk_bf16_f32 v51, v154, v155
    buffer_store_dwordx4 v[48:51], v7, s[8:11], s39 offen offset:0 sc1
    v_cvt_pk_bf16_f32 v52, v140, v141
    v_cvt_pk_bf16_f32 v53, v156, v157
    v_cvt_pk_bf16_f32 v54, v142, v143
    v_cvt_pk_bf16_f32 v55, v158, v159
    buffer_store_dwordx4 v[52:55], v7, s[8:11], s39 offen offset:1024 sc1
    s_add_u32 s39, s38, 528384
    v_cvt_pk_bf16_f32 v56, v168, v169
    v_cvt_pk_bf16_f32 v57, v184, v185
    v_cvt_pk_bf16_f32 v58, v170, v171
    v_cvt_pk_bf16_f32 v59, v186, v187
    buffer_store_dwordx4 v[56:59], v7, s[8:11], s39 offen offset:0 sc1
    v_cvt_pk_bf16_f32 v60, v172, v173
    v_cvt_pk_bf16_f32 v61, v188, v189
    v_cvt_pk_bf16_f32 v62, v174, v175
    v_cvt_pk_bf16_f32 v63, v190, v191
    buffer_store_dwordx4 v[60:63], v7, s[8:11], s39 offen offset:1024 sc1
    s_waitcnt vmcnt(0)
    s_lshr_b32 s37, s49, 24
    v_lshlrev_b32 v26, 6, v2
    s_cmp_ge_u32 s37, 128
    s_cbranch_scc1 to_155
    s_add_u32 s38, s37, 0
    s_lshl_b32 s38, s38, 2
    s_add_u32 s38, s38, s43
    s_lshl_b32 s38, s38, 3
    s_add_u32 s38, s38, s26
    s_lshl_b32 s38, s38, 12
    s_mov_b64 s[60:61], s[82:83]
    s_mov_b32 s39, 0
    s_cmp_ge_u32 s38, 4194304
    s_cselect_b64 s[60:61], s[92:93], s[60:61]
    s_cselect_b32 s39, 4194304, s39
    s_cmp_ge_u32 s38, 8388608
    s_cselect_b64 s[60:61], s[94:95], s[60:61]
    s_cselect_b32 s39, 8388608, s39
    s_cmp_ge_u32 s38, 14680064
    s_cselect_b64 s[60:61], s[96:97], s[60:61]
    s_cselect_b32 s39, 14680064, s39
    s_sub_u32 s38, s38, s39
    s_and_b32 s61, s61, 0xffff
    s_add_u32 s62, s38, 4096
    s_mov_b32 s63, 0x20000
    buffer_load_dword v1, v26, s[60:63], s38 offen
    s_cmp_ge_u32 s37, 127
    s_cbranch_scc1 to_155
    s_add_u32 s38, s37, 1
    s_lshl_b32 s38, s38, 2
    s_add_u32 s38, s38, s43
    s_lshl_b32 s38, s38, 3
    s_add_u32 s38, s38, s26
    s_lshl_b32 s38, s38, 12
    s_mov_b64 s[60:61], s[82:83]
    s_mov_b32 s39, 0
    s_cmp_ge_u32 s38, 4194304
    s_cselect_b64 s[60:61], s[92:93], s[60:61]
    s_cselect_b32 s39, 4194304, s39
    s_cmp_ge_u32 s38, 8388608
    s_cselect_b64 s[60:61], s[94:95], s[60:61]
    s_cselect_b32 s39, 8388608, s39
    s_cmp_ge_u32 s38, 14680064
    s_cselect_b64 s[60:61], s[96:97], s[60:61]
    s_cselect_b32 s39, 14680064, s39
    s_sub_u32 s38, s38, s39
    s_and_b32 s61, s61, 0xffff
    s_add_u32 s62, s38, 4096
    s_mov_b32 s63, 0x20000
    buffer_load_dword v1, v26, s[60:63], s38 offen
to_155:
    s_lshr_b32 s40, s41, 8
    s_lshl_b32 s40, s40, 2
    s_add_u32 s40, s40, s43
    s_lshl_b32 s40, s40, 7
    s_add_u32 s40, s40, 79720448
    s_waitcnt vmcnt(2)
    s_barrier
    s_cmp_lg_u32 s26, 1
    s_cbranch_scc1 sg_156
    v_mov_b32 v4, s40
    v_mov_b32 v5, 2
    s_mov_b64 exec, 1
    buffer_atomic_add v5, v4, s[8:11], 0 offen sc1
    s_mov_b64 exec, -1
sg_156:
    s_cmp_eq_u32 s6, 0
    s_cbranch_scc1 D_pre
    s_mov_b32 s6, 0
    s_branch D_main
LP_K:
    s_mov_b32 s34, 13
    s_mov_b32 s27, 0
    s_waitcnt vmcnt(8)
    s_barrier
    ds_read_b64_tr_b16 v[64:65], v18 offset:32768
    ds_read_b64_tr_b16 v[66:67], v18 offset:34816
    ds_read_b64_tr_b16 v[68:69], v19 offset:32768
    ds_read_b64_tr_b16 v[70:71], v19 offset:34816
    ds_read_b64_tr_b16 v[72:73], v20 offset:32768
    ds_read_b64_tr_b16 v[74:75], v20 offset:34816
    ds_read_b64_tr_b16 v[76:77], v21 offset:32768
    ds_read_b64_tr_b16 v[78:79], v21 offset:34816
    ds_read_b128 v[32:35], v16 offset:0
    ds_read_b128 v[36:39], v16 offset:2048
    ds_read_b128 v[40:43], v16 offset:4096
    ds_read_b128 v[44:47], v16 offset:6144
    ds_read_b128 v[48:51], v16 offset:8192
    ds_read_b128 v[52:55], v16 offset:10240
    ds_read_b128 v[56:59], v16 offset:12288
    ds_read_b128 v[60:63], v16 offset:14336
    s_waitcnt lgkmcnt(0)
    v_mfma_f32_16x16x32_bf16 v[128:131], v[64:67], v[32:35], 0
    ds_read_b64_tr_b16 v[112:113], v18 offset:49152
    v_mfma_f32_16x16x32_bf16 v[132:135], v[68:71], v[32:35], 0
    ds_read_b64_tr_b16 v[114:115], v18 offset:51200
    v_mfma_f32_16x16x32_bf16 v[136:139], v[72:75], v[32:35], 0
    ds_read_b64_tr_b16 v[116:117], v19 offset:49152
    v_mfma_f32_16x16x32_bf16 v[140:143], v[76:79], v[32:35], 0
    ds_read_b64_tr_b16 v[118:119], v19 offset:51200
    v_mfma_f32_16x16x32_bf16 v[144:147], v[64:67], v[36:39], 0
    ds_read_b64_tr_b16 v[120:121], v20 offset:49152
    v_mfma_f32_16x16x32_bf16 v[148:151], v[68:71], v[36:39], 0
    ds_read_b64_tr_b16 v[122:123], v20 offset:51200
    v_mfma_f32_16x16x32_bf16 v[152:155], v[72:75], v[36:39], 0
    ds_read_b64_tr_b16 v[124:125], v21 offset:49152
    v_mfma_f32_16x16x32_bf16 v[156:159], v[76:79], v[36:39], 0
    ds_read_b64_tr_b16 v[126:127], v21 offset:51200
    v_mfma_f32_16x16x32_bf16 v[160:163], v[64:67], v[40:43], 0
    ds_read_b128 v[80:83], v17 offset:0
    v_mfma_f32_16x16x32_bf16 v[164:167], v[68:71], v[40:43], 0
    ds_read_b128 v[84:87], v17 offset:2048
    v_mfma_f32_16x16x32_bf16 v[168:171], v[72:75], v[40:43], 0
    ds_read_b128 v[88:91], v17 offset:4096
    v_mfma_f32_16x16x32_bf16 v[172:175], v[76:79], v[40:43], 0
    ds_read_b128 v[92:95], v17 offset:6144
    v_mfma_f32_16x16x32_bf16 v[176:179], v[64:67], v[44:47], 0
    ds_read_b128 v[96:99], v17 offset:8192
    v_mfma_f32_16x16x32_bf16 v[180:183], v[68:71], v[44:47], 0
    ds_read_b128 v[100:103], v17 offset:10240
    v_mfma_f32_16x16x32_bf16 v[184:187], v[72:75], v[44:47], 0
    ds_read_b128 v[104:107], v17 offset:12288
    v_mfma_f32_16x16x32_bf16 v[188:191], v[76:79], v[44:47], 0
    ds_read_b128 v[108:111], v17 offset:14336
    v_mfma_f32_16x16x32_bf16 v[192:195], v[64:67], v[48:51], 0
    v_xor_b32 v16, 65536, v16
    v_mfma_f32_16x16x32_bf16 v[196:199], v[68:71], v[48:51], 0
    v_xor_b32 v17, 65536, v17
    v_mfma_f32_16x16x32_bf16 v[200:203], v[72:75], v[48:51], 0
    v_xor_b32 v18, 65536, v18
    v_mfma_f32_16x16x32_bf16 v[204:207], v[76:79], v[48:51], 0
    v_xor_b32 v19, 65536, v19
    v_mfma_f32_16x16x32_bf16 v[208:211], v[64:67], v[52:55], 0
    v_xor_b32 v20, 65536, v20
    v_mfma_f32_16x16x32_bf16 v[212:215], v[68:71], v[52:55], 0
    v_xor_b32 v21, 65536, v21
    v_mfma_f32_16x16x32_bf16 v[216:219], v[72:75], v[52:55], 0
    v_mfma_f32_16x16x32_bf16 v[220:223], v[76:79], v[52:55], 0
    v_mfma_f32_16x16x32_bf16 v[224:227], v[64:67], v[56:59], 0
    v_mfma_f32_16x16x32_bf16 v[228:231], v[68:71], v[56:59], 0
    v_mfma_f32_16x16x32_bf16 v[232:235], v[72:75], v[56:59], 0
    v_mfma_f32_16x16x32_bf16 v[236:239], v[76:79], v[56:59], 0
    v_mfma_f32_16x16x32_bf16 v[240:243], v[64:67], v[60:63], 0
    v_mfma_f32_16x16x32_bf16 v[244:247], v[68:71], v[60:63], 0
    v_mfma_f32_16x16x32_bf16 v[248:251], v[72:75], v[60:63], 0
    v_mfma_f32_16x16x32_bf16 v[252:255], v[76:79], v[60:63], 0
    s_waitcnt vmcnt(0) lgkmcnt(0)
    s_barrier
    v_mfma_f32_16x16x32_bf16 v[128:131], v[112:115], v[80:83], v[128:131]
    s_mov_b32 m0, s35
    s_xor_b32 s35, s35, 65536
    v_mfma_f32_16x16x32_bf16 v[132:135], v[116:119], v[80:83], v[132:135]
    ds_read_b64_tr_b16 v[64:65], v18 offset:32768
    v_mfma_f32_16x16x32_bf16 v[136:139], v[120:123], v[80:83], v[136:139]
    buffer_load_dwordx4 v8, s[12:15], s31 offen offset:0  lds
    v_mfma_f32_16x16x32_bf16 v[140:143], v[124:127], v[80:83], v[140:143]
    ds_read_b64_tr_b16 v[66:67], v18 offset:34816
    v_mfma_f32_16x16x32_bf16 v[144:147], v[112:115], v[84:87], v[144:147]
    buffer_load_dwordx4 v9, s[12:15], s31 offen offset:1024  lds
    v_mfma_f32_16x16x32_bf16 v[148:151], v[116:119], v[84:87], v[148:151]
    ds_read_b64_tr_b16 v[68:69], v19 offset:32768
    v_mfma_f32_16x16x32_bf16 v[152:155], v[120:123], v[84:87], v[152:155]
    buffer_load_dwordx4 v10, s[12:15], s31 offen offset:2048  lds
    v_mfma_f32_16x16x32_bf16 v[156:159], v[124:127], v[84:87], v[156:159]
    ds_read_b64_tr_b16 v[70:71], v19 offset:34816
    v_mfma_f32_16x16x32_bf16 v[160:163], v[112:115], v[88:91], v[160:163]
    buffer_load_dwordx4 v11, s[12:15], s31 offen offset:3072  lds
    v_mfma_f32_16x16x32_bf16 v[164:167], v[116:119], v[88:91], v[164:167]
    ds_read_b64_tr_b16 v[72:73], v20 offset:32768
    v_mfma_f32_16x16x32_bf16 v[168:171], v[120:123], v[88:91], v[168:171]
    s_mov_b32 m0, s36
    s_add_u32 s31, s31, 128
    s_xor_b32 s36, s36, 65536
    v_mfma_f32_16x16x32_bf16 v[172:175], v[124:127], v[88:91], v[172:175]
    ds_read_b64_tr_b16 v[74:75], v20 offset:34816
    v_mfma_f32_16x16x32_bf16 v[176:179], v[112:115], v[92:95], v[176:179]
    buffer_load_dwordx4 v12, s[16:19], s32 offen offset:0  lds
    v_mfma_f32_16x16x32_bf16 v[180:183], v[116:119], v[92:95], v[180:183]
    ds_read_b64_tr_b16 v[76:77], v21 offset:32768
    v_mfma_f32_16x16x32_bf16 v[184:187], v[120:123], v[92:95], v[184:187]
    buffer_load_dwordx4 v13, s[16:19], s32 offen offset:1024  lds
    v_mfma_f32_16x16x32_bf16 v[188:191], v[124:127], v[92:95], v[188:191]
    ds_read_b64_tr_b16 v[78:79], v21 offset:34816
    v_mfma_f32_16x16x32_bf16 v[192:195], v[112:115], v[96:99], v[192:195]
    buffer_load_dwordx4 v14, s[16:19], s32 offen offset:2048  lds
    v_mfma_f32_16x16x32_bf16 v[196:199], v[116:119], v[96:99], v[196:199]
    ds_read_b128 v[32:35], v16 offset:0
    v_mfma_f32_16x16x32_bf16 v[200:203], v[120:123], v[96:99], v[200:203]
    buffer_load_dwordx4 v15, s[16:19], s32 offen offset:3072  lds
    v_mfma_f32_16x16x32_bf16 v[204:207], v[124:127], v[96:99], v[204:207]
    ds_read_b128 v[36:39], v16 offset:2048
    v_mfma_f32_16x16x32_bf16 v[208:211], v[112:115], v[100:103], v[208:211]
    s_add_u32 s32, s32, s33
    v_mfma_f32_16x16x32_bf16 v[212:215], v[116:119], v[100:103], v[212:215]
    ds_read_b128 v[40:43], v16 offset:4096
    v_mfma_f32_16x16x32_bf16 v[216:219], v[120:123], v[100:103], v[216:219]
    ds_read_b128 v[44:47], v16 offset:6144
    v_mfma_f32_16x16x32_bf16 v[220:223], v[124:127], v[100:103], v[220:223]
    ds_read_b128 v[48:51], v16 offset:8192
    v_mfma_f32_16x16x32_bf16 v[224:227], v[112:115], v[104:107], v[224:227]
    ds_read_b128 v[52:55], v16 offset:10240
    v_mfma_f32_16x16x32_bf16 v[228:231], v[116:119], v[104:107], v[228:231]
    ds_read_b128 v[56:59], v16 offset:12288
    v_mfma_f32_16x16x32_bf16 v[232:235], v[120:123], v[104:107], v[232:235]
    ds_read_b128 v[60:63], v16 offset:14336
    v_mfma_f32_16x16x32_bf16 v[236:239], v[124:127], v[104:107], v[236:239]
    v_mfma_f32_16x16x32_bf16 v[240:243], v[112:115], v[108:111], v[240:243]
    v_mfma_f32_16x16x32_bf16 v[244:247], v[116:119], v[108:111], v[244:247]
    v_mfma_f32_16x16x32_bf16 v[248:251], v[120:123], v[108:111], v[248:251]
    v_mfma_f32_16x16x32_bf16 v[252:255], v[124:127], v[108:111], v[252:255]
gl_157:
    s_waitcnt lgkmcnt(0)
    v_mfma_f32_16x16x32_bf16 v[128:131], v[64:67], v[32:35], v[128:131]
    ds_read_b64_tr_b16 v[112:113], v18 offset:49152
    v_mfma_f32_16x16x32_bf16 v[132:135], v[68:71], v[32:35], v[132:135]
    ds_read_b64_tr_b16 v[114:115], v18 offset:51200
    v_mfma_f32_16x16x32_bf16 v[136:139], v[72:75], v[32:35], v[136:139]
    ds_read_b64_tr_b16 v[116:117], v19 offset:49152
    v_mfma_f32_16x16x32_bf16 v[140:143], v[76:79], v[32:35], v[140:143]
    ds_read_b64_tr_b16 v[118:119], v19 offset:51200
    v_mfma_f32_16x16x32_bf16 v[144:147], v[64:67], v[36:39], v[144:147]
    ds_read_b64_tr_b16 v[120:121], v20 offset:49152
    v_mfma_f32_16x16x32_bf16 v[148:151], v[68:71], v[36:39], v[148:151]
    ds_read_b64_tr_b16 v[122:123], v20 offset:51200
    v_mfma_f32_16x16x32_bf16 v[152:155], v[72:75], v[36:39], v[152:155]
    ds_read_b64_tr_b16 v[124:125], v21 offset:49152
    v_mfma_f32_16x16x32_bf16 v[156:159], v[76:79], v[36:39], v[156:159]
    ds_read_b64_tr_b16 v[126:127], v21 offset:51200
    v_mfma_f32_16x16x32_bf16 v[160:163], v[64:67], v[40:43], v[160:163]
    ds_read_b128 v[80:83], v17 offset:0
    v_mfma_f32_16x16x32_bf16 v[164:167], v[68:71], v[40:43], v[164:167]
    ds_read_b128 v[84:87], v17 offset:2048
    v_mfma_f32_16x16x32_bf16 v[168:171], v[72:75], v[40:43], v[168:171]
    ds_read_b128 v[88:91], v17 offset:4096
    v_mfma_f32_16x16x32_bf16 v[172:175], v[76:79], v[40:43], v[172:175]
    ds_read_b128 v[92:95], v17 offset:6144
    v_mfma_f32_16x16x32_bf16 v[176:179], v[64:67], v[44:47], v[176:179]
    ds_read_b128 v[96:99], v17 offset:8192
    v_mfma_f32_16x16x32_bf16 v[180:183], v[68:71], v[44:47], v[180:183]
    ds_read_b128 v[100:103], v17 offset:10240
    v_mfma_f32_16x16x32_bf16 v[184:187], v[72:75], v[44:47], v[184:187]
    ds_read_b128 v[104:107], v17 offset:12288
    v_mfma_f32_16x16x32_bf16 v[188:191], v[76:79], v[44:47], v[188:191]
    ds_read_b128 v[108:111], v17 offset:14336
    v_mfma_f32_16x16x32_bf16 v[192:195], v[64:67], v[48:51], v[192:195]
    v_xor_b32 v16, 65536, v16
    v_mfma_f32_16x16x32_bf16 v[196:199], v[68:71], v[48:51], v[196:199]
    v_xor_b32 v17, 65536, v17
    v_mfma_f32_16x16x32_bf16 v[200:203], v[72:75], v[48:51], v[200:203]
    v_xor_b32 v18, 65536, v18
    v_mfma_f32_16x16x32_bf16 v[204:207], v[76:79], v[48:51], v[204:207]
    v_xor_b32 v19, 65536, v19
    v_mfma_f32_16x16x32_bf16 v[208:211], v[64:67], v[52:55], v[208:211]
    v_xor_b32 v20, 65536, v20
    v_mfma_f32_16x16x32_bf16 v[212:215], v[68:71], v[52:55], v[212:215]
    v_xor_b32 v21, 65536, v21
    v_mfma_f32_16x16x32_bf16 v[216:219], v[72:75], v[52:55], v[216:219]
    v_mfma_f32_16x16x32_bf16 v[220:223], v[76:79], v[52:55], v[220:223]
    v_mfma_f32_16x16x32_bf16 v[224:227], v[64:67], v[56:59], v[224:227]
    v_mfma_f32_16x16x32_bf16 v[228:231], v[68:71], v[56:59], v[228:231]
    v_mfma_f32_16x16x32_bf16 v[232:235], v[72:75], v[56:59], v[232:235]
    v_mfma_f32_16x16x32_bf16 v[236:239], v[76:79], v[56:59], v[236:239]
    v_mfma_f32_16x16x32_bf16 v[240:243], v[64:67], v[60:63], v[240:243]
    v_mfma_f32_16x16x32_bf16 v[244:247], v[68:71], v[60:63], v[244:247]
    v_mfma_f32_16x16x32_bf16 v[248:251], v[72:75], v[60:63], v[248:251]
    v_mfma_f32_16x16x32_bf16 v[252:255], v[76:79], v[60:63], v[252:255]
    s_waitcnt vmcnt(0) lgkmcnt(0)
    s_barrier
    v_mfma_f32_16x16x32_bf16 v[128:131], v[112:115], v[80:83], v[128:131]
    s_mov_b32 m0, s35
    s_xor_b32 s35, s35, 65536
    v_mfma_f32_16x16x32_bf16 v[132:135], v[116:119], v[80:83], v[132:135]
    ds_read_b64_tr_b16 v[64:65], v18 offset:32768
    v_mfma_f32_16x16x32_bf16 v[136:139], v[120:123], v[80:83], v[136:139]
    buffer_load_dwordx4 v8, s[12:15], s31 offen offset:0  lds
    v_mfma_f32_16x16x32_bf16 v[140:143], v[124:127], v[80:83], v[140:143]
    ds_read_b64_tr_b16 v[66:67], v18 offset:34816
    v_mfma_f32_16x16x32_bf16 v[144:147], v[112:115], v[84:87], v[144:147]
    buffer_load_dwordx4 v9, s[12:15], s31 offen offset:1024  lds
    v_mfma_f32_16x16x32_bf16 v[148:151], v[116:119], v[84:87], v[148:151]
    ds_read_b64_tr_b16 v[68:69], v19 offset:32768
    v_mfma_f32_16x16x32_bf16 v[152:155], v[120:123], v[84:87], v[152:155]
    buffer_load_dwordx4 v10, s[12:15], s31 offen offset:2048  lds
    v_mfma_f32_16x16x32_bf16 v[156:159], v[124:127], v[84:87], v[156:159]
    ds_read_b64_tr_b16 v[70:71], v19 offset:34816
    v_mfma_f32_16x16x32_bf16 v[160:163], v[112:115], v[88:91], v[160:163]
    buffer_load_dwordx4 v11, s[12:15], s31 offen offset:3072  lds
    v_mfma_f32_16x16x32_bf16 v[164:167], v[116:119], v[88:91], v[164:167]
    ds_read_b64_tr_b16 v[72:73], v20 offset:32768
    v_mfma_f32_16x16x32_bf16 v[168:171], v[120:123], v[88:91], v[168:171]
    s_mov_b32 m0, s36
    s_add_u32 s31, s31, 128
    s_xor_b32 s36, s36, 65536
    v_mfma_f32_16x16x32_bf16 v[172:175], v[124:127], v[88:91], v[172:175]
    ds_read_b64_tr_b16 v[74:75], v20 offset:34816
    v_mfma_f32_16x16x32_bf16 v[176:179], v[112:115], v[92:95], v[176:179]
    buffer_load_dwordx4 v12, s[16:19], s32 offen offset:0  lds
    v_mfma_f32_16x16x32_bf16 v[180:183], v[116:119], v[92:95], v[180:183]
    ds_read_b64_tr_b16 v[76:77], v21 offset:32768
    v_mfma_f32_16x16x32_bf16 v[184:187], v[120:123], v[92:95], v[184:187]
    buffer_load_dwordx4 v13, s[16:19], s32 offen offset:1024  lds
    v_mfma_f32_16x16x32_bf16 v[188:191], v[124:127], v[92:95], v[188:191]
    ds_read_b64_tr_b16 v[78:79], v21 offset:34816
    v_mfma_f32_16x16x32_bf16 v[192:195], v[112:115], v[96:99], v[192:195]
    buffer_load_dwordx4 v14, s[16:19], s32 offen offset:2048  lds
    v_mfma_f32_16x16x32_bf16 v[196:199], v[116:119], v[96:99], v[196:199]
    ds_read_b128 v[32:35], v16 offset:0
    v_mfma_f32_16x16x32_bf16 v[200:203], v[120:123], v[96:99], v[200:203]
    buffer_load_dwordx4 v15, s[16:19], s32 offen offset:3072  lds
    v_mfma_f32_16x16x32_bf16 v[204:207], v[124:127], v[96:99], v[204:207]
    ds_read_b128 v[36:39], v16 offset:2048
    v_mfma_f32_16x16x32_bf16 v[208:211], v[112:115], v[100:103], v[208:211]
    s_add_u32 s32, s32, s33
    v_mfma_f32_16x16x32_bf16 v[212:215], v[116:119], v[100:103], v[212:215]
    ds_read_b128 v[40:43], v16 offset:4096
    v_mfma_f32_16x16x32_bf16 v[216:219], v[120:123], v[100:103], v[216:219]
    ds_read_b128 v[44:47], v16 offset:6144
    v_mfma_f32_16x16x32_bf16 v[220:223], v[124:127], v[100:103], v[220:223]
    ds_read_b128 v[48:51], v16 offset:8192
    v_mfma_f32_16x16x32_bf16 v[224:227], v[112:115], v[104:107], v[224:227]
    ds_read_b128 v[52:55], v16 offset:10240
    v_mfma_f32_16x16x32_bf16 v[228:231], v[116:119], v[104:107], v[228:231]
    ds_read_b128 v[56:59], v16 offset:12288
    v_mfma_f32_16x16x32_bf16 v[232:235], v[120:123], v[104:107], v[232:235]
    ds_read_b128 v[60:63], v16 offset:14336
    v_mfma_f32_16x16x32_bf16 v[236:239], v[124:127], v[104:107], v[236:239]
    v_mfma_f32_16x16x32_bf16 v[240:243], v[112:115], v[108:111], v[240:243]
    v_mfma_f32_16x16x32_bf16 v[244:247], v[116:119], v[108:111], v[244:247]
    v_mfma_f32_16x16x32_bf16 v[248:251], v[120:123], v[108:111], v[248:251]
    v_mfma_f32_16x16x32_bf16 v[252:255], v[124:127], v[108:111], v[252:255]
    s_sub_u32 s34, s34, 1
    s_cmp_lg_u32 s34, 0
    s_cbranch_scc1 gl_157
    s_cmp_lg_u32 s26, 0
    s_cbranch_scc1 ti_158
    s_lshl_b32 s3, s43, 2
    s_add_u32 s3, s3, 16
    v_mov_b32 v27, s3
    v_mov_b32 v28, 1
    s_mov_b64 exec, 1
    buffer_atomic_add v28, v27, s[20:23], 0 offen sc0 sc1
    s_mov_b64 exec, -1
ti_158:
    s_waitcnt lgkmcnt(0)
    v_mfma_f32_16x16x32_bf16 v[128:131], v[64:67], v[32:35], v[128:131]
    ds_read_b64_tr_b16 v[112:113], v18 offset:49152
    v_mfma_f32_16x16x32_bf16 v[132:135], v[68:71], v[32:35], v[132:135]
    ds_read_b64_tr_b16 v[114:115], v18 offset:51200
    v_mfma_f32_16x16x32_bf16 v[136:139], v[72:75], v[32:35], v[136:139]
    ds_read_b64_tr_b16 v[116:117], v19 offset:49152
    v_mfma_f32_16x16x32_bf16 v[140:143], v[76:79], v[32:35], v[140:143]
    ds_read_b64_tr_b16 v[118:119], v19 offset:51200
    v_mfma_f32_16x16x32_bf16 v[144:147], v[64:67], v[36:39], v[144:147]
    ds_read_b64_tr_b16 v[120:121], v20 offset:49152
    v_mfma_f32_16x16x32_bf16 v[148:151], v[68:71], v[36:39], v[148:151]
    ds_read_b64_tr_b16 v[122:123], v20 offset:51200
    v_mfma_f32_16x16x32_bf16 v[152:155], v[72:75], v[36:39], v[152:155]
    ds_read_b64_tr_b16 v[124:125], v21 offset:49152
    v_mfma_f32_16x16x32_bf16 v[156:159], v[76:79], v[36:39], v[156:159]
    ds_read_b64_tr_b16 v[126:127], v21 offset:51200
    v_mfma_f32_16x16x32_bf16 v[160:163], v[64:67], v[40:43], v[160:163]
    ds_read_b128 v[80:83], v17 offset:0
    v_mfma_f32_16x16x32_bf16 v[164:167], v[68:71], v[40:43], v[164:167]
    ds_read_b128 v[84:87], v17 offset:2048
    v_mfma_f32_16x16x32_bf16 v[168:171], v[72:75], v[40:43], v[168:171]
    ds_read_b128 v[88:91], v17 offset:4096
    v_mfma_f32_16x16x32_bf16 v[172:175], v[76:79], v[40:43], v[172:175]
    ds_read_b128 v[92:95], v17 offset:6144
    v_mfma_f32_16x16x32_bf16 v[176:179], v[64:67], v[44:47], v[176:179]
    ds_read_b128 v[96:99], v17 offset:8192
    v_mfma_f32_16x16x32_bf16 v[180:183], v[68:71], v[44:47], v[180:183]
    ds_read_b128 v[100:103], v17 offset:10240
    v_mfma_f32_16x16x32_bf16 v[184:187], v[72:75], v[44:47], v[184:187]
    ds_read_b128 v[104:107], v17 offset:12288
    v_mfma_f32_16x16x32_bf16 v[188:191], v[76:79], v[44:47], v[188:191]
    ds_read_b128 v[108:111], v17 offset:14336
    v_mfma_f32_16x16x32_bf16 v[192:195], v[64:67], v[48:51], v[192:195]
    v_xor_b32 v16, 65536, v16
    v_mfma_f32_16x16x32_bf16 v[196:199], v[68:71], v[48:51], v[196:199]
    v_xor_b32 v17, 65536, v17
    v_mfma_f32_16x16x32_bf16 v[200:203], v[72:75], v[48:51], v[200:203]
    v_xor_b32 v18, 65536, v18
    v_mfma_f32_16x16x32_bf16 v[204:207], v[76:79], v[48:51], v[204:207]
    v_xor_b32 v19, 65536, v19
    v_mfma_f32_16x16x32_bf16 v[208:211], v[64:67], v[52:55], v[208:211]
    v_xor_b32 v20, 65536, v20
    v_mfma_f32_16x16x32_bf16 v[212:215], v[68:71], v[52:55], v[212:215]
    v_xor_b32 v21, 65536, v21
    v_mfma_f32_16x16x32_bf16 v[216:219], v[72:75], v[52:55], v[216:219]
    v_mfma_f32_16x16x32_bf16 v[220:223], v[76:79], v[52:55], v[220:223]
    v_mfma_f32_16x16x32_bf16 v[224:227], v[64:67], v[56:59], v[224:227]
    v_mfma_f32_16x16x32_bf16 v[228:231], v[68:71], v[56:59], v[228:231]
    v_mfma_f32_16x16x32_bf16 v[232:235], v[72:75], v[56:59], v[232:235]
    v_mfma_f32_16x16x32_bf16 v[236:239], v[76:79], v[56:59], v[236:239]
    v_mfma_f32_16x16x32_bf16 v[240:243], v[64:67], v[60:63], v[240:243]
    v_mfma_f32_16x16x32_bf16 v[244:247], v[68:71], v[60:63], v[244:247]
    v_mfma_f32_16x16x32_bf16 v[248:251], v[72:75], v[60:63], v[248:251]
    v_mfma_f32_16x16x32_bf16 v[252:255], v[76:79], v[60:63], v[252:255]
    s_waitcnt vmcnt(0) lgkmcnt(0)
    s_barrier
    v_mfma_f32_16x16x32_bf16 v[128:131], v[112:115], v[80:83], v[128:131]
    ds_read_b64_tr_b16 v[64:65], v18 offset:32768
    v_mfma_f32_16x16x32_bf16 v[132:135], v[116:119], v[80:83], v[132:135]
    ds_read_b64_tr_b16 v[66:67], v18 offset:34816
    v_mfma_f32_16x16x32_bf16 v[136:139], v[120:123], v[80:83], v[136:139]
    ds_read_b64_tr_b16 v[68:69], v19 offset:32768
    v_mfma_f32_16x16x32_bf16 v[140:143], v[124:127], v[80:83], v[140:143]
    ds_read_b64_tr_b16 v[70:71], v19 offset:34816
    v_mfma_f32_16x16x32_bf16 v[144:147], v[112:115], v[84:87], v[144:147]
    ds_read_b64_tr_b16 v[72:73], v20 offset:32768
    v_mfma_f32_16x16x32_bf16 v[148:151], v[116:119], v[84:87], v[148:151]
    ds_read_b64_tr_b16 v[74:75], v20 offset:34816
    v_mfma_f32_16x16x32_bf16 v[152:155], v[120:123], v[84:87], v[152:155]
    ds_read_b64_tr_b16 v[76:77], v21 offset:32768
    v_mfma_f32_16x16x32_bf16 v[156:159], v[124:127], v[84:87], v[156:159]
    ds_read_b64_tr_b16 v[78:79], v21 offset:34816
    v_mfma_f32_16x16x32_bf16 v[160:163], v[112:115], v[88:91], v[160:163]
    ds_read_b128 v[32:35], v16 offset:0
    v_mfma_f32_16x16x32_bf16 v[164:167], v[116:119], v[88:91], v[164:167]
    ds_read_b128 v[36:39], v16 offset:2048
    v_mfma_f32_16x16x32_bf16 v[168:171], v[120:123], v[88:91], v[168:171]
    ds_read_b128 v[40:43], v16 offset:4096
    v_mfma_f32_16x16x32_bf16 v[172:175], v[124:127], v[88:91], v[172:175]
    ds_read_b128 v[44:47], v16 offset:6144
    v_mfma_f32_16x16x32_bf16 v[176:179], v[112:115], v[92:95], v[176:179]
    ds_read_b128 v[48:51], v16 offset:8192
    v_mfma_f32_16x16x32_bf16 v[180:183], v[116:119], v[92:95], v[180:183]
    ds_read_b128 v[52:55], v16 offset:10240
    v_mfma_f32_16x16x32_bf16 v[184:187], v[120:123], v[92:95], v[184:187]
    ds_read_b128 v[56:59], v16 offset:12288
    v_mfma_f32_16x16x32_bf16 v[188:191], v[124:127], v[92:95], v[188:191]
    ds_read_b128 v[60:63], v16 offset:14336
    v_mfma_f32_16x16x32_bf16 v[192:195], v[112:115], v[96:99], v[192:195]
    v_mfma_f32_16x16x32_bf16 v[196:199], v[116:119], v[96:99], v[196:199]
    v_mfma_f32_16x16x32_bf16 v[200:203], v[120:123], v[96:99], v[200:203]
    v_mfma_f32_16x16x32_bf16 v[204:207], v[124:127], v[96:99], v[204:207]
    v_mfma_f32_16x16x32_bf16 v[208:211], v[112:115], v[100:103], v[208:211]
    v_mfma_f32_16x16x32_bf16 v[212:215], v[116:119], v[100:103], v[212:215]
    v_mfma_f32_16x16x32_bf16 v[216:219], v[120:123], v[100:103], v[216:219]
    v_mfma_f32_16x16x32_bf16 v[220:223], v[124:127], v[100:103], v[220:223]
    v_mfma_f32_16x16x32_bf16 v[224:227], v[112:115], v[104:107], v[224:227]
    v_mfma_f32_16x16x32_bf16 v[228:231], v[116:119], v[104:107], v[228:231]
    v_mfma_f32_16x16x32_bf16 v[232:235], v[120:123], v[104:107], v[232:235]
    v_mfma_f32_16x16x32_bf16 v[236:239], v[124:127], v[104:107], v[236:239]
    v_mfma_f32_16x16x32_bf16 v[240:243], v[112:115], v[108:111], v[240:243]
    v_mfma_f32_16x16x32_bf16 v[244:247], v[116:119], v[108:111], v[244:247]
    v_mfma_f32_16x16x32_bf16 v[248:251], v[120:123], v[108:111], v[248:251]
    v_mfma_f32_16x16x32_bf16 v[252:255], v[124:127], v[108:111], v[252:255]
    s_waitcnt lgkmcnt(0)
    v_mfma_f32_16x16x32_bf16 v[128:131], v[64:67], v[32:35], v[128:131]
    ds_read_b64_tr_b16 v[112:113], v18 offset:49152
    v_mfma_f32_16x16x32_bf16 v[132:135], v[68:71], v[32:35], v[132:135]
    ds_read_b64_tr_b16 v[114:115], v18 offset:51200
    v_mfma_f32_16x16x32_bf16 v[136:139], v[72:75], v[32:35], v[136:139]
    ds_read_b64_tr_b16 v[116:117], v19 offset:49152
    v_mfma_f32_16x16x32_bf16 v[140:143], v[76:79], v[32:35], v[140:143]
    ds_read_b64_tr_b16 v[118:119], v19 offset:51200
    v_mfma_f32_16x16x32_bf16 v[144:147], v[64:67], v[36:39], v[144:147]
    ds_read_b64_tr_b16 v[120:121], v20 offset:49152
    v_mfma_f32_16x16x32_bf16 v[148:151], v[68:71], v[36:39], v[148:151]
    ds_read_b64_tr_b16 v[122:123], v20 offset:51200
    v_mfma_f32_16x16x32_bf16 v[152:155], v[72:75], v[36:39], v[152:155]
    ds_read_b64_tr_b16 v[124:125], v21 offset:49152
    v_mfma_f32_16x16x32_bf16 v[156:159], v[76:79], v[36:39], v[156:159]
    ds_read_b64_tr_b16 v[126:127], v21 offset:51200
    v_mfma_f32_16x16x32_bf16 v[160:163], v[64:67], v[40:43], v[160:163]
    ds_read_b128 v[80:83], v17 offset:0
    v_mfma_f32_16x16x32_bf16 v[164:167], v[68:71], v[40:43], v[164:167]
    ds_read_b128 v[84:87], v17 offset:2048
    v_mfma_f32_16x16x32_bf16 v[168:171], v[72:75], v[40:43], v[168:171]
    ds_read_b128 v[88:91], v17 offset:4096
    v_mfma_f32_16x16x32_bf16 v[172:175], v[76:79], v[40:43], v[172:175]
    ds_read_b128 v[92:95], v17 offset:6144
    v_mfma_f32_16x16x32_bf16 v[176:179], v[64:67], v[44:47], v[176:179]
    ds_read_b128 v[96:99], v17 offset:8192
    v_mfma_f32_16x16x32_bf16 v[180:183], v[68:71], v[44:47], v[180:183]
    ds_read_b128 v[100:103], v17 offset:10240
    v_mfma_f32_16x16x32_bf16 v[184:187], v[72:75], v[44:47], v[184:187]
    ds_read_b128 v[104:107], v17 offset:12288
    v_mfma_f32_16x16x32_bf16 v[188:191], v[76:79], v[44:47], v[188:191]
    ds_read_b128 v[108:111], v17 offset:14336
    v_mfma_f32_16x16x32_bf16 v[192:195], v[64:67], v[48:51], v[192:195]
    v_xor_b32 v16, 65536, v16
    v_mfma_f32_16x16x32_bf16 v[196:199], v[68:71], v[48:51], v[196:199]
    v_xor_b32 v17, 65536, v17
    v_mfma_f32_16x16x32_bf16 v[200:203], v[72:75], v[48:51], v[200:203]
    v_xor_b32 v18, 65536, v18
    v_mfma_f32_16x16x32_bf16 v[204:207], v[76:79], v[48:51], v[204:207]
    v_xor_b32 v19, 65536, v19
    v_mfma_f32_16x16x32_bf16 v[208:211], v[64:67], v[52:55], v[208:211]
    v_xor_b32 v20, 65536, v20
    v_mfma_f32_16x16x32_bf16 v[212:215], v[68:71], v[52:55], v[212:215]
    v_xor_b32 v21, 65536, v21
    v_mfma_f32_16x16x32_bf16 v[216:219], v[72:75], v[52:55], v[216:219]
    v_mfma_f32_16x16x32_bf16 v[220:223], v[76:79], v[52:55], v[220:223]
    v_mfma_f32_16x16x32_bf16 v[224:227], v[64:67], v[56:59], v[224:227]
    v_mfma_f32_16x16x32_bf16 v[228:231], v[68:71], v[56:59], v[228:231]
    v_mfma_f32_16x16x32_bf16 v[232:235], v[72:75], v[56:59], v[232:235]
    v_mfma_f32_16x16x32_bf16 v[236:239], v[76:79], v[56:59], v[236:239]
    v_mfma_f32_16x16x32_bf16 v[240:243], v[64:67], v[60:63], v[240:243]
    v_mfma_f32_16x16x32_bf16 v[244:247], v[68:71], v[60:63], v[244:247]
    v_mfma_f32_16x16x32_bf16 v[248:251], v[72:75], v[60:63], v[248:251]
    v_mfma_f32_16x16x32_bf16 v[252:255], v[76:79], v[60:63], v[252:255]
    s_waitcnt lgkmcnt(0)
    v_mfma_f32_16x16x32_bf16 v[128:131], v[112:115], v[80:83], v[128:131]
    v_mfma_f32_16x16x32_bf16 v[132:135], v[116:119], v[80:83], v[132:135]
    v_mfma_f32_16x16x32_bf16 v[136:139], v[120:123], v[80:83], v[136:139]
    v_mfma_f32_16x16x32_bf16 v[140:143], v[124:127], v[80:83], v[140:143]
    v_mfma_f32_16x16x32_bf16 v[144:147], v[112:115], v[84:87], v[144:147]
    v_mfma_f32_16x16x32_bf16 v[148:151], v[116:119], v[84:87], v[148:151]
    v_mfma_f32_16x16x32_bf16 v[152:155], v[120:123], v[84:87], v[152:155]
    v_mfma_f32_16x16x32_bf16 v[156:159], v[124:127], v[84:87], v[156:159]
    v_mfma_f32_16x16x32_bf16 v[160:163], v[112:115], v[88:91], v[160:163]
    v_mfma_f32_16x16x32_bf16 v[164:167], v[116:119], v[88:91], v[164:167]
    v_mfma_f32_16x16x32_bf16 v[168:171], v[120:123], v[88:91], v[168:171]
    v_mfma_f32_16x16x32_bf16 v[172:175], v[124:127], v[88:91], v[172:175]
    v_mfma_f32_16x16x32_bf16 v[176:179], v[112:115], v[92:95], v[176:179]
    v_mfma_f32_16x16x32_bf16 v[180:183], v[116:119], v[92:95], v[180:183]
    v_mfma_f32_16x16x32_bf16 v[184:187], v[120:123], v[92:95], v[184:187]
    v_mfma_f32_16x16x32_bf16 v[188:191], v[124:127], v[92:95], v[188:191]
    v_mfma_f32_16x16x32_bf16 v[192:195], v[112:115], v[96:99], v[192:195]
    v_mfma_f32_16x16x32_bf16 v[196:199], v[116:119], v[96:99], v[196:199]
    v_mfma_f32_16x16x32_bf16 v[200:203], v[120:123], v[96:99], v[200:203]
    v_mfma_f32_16x16x32_bf16 v[204:207], v[124:127], v[96:99], v[204:207]
    v_mfma_f32_16x16x32_bf16 v[208:211], v[112:115], v[100:103], v[208:211]
    v_mfma_f32_16x16x32_bf16 v[212:215], v[116:119], v[100:103], v[212:215]
    v_mfma_f32_16x16x32_bf16 v[216:219], v[120:123], v[100:103], v[216:219]
    v_mfma_f32_16x16x32_bf16 v[220:223], v[124:127], v[100:103], v[220:223]
    v_mfma_f32_16x16x32_bf16 v[224:227], v[112:115], v[104:107], v[224:227]
    v_mfma_f32_16x16x32_bf16 v[228:231], v[116:119], v[104:107], v[228:231]
    v_mfma_f32_16x16x32_bf16 v[232:235], v[120:123], v[104:107], v[232:235]
    v_mfma_f32_16x16x32_bf16 v[236:239], v[124:127], v[104:107], v[236:239]
    v_mfma_f32_16x16x32_bf16 v[240:243], v[112:115], v[108:111], v[240:243]
    v_mfma_f32_16x16x32_bf16 v[244:247], v[116:119], v[108:111], v[244:247]
    v_mfma_f32_16x16x32_bf16 v[248:251], v[120:123], v[108:111], v[248:251]
    v_mfma_f32_16x16x32_bf16 v[252:255], v[124:127], v[108:111], v[252:255]
    s_nop 7
LE_K:
    v_mov_b32 v3, 163584
    s_cmp_lg_u32 s26, 0
    s_cbranch_scc1 tt_159
    s_waitcnt vmcnt(0)
    s_mov_b64 exec, 1
    ds_write_b32 v3, v28
    s_waitcnt lgkmcnt(0)
    s_mov_b64 exec, -1
tt_159:
    s_barrier
    ds_read_b32 v5, v3
    s_waitcnt lgkmcnt(0)
    v_readfirstlane_b32 s25, v5
    s_nop 3
    s_lshr_b32 s37, s49, 24
    v_lshlrev_b32 v26, 6, v2
    s_cmp_ge_u32 s37, 128
    s_cbranch_scc1 to_160
    s_add_u32 s38, s37, 0
    s_lshl_b32 s38, s38, 2
    s_add_u32 s38, s38, s43
    s_lshl_b32 s38, s38, 3
    s_add_u32 s38, s38, s26
    s_lshl_b32 s38, s38, 12
    s_mov_b64 s[60:61], s[82:83]
    s_mov_b32 s39, 0
    s_cmp_ge_u32 s38, 4194304
    s_cselect_b64 s[60:61], s[92:93], s[60:61]
    s_cselect_b32 s39, 4194304, s39
    s_cmp_ge_u32 s38, 8388608
    s_cselect_b64 s[60:61], s[94:95], s[60:61]
    s_cselect_b32 s39, 8388608, s39
    s_cmp_ge_u32 s38, 14680064
    s_cselect_b64 s[60:61], s[96:97], s[60:61]
    s_cselect_b32 s39, 14680064, s39
    s_sub_u32 s38, s38, s39
    s_and_b32 s61, s61, 0xffff
    s_add_u32 s62, s38, 4096
    s_mov_b32 s63, 0x20000
    buffer_load_dword v1, v26, s[60:63], s38 offen
    s_cmp_ge_u32 s37, 127
    s_cbranch_scc1 to_160
    s_add_u32 s38, s37, 1
    s_lshl_b32 s38, s38, 2
    s_add_u32 s38, s38, s43
    s_lshl_b32 s38, s38, 3
    s_add_u32 s38, s38, s26
    s_lshl_b32 s38, s38, 12
    s_mov_b64 s[60:61], s[82:83]
    s_mov_b32 s39, 0
    s_cmp_ge_u32 s38, 4194304
    s_cselect_b64 s[60:61], s[92:93], s[60:61]
    s_cselect_b32 s39, 4194304, s39
    s_cmp_ge_u32 s38, 8388608
    s_cselect_b64 s[60:61], s[94:95], s[60:61]
    s_cselect_b32 s39, 8388608, s39
    s_cmp_ge_u32 s38, 14680064
    s_cselect_b64 s[60:61], s[96:97], s[60:61]
    s_cselect_b32 s39, 14680064, s39
    s_sub_u32 s38, s38, s39
    s_and_b32 s61, s61, 0xffff
    s_add_u32 s62, s38, 4096
    s_mov_b32 s63, 0x20000
    buffer_load_dword v1, v26, s[60:63], s38 offen
    s_cmp_ge_u32 s37, 126
    s_cbranch_scc1 to_160
    s_add_u32 s38, s37, 2
    s_lshl_b32 s38, s38, 2
    s_add_u32 s38, s38, s43
    s_lshl_b32 s38, s38, 3
    s_add_u32 s38, s38, s26
    s_lshl_b32 s38, s38, 12
    s_mov_b64 s[60:61], s[82:83]
    s_mov_b32 s39, 0
    s_cmp_ge_u32 s38, 4194304
    s_cselect_b64 s[60:61], s[92:93], s[60:61]
    s_cselect_b32 s39, 4194304, s39
    s_cmp_ge_u32 s38, 8388608
    s_cselect_b64 s[60:61], s[94:95], s[60:61]
    s_cselect_b32 s39, 8388608, s39
    s_cmp_ge_u32 s38, 14680064
    s_cselect_b64 s[60:61], s[96:97], s[60:61]
    s_cselect_b32 s39, 14680064, s39
    s_sub_u32 s38, s38, s39
    s_and_b32 s61, s61, 0xffff
    s_add_u32 s62, s38, 4096
    s_mov_b32 s63, 0x20000
    buffer_load_dword v1, v26, s[60:63], s38 offen
    s_cmp_ge_u32 s37, 125
    s_cbranch_scc1 to_160
    s_add_u32 s38, s37, 3
    s_lshl_b32 s38, s38, 2
    s_add_u32 s38, s38, s43
    s_lshl_b32 s38, s38, 3
    s_add_u32 s38, s38, s26
    s_lshl_b32 s38, s38, 12
    s_mov_b64 s[60:61], s[82:83]
    s_mov_b32 s39, 0
    s_cmp_ge_u32 s38, 4194304
    s_cselect_b64 s[60:61], s[92:93], s[60:61]
    s_cselect_b32 s39, 4194304, s39
    s_cmp_ge_u32 s38, 8388608
    s_cselect_b64 s[60:61], s[94:95], s[60:61]
    s_cselect_b32 s39, 8388608, s39
    s_cmp_ge_u32 s38, 14680064
    s_cselect_b64 s[60:61], s[96:97], s[60:61]
    s_cselect_b32 s39, 14680064, s39
    s_sub_u32 s38, s38, s39
    s_and_b32 s61, s61, 0xffff
    s_add_u32 s62, s38, 4096
    s_mov_b32 s63, 0x20000
    buffer_load_dword v1, v26, s[60:63], s38 offen
to_160:
    s_min_u32 s3, s25, 204
    s_lshl_b32 s3, s3, 2
    s_load_dword s7, s[50:51], s3
    s_waitcnt lgkmcnt(0)
E_K:
    s_cmp_lg_u32 s79, -1
    s_cbranch_scc1 hp_161
ht_162:
    s_sub_u32 s30, s30, 1
    s_cbranch_scc1 L_end
    v_mov_b32 v30, 128
    buffer_load_dword v31, v30, s[20:23], 0 offen sc1
hc_163:
    s_waitcnt vmcnt(0)
    v_readfirstlane_b32 s3, v31
    s_nop 3
    s_and_b32 s40, s3, 0xffff
    s_cmp_lt_u32 s40, 128
    s_cbranch_scc1 ht_162
    s_add_u32 s3, s3, 4128768
    s_lshr_b32 s3, s3, 10
    s_and_b32 s79, s3, 8192
hp_161:
    v_lshlrev_b32 v7, 4, v2
    s_lshr_b32 s38, s42, 5
    s_mul_i32 s39, s45, 2
    s_add_u32 s38, s38, s39
    s_lshl_b32 s38, s38, 6
    s_lshr_b32 s39, s41, 5
    s_add_u32 s38, s38, s39
    s_mul_i32 s39, s44, 4
    s_add_u32 s38, s38, s39
    s_mov_b32 s39, s38
    s_lshl_b32 s38, s38, 13
    s_add_u32 s38, s38, 134217728
    s_bfe_u32 s3, s39, 0x10008
    s_lshl_b32 s3, s3, 13
    s_xor_b32 s3, s3, s79
    s_xor_b32 s3, s3, 8192
    s_add_u32 s38, s38, s3
    s_add_u32 s39, s38, 0
    v_cvt_pk_bf16_f32 v32, v128, v129
    v_cvt_pk_bf16_f32 v33, v130, v131
    v_cvt_pk_bf16_f32 v34, v132, v133
    v_cvt_pk_bf16_f32 v35, v134, v135
    buffer_store_dwordx4 v[32:35], v7, s[8:11], s39 offen offset:0 sc1
    v_cvt_pk_bf16_f32 v36, v144, v145
    v_cvt_pk_bf16_f32 v37, v146, v147
    v_cvt_pk_bf16_f32 v38, v148, v149
    v_cvt_pk_bf16_f32 v39, v150, v151
    buffer_store_dwordx4 v[36:39], v7, s[8:11], s39 offen offset:1024 sc1
    s_add_u32 s39, s38, 4096
    v_cvt_pk_bf16_f32 v40, v160, v161
    v_cvt_pk_bf16_f32 v41, v162, v163
    v_cvt_pk_bf16_f32 v42, v164, v165
    v_cvt_pk_bf16_f32 v43, v166, v167
    buffer_store_dwordx4 v[40:43], v7, s[8:11], s39 offen offset:0 sc1
    v_cvt_pk_bf16_f32 v44, v176, v177
    v_cvt_pk_bf16_f32 v45, v178, v179
    v_cvt_pk_bf16_f32 v46, v180, v181
    v_cvt_pk_bf16_f32 v47, v182, v183
    buffer_store_dwordx4 v[44:47], v7, s[8:11], s39 offen offset:1024 sc1
    s_add_u32 s39, s38, 16384
    v_cvt_pk_bf16_f32 v48, v192, v193
    v_cvt_pk_bf16_f32 v49, v194, v195
    v_cvt_pk_bf16_f32 v50, v196, v197
    v_cvt_pk_bf16_f32 v51, v198, v199
    buffer_store_dwordx4 v[48:51], v7, s[8:11], s39 offen offset:0 sc1
    v_cvt_pk_bf16_f32 v52, v208, v209
    v_cvt_pk_bf16_f32 v53, v210, v211
    v_cvt_pk_bf16_f32 v54, v212, v213
    v_cvt_pk_bf16_f32 v55, v214, v215
    buffer_store_dwordx4 v[52:55], v7, s[8:11], s39 offen offset:1024 sc1
    s_add_u32 s39, s38, 20480
    v_cvt_pk_bf16_f32 v56, v224, v225
    v_cvt_pk_bf16_f32 v57, v226, v227
    v_cvt_pk_bf16_f32 v58, v228, v229
    v_cvt_pk_bf16_f32 v59, v230, v231
    buffer_store_dwordx4 v[56:59], v7, s[8:11], s39 offen offset:0 sc1
    v_cvt_pk_bf16_f32 v60, v240, v241
    v_cvt_pk_bf16_f32 v61, v242, v243
    v_cvt_pk_bf16_f32 v62, v244, v245
    v_cvt_pk_bf16_f32 v63, v246, v247
    buffer_store_dwordx4 v[60:63], v7, s[8:11], s39 offen offset:1024 sc1
    s_add_u32 s39, s38, 524288
    v_cvt_pk_bf16_f32 v32, v136, v137
    v_cvt_pk_bf16_f32 v33, v138, v139
    v_cvt_pk_bf16_f32 v34, v140, v141
    v_cvt_pk_bf16_f32 v35, v142, v143
    buffer_store_dwordx4 v[32:35], v7, s[8:11], s39 offen offset:0 sc1
    v_cvt_pk_bf16_f32 v36, v152, v153
    v_cvt_pk_bf16_f32 v37, v154, v155
    v_cvt_pk_bf16_f32 v38, v156, v157
    v_cvt_pk_bf16_f32 v39, v158, v159
    buffer_store_dwordx4 v[36:39], v7, s[8:11], s39 offen offset:1024 sc1
    s_add_u32 s39, s38, 528384
    v_cvt_pk_bf16_f32 v40, v168, v169
    v_cvt_pk_bf16_f32 v41, v170, v171
    v_cvt_pk_bf16_f32 v42, v172, v173
    v_cvt_pk_bf16_f32 v43, v174, v175
    buffer_store_dwordx4 v[40:43], v7, s[8:11], s39 offen offset:0 sc1
    v_cvt_pk_bf16_f32 v44, v184, v185
    v_cvt_pk_bf16_f32 v45, v186, v187
    v_cvt_pk_bf16_f32 v46, v188, v189
    v_cvt_pk_bf16_f32 v47, v190, v191
    buffer_store_dwordx4 v[44:47], v7, s[8:11], s39 offen offset:1024 sc1
    s_add_u32 s39, s38, 540672
    v_cvt_pk_bf16_f32 v48, v200, v201
    v_cvt_pk_bf16_f32 v49, v202, v203
    v_cvt_pk_bf16_f32 v50, v204, v205
    v_cvt_pk_bf16_f32 v51, v206, v207
    buffer_store_dwordx4 v[48:51], v7, s[8:11], s39 offen offset:0 sc1
    v_cvt_pk_bf16_f32 v52, v216, v217
    v_cvt_pk_bf16_f32 v53, v218, v219
    v_cvt_pk_bf16_f32 v54, v220, v221
    v_cvt_pk_bf16_f32 v55, v222, v223
    buffer_store_dwordx4 v[52:55], v7, s[8:11], s39 offen offset:1024 sc1
    s_add_u32 s39, s38, 544768
    v_cvt_pk_bf16_f32 v56, v232, v233
    v_cvt_pk_bf16_f32 v57, v234, v235
    v_cvt_pk_bf16_f32 v58, v236, v237
    v_cvt_pk_bf16_f32 v59, v238, v239
    buffer_store_dwordx4 v[56:59], v7, s[8:11], s39 offen offset:0 sc1
    v_cvt_pk_bf16_f32 v60, v248, v249
    v_cvt_pk_bf16_f32 v61, v250, v251
    v_cvt_pk_bf16_f32 v62, v252, v253
    v_cvt_pk_bf16_f32 v63, v254, v255
    buffer_store_dwordx4 v[60:63], v7, s[8:11], s39 offen offset:1024 sc1
    s_lshr_b32 s40, s41, 8
    s_lshl_b32 s40, s40, 2
    s_add_u32 s40, s40, s43
    s_lshl_b32 s40, s40, 7
    s_add_u32 s40, s40, 79720448
    s_waitcnt vmcnt(0)
    s_barrier
    s_cmp_lg_u32 s26, 1
    s_cbranch_scc1 sg_164
    v_mov_b32 v4, s40
    v_mov_b32 v5, 4
    s_mov_b64 exec, 1
    buffer_atomic_add v5, v4, s[8:11], 0 offen sc1
    s_mov_b64 exec, -1
sg_164:
    s_cmp_eq_u32 s6, 0
    s_cbranch_scc1 D_pre
    s_mov_b32 s6, 0
    s_branch D_main
LP_V:
    s_mov_b32 s34, 13
    s_mov_b32 s27, 0
    s_waitcnt vmcnt(8)
    s_barrier
    ds_read_b64_tr_b16 v[64:65], v18 offset:32768
    ds_read_b64_tr_b16 v[66:67], v18 offset:34816
    ds_read_b64_tr_b16 v[68:69], v19 offset:32768
    ds_read_b64_tr_b16 v[70:71], v19 offset:34816
    ds_read_b64_tr_b16 v[72:73], v20 offset:32768
    ds_read_b64_tr_b16 v[74:75], v20 offset:34816
    ds_read_b64_tr_b16 v[76:77], v21 offset:32768
    ds_read_b64_tr_b16 v[78:79], v21 offset:34816
    ds_read_b128 v[32:35], v16 offset:0
    ds_read_b128 v[36:39], v16 offset:2048
    ds_read_b128 v[40:43], v16 offset:4096
    ds_read_b128 v[44:47], v16 offset:6144
    ds_read_b128 v[48:51], v16 offset:8192
    ds_read_b128 v[52:55], v16 offset:10240
    ds_read_b128 v[56:59], v16 offset:12288
    ds_read_b128 v[60:63], v16 offset:14336
    s_waitcnt lgkmcnt(0)
    v_mfma_f32_16x16x32_bf16 v[128:131], v[32:35], v[64:67], 0
    ds_read_b64_tr_b16 v[112:113], v18 offset:49152
    v_mfma_f32_16x16x32_bf16 v[132:135], v[32:35], v[68:71], 0
    ds_read_b64_tr_b16 v[114:115], v18 offset:51200
    v_mfma_f32_16x16x32_bf16 v[136:139], v[32:35], v[72:75], 0
    ds_read_b64_tr_b16 v[116:117], v19 offset:49152
    v_mfma_f32_16x16x32_bf16 v[140:143], v[32:35], v[76:79], 0
    ds_read_b64_tr_b16 v[118:119], v19 offset:51200
    v_mfma_f32_16x16x32_bf16 v[144:147], v[36:39], v[64:67], 0
    ds_read_b64_tr_b16 v[120:121], v20 offset:49152
    v_mfma_f32_16x16x32_bf16 v[148:151], v[36:39], v[68:71], 0
    ds_read_b64_tr_b16 v[122:123], v20 offset:51200
    v_mfma_f32_16x16x32_bf16 v[152:155], v[36:39], v[72:75], 0
    ds_read_b64_tr_b16 v[124:125], v21 offset:49152
    v_mfma_f32_16x16x32_bf16 v[156:159], v[36:39], v[76:79], 0
    ds_read_b64_tr_b16 v[126:127], v21 offset:51200
    v_mfma_f32_16x16x32_bf16 v[160:163], v[40:43], v[64:67], 0
    ds_read_b128 v[80:83], v17 offset:0
    v_mfma_f32_16x16x32_bf16 v[164:167], v[40:43], v[68:71], 0
    ds_read_b128 v[84:87], v17 offset:2048
    v_mfma_f32_16x16x32_bf16 v[168:171], v[40:43], v[72:75], 0
    ds_read_b128 v[88:91], v17 offset:4096
    v_mfma_f32_16x16x32_bf16 v[172:175], v[40:43], v[76:79], 0
    ds_read_b128 v[92:95], v17 offset:6144
    v_mfma_f32_16x16x32_bf16 v[176:179], v[44:47], v[64:67], 0
    ds_read_b128 v[96:99], v17 offset:8192
    v_mfma_f32_16x16x32_bf16 v[180:183], v[44:47], v[68:71], 0
    ds_read_b128 v[100:103], v17 offset:10240
    v_mfma_f32_16x16x32_bf16 v[184:187], v[44:47], v[72:75], 0
    ds_read_b128 v[104:107], v17 offset:12288
    v_mfma_f32_16x16x32_bf16 v[188:191], v[44:47], v[76:79], 0
    ds_read_b128 v[108:111], v17 offset:14336
    v_mfma_f32_16x16x32_bf16 v[192:195], v[48:51], v[64:67], 0
    v_xor_b32 v16, 65536, v16
    v_mfma_f32_16x16x32_bf16 v[196:199], v[48:51], v[68:71], 0
    v_xor_b32 v17, 65536, v17
    v_mfma_f32_16x16x32_bf16 v[200:203], v[48:51], v[72:75], 0
    v_xor_b32 v18, 65536, v18
    v_mfma_f32_16x16x32_bf16 v[204:207], v[48:51], v[76:79], 0
    v_xor_b32 v19, 65536, v19
    v_mfma_f32_16x16x32_bf16 v[208:211], v[52:55], v[64:67], 0
    v_xor_b32 v20, 65536, v20
    v_mfma_f32_16x16x32_bf16 v[212:215], v[52:55], v[68:71], 0
    v_xor_b32 v21, 65536, v21
    v_mfma_f32_16x16x32_bf16 v[216:219], v[52:55], v[72:75], 0
    v_mfma_f32_16x16x32_bf16 v[220:223], v[52:55], v[76:79], 0
    v_mfma_f32_16x16x32_bf16 v[224:227], v[56:59], v[64:67], 0
    v_mfma_f32_16x16x32_bf16 v[228:231], v[56:59], v[68:71], 0
    v_mfma_f32_16x16x32_bf16 v[232:235], v[56:59], v[72:75], 0
    v_mfma_f32_16x16x32_bf16 v[236:239], v[56:59], v[76:79], 0
    v_mfma_f32_16x16x32_bf16 v[240:243], v[60:63], v[64:67], 0
    v_mfma_f32_16x16x32_bf16 v[244:247], v[60:63], v[68:71], 0
    v_mfma_f32_16x16x32_bf16 v[248:251], v[60:63], v[72:75], 0
    v_mfma_f32_16x16x32_bf16 v[252:255], v[60:63], v[76:79], 0
    s_waitcnt vmcnt(0) lgkmcnt(0)
    s_barrier
    v_mfma_f32_16x16x32_bf16 v[128:131], v[80:83], v[112:115], v[128:131]
    s_mov_b32 m0, s35
    s_xor_b32 s35, s35, 65536
    v_mfma_f32_16x16x32_bf16 v[132:135], v[80:83], v[116:119], v[132:135]
    ds_read_b64_tr_b16 v[64:65], v18 offset:32768
    v_mfma_f32_16x16x32_bf16 v[136:139], v[80:83], v[120:123], v[136:139]
    buffer_load_dwordx4 v8, s[12:15], s31 offen offset:0  lds
    v_mfma_f32_16x16x32_bf16 v[140:143], v[80:83], v[124:127], v[140:143]
    ds_read_b64_tr_b16 v[66:67], v18 offset:34816
    v_mfma_f32_16x16x32_bf16 v[144:147], v[84:87], v[112:115], v[144:147]
    buffer_load_dwordx4 v9, s[12:15], s31 offen offset:1024  lds
    v_mfma_f32_16x16x32_bf16 v[148:151], v[84:87], v[116:119], v[148:151]
    ds_read_b64_tr_b16 v[68:69], v19 offset:32768
    v_mfma_f32_16x16x32_bf16 v[152:155], v[84:87], v[120:123], v[152:155]
    buffer_load_dwordx4 v10, s[12:15], s31 offen offset:2048  lds
    v_mfma_f32_16x16x32_bf16 v[156:159], v[84:87], v[124:127], v[156:159]
    ds_read_b64_tr_b16 v[70:71], v19 offset:34816
    v_mfma_f32_16x16x32_bf16 v[160:163], v[88:91], v[112:115], v[160:163]
    buffer_load_dwordx4 v11, s[12:15], s31 offen offset:3072  lds
    v_mfma_f32_16x16x32_bf16 v[164:167], v[88:91], v[116:119], v[164:167]
    ds_read_b64_tr_b16 v[72:73], v20 offset:32768
    v_mfma_f32_16x16x32_bf16 v[168:171], v[88:91], v[120:123], v[168:171]
    s_mov_b32 m0, s36
    s_add_u32 s31, s31, 128
    s_xor_b32 s36, s36, 65536
    v_mfma_f32_16x16x32_bf16 v[172:175], v[88:91], v[124:127], v[172:175]
    ds_read_b64_tr_b16 v[74:75], v20 offset:34816
    v_mfma_f32_16x16x32_bf16 v[176:179], v[92:95], v[112:115], v[176:179]
    buffer_load_dwordx4 v12, s[16:19], s32 offen offset:0  lds
    v_mfma_f32_16x16x32_bf16 v[180:183], v[92:95], v[116:119], v[180:183]
    ds_read_b64_tr_b16 v[76:77], v21 offset:32768
    v_mfma_f32_16x16x32_bf16 v[184:187], v[92:95], v[120:123], v[184:187]
    buffer_load_dwordx4 v13, s[16:19], s32 offen offset:1024  lds
    v_mfma_f32_16x16x32_bf16 v[188:191], v[92:95], v[124:127], v[188:191]
    ds_read_b64_tr_b16 v[78:79], v21 offset:34816
    v_mfma_f32_16x16x32_bf16 v[192:195], v[96:99], v[112:115], v[192:195]
    buffer_load_dwordx4 v14, s[16:19], s32 offen offset:2048  lds
    v_mfma_f32_16x16x32_bf16 v[196:199], v[96:99], v[116:119], v[196:199]
    ds_read_b128 v[32:35], v16 offset:0
    v_mfma_f32_16x16x32_bf16 v[200:203], v[96:99], v[120:123], v[200:203]
    buffer_load_dwordx4 v15, s[16:19], s32 offen offset:3072  lds
    v_mfma_f32_16x16x32_bf16 v[204:207], v[96:99], v[124:127], v[204:207]
    ds_read_b128 v[36:39], v16 offset:2048
    v_mfma_f32_16x16x32_bf16 v[208:211], v[100:103], v[112:115], v[208:211]
    s_add_u32 s32, s32, s33
    v_mfma_f32_16x16x32_bf16 v[212:215], v[100:103], v[116:119], v[212:215]
    ds_read_b128 v[40:43], v16 offset:4096
    v_mfma_f32_16x16x32_bf16 v[216:219], v[100:103], v[120:123], v[216:219]
    ds_read_b128 v[44:47], v16 offset:6144
    v_mfma_f32_16x16x32_bf16 v[220:223], v[100:103], v[124:127], v[220:223]
    ds_read_b128 v[48:51], v16 offset:8192
    v_mfma_f32_16x16x32_bf16 v[224:227], v[104:107], v[112:115], v[224:227]
    ds_read_b128 v[52:55], v16 offset:10240
    v_mfma_f32_16x16x32_bf16 v[228:231], v[104:107], v[116:119], v[228:231]
    ds_read_b128 v[56:59], v16 offset:12288
    v_mfma_f32_16x16x32_bf16 v[232:235], v[104:107], v[120:123], v[232:235]
    ds_read_b128 v[60:63], v16 offset:14336
    v_mfma_f32_16x16x32_bf16 v[236:239], v[104:107], v[124:127], v[236:239]
    v_mfma_f32_16x16x32_bf16 v[240:243], v[108:111], v[112:115], v[240:243]
    v_mfma_f32_16x16x32_bf16 v[244:247], v[108:111], v[116:119], v[244:247]
    v_mfma_f32_16x16x32_bf16 v[248:251], v[108:111], v[120:123], v[248:251]
    v_mfma_f32_16x16x32_bf16 v[252:255], v[108:111], v[124:127], v[252:255]
gl_165:
    s_waitcnt lgkmcnt(0)
    v_mfma_f32_16x16x32_bf16 v[128:131], v[32:35], v[64:67], v[128:131]
    ds_read_b64_tr_b16 v[112:113], v18 offset:49152
    v_mfma_f32_16x16x32_bf16 v[132:135], v[32:35], v[68:71], v[132:135]
    ds_read_b64_tr_b16 v[114:115], v18 offset:51200
    v_mfma_f32_16x16x32_bf16 v[136:139], v[32:35], v[72:75], v[136:139]
    ds_read_b64_tr_b16 v[116:117], v19 offset:49152
    v_mfma_f32_16x16x32_bf16 v[140:143], v[32:35], v[76:79], v[140:143]
    ds_read_b64_tr_b16 v[118:119], v19 offset:51200
    v_mfma_f32_16x16x32_bf16 v[144:147], v[36:39], v[64:67], v[144:147]
    ds_read_b64_tr_b16 v[120:121], v20 offset:49152
    v_mfma_f32_16x16x32_bf16 v[148:151], v[36:39], v[68:71], v[148:151]
    ds_read_b64_tr_b16 v[122:123], v20 offset:51200
    v_mfma_f32_16x16x32_bf16 v[152:155], v[36:39], v[72:75], v[152:155]
    ds_read_b64_tr_b16 v[124:125], v21 offset:49152
    v_mfma_f32_16x16x32_bf16 v[156:159], v[36:39], v[76:79], v[156:159]
    ds_read_b64_tr_b16 v[126:127], v21 offset:51200
    v_mfma_f32_16x16x32_bf16 v[160:163], v[40:43], v[64:67], v[160:163]
    ds_read_b128 v[80:83], v17 offset:0
    v_mfma_f32_16x16x32_bf16 v[164:167], v[40:43], v[68:71], v[164:167]
    ds_read_b128 v[84:87], v17 offset:2048
    v_mfma_f32_16x16x32_bf16 v[168:171], v[40:43], v[72:75], v[168:171]
    ds_read_b128 v[88:91], v17 offset:4096
    v_mfma_f32_16x16x32_bf16 v[172:175], v[40:43], v[76:79], v[172:175]
    ds_read_b128 v[92:95], v17 offset:6144
    v_mfma_f32_16x16x32_bf16 v[176:179], v[44:47], v[64:67], v[176:179]
    ds_read_b128 v[96:99], v17 offset:8192
    v_mfma_f32_16x16x32_bf16 v[180:183], v[44:47], v[68:71], v[180:183]
    ds_read_b128 v[100:103], v17 offset:10240
    v_mfma_f32_16x16x32_bf16 v[184:187], v[44:47], v[72:75], v[184:187]
    ds_read_b128 v[104:107], v17 offset:12288
    v_mfma_f32_16x16x32_bf16 v[188:191], v[44:47], v[76:79], v[188:191]
    ds_read_b128 v[108:111], v17 offset:14336
    v_mfma_f32_16x16x32_bf16 v[192:195], v[48:51], v[64:67], v[192:195]
    v_xor_b32 v16, 65536, v16
    v_mfma_f32_16x16x32_bf16 v[196:199], v[48:51], v[68:71], v[196:199]
    v_xor_b32 v17, 65536, v17
    v_mfma_f32_16x16x32_bf16 v[200:203], v[48:51], v[72:75], v[200:203]
    v_xor_b32 v18, 65536, v18
    v_mfma_f32_16x16x32_bf16 v[204:207], v[48:51], v[76:79], v[204:207]
    v_xor_b32 v19, 65536, v19
    v_mfma_f32_16x16x32_bf16 v[208:211], v[52:55], v[64:67], v[208:211]
    v_xor_b32 v20, 65536, v20
    v_mfma_f32_16x16x32_bf16 v[212:215], v[52:55], v[68:71], v[212:215]
    v_xor_b32 v21, 65536, v21
    v_mfma_f32_16x16x32_bf16 v[216:219], v[52:55], v[72:75], v[216:219]
    v_mfma_f32_16x16x32_bf16 v[220:223], v[52:55], v[76:79], v[220:223]
    v_mfma_f32_16x16x32_bf16 v[224:227], v[56:59], v[64:67], v[224:227]
    v_mfma_f32_16x16x32_bf16 v[228:231], v[56:59], v[68:71], v[228:231]
    v_mfma_f32_16x16x32_bf16 v[232:235], v[56:59], v[72:75], v[232:235]
    v_mfma_f32_16x16x32_bf16 v[236:239], v[56:59], v[76:79], v[236:239]
    v_mfma_f32_16x16x32_bf16 v[240:243], v[60:63], v[64:67], v[240:243]
    v_mfma_f32_16x16x32_bf16 v[244:247], v[60:63], v[68:71], v[244:247]
    v_mfma_f32_16x16x32_bf16 v[248:251], v[60:63], v[72:75], v[248:251]
    v_mfma_f32_16x16x32_bf16 v[252:255], v[60:63], v[76:79], v[252:255]
    s_waitcnt vmcnt(0) lgkmcnt(0)
    s_barrier
    v_mfma_f32_16x16x32_bf16 v[128:131], v[80:83], v[112:115], v[128:131]
    s_mov_b32 m0, s35
    s_xor_b32 s35, s35, 65536
    v_mfma_f32_16x16x32_bf16 v[132:135], v[80:83], v[116:119], v[132:135]
    ds_read_b64_tr_b16 v[64:65], v18 offset:32768
    v_mfma_f32_16x16x32_bf16 v[136:139], v[80:83], v[120:123], v[136:139]
    buffer_load_dwordx4 v8, s[12:15], s31 offen offset:0  lds
    v_mfma_f32_16x16x32_bf16 v[140:143], v[80:83], v[124:127], v[140:143]
    ds_read_b64_tr_b16 v[66:67], v18 offset:34816
    v_mfma_f32_16x16x32_bf16 v[144:147], v[84:87], v[112:115], v[144:147]
    buffer_load_dwordx4 v9, s[12:15], s31 offen offset:1024  lds
    v_mfma_f32_16x16x32_bf16 v[148:151], v[84:87], v[116:119], v[148:151]
    ds_read_b64_tr_b16 v[68:69], v19 offset:32768
    v_mfma_f32_16x16x32_bf16 v[152:155], v[84:87], v[120:123], v[152:155]
    buffer_load_dwordx4 v10, s[12:15], s31 offen offset:2048  lds
    v_mfma_f32_16x16x32_bf16 v[156:159], v[84:87], v[124:127], v[156:159]
    ds_read_b64_tr_b16 v[70:71], v19 offset:34816
    v_mfma_f32_16x16x32_bf16 v[160:163], v[88:91], v[112:115], v[160:163]
    buffer_load_dwordx4 v11, s[12:15], s31 offen offset:3072  lds
    v_mfma_f32_16x16x32_bf16 v[164:167], v[88:91], v[116:119], v[164:167]
    ds_read_b64_tr_b16 v[72:73], v20 offset:32768
    v_mfma_f32_16x16x32_bf16 v[168:171], v[88:91], v[120:123], v[168:171]
    s_mov_b32 m0, s36
    s_add_u32 s31, s31, 128
    s_xor_b32 s36, s36, 65536
    v_mfma_f32_16x16x32_bf16 v[172:175], v[88:91], v[124:127], v[172:175]
    ds_read_b64_tr_b16 v[74:75], v20 offset:34816
    v_mfma_f32_16x16x32_bf16 v[176:179], v[92:95], v[112:115], v[176:179]
    buffer_load_dwordx4 v12, s[16:19], s32 offen offset:0  lds
    v_mfma_f32_16x16x32_bf16 v[180:183], v[92:95], v[116:119], v[180:183]
    ds_read_b64_tr_b16 v[76:77], v21 offset:32768
    v_mfma_f32_16x16x32_bf16 v[184:187], v[92:95], v[120:123], v[184:187]
    buffer_load_dwordx4 v13, s[16:19], s32 offen offset:1024  lds
    v_mfma_f32_16x16x32_bf16 v[188:191], v[92:95], v[124:127], v[188:191]
    ds_read_b64_tr_b16 v[78:79], v21 offset:34816
    v_mfma_f32_16x16x32_bf16 v[192:195], v[96:99], v[112:115], v[192:195]
    buffer_load_dwordx4 v14, s[16:19], s32 offen offset:2048  lds
    v_mfma_f32_16x16x32_bf16 v[196:199], v[96:99], v[116:119], v[196:199]
    ds_read_b128 v[32:35], v16 offset:0
    v_mfma_f32_16x16x32_bf16 v[200:203], v[96:99], v[120:123], v[200:203]
    buffer_load_dwordx4 v15, s[16:19], s32 offen offset:3072  lds
    v_mfma_f32_16x16x32_bf16 v[204:207], v[96:99], v[124:127], v[204:207]
    ds_read_b128 v[36:39], v16 offset:2048
    v_mfma_f32_16x16x32_bf16 v[208:211], v[100:103], v[112:115], v[208:211]
    s_add_u32 s32, s32, s33
    v_mfma_f32_16x16x32_bf16 v[212:215], v[100:103], v[116:119], v[212:215]
    ds_read_b128 v[40:43], v16 offset:4096
    v_mfma_f32_16x16x32_bf16 v[216:219], v[100:103], v[120:123], v[216:219]
    ds_read_b128 v[44:47], v16 offset:6144
    v_mfma_f32_16x16x32_bf16 v[220:223], v[100:103], v[124:127], v[220:223]
    ds_read_b128 v[48:51], v16 offset:8192
    v_mfma_f32_16x16x32_bf16 v[224:227], v[104:107], v[112:115], v[224:227]
    ds_read_b128 v[52:55], v16 offset:10240
    v_mfma_f32_16x16x32_bf16 v[228:231], v[104:107], v[116:119], v[228:231]
    ds_read_b128 v[56:59], v16 offset:12288
    v_mfma_f32_16x16x32_bf16 v[232:235], v[104:107], v[120:123], v[232:235]
    ds_read_b128 v[60:63], v16 offset:14336
    v_mfma_f32_16x16x32_bf16 v[236:239], v[104:107], v[124:127], v[236:239]
    v_mfma_f32_16x16x32_bf16 v[240:243], v[108:111], v[112:115], v[240:243]
    v_mfma_f32_16x16x32_bf16 v[244:247], v[108:111], v[116:119], v[244:247]
    v_mfma_f32_16x16x32_bf16 v[248:251], v[108:111], v[120:123], v[248:251]
    v_mfma_f32_16x16x32_bf16 v[252:255], v[108:111], v[124:127], v[252:255]
    s_sub_u32 s34, s34, 1
    s_cmp_lg_u32 s34, 0
    s_cbranch_scc1 gl_165
    s_cmp_lg_u32 s26, 0
    s_cbranch_scc1 ti_166
    s_lshl_b32 s3, s43, 2
    s_add_u32 s3, s3, 16
    v_mov_b32 v27, s3
    v_mov_b32 v28, 1
    s_mov_b64 exec, 1
    buffer_atomic_add v28, v27, s[20:23], 0 offen sc0 sc1
    s_mov_b64 exec, -1
ti_166:
    s_waitcnt lgkmcnt(0)
    v_mfma_f32_16x16x32_bf16 v[128:131], v[32:35], v[64:67], v[128:131]
    ds_read_b64_tr_b16 v[112:113], v18 offset:49152
    v_mfma_f32_16x16x32_bf16 v[132:135], v[32:35], v[68:71], v[132:135]
    ds_read_b64_tr_b16 v[114:115], v18 offset:51200
    v_mfma_f32_16x16x32_bf16 v[136:139], v[32:35], v[72:75], v[136:139]
    ds_read_b64_tr_b16 v[116:117], v19 offset:49152
    v_mfma_f32_16x16x32_bf16 v[140:143], v[32:35], v[76:79], v[140:143]
    ds_read_b64_tr_b16 v[118:119], v19 offset:51200
    v_mfma_f32_16x16x32_bf16 v[144:147], v[36:39], v[64:67], v[144:147]
    ds_read_b64_tr_b16 v[120:121], v20 offset:49152
    v_mfma_f32_16x16x32_bf16 v[148:151], v[36:39], v[68:71], v[148:151]
    ds_read_b64_tr_b16 v[122:123], v20 offset:51200
    v_mfma_f32_16x16x32_bf16 v[152:155], v[36:39], v[72:75], v[152:155]
    ds_read_b64_tr_b16 v[124:125], v21 offset:49152
    v_mfma_f32_16x16x32_bf16 v[156:159], v[36:39], v[76:79], v[156:159]
    ds_read_b64_tr_b16 v[126:127], v21 offset:51200
    v_mfma_f32_16x16x32_bf16 v[160:163], v[40:43], v[64:67], v[160:163]
    ds_read_b128 v[80:83], v17 offset:0
    v_mfma_f32_16x16x32_bf16 v[164:167], v[40:43], v[68:71], v[164:167]
    ds_read_b128 v[84:87], v17 offset:2048
    v_mfma_f32_16x16x32_bf16 v[168:171], v[40:43], v[72:75], v[168:171]
    ds_read_b128 v[88:91], v17 offset:4096
    v_mfma_f32_16x16x32_bf16 v[172:175], v[40:43], v[76:79], v[172:175]
    ds_read_b128 v[92:95], v17 offset:6144
    v_mfma_f32_16x16x32_bf16 v[176:179], v[44:47], v[64:67], v[176:179]
    ds_read_b128 v[96:99], v17 offset:8192
    v_mfma_f32_16x16x32_bf16 v[180:183], v[44:47], v[68:71], v[180:183]
    ds_read_b128 v[100:103], v17 offset:10240
    v_mfma_f32_16x16x32_bf16 v[184:187], v[44:47], v[72:75], v[184:187]
    ds_read_b128 v[104:107], v17 offset:12288
    v_mfma_f32_16x16x32_bf16 v[188:191], v[44:47], v[76:79], v[188:191]
    ds_read_b128 v[108:111], v17 offset:14336
    v_mfma_f32_16x16x32_bf16 v[192:195], v[48:51], v[64:67], v[192:195]
    v_xor_b32 v16, 65536, v16
    v_mfma_f32_16x16x32_bf16 v[196:199], v[48:51], v[68:71], v[196:199]
    v_xor_b32 v17, 65536, v17
    v_mfma_f32_16x16x32_bf16 v[200:203], v[48:51], v[72:75], v[200:203]
    v_xor_b32 v18, 65536, v18
    v_mfma_f32_16x16x32_bf16 v[204:207], v[48:51], v[76:79], v[204:207]
    v_xor_b32 v19, 65536, v19
    v_mfma_f32_16x16x32_bf16 v[208:211], v[52:55], v[64:67], v[208:211]
    v_xor_b32 v20, 65536, v20
    v_mfma_f32_16x16x32_bf16 v[212:215], v[52:55], v[68:71], v[212:215]
    v_xor_b32 v21, 65536, v21
    v_mfma_f32_16x16x32_bf16 v[216:219], v[52:55], v[72:75], v[216:219]
    v_mfma_f32_16x16x32_bf16 v[220:223], v[52:55], v[76:79], v[220:223]
    v_mfma_f32_16x16x32_bf16 v[224:227], v[56:59], v[64:67], v[224:227]
    v_mfma_f32_16x16x32_bf16 v[228:231], v[56:59], v[68:71], v[228:231]
    v_mfma_f32_16x16x32_bf16 v[232:235], v[56:59], v[72:75], v[232:235]
    v_mfma_f32_16x16x32_bf16 v[236:239], v[56:59], v[76:79], v[236:239]
    v_mfma_f32_16x16x32_bf16 v[240:243], v[60:63], v[64:67], v[240:243]
    v_mfma_f32_16x16x32_bf16 v[244:247], v[60:63], v[68:71], v[244:247]
    v_mfma_f32_16x16x32_bf16 v[248:251], v[60:63], v[72:75], v[248:251]
    v_mfma_f32_16x16x32_bf16 v[252:255], v[60:63], v[76:79], v[252:255]
    s_waitcnt vmcnt(0) lgkmcnt(0)
    s_barrier
    v_mfma_f32_16x16x32_bf16 v[128:131], v[80:83], v[112:115], v[128:131]
    ds_read_b64_tr_b16 v[64:65], v18 offset:32768
    v_mfma_f32_16x16x32_bf16 v[132:135], v[80:83], v[116:119], v[132:135]
    ds_read_b64_tr_b16 v[66:67], v18 offset:34816
    v_mfma_f32_16x16x32_bf16 v[136:139], v[80:83], v[120:123], v[136:139]
    ds_read_b64_tr_b16 v[68:69], v19 offset:32768
    v_mfma_f32_16x16x32_bf16 v[140:143], v[80:83], v[124:127], v[140:143]
    ds_read_b64_tr_b16 v[70:71], v19 offset:34816
    v_mfma_f32_16x16x32_bf16 v[144:147], v[84:87], v[112:115], v[144:147]
    ds_read_b64_tr_b16 v[72:73], v20 offset:32768
    v_mfma_f32_16x16x32_bf16 v[148:151], v[84:87], v[116:119], v[148:151]
    ds_read_b64_tr_b16 v[74:75], v20 offset:34816
    v_mfma_f32_16x16x32_bf16 v[152:155], v[84:87], v[120:123], v[152:155]
    ds_read_b64_tr_b16 v[76:77], v21 offset:32768
    v_mfma_f32_16x16x32_bf16 v[156:159], v[84:87], v[124:127], v[156:159]
    ds_read_b64_tr_b16 v[78:79], v21 offset:34816
    v_mfma_f32_16x16x32_bf16 v[160:163], v[88:91], v[112:115], v[160:163]
    ds_read_b128 v[32:35], v16 offset:0
    v_mfma_f32_16x16x32_bf16 v[164:167], v[88:91], v[116:119], v[164:167]
    ds_read_b128 v[36:39], v16 offset:2048
    v_mfma_f32_16x16x32_bf16 v[168:171], v[88:91], v[120:123], v[168:171]
    ds_read_b128 v[40:43], v16 offset:4096
    v_mfma_f32_16x16x32_bf16 v[172:175], v[88:91], v[124:127], v[172:175]
    ds_read_b128 v[44:47], v16 offset:6144
    v_mfma_f32_16x16x32_bf16 v[176:179], v[92:95], v[112:115], v[176:179]
    ds_read_b128 v[48:51], v16 offset:8192
    v_mfma_f32_16x16x32_bf16 v[180:183], v[92:95], v[116:119], v[180:183]
    ds_read_b128 v[52:55], v16 offset:10240
    v_mfma_f32_16x16x32_bf16 v[184:187], v[92:95], v[120:123], v[184:187]
    ds_read_b128 v[56:59], v16 offset:12288
    v_mfma_f32_16x16x32_bf16 v[188:191], v[92:95], v[124:127], v[188:191]
    ds_read_b128 v[60:63], v16 offset:14336
    v_mfma_f32_16x16x32_bf16 v[192:195], v[96:99], v[112:115], v[192:195]
    v_mfma_f32_16x16x32_bf16 v[196:199], v[96:99], v[116:119], v[196:199]
    v_mfma_f32_16x16x32_bf16 v[200:203], v[96:99], v[120:123], v[200:203]
    v_mfma_f32_16x16x32_bf16 v[204:207], v[96:99], v[124:127], v[204:207]
    v_mfma_f32_16x16x32_bf16 v[208:211], v[100:103], v[112:115], v[208:211]
    v_mfma_f32_16x16x32_bf16 v[212:215], v[100:103], v[116:119], v[212:215]
    v_mfma_f32_16x16x32_bf16 v[216:219], v[100:103], v[120:123], v[216:219]
    v_mfma_f32_16x16x32_bf16 v[220:223], v[100:103], v[124:127], v[220:223]
    v_mfma_f32_16x16x32_bf16 v[224:227], v[104:107], v[112:115], v[224:227]
    v_mfma_f32_16x16x32_bf16 v[228:231], v[104:107], v[116:119], v[228:231]
    v_mfma_f32_16x16x32_bf16 v[232:235], v[104:107], v[120:123], v[232:235]
    v_mfma_f32_16x16x32_bf16 v[236:239], v[104:107], v[124:127], v[236:239]
    v_mfma_f32_16x16x32_bf16 v[240:243], v[108:111], v[112:115], v[240:243]
    v_mfma_f32_16x16x32_bf16 v[244:247], v[108:111], v[116:119], v[244:247]
    v_mfma_f32_16x16x32_bf16 v[248:251], v[108:111], v[120:123], v[248:251]
    v_mfma_f32_16x16x32_bf16 v[252:255], v[108:111], v[124:127], v[252:255]
    s_waitcnt lgkmcnt(0)
    v_mfma_f32_16x16x32_bf16 v[128:131], v[32:35], v[64:67], v[128:131]
    ds_read_b64_tr_b16 v[112:113], v18 offset:49152
    v_mfma_f32_16x16x32_bf16 v[132:135], v[32:35], v[68:71], v[132:135]
    ds_read_b64_tr_b16 v[114:115], v18 offset:51200
    v_mfma_f32_16x16x32_bf16 v[136:139], v[32:35], v[72:75], v[136:139]
    ds_read_b64_tr_b16 v[116:117], v19 offset:49152
    v_mfma_f32_16x16x32_bf16 v[140:143], v[32:35], v[76:79], v[140:143]
    ds_read_b64_tr_b16 v[118:119], v19 offset:51200
    v_mfma_f32_16x16x32_bf16 v[144:147], v[36:39], v[64:67], v[144:147]
    ds_read_b64_tr_b16 v[120:121], v20 offset:49152
    v_mfma_f32_16x16x32_bf16 v[148:151], v[36:39], v[68:71], v[148:151]
    ds_read_b64_tr_b16 v[122:123], v20 offset:51200
    v_mfma_f32_16x16x32_bf16 v[152:155], v[36:39], v[72:75], v[152:155]
    ds_read_b64_tr_b16 v[124:125], v21 offset:49152
    v_mfma_f32_16x16x32_bf16 v[156:159], v[36:39], v[76:79], v[156:159]
    ds_read_b64_tr_b16 v[126:127], v21 offset:51200
    v_mfma_f32_16x16x32_bf16 v[160:163], v[40:43], v[64:67], v[160:163]
    ds_read_b128 v[80:83], v17 offset:0
    v_mfma_f32_16x16x32_bf16 v[164:167], v[40:43], v[68:71], v[164:167]
    ds_read_b128 v[84:87], v17 offset:2048
    v_mfma_f32_16x16x32_bf16 v[168:171], v[40:43], v[72:75], v[168:171]
    ds_read_b128 v[88:91], v17 offset:4096
    v_mfma_f32_16x16x32_bf16 v[172:175], v[40:43], v[76:79], v[172:175]
    ds_read_b128 v[92:95], v17 offset:6144
    v_mfma_f32_16x16x32_bf16 v[176:179], v[44:47], v[64:67], v[176:179]
    ds_read_b128 v[96:99], v17 offset:8192
    v_mfma_f32_16x16x32_bf16 v[180:183], v[44:47], v[68:71], v[180:183]
    ds_read_b128 v[100:103], v17 offset:10240
    v_mfma_f32_16x16x32_bf16 v[184:187], v[44:47], v[72:75], v[184:187]
    ds_read_b128 v[104:107], v17 offset:12288
    v_mfma_f32_16x16x32_bf16 v[188:191], v[44:47], v[76:79], v[188:191]
    ds_read_b128 v[108:111], v17 offset:14336
    v_mfma_f32_16x16x32_bf16 v[192:195], v[48:51], v[64:67], v[192:195]
    v_xor_b32 v16, 65536, v16
    v_mfma_f32_16x16x32_bf16 v[196:199], v[48:51], v[68:71], v[196:199]
    v_xor_b32 v17, 65536, v17
    v_mfma_f32_16x16x32_bf16 v[200:203], v[48:51], v[72:75], v[200:203]
    v_xor_b32 v18, 65536, v18
    v_mfma_f32_16x16x32_bf16 v[204:207], v[48:51], v[76:79], v[204:207]
    v_xor_b32 v19, 65536, v19
    v_mfma_f32_16x16x32_bf16 v[208:211], v[52:55], v[64:67], v[208:211]
    v_xor_b32 v20, 65536, v20
    v_mfma_f32_16x16x32_bf16 v[212:215], v[52:55], v[68:71], v[212:215]
    v_xor_b32 v21, 65536, v21
    v_mfma_f32_16x16x32_bf16 v[216:219], v[52:55], v[72:75], v[216:219]
    v_mfma_f32_16x16x32_bf16 v[220:223], v[52:55], v[76:79], v[220:223]
    v_mfma_f32_16x16x32_bf16 v[224:227], v[56:59], v[64:67], v[224:227]
    v_mfma_f32_16x16x32_bf16 v[228:231], v[56:59], v[68:71], v[228:231]
    v_mfma_f32_16x16x32_bf16 v[232:235], v[56:59], v[72:75], v[232:235]
    v_mfma_f32_16x16x32_bf16 v[236:239], v[56:59], v[76:79], v[236:239]
    v_mfma_f32_16x16x32_bf16 v[240:243], v[60:63], v[64:67], v[240:243]
    v_mfma_f32_16x16x32_bf16 v[244:247], v[60:63], v[68:71], v[244:247]
    v_mfma_f32_16x16x32_bf16 v[248:251], v[60:63], v[72:75], v[248:251]
    v_mfma_f32_16x16x32_bf16 v[252:255], v[60:63], v[76:79], v[252:255]
    s_waitcnt lgkmcnt(0)
    v_mfma_f32_16x16x32_bf16 v[128:131], v[80:83], v[112:115], v[128:131]
    v_mfma_f32_16x16x32_bf16 v[132:135], v[80:83], v[116:119], v[132:135]
    v_mfma_f32_16x16x32_bf16 v[136:139], v[80:83], v[120:123], v[136:139]
    v_mfma_f32_16x16x32_bf16 v[140:143], v[80:83], v[124:127], v[140:143]
    v_mfma_f32_16x16x32_bf16 v[144:147], v[84:87], v[112:115], v[144:147]
    v_mfma_f32_16x16x32_bf16 v[148:151], v[84:87], v[116:119], v[148:151]
    v_mfma_f32_16x16x32_bf16 v[152:155], v[84:87], v[120:123], v[152:155]
    v_mfma_f32_16x16x32_bf16 v[156:159], v[84:87], v[124:127], v[156:159]
    v_mfma_f32_16x16x32_bf16 v[160:163], v[88:91], v[112:115], v[160:163]
    v_mfma_f32_16x16x32_bf16 v[164:167], v[88:91], v[116:119], v[164:167]
    v_mfma_f32_16x16x32_bf16 v[168:171], v[88:91], v[120:123], v[168:171]
    v_mfma_f32_16x16x32_bf16 v[172:175], v[88:91], v[124:127], v[172:175]
    v_mfma_f32_16x16x32_bf16 v[176:179], v[92:95], v[112:115], v[176:179]
    v_mfma_f32_16x16x32_bf16 v[180:183], v[92:95], v[116:119], v[180:183]
    v_mfma_f32_16x16x32_bf16 v[184:187], v[92:95], v[120:123], v[184:187]
    v_mfma_f32_16x16x32_bf16 v[188:191], v[92:95], v[124:127], v[188:191]
    v_mfma_f32_16x16x32_bf16 v[192:195], v[96:99], v[112:115], v[192:195]
    v_mfma_f32_16x16x32_bf16 v[196:199], v[96:99], v[116:119], v[196:199]
    v_mfma_f32_16x16x32_bf16 v[200:203], v[96:99], v[120:123], v[200:203]
    v_mfma_f32_16x16x32_bf16 v[204:207], v[96:99], v[124:127], v[204:207]
    v_mfma_f32_16x16x32_bf16 v[208:211], v[100:103], v[112:115], v[208:211]
    v_mfma_f32_16x16x32_bf16 v[212:215], v[100:103], v[116:119], v[212:215]
    v_mfma_f32_16x16x32_bf16 v[216:219], v[100:103], v[120:123], v[216:219]
    v_mfma_f32_16x16x32_bf16 v[220:223], v[100:103], v[124:127], v[220:223]
    v_mfma_f32_16x16x32_bf16 v[224:227], v[104:107], v[112:115], v[224:227]
    v_mfma_f32_16x16x32_bf16 v[228:231], v[104:107], v[116:119], v[228:231]
    v_mfma_f32_16x16x32_bf16 v[232:235], v[104:107], v[120:123], v[232:235]
    v_mfma_f32_16x16x32_bf16 v[236:239], v[104:107], v[124:127], v[236:239]
    v_mfma_f32_16x16x32_bf16 v[240:243], v[108:111], v[112:115], v[240:243]
    v_mfma_f32_16x16x32_bf16 v[244:247], v[108:111], v[116:119], v[244:247]
    v_mfma_f32_16x16x32_bf16 v[248:251], v[108:111], v[120:123], v[248:251]
    v_mfma_f32_16x16x32_bf16 v[252:255], v[108:111], v[124:127], v[252:255]
    s_nop 7
LE_V:
    v_mov_b32 v3, 163584
    s_cmp_lg_u32 s26, 0
    s_cbranch_scc1 tt_167
    s_waitcnt vmcnt(0)
    s_mov_b64 exec, 1
    ds_write_b32 v3, v28
    s_waitcnt lgkmcnt(0)
    s_mov_b64 exec, -1
tt_167:
    s_barrier
    ds_read_b32 v5, v3
    s_waitcnt lgkmcnt(0)
    v_readfirstlane_b32 s25, v5
    s_nop 3
    s_lshr_b32 s37, s49, 24
    v_lshlrev_b32 v26, 6, v2
    s_cmp_ge_u32 s37, 128
    s_cbranch_scc1 to_168
    s_add_u32 s38, s37, 0
    s_lshl_b32 s38, s38, 2
    s_add_u32 s38, s38, s43
    s_lshl_b32 s38, s38, 3
    s_add_u32 s38, s38, s26
    s_lshl_b32 s38, s38, 12
    s_mov_b64 s[60:61], s[82:83]
    s_mov_b32 s39, 0
    s_cmp_ge_u32 s38, 4194304
    s_cselect_b64 s[60:61], s[92:93], s[60:61]
    s_cselect_b32 s39, 4194304, s39
    s_cmp_ge_u32 s38, 8388608
    s_cselect_b64 s[60:61], s[94:95], s[60:61]
    s_cselect_b32 s39, 8388608, s39
    s_cmp_ge_u32 s38, 14680064
    s_cselect_b64 s[60:61], s[96:97], s[60:61]
    s_cselect_b32 s39, 14680064, s39
    s_sub_u32 s38, s38, s39
    s_and_b32 s61, s61, 0xffff
    s_add_u32 s62, s38, 4096
    s_mov_b32 s63, 0x20000
    buffer_load_dword v1, v26, s[60:63], s38 offen
    s_cmp_ge_u32 s37, 127
    s_cbranch_scc1 to_168
    s_add_u32 s38, s37, 1
    s_lshl_b32 s38, s38, 2
    s_add_u32 s38, s38, s43
    s_lshl_b32 s38, s38, 3
    s_add_u32 s38, s38, s26
    s_lshl_b32 s38, s38, 12
    s_mov_b64 s[60:61], s[82:83]
    s_mov_b32 s39, 0
    s_cmp_ge_u32 s38, 4194304
    s_cselect_b64 s[60:61], s[92:93], s[60:61]
    s_cselect_b32 s39, 4194304, s39
    s_cmp_ge_u32 s38, 8388608
    s_cselect_b64 s[60:61], s[94:95], s[60:61]
    s_cselect_b32 s39, 8388608, s39
    s_cmp_ge_u32 s38, 14680064
    s_cselect_b64 s[60:61], s[96:97], s[60:61]
    s_cselect_b32 s39, 14680064, s39
    s_sub_u32 s38, s38, s39
    s_and_b32 s61, s61, 0xffff
    s_add_u32 s62, s38, 4096
    s_mov_b32 s63, 0x20000
    buffer_load_dword v1, v26, s[60:63], s38 offen
    s_cmp_ge_u32 s37, 126
    s_cbranch_scc1 to_168
    s_add_u32 s38, s37, 2
    s_lshl_b32 s38, s38, 2
    s_add_u32 s38, s38, s43
    s_lshl_b32 s38, s38, 3
    s_add_u32 s38, s38, s26
    s_lshl_b32 s38, s38, 12
    s_mov_b64 s[60:61], s[82:83]
    s_mov_b32 s39, 0
    s_cmp_ge_u32 s38, 4194304
    s_cselect_b64 s[60:61], s[92:93], s[60:61]
    s_cselect_b32 s39, 4194304, s39
    s_cmp_ge_u32 s38, 8388608
    s_cselect_b64 s[60:61], s[94:95], s[60:61]
    s_cselect_b32 s39, 8388608, s39
    s_cmp_ge_u32 s38, 14680064
    s_cselect_b64 s[60:61], s[96:97], s[60:61]
    s_cselect_b32 s39, 14680064, s39
    s_sub_u32 s38, s38, s39
    s_and_b32 s61, s61, 0xffff
    s_add_u32 s62, s38, 4096
    s_mov_b32 s63, 0x20000
    buffer_load_dword v1, v26, s[60:63], s38 offen
    s_cmp_ge_u32 s37, 125
    s_cbranch_scc1 to_168
    s_add_u32 s38, s37, 3
    s_lshl_b32 s38, s38, 2
    s_add_u32 s38, s38, s43
    s_lshl_b32 s38, s38, 3
    s_add_u32 s38, s38, s26
    s_lshl_b32 s38, s38, 12
    s_mov_b64 s[60:61], s[82:83]
    s_mov_b32 s39, 0
    s_cmp_ge_u32 s38, 4194304
    s_cselect_b64 s[60:61], s[92:93], s[60:61]
    s_cselect_b32 s39, 4194304, s39
    s_cmp_ge_u32 s38, 8388608
    s_cselect_b64 s[60:61], s[94:95], s[60:61]
    s_cselect_b32 s39, 8388608, s39
    s_cmp_ge_u32 s38, 14680064
    s_cselect_b64 s[60:61], s[96:97], s[60:61]
    s_cselect_b32 s39, 14680064, s39
    s_sub_u32 s38, s38, s39
    s_and_b32 s61, s61, 0xffff
    s_add_u32 s62, s38, 4096
    s_mov_b32 s63, 0x20000
    buffer_load_dword v1, v26, s[60:63], s38 offen
to_168:
    s_min_u32 s3, s25, 204
    s_lshl_b32 s3, s3, 2
    s_load_dword s7, s[50:51], s3
    s_waitcnt lgkmcnt(0)
E_V:
    s_cmp_lg_u32 s79, -1
    s_cbranch_scc1 hp_169
ht_170:
    s_sub_u32 s30, s30, 1
    s_cbranch_scc1 L_end
    v_mov_b32 v30, 128
    buffer_load_dword v31, v30, s[20:23], 0 offen sc1
hc_171:
    s_waitcnt vmcnt(0)
    v_readfirstlane_b32 s3, v31
    s_nop 3
    s_and_b32 s40, s3, 0xffff
    s_cmp_lt_u32 s40, 128
    s_cbranch_scc1 ht_170
    s_add_u32 s3, s3, 4128768
    s_lshr_b32 s3, s3, 10
    s_and_b32 s79, s3, 8192
hp_169:
    v_lshlrev_b32 v7, 4, v2
    s_lshr_b32 s38, s42, 5
    s_mul_i32 s39, s45, 2
    s_add_u32 s38, s38, s39
    s_lshl_b32 s38, s38, 6
    s_lshr_b32 s39, s41, 5
    s_add_u32 s38, s38, s39
    s_mul_i32 s39, s44, 4
    s_add_u32 s38, s38, s39
    s_mov_b32 s39, s38
    s_lshl_b32 s38, s38, 13
    s_add_u32 s38, s38, 134219776
    s_bfe_u32 s3, s39, 0x10008
    s_lshl_b32 s3, s3, 13
    s_xor_b32 s3, s3, s79
    s_xor_b32 s3, s3, 8192
    s_add_u32 s38, s38, s3
    s_add_u32 s39, s38, 0
    v_cvt_pk_bf16_f32 v32, v128, v129
    v_cvt_pk_bf16_f32 v33, v144, v145
    v_cvt_pk_bf16_f32 v34, v130, v131
    v_cvt_pk_bf16_f32 v35, v146, v147
    buffer_store_dwordx4 v[32:35], v7, s[8:11], s39 offen offset:0 sc1
    v_cvt_pk_bf16_f32 v36, v132, v133
    v_cvt_pk_bf16_f32 v37, v148, v149
    v_cvt_pk_bf16_f32 v38, v134, v135
    v_cvt_pk_bf16_f32 v39, v150, v151
    buffer_store_dwordx4 v[36:39], v7, s[8:11], s39 offen offset:1024 sc1
    s_add_u32 s39, s38, 4096
    v_cvt_pk_bf16_f32 v40, v160, v161
    v_cvt_pk_bf16_f32 v41, v176, v177
    v_cvt_pk_bf16_f32 v42, v162, v163
    v_cvt_pk_bf16_f32 v43, v178, v179
    buffer_store_dwordx4 v[40:43], v7, s[8:11], s39 offen offset:0 sc1
    v_cvt_pk_bf16_f32 v44, v164, v165
    v_cvt_pk_bf16_f32 v45, v180, v181
    v_cvt_pk_bf16_f32 v46, v166, v167
    v_cvt_pk_bf16_f32 v47, v182, v183
    buffer_store_dwordx4 v[44:47], v7, s[8:11], s39 offen offset:1024 sc1
    s_add_u32 s39, s38, 16384
    v_cvt_pk_bf16_f32 v48, v192, v193
    v_cvt_pk_bf16_f32 v49, v208, v209
    v_cvt_pk_bf16_f32 v50, v194, v195
    v_cvt_pk_bf16_f32 v51, v210, v211
    buffer_store_dwordx4 v[48:51], v7, s[8:11], s39 offen offset:0 sc1
    v_cvt_pk_bf16_f32 v52, v196, v197
    v_cvt_pk_bf16_f32 v53, v212, v213
    v_cvt_pk_bf16_f32 v54, v198, v199
    v_cvt_pk_bf16_f32 v55, v214, v215
    buffer_store_dwordx4 v[52:55], v7, s[8:11], s39 offen offset:1024 sc1
    s_add_u32 s39, s38, 20480
    v_cvt_pk_bf16_f32 v56, v224, v225
    v_cvt_pk_bf16_f32 v57, v240, v241
    v_cvt_pk_bf16_f32 v58, v226, v227
    v_cvt_pk_bf16_f32 v59, v242, v243
    buffer_store_dwordx4 v[56:59], v7, s[8:11], s39 offen offset:0 sc1
    v_cvt_pk_bf16_f32 v60, v228, v229
    v_cvt_pk_bf16_f32 v61, v244, v245
    v_cvt_pk_bf16_f32 v62, v230, v231
    v_cvt_pk_bf16_f32 v63, v246, v247
    buffer_store_dwordx4 v[60:63], v7, s[8:11], s39 offen offset:1024 sc1
    s_add_u32 s39, s38, 524288
    v_cvt_pk_bf16_f32 v32, v136, v137
    v_cvt_pk_bf16_f32 v33, v152, v153
    v_cvt_pk_bf16_f32 v34, v138, v139
    v_cvt_pk_bf16_f32 v35, v154, v155
    buffer_store_dwordx4 v[32:35], v7, s[8:11], s39 offen offset:0 sc1
    v_cvt_pk_bf16_f32 v36, v140, v141
    v_cvt_pk_bf16_f32 v37, v156, v157
    v_cvt_pk_bf16_f32 v38, v142, v143
    v_cvt_pk_bf16_f32 v39, v158, v159
    buffer_store_dwordx4 v[36:39], v7, s[8:11], s39 offen offset:1024 sc1
    s_add_u32 s39, s38, 528384
    v_cvt_pk_bf16_f32 v40, v168, v169
    v_cvt_pk_bf16_f32 v41, v184, v185
    v_cvt_pk_bf16_f32 v42, v170, v171
    v_cvt_pk_bf16_f32 v43, v186, v187
    buffer_store_dwordx4 v[40:43], v7, s[8:11], s39 offen offset:0 sc1
    v_cvt_pk_bf16_f32 v44, v172, v173
    v_cvt_pk_bf16_f32 v45, v188, v189
    v_cvt_pk_bf16_f32 v46, v174, v175
    v_cvt_pk_bf16_f32 v47, v190, v191
    buffer_store_dwordx4 v[44:47], v7, s[8:11], s39 offen offset:1024 sc1
    s_add_u32 s39, s38, 540672
    v_cvt_pk_bf16_f32 v48, v200, v201
    v_cvt_pk_bf16_f32 v49, v216, v217
    v_cvt_pk_bf16_f32 v50, v202, v203
    v_cvt_pk_bf16_f32 v51, v218, v219
    buffer_store_dwordx4 v[48:51], v7, s[8:11], s39 offen offset:0 sc1
    v_cvt_pk_bf16_f32 v52, v204, v205
    v_cvt_pk_bf16_f32 v53, v220, v221
    v_cvt_pk_bf16_f32 v54, v206, v207
    v_cvt_pk_bf16_f32 v55, v222, v223
    buffer_store_dwordx4 v[52:55], v7, s[8:11], s39 offen offset:1024 sc1
    s_add_u32 s39, s38, 544768
    v_cvt_pk_bf16_f32 v56, v232, v233
    v_cvt_pk_bf16_f32 v57, v248, v249
    v_cvt_pk_bf16_f32 v58, v234, v235
    v_cvt_pk_bf16_f32 v59, v250, v251
    buffer_store_dwordx4 v[56:59], v7, s[8:11], s39 offen offset:0 sc1
    v_cvt_pk_bf16_f32 v60, v236, v237
    v_cvt_pk_bf16_f32 v61, v252, v253
    v_cvt_pk_bf16_f32 v62, v238, v239
    v_cvt_pk_bf16_f32 v63, v254, v255
    buffer_store_dwordx4 v[60:63], v7, s[8:11], s39 offen offset:1024 sc1
    s_lshr_b32 s40, s41, 8
    s_lshl_b32 s40, s40, 2
    s_add_u32 s40, s40, s43
    s_lshl_b32 s40, s40, 7
    s_add_u32 s40, s40, 79720448
    s_waitcnt vmcnt(0)
    s_barrier
    s_cmp_lg_u32 s26, 1
    s_cbranch_scc1 sg_172
    v_mov_b32 v4, s40
    v_mov_b32 v5, 4
    s_mov_b64 exec, 1
    buffer_atomic_add v5, v4, s[8:11], 0 offen sc1
    s_mov_b64 exec, -1
sg_172:
    s_cmp_eq_u32 s6, 0
    s_cbranch_scc1 D_pre
    s_mov_b32 s6, 0
    s_branch D_main
LP_AKV:
    s_mov_b32 s34, 13
    s_mov_b32 s27, 0
    s_waitcnt vmcnt(8)
    s_barrier
    ds_read_b64_tr_b16 v[64:65], v18 offset:32768
    ds_read_b64_tr_b16 v[66:67], v18 offset:34816
    ds_read_b64_tr_b16 v[68:69], v19 offset:32768
    ds_read_b64_tr_b16 v[70:71], v19 offset:34816
    ds_read_b64_tr_b16 v[72:73], v20 offset:32768
    ds_read_b64_tr_b16 v[74:75], v20 offset:34816
    ds_read_b64_tr_b16 v[76:77], v21 offset:32768
    ds_read_b64_tr_b16 v[78:79], v21 offset:34816
    ds_read_b128 v[32:35], v16 offset:0
    ds_read_b128 v[36:39], v16 offset:2048
    ds_read_b128 v[40:43], v16 offset:4096
    ds_read_b128 v[44:47], v16 offset:6144
    ds_read_b128 v[48:51], v16 offset:8192
    ds_read_b128 v[52:55], v16 offset:10240
    ds_read_b128 v[56:59], v16 offset:12288
    ds_read_b128 v[60:63], v16 offset:14336
    s_waitcnt lgkmcnt(0)
    v_mfma_f32_16x16x32_bf16 v[128:131], v[32:35], v[64:67], 0
    ds_read_b64_tr_b16 v[112:113], v18 offset:49152
    v_mfma_f32_16x16x32_bf16 v[132:135], v[32:35], v[68:71], 0
    ds_read_b64_tr_b16 v[114:115], v18 offset:51200
    v_mfma_f32_16x16x32_bf16 v[136:139], v[32:35], v[72:75], 0
    ds_read_b64_tr_b16 v[116:117], v19 offset:49152
    v_mfma_f32_16x16x32_bf16 v[140:143], v[32:35], v[76:79], 0
    ds_read_b64_tr_b16 v[118:119], v19 offset:51200
    v_mfma_f32_16x16x32_bf16 v[144:147], v[36:39], v[64:67], 0
    ds_read_b64_tr_b16 v[120:121], v20 offset:49152
    v_mfma_f32_16x16x32_bf16 v[148:151], v[36:39], v[68:71], 0
    ds_read_b64_tr_b16 v[122:123], v20 offset:51200
    v_mfma_f32_16x16x32_bf16 v[152:155], v[36:39], v[72:75], 0
    ds_read_b64_tr_b16 v[124:125], v21 offset:49152
    v_mfma_f32_16x16x32_bf16 v[156:159], v[36:39], v[76:79], 0
    ds_read_b64_tr_b16 v[126:127], v21 offset:51200
    v_mfma_f32_16x16x32_bf16 v[160:163], v[40:43], v[64:67], 0
    ds_read_b128 v[80:83], v17 offset:0
    v_mfma_f32_16x16x32_bf16 v[164:167], v[40:43], v[68:71], 0
    ds_read_b128 v[84:87], v17 offset:2048
    v_mfma_f32_16x16x32_bf16 v[168:171], v[40:43], v[72:75], 0
    ds_read_b128 v[88:91], v17 offset:4096
    v_mfma_f32_16x16x32_bf16 v[172:175], v[40:43], v[76:79], 0
    ds_read_b128 v[92:95], v17 offset:6144
    v_mfma_f32_16x16x32_bf16 v[176:179], v[44:47], v[64:67], 0
    ds_read_b128 v[96:99], v17 offset:8192
    v_mfma_f32_16x16x32_bf16 v[180:183], v[44:47], v[68:71], 0
    ds_read_b128 v[100:103], v17 offset:10240
    v_mfma_f32_16x16x32_bf16 v[184:187], v[44:47], v[72:75], 0
    ds_read_b128 v[104:107], v17 offset:12288
    v_mfma_f32_16x16x32_bf16 v[188:191], v[44:47], v[76:79], 0
    ds_read_b128 v[108:111], v17 offset:14336
    v_mfma_f32_16x16x32_bf16 v[192:195], v[48:51], v[64:67], 0
    v_xor_b32 v16, 65536, v16
    v_mfma_f32_16x16x32_bf16 v[196:199], v[48:51], v[68:71], 0
    v_xor_b32 v17, 65536, v17
    v_mfma_f32_16x16x32_bf16 v[200:203], v[48:51], v[72:75], 0
    v_xor_b32 v18, 65536, v18
    v_mfma_f32_16x16x32_bf16 v[204:207], v[48:51], v[76:79], 0
    v_xor_b32 v19, 65536, v19
    v_mfma_f32_16x16x32_bf16 v[208:211], v[52:55], v[64:67], 0
    v_xor_b32 v20, 65536, v20
    v_mfma_f32_16x16x32_bf16 v[212:215], v[52:55], v[68:71], 0
    v_xor_b32 v21, 65536, v21
    v_mfma_f32_16x16x32_bf16 v[216:219], v[52:55], v[72:75], 0
    v_mfma_f32_16x16x32_bf16 v[220:223], v[52:55], v[76:79], 0
    v_mfma_f32_16x16x32_bf16 v[224:227], v[56:59], v[64:67], 0
    v_mfma_f32_16x16x32_bf16 v[228:231], v[56:59], v[68:71], 0
    v_mfma_f32_16x16x32_bf16 v[232:235], v[56:59], v[72:75], 0
    v_mfma_f32_16x16x32_bf16 v[236:239], v[56:59], v[76:79], 0
    v_mfma_f32_16x16x32_bf16 v[240:243], v[60:63], v[64:67], 0
    v_mfma_f32_16x16x32_bf16 v[244:247], v[60:63], v[68:71], 0
    v_mfma_f32_16x16x32_bf16 v[248:251], v[60:63], v[72:75], 0
    v_mfma_f32_16x16x32_bf16 v[252:255], v[60:63], v[76:79], 0
    s_waitcnt vmcnt(0) lgkmcnt(0)
    s_barrier
    v_mfma_f32_16x16x32_bf16 v[128:131], v[80:83], v[112:115], v[128:131]
    s_mov_b32 m0, s35
    s_xor_b32 s35, s35, 65536
    v_mfma_f32_16x16x32_bf16 v[132:135], v[80:83], v[116:119], v[132:135]
    ds_read_b64_tr_b16 v[64:65], v18 offset:32768
    v_mfma_f32_16x16x32_bf16 v[136:139], v[80:83], v[120:123], v[136:139]
    buffer_load_dwordx4 v8, s[12:15], s31 offen offset:0  lds
    v_mfma_f32_16x16x32_bf16 v[140:143], v[80:83], v[124:127], v[140:143]
    ds_read_b64_tr_b16 v[66:67], v18 offset:34816
    v_mfma_f32_16x16x32_bf16 v[144:147], v[84:87], v[112:115], v[144:147]
    buffer_load_dwordx4 v9, s[12:15], s31 offen offset:1024  lds
    v_mfma_f32_16x16x32_bf16 v[148:151], v[84:87], v[116:119], v[148:151]
    ds_read_b64_tr_b16 v[68:69], v19 offset:32768
    v_mfma_f32_16x16x32_bf16 v[152:155], v[84:87], v[120:123], v[152:155]
    buffer_load_dwordx4 v10, s[12:15], s31 offen offset:2048  lds
    v_mfma_f32_16x16x32_bf16 v[156:159], v[84:87], v[124:127], v[156:159]
    ds_read_b64_tr_b16 v[70:71], v19 offset:34816
    v_mfma_f32_16x16x32_bf16 v[160:163], v[88:91], v[112:115], v[160:163]
    buffer_load_dwordx4 v11, s[12:15], s31 offen offset:3072  lds
    v_mfma_f32_16x16x32_bf16 v[164:167], v[88:91], v[116:119], v[164:167]
    ds_read_b64_tr_b16 v[72:73], v20 offset:32768
    v_mfma_f32_16x16x32_bf16 v[168:171], v[88:91], v[120:123], v[168:171]
    s_mov_b32 m0, s36
    s_add_u32 s31, s31, 128
    s_xor_b32 s36, s36, 65536
    v_mfma_f32_16x16x32_bf16 v[172:175], v[88:91], v[124:127], v[172:175]
    ds_read_b64_tr_b16 v[74:75], v20 offset:34816
    v_mfma_f32_16x16x32_bf16 v[176:179], v[92:95], v[112:115], v[176:179]
    buffer_load_dwordx4 v12, s[16:19], s32 offen offset:0  lds
    v_mfma_f32_16x16x32_bf16 v[180:183], v[92:95], v[116:119], v[180:183]
    ds_read_b64_tr_b16 v[76:77], v21 offset:32768
    v_mfma_f32_16x16x32_bf16 v[184:187], v[92:95], v[120:123], v[184:187]
    buffer_load_dwordx4 v13, s[16:19], s32 offen offset:1024  lds
    v_mfma_f32_16x16x32_bf16 v[188:191], v[92:95], v[124:127], v[188:191]
    ds_read_b64_tr_b16 v[78:79], v21 offset:34816
    v_mfma_f32_16x16x32_bf16 v[192:195], v[96:99], v[112:115], v[192:195]
    buffer_load_dwordx4 v14, s[16:19], s32 offen offset:2048  lds
    v_mfma_f32_16x16x32_bf16 v[196:199], v[96:99], v[116:119], v[196:199]
    ds_read_b128 v[32:35], v16 offset:0
    v_mfma_f32_16x16x32_bf16 v[200:203], v[96:99], v[120:123], v[200:203]
    buffer_load_dwordx4 v15, s[16:19], s32 offen offset:3072  lds
    v_mfma_f32_16x16x32_bf16 v[204:207], v[96:99], v[124:127], v[204:207]
    ds_read_b128 v[36:39], v16 offset:2048
    v_mfma_f32_16x16x32_bf16 v[208:211], v[100:103], v[112:115], v[208:211]
    s_add_u32 s32, s32, s33
    v_mfma_f32_16x16x32_bf16 v[212:215], v[100:103], v[116:119], v[212:215]
    ds_read_b128 v[40:43], v16 offset:4096
    v_mfma_f32_16x16x32_bf16 v[216:219], v[100:103], v[120:123], v[216:219]
    ds_read_b128 v[44:47], v16 offset:6144
    v_mfma_f32_16x16x32_bf16 v[220:223], v[100:103], v[124:127], v[220:223]
    ds_read_b128 v[48:51], v16 offset:8192
    v_mfma_f32_16x16x32_bf16 v[224:227], v[104:107], v[112:115], v[224:227]
    ds_read_b128 v[52:55], v16 offset:10240
    v_mfma_f32_16x16x32_bf16 v[228:231], v[104:107], v[116:119], v[228:231]
    ds_read_b128 v[56:59], v16 offset:12288
    v_mfma_f32_16x16x32_bf16 v[232:235], v[104:107], v[120:123], v[232:235]
    ds_read_b128 v[60:63], v16 offset:14336
    v_mfma_f32_16x16x32_bf16 v[236:239], v[104:107], v[124:127], v[236:239]
    v_mfma_f32_16x16x32_bf16 v[240:243], v[108:111], v[112:115], v[240:243]
    v_mfma_f32_16x16x32_bf16 v[244:247], v[108:111], v[116:119], v[244:247]
    v_mfma_f32_16x16x32_bf16 v[248:251], v[108:111], v[120:123], v[248:251]
    v_mfma_f32_16x16x32_bf16 v[252:255], v[108:111], v[124:127], v[252:255]
gl_173:
    s_waitcnt lgkmcnt(0)
    v_mfma_f32_16x16x32_bf16 v[128:131], v[32:35], v[64:67], v[128:131]
    ds_read_b64_tr_b16 v[112:113], v18 offset:49152
    v_mfma_f32_16x16x32_bf16 v[132:135], v[32:35], v[68:71], v[132:135]
    ds_read_b64_tr_b16 v[114:115], v18 offset:51200
    v_mfma_f32_16x16x32_bf16 v[136:139], v[32:35], v[72:75], v[136:139]
    ds_read_b64_tr_b16 v[116:117], v19 offset:49152
    v_mfma_f32_16x16x32_bf16 v[140:143], v[32:35], v[76:79], v[140:143]
    ds_read_b64_tr_b16 v[118:119], v19 offset:51200
    v_mfma_f32_16x16x32_bf16 v[144:147], v[36:39], v[64:67], v[144:147]
    ds_read_b64_tr_b16 v[120:121], v20 offset:49152
    v_mfma_f32_16x16x32_bf16 v[148:151], v[36:39], v[68:71], v[148:151]
    ds_read_b64_tr_b16 v[122:123], v20 offset:51200
    v_mfma_f32_16x16x32_bf16 v[152:155], v[36:39], v[72:75], v[152:155]
    ds_read_b64_tr_b16 v[124:125], v21 offset:49152
    v_mfma_f32_16x16x32_bf16 v[156:159], v[36:39], v[76:79], v[156:159]
    ds_read_b64_tr_b16 v[126:127], v21 offset:51200
    v_mfma_f32_16x16x32_bf16 v[160:163], v[40:43], v[64:67], v[160:163]
    ds_read_b128 v[80:83], v17 offset:0
    v_mfma_f32_16x16x32_bf16 v[164:167], v[40:43], v[68:71], v[164:167]
    ds_read_b128 v[84:87], v17 offset:2048
    v_mfma_f32_16x16x32_bf16 v[168:171], v[40:43], v[72:75], v[168:171]
    ds_read_b128 v[88:91], v17 offset:4096
    v_mfma_f32_16x16x32_bf16 v[172:175], v[40:43], v[76:79], v[172:175]
    ds_read_b128 v[92:95], v17 offset:6144
    v_mfma_f32_16x16x32_bf16 v[176:179], v[44:47], v[64:67], v[176:179]
    ds_read_b128 v[96:99], v17 offset:8192
    v_mfma_f32_16x16x32_bf16 v[180:183], v[44:47], v[68:71], v[180:183]
    ds_read_b128 v[100:103], v17 offset:10240
    v_mfma_f32_16x16x32_bf16 v[184:187], v[44:47], v[72:75], v[184:187]
    ds_read_b128 v[104:107], v17 offset:12288
    v_mfma_f32_16x16x32_bf16 v[188:191], v[44:47], v[76:79], v[188:191]
    ds_read_b128 v[108:111], v17 offset:14336
    v_mfma_f32_16x16x32_bf16 v[192:195], v[48:51], v[64:67], v[192:195]
    v_xor_b32 v16, 65536, v16
    v_mfma_f32_16x16x32_bf16 v[196:199], v[48:51], v[68:71], v[196:199]
    v_xor_b32 v17, 65536, v17
    v_mfma_f32_16x16x32_bf16 v[200:203], v[48:51], v[72:75], v[200:203]
    v_xor_b32 v18, 65536, v18
    v_mfma_f32_16x16x32_bf16 v[204:207], v[48:51], v[76:79], v[204:207]
    v_xor_b32 v19, 65536, v19
    v_mfma_f32_16x16x32_bf16 v[208:211], v[52:55], v[64:67], v[208:211]
    v_xor_b32 v20, 65536, v20
    v_mfma_f32_16x16x32_bf16 v[212:215], v[52:55], v[68:71], v[212:215]
    v_xor_b32 v21, 65536, v21
    v_mfma_f32_16x16x32_bf16 v[216:219], v[52:55], v[72:75], v[216:219]
    v_mfma_f32_16x16x32_bf16 v[220:223], v[52:55], v[76:79], v[220:223]
    v_mfma_f32_16x16x32_bf16 v[224:227], v[56:59], v[64:67], v[224:227]
    v_mfma_f32_16x16x32_bf16 v[228:231], v[56:59], v[68:71], v[228:231]
    v_mfma_f32_16x16x32_bf16 v[232:235], v[56:59], v[72:75], v[232:235]
    v_mfma_f32_16x16x32_bf16 v[236:239], v[56:59], v[76:79], v[236:239]
    v_mfma_f32_16x16x32_bf16 v[240:243], v[60:63], v[64:67], v[240:243]
    v_mfma_f32_16x16x32_bf16 v[244:247], v[60:63], v[68:71], v[244:247]
    v_mfma_f32_16x16x32_bf16 v[248:251], v[60:63], v[72:75], v[248:251]
    v_mfma_f32_16x16x32_bf16 v[252:255], v[60:63], v[76:79], v[252:255]
    s_waitcnt vmcnt(0) lgkmcnt(0)
    s_barrier
    v_mfma_f32_16x16x32_bf16 v[128:131], v[80:83], v[112:115], v[128:131]
    s_mov_b32 m0, s35
    s_xor_b32 s35, s35, 65536
    v_mfma_f32_16x16x32_bf16 v[132:135], v[80:83], v[116:119], v[132:135]
    ds_read_b64_tr_b16 v[64:65], v18 offset:32768
    v_mfma_f32_16x16x32_bf16 v[136:139], v[80:83], v[120:123], v[136:139]
    buffer_load_dwordx4 v8, s[12:15], s31 offen offset:0  lds
    v_mfma_f32_16x16x32_bf16 v[140:143], v[80:83], v[124:127], v[140:143]
    ds_read_b64_tr_b16 v[66:67], v18 offset:34816
    v_mfma_f32_16x16x32_bf16 v[144:147], v[84:87], v[112:115], v[144:147]
    buffer_load_dwordx4 v9, s[12:15], s31 offen offset:1024  lds
    v_mfma_f32_16x16x32_bf16 v[148:151], v[84:87], v[116:119], v[148:151]
    ds_read_b64_tr_b16 v[68:69], v19 offset:32768
    v_mfma_f32_16x16x32_bf16 v[152:155], v[84:87], v[120:123], v[152:155]
    buffer_load_dwordx4 v10, s[12:15], s31 offen offset:2048  lds
    v_mfma_f32_16x16x32_bf16 v[156:159], v[84:87], v[124:127], v[156:159]
    ds_read_b64_tr_b16 v[70:71], v19 offset:34816
    v_mfma_f32_16x16x32_bf16 v[160:163], v[88:91], v[112:115], v[160:163]
    buffer_load_dwordx4 v11, s[12:15], s31 offen offset:3072  lds
    v_mfma_f32_16x16x32_bf16 v[164:167], v[88:91], v[116:119], v[164:167]
    ds_read_b64_tr_b16 v[72:73], v20 offset:32768
    v_mfma_f32_16x16x32_bf16 v[168:171], v[88:91], v[120:123], v[168:171]
    s_mov_b32 m0, s36
    s_add_u32 s31, s31, 128
    s_xor_b32 s36, s36, 65536
    v_mfma_f32_16x16x32_bf16 v[172:175], v[88:91], v[124:127], v[172:175]
    ds_read_b64_tr_b16 v[74:75], v20 offset:34816
    v_mfma_f32_16x16x32_bf16 v[176:179], v[92:95], v[112:115], v[176:179]
    buffer_load_dwordx4 v12, s[16:19], s32 offen offset:0  lds
    v_mfma_f32_16x16x32_bf16 v[180:183], v[92:95], v[116:119], v[180:183]
    ds_read_b64_tr_b16 v[76:77], v21 offset:32768
    v_mfma_f32_16x16x32_bf16 v[184:187], v[92:95], v[120:123], v[184:187]
    buffer_load_dwordx4 v13, s[16:19], s32 offen offset:1024  lds
    v_mfma_f32_16x16x32_bf16 v[188:191], v[92:95], v[124:127], v[188:191]
    ds_read_b64_tr_b16 v[78:79], v21 offset:34816
    v_mfma_f32_16x16x32_bf16 v[192:195], v[96:99], v[112:115], v[192:195]
    buffer_load_dwordx4 v14, s[16:19], s32 offen offset:2048  lds
    v_mfma_f32_16x16x32_bf16 v[196:199], v[96:99], v[116:119], v[196:199]
    ds_read_b128 v[32:35], v16 offset:0
    v_mfma_f32_16x16x32_bf16 v[200:203], v[96:99], v[120:123], v[200:203]
    buffer_load_dwordx4 v15, s[16:19], s32 offen offset:3072  lds
    v_mfma_f32_16x16x32_bf16 v[204:207], v[96:99], v[124:127], v[204:207]
    ds_read_b128 v[36:39], v16 offset:2048
    v_mfma_f32_16x16x32_bf16 v[208:211], v[100:103], v[112:115], v[208:211]
    s_add_u32 s32, s32, s33
    v_mfma_f32_16x16x32_bf16 v[212:215], v[100:103], v[116:119], v[212:215]
    ds_read_b128 v[40:43], v16 offset:4096
    v_mfma_f32_16x16x32_bf16 v[216:219], v[100:103], v[120:123], v[216:219]
    ds_read_b128 v[44:47], v16 offset:6144
    v_mfma_f32_16x16x32_bf16 v[220:223], v[100:103], v[124:127], v[220:223]
    ds_read_b128 v[48:51], v16 offset:8192
    v_mfma_f32_16x16x32_bf16 v[224:227], v[104:107], v[112:115], v[224:227]
    ds_read_b128 v[52:55], v16 offset:10240
    v_mfma_f32_16x16x32_bf16 v[228:231], v[104:107], v[116:119], v[228:231]
    ds_read_b128 v[56:59], v16 offset:12288
    v_mfma_f32_16x16x32_bf16 v[232:235], v[104:107], v[120:123], v[232:235]
    ds_read_b128 v[60:63], v16 offset:14336
    v_mfma_f32_16x16x32_bf16 v[236:239], v[104:107], v[124:127], v[236:239]
    v_mfma_f32_16x16x32_bf16 v[240:243], v[108:111], v[112:115], v[240:243]
    v_mfma_f32_16x16x32_bf16 v[244:247], v[108:111], v[116:119], v[244:247]
    v_mfma_f32_16x16x32_bf16 v[248:251], v[108:111], v[120:123], v[248:251]
    v_mfma_f32_16x16x32_bf16 v[252:255], v[108:111], v[124:127], v[252:255]
    s_sub_u32 s34, s34, 1
    s_cmp_lg_u32 s34, 0
    s_cbranch_scc1 gl_173
    s_cmp_lg_u32 s26, 0
    s_cbranch_scc1 ti_174
    s_lshl_b32 s3, s43, 2
    s_add_u32 s3, s3, 16
    v_mov_b32 v27, s3
    v_mov_b32 v28, 1
    s_mov_b64 exec, 1
    buffer_atomic_add v28, v27, s[20:23], 0 offen sc0 sc1
    s_mov_b64 exec, -1
ti_174:
    s_waitcnt lgkmcnt(0)
    v_mfma_f32_16x16x32_bf16 v[128:131], v[32:35], v[64:67], v[128:131]
    ds_read_b64_tr_b16 v[112:113], v18 offset:49152
    v_mfma_f32_16x16x32_bf16 v[132:135], v[32:35], v[68:71], v[132:135]
    ds_read_b64_tr_b16 v[114:115], v18 offset:51200
    v_mfma_f32_16x16x32_bf16 v[136:139], v[32:35], v[72:75], v[136:139]
    ds_read_b64_tr_b16 v[116:117], v19 offset:49152
    v_mfma_f32_16x16x32_bf16 v[140:143], v[32:35], v[76:79], v[140:143]
    ds_read_b64_tr_b16 v[118:119], v19 offset:51200
    v_mfma_f32_16x16x32_bf16 v[144:147], v[36:39], v[64:67], v[144:147]
    ds_read_b64_tr_b16 v[120:121], v20 offset:49152
    v_mfma_f32_16x16x32_bf16 v[148:151], v[36:39], v[68:71], v[148:151]
    ds_read_b64_tr_b16 v[122:123], v20 offset:51200
    v_mfma_f32_16x16x32_bf16 v[152:155], v[36:39], v[72:75], v[152:155]
    ds_read_b64_tr_b16 v[124:125], v21 offset:49152
    v_mfma_f32_16x16x32_bf16 v[156:159], v[36:39], v[76:79], v[156:159]
    ds_read_b64_tr_b16 v[126:127], v21 offset:51200
    v_mfma_f32_16x16x32_bf16 v[160:163], v[40:43], v[64:67], v[160:163]
    ds_read_b128 v[80:83], v17 offset:0
    v_mfma_f32_16x16x32_bf16 v[164:167], v[40:43], v[68:71], v[164:167]
    ds_read_b128 v[84:87], v17 offset:2048
    v_mfma_f32_16x16x32_bf16 v[168:171], v[40:43], v[72:75], v[168:171]
    ds_read_b128 v[88:91], v17 offset:4096
    v_mfma_f32_16x16x32_bf16 v[172:175], v[40:43], v[76:79], v[172:175]
    ds_read_b128 v[92:95], v17 offset:6144
    v_mfma_f32_16x16x32_bf16 v[176:179], v[44:47], v[64:67], v[176:179]
    ds_read_b128 v[96:99], v17 offset:8192
    v_mfma_f32_16x16x32_bf16 v[180:183], v[44:47], v[68:71], v[180:183]
    ds_read_b128 v[100:103], v17 offset:10240
    v_mfma_f32_16x16x32_bf16 v[184:187], v[44:47], v[72:75], v[184:187]
    ds_read_b128 v[104:107], v17 offset:12288
    v_mfma_f32_16x16x32_bf16 v[188:191], v[44:47], v[76:79], v[188:191]
    ds_read_b128 v[108:111], v17 offset:14336
    v_mfma_f32_16x16x32_bf16 v[192:195], v[48:51], v[64:67], v[192:195]
    v_xor_b32 v16, 65536, v16
    v_mfma_f32_16x16x32_bf16 v[196:199], v[48:51], v[68:71], v[196:199]
    v_xor_b32 v17, 65536, v17
    v_mfma_f32_16x16x32_bf16 v[200:203], v[48:51], v[72:75], v[200:203]
    v_xor_b32 v18, 65536, v18
    v_mfma_f32_16x16x32_bf16 v[204:207], v[48:51], v[76:79], v[204:207]
    v_xor_b32 v19, 65536, v19
    v_mfma_f32_16x16x32_bf16 v[208:211], v[52:55], v[64:67], v[208:211]
    v_xor_b32 v20, 65536, v20
    v_mfma_f32_16x16x32_bf16 v[212:215], v[52:55], v[68:71], v[212:215]
    v_xor_b32 v21, 65536, v21
    v_mfma_f32_16x16x32_bf16 v[216:219], v[52:55], v[72:75], v[216:219]
    v_mfma_f32_16x16x32_bf16 v[220:223], v[52:55], v[76:79], v[220:223]
    v_mfma_f32_16x16x32_bf16 v[224:227], v[56:59], v[64:67], v[224:227]
    v_mfma_f32_16x16x32_bf16 v[228:231], v[56:59], v[68:71], v[228:231]
    v_mfma_f32_16x16x32_bf16 v[232:235], v[56:59], v[72:75], v[232:235]
    v_mfma_f32_16x16x32_bf16 v[236:239], v[56:59], v[76:79], v[236:239]
    v_mfma_f32_16x16x32_bf16 v[240:243], v[60:63], v[64:67], v[240:243]
    v_mfma_f32_16x16x32_bf16 v[244:247], v[60:63], v[68:71], v[244:247]
    v_mfma_f32_16x16x32_bf16 v[248:251], v[60:63], v[72:75], v[248:251]
    v_mfma_f32_16x16x32_bf16 v[252:255], v[60:63], v[76:79], v[252:255]
    s_waitcnt vmcnt(0) lgkmcnt(0)
    s_barrier
    v_mfma_f32_16x16x32_bf16 v[128:131], v[80:83], v[112:115], v[128:131]
    ds_read_b64_tr_b16 v[64:65], v18 offset:32768
    v_mfma_f32_16x16x32_bf16 v[132:135], v[80:83], v[116:119], v[132:135]
    ds_read_b64_tr_b16 v[66:67], v18 offset:34816
    v_mfma_f32_16x16x32_bf16 v[136:139], v[80:83], v[120:123], v[136:139]
    ds_read_b64_tr_b16 v[68:69], v19 offset:32768
    v_mfma_f32_16x16x32_bf16 v[140:143], v[80:83], v[124:127], v[140:143]
    ds_read_b64_tr_b16 v[70:71], v19 offset:34816
    v_mfma_f32_16x16x32_bf16 v[144:147], v[84:87], v[112:115], v[144:147]
    ds_read_b64_tr_b16 v[72:73], v20 offset:32768
    v_mfma_f32_16x16x32_bf16 v[148:151], v[84:87], v[116:119], v[148:151]
    ds_read_b64_tr_b16 v[74:75], v20 offset:34816
    v_mfma_f32_16x16x32_bf16 v[152:155], v[84:87], v[120:123], v[152:155]
    ds_read_b64_tr_b16 v[76:77], v21 offset:32768
    v_mfma_f32_16x16x32_bf16 v[156:159], v[84:87], v[124:127], v[156:159]
    ds_read_b64_tr_b16 v[78:79], v21 offset:34816
    v_mfma_f32_16x16x32_bf16 v[160:163], v[88:91], v[112:115], v[160:163]
    ds_read_b128 v[32:35], v16 offset:0
    v_mfma_f32_16x16x32_bf16 v[164:167], v[88:91], v[116:119], v[164:167]
    ds_read_b128 v[36:39], v16 offset:2048
    v_mfma_f32_16x16x32_bf16 v[168:171], v[88:91], v[120:123], v[168:171]
    ds_read_b128 v[40:43], v16 offset:4096
    v_mfma_f32_16x16x32_bf16 v[172:175], v[88:91], v[124:127], v[172:175]
    ds_read_b128 v[44:47], v16 offset:6144
    v_mfma_f32_16x16x32_bf16 v[176:179], v[92:95], v[112:115], v[176:179]
    ds_read_b128 v[48:51], v16 offset:8192
    v_mfma_f32_16x16x32_bf16 v[180:183], v[92:95], v[116:119], v[180:183]
    ds_read_b128 v[52:55], v16 offset:10240
    v_mfma_f32_16x16x32_bf16 v[184:187], v[92:95], v[120:123], v[184:187]
    ds_read_b128 v[56:59], v16 offset:12288
    v_mfma_f32_16x16x32_bf16 v[188:191], v[92:95], v[124:127], v[188:191]
    ds_read_b128 v[60:63], v16 offset:14336
    v_mfma_f32_16x16x32_bf16 v[192:195], v[96:99], v[112:115], v[192:195]
    v_mfma_f32_16x16x32_bf16 v[196:199], v[96:99], v[116:119], v[196:199]
    v_mfma_f32_16x16x32_bf16 v[200:203], v[96:99], v[120:123], v[200:203]
    v_mfma_f32_16x16x32_bf16 v[204:207], v[96:99], v[124:127], v[204:207]
    v_mfma_f32_16x16x32_bf16 v[208:211], v[100:103], v[112:115], v[208:211]
    v_mfma_f32_16x16x32_bf16 v[212:215], v[100:103], v[116:119], v[212:215]
    v_mfma_f32_16x16x32_bf16 v[216:219], v[100:103], v[120:123], v[216:219]
    v_mfma_f32_16x16x32_bf16 v[220:223], v[100:103], v[124:127], v[220:223]
    v_mfma_f32_16x16x32_bf16 v[224:227], v[104:107], v[112:115], v[224:227]
    v_mfma_f32_16x16x32_bf16 v[228:231], v[104:107], v[116:119], v[228:231]
    v_mfma_f32_16x16x32_bf16 v[232:235], v[104:107], v[120:123], v[232:235]
    v_mfma_f32_16x16x32_bf16 v[236:239], v[104:107], v[124:127], v[236:239]
    v_mfma_f32_16x16x32_bf16 v[240:243], v[108:111], v[112:115], v[240:243]
    v_mfma_f32_16x16x32_bf16 v[244:247], v[108:111], v[116:119], v[244:247]
    v_mfma_f32_16x16x32_bf16 v[248:251], v[108:111], v[120:123], v[248:251]
    v_mfma_f32_16x16x32_bf16 v[252:255], v[108:111], v[124:127], v[252:255]
    s_waitcnt lgkmcnt(0)
    v_mfma_f32_16x16x32_bf16 v[128:131], v[32:35], v[64:67], v[128:131]
    ds_read_b64_tr_b16 v[112:113], v18 offset:49152
    v_mfma_f32_16x16x32_bf16 v[132:135], v[32:35], v[68:71], v[132:135]
    ds_read_b64_tr_b16 v[114:115], v18 offset:51200
    v_mfma_f32_16x16x32_bf16 v[136:139], v[32:35], v[72:75], v[136:139]
    ds_read_b64_tr_b16 v[116:117], v19 offset:49152
    v_mfma_f32_16x16x32_bf16 v[140:143], v[32:35], v[76:79], v[140:143]
    ds_read_b64_tr_b16 v[118:119], v19 offset:51200
    v_mfma_f32_16x16x32_bf16 v[144:147], v[36:39], v[64:67], v[144:147]
    ds_read_b64_tr_b16 v[120:121], v20 offset:49152
    v_mfma_f32_16x16x32_bf16 v[148:151], v[36:39], v[68:71], v[148:151]
    ds_read_b64_tr_b16 v[122:123], v20 offset:51200
    v_mfma_f32_16x16x32_bf16 v[152:155], v[36:39], v[72:75], v[152:155]
    ds_read_b64_tr_b16 v[124:125], v21 offset:49152
    v_mfma_f32_16x16x32_bf16 v[156:159], v[36:39], v[76:79], v[156:159]
    ds_read_b64_tr_b16 v[126:127], v21 offset:51200
    v_mfma_f32_16x16x32_bf16 v[160:163], v[40:43], v[64:67], v[160:163]
    ds_read_b128 v[80:83], v17 offset:0
    v_mfma_f32_16x16x32_bf16 v[164:167], v[40:43], v[68:71], v[164:167]
    ds_read_b128 v[84:87], v17 offset:2048
    v_mfma_f32_16x16x32_bf16 v[168:171], v[40:43], v[72:75], v[168:171]
    ds_read_b128 v[88:91], v17 offset:4096
    v_mfma_f32_16x16x32_bf16 v[172:175], v[40:43], v[76:79], v[172:175]
    ds_read_b128 v[92:95], v17 offset:6144
    v_mfma_f32_16x16x32_bf16 v[176:179], v[44:47], v[64:67], v[176:179]
    ds_read_b128 v[96:99], v17 offset:8192
    v_mfma_f32_16x16x32_bf16 v[180:183], v[44:47], v[68:71], v[180:183]
    ds_read_b128 v[100:103], v17 offset:10240
    v_mfma_f32_16x16x32_bf16 v[184:187], v[44:47], v[72:75], v[184:187]
    ds_read_b128 v[104:107], v17 offset:12288
    v_mfma_f32_16x16x32_bf16 v[188:191], v[44:47], v[76:79], v[188:191]
    ds_read_b128 v[108:111], v17 offset:14336
    v_mfma_f32_16x16x32_bf16 v[192:195], v[48:51], v[64:67], v[192:195]
    v_xor_b32 v16, 65536, v16
    v_mfma_f32_16x16x32_bf16 v[196:199], v[48:51], v[68:71], v[196:199]
    v_xor_b32 v17, 65536, v17
    v_mfma_f32_16x16x32_bf16 v[200:203], v[48:51], v[72:75], v[200:203]
    v_xor_b32 v18, 65536, v18
    v_mfma_f32_16x16x32_bf16 v[204:207], v[48:51], v[76:79], v[204:207]
    v_xor_b32 v19, 65536, v19
    v_mfma_f32_16x16x32_bf16 v[208:211], v[52:55], v[64:67], v[208:211]
    v_xor_b32 v20, 65536, v20
    v_mfma_f32_16x16x32_bf16 v[212:215], v[52:55], v[68:71], v[212:215]
    v_xor_b32 v21, 65536, v21
    v_mfma_f32_16x16x32_bf16 v[216:219], v[52:55], v[72:75], v[216:219]
    v_mfma_f32_16x16x32_bf16 v[220:223], v[52:55], v[76:79], v[220:223]
    v_mfma_f32_16x16x32_bf16 v[224:227], v[56:59], v[64:67], v[224:227]
    v_mfma_f32_16x16x32_bf16 v[228:231], v[56:59], v[68:71], v[228:231]
    v_mfma_f32_16x16x32_bf16 v[232:235], v[56:59], v[72:75], v[232:235]
    v_mfma_f32_16x16x32_bf16 v[236:239], v[56:59], v[76:79], v[236:239]
    v_mfma_f32_16x16x32_bf16 v[240:243], v[60:63], v[64:67], v[240:243]
    v_mfma_f32_16x16x32_bf16 v[244:247], v[60:63], v[68:71], v[244:247]
    v_mfma_f32_16x16x32_bf16 v[248:251], v[60:63], v[72:75], v[248:251]
    v_mfma_f32_16x16x32_bf16 v[252:255], v[60:63], v[76:79], v[252:255]
    s_waitcnt lgkmcnt(0)
    v_mfma_f32_16x16x32_bf16 v[128:131], v[80:83], v[112:115], v[128:131]
    v_mfma_f32_16x16x32_bf16 v[132:135], v[80:83], v[116:119], v[132:135]
    v_mfma_f32_16x16x32_bf16 v[136:139], v[80:83], v[120:123], v[136:139]
    v_mfma_f32_16x16x32_bf16 v[140:143], v[80:83], v[124:127], v[140:143]
    v_mfma_f32_16x16x32_bf16 v[144:147], v[84:87], v[112:115], v[144:147]
    v_mfma_f32_16x16x32_bf16 v[148:151], v[84:87], v[116:119], v[148:151]
    v_mfma_f32_16x16x32_bf16 v[152:155], v[84:87], v[120:123], v[152:155]
    v_mfma_f32_16x16x32_bf16 v[156:159], v[84:87], v[124:127], v[156:159]
    v_mfma_f32_16x16x32_bf16 v[160:163], v[88:91], v[112:115], v[160:163]
    v_mfma_f32_16x16x32_bf16 v[164:167], v[88:91], v[116:119], v[164:167]
    v_mfma_f32_16x16x32_bf16 v[168:171], v[88:91], v[120:123], v[168:171]
    v_mfma_f32_16x16x32_bf16 v[172:175], v[88:91], v[124:127], v[172:175]
    v_mfma_f32_16x16x32_bf16 v[176:179], v[92:95], v[112:115], v[176:179]
    v_mfma_f32_16x16x32_bf16 v[180:183], v[92:95], v[116:119], v[180:183]
    v_mfma_f32_16x16x32_bf16 v[184:187], v[92:95], v[120:123], v[184:187]
    v_mfma_f32_16x16x32_bf16 v[188:191], v[92:95], v[124:127], v[188:191]
    v_mfma_f32_16x16x32_bf16 v[192:195], v[96:99], v[112:115], v[192:195]
    v_mfma_f32_16x16x32_bf16 v[196:199], v[96:99], v[116:119], v[196:199]
    v_mfma_f32_16x16x32_bf16 v[200:203], v[96:99], v[120:123], v[200:203]
    v_mfma_f32_16x16x32_bf16 v[204:207], v[96:99], v[124:127], v[204:207]
    v_mfma_f32_16x16x32_bf16 v[208:211], v[100:103], v[112:115], v[208:211]
    v_mfma_f32_16x16x32_bf16 v[212:215], v[100:103], v[116:119], v[212:215]
    v_mfma_f32_16x16x32_bf16 v[216:219], v[100:103], v[120:123], v[216:219]
    v_mfma_f32_16x16x32_bf16 v[220:223], v[100:103], v[124:127], v[220:223]
    v_mfma_f32_16x16x32_bf16 v[224:227], v[104:107], v[112:115], v[224:227]
    v_mfma_f32_16x16x32_bf16 v[228:231], v[104:107], v[116:119], v[228:231]
    v_mfma_f32_16x16x32_bf16 v[232:235], v[104:107], v[120:123], v[232:235]
    v_mfma_f32_16x16x32_bf16 v[236:239], v[104:107], v[124:127], v[236:239]
    v_mfma_f32_16x16x32_bf16 v[240:243], v[108:111], v[112:115], v[240:243]
    v_mfma_f32_16x16x32_bf16 v[244:247], v[108:111], v[116:119], v[244:247]
    v_mfma_f32_16x16x32_bf16 v[248:251], v[108:111], v[120:123], v[248:251]
    v_mfma_f32_16x16x32_bf16 v[252:255], v[108:111], v[124:127], v[252:255]
    s_nop 7
LE_AKV:
    v_mov_b32 v3, 163584
    s_cmp_lg_u32 s26, 0
    s_cbranch_scc1 tt_175
    s_waitcnt vmcnt(0)
    s_mov_b64 exec, 1
    ds_write_b32 v3, v28
    s_waitcnt lgkmcnt(0)
    s_mov_b64 exec, -1
tt_175:
    s_barrier
    ds_read_b32 v5, v3
    s_waitcnt lgkmcnt(0)
    v_readfirstlane_b32 s25, v5
    s_nop 3
    s_min_u32 s3, s25, 204
    s_lshl_b32 s3, s3, 2
    s_load_dword s7, s[50:51], s3
    s_waitcnt lgkmcnt(0)
E_AKV:
    s_cmp_lg_u32 s79, -1
    s_cbranch_scc1 hp_176
ht_177:
    s_sub_u32 s30, s30, 1
    s_cbranch_scc1 L_end
    v_mov_b32 v30, 128
    buffer_load_dword v31, v30, s[20:23], 0 offen sc1
hc_178:
    s_waitcnt vmcnt(0)
    v_readfirstlane_b32 s3, v31
    s_nop 3
    s_and_b32 s40, s3, 0xffff
    s_cmp_lt_u32 s40, 128
    s_cbranch_scc1 ht_177
    s_add_u32 s3, s3, 4128768
    s_lshr_b32 s3, s3, 10
    s_and_b32 s79, s3, 8192
hp_176:
    s_mov_b32 s46, 0x3fb8aa3b
    s_mov_b32 s47, 0x358637bd
    s_mov_b32 s48, 0xffff0000
    v_mov_b32 v22, s46
    v_mov_b32 v23, s47
    v_mov_b32 v48, 0x3f803f80
    v_mov_b32 v49, 0x3f803f80
    v_mov_b32 v50, 0x3f803f80
    v_mov_b32 v51, 0x3f803f80
    v_cvt_pk_bf16_f32 v80, v128, v129
    v_cvt_pk_bf16_f32 v81, v130, v131
    v_cvt_pk_bf16_f32 v82, v144, v145
    v_cvt_pk_bf16_f32 v83, v146, v147
    v_lshlrev_b32 v128, 16, v80
    v_and_b32 v129, s48, v80
    v_lshlrev_b32 v130, 16, v81
    v_and_b32 v131, s48, v81
    v_lshlrev_b32 v144, 16, v82
    v_and_b32 v145, s48, v82
    v_lshlrev_b32 v146, 16, v83
    v_and_b32 v147, s48, v83
    v_pk_mul_f32 v[80:81], v[128:129], v[22:23] op_sel_hi:[1,0]
    v_pk_mul_f32 v[82:83], v[130:131], v[22:23] op_sel_hi:[1,0]
    v_pk_mul_f32 v[84:85], v[144:145], v[22:23] op_sel_hi:[1,0]
    v_pk_mul_f32 v[86:87], v[146:147], v[22:23] op_sel_hi:[1,0]
    v_exp_f32 v80, v80 clamp
    v_exp_f32 v81, v81 clamp
    v_exp_f32 v82, v82 clamp
    v_exp_f32 v83, v83 clamp
    v_exp_f32 v84, v84 clamp
    v_exp_f32 v85, v85 clamp
    v_exp_f32 v86, v86 clamp
    v_exp_f32 v87, v87 clamp
    v_maximum3_f32 v128, v128, 0, 0
    v_maximum3_f32 v129, v129, 0, 0
    v_maximum3_f32 v130, v130, 0, 0
    v_maximum3_f32 v131, v131, 0, 0
    v_maximum3_f32 v144, v144, 0, 0
    v_maximum3_f32 v145, v145, 0, 0
    v_maximum3_f32 v146, v146, 0, 0
    v_maximum3_f32 v147, v147, 0, 0
    v_pk_add_f32 v[80:81], v[80:81], v[22:23] op_sel:[0,1] op_sel_hi:[1,1]
    v_pk_add_f32 v[82:83], v[82:83], v[22:23] op_sel:[0,1] op_sel_hi:[1,1]
    v_pk_add_f32 v[84:85], v[84:85], v[22:23] op_sel:[0,1] op_sel_hi:[1,1]
    v_pk_add_f32 v[86:87], v[86:87], v[22:23] op_sel:[0,1] op_sel_hi:[1,1]
    v_pk_add_f32 v[128:129], v[128:129], v[80:81]
    v_pk_add_f32 v[130:131], v[130:131], v[82:83]
    v_pk_add_f32 v[144:145], v[144:145], v[84:85]
    v_pk_add_f32 v[146:147], v[146:147], v[86:87]
    v_cvt_pk_bf16_f32 v32, v128, v129
    v_cvt_pk_bf16_f32 v33, v130, v131
    v_cvt_pk_bf16_f32 v34, v144, v145
    v_cvt_pk_bf16_f32 v35, v146, v147
    v_cvt_pk_bf16_f32 v40, v136, v137
    v_cvt_pk_bf16_f32 v41, v138, v139
    v_cvt_pk_bf16_f32 v42, v152, v153
    v_cvt_pk_bf16_f32 v43, v154, v155
    v_cvt_pk_bf16_f32 v80, v132, v133
    v_cvt_pk_bf16_f32 v81, v134, v135
    v_cvt_pk_bf16_f32 v82, v148, v149
    v_cvt_pk_bf16_f32 v83, v150, v151
    v_lshlrev_b32 v132, 16, v80
    v_and_b32 v133, s48, v80
    v_lshlrev_b32 v134, 16, v81
    v_and_b32 v135, s48, v81
    v_lshlrev_b32 v148, 16, v82
    v_and_b32 v149, s48, v82
    v_lshlrev_b32 v150, 16, v83
    v_and_b32 v151, s48, v83
    v_pk_mul_f32 v[80:81], v[132:133], v[22:23] op_sel_hi:[1,0]
    v_pk_mul_f32 v[82:83], v[134:135], v[22:23] op_sel_hi:[1,0]
    v_pk_mul_f32 v[84:85], v[148:149], v[22:23] op_sel_hi:[1,0]
    v_pk_mul_f32 v[86:87], v[150:151], v[22:23] op_sel_hi:[1,0]
    v_exp_f32 v80, v80 clamp
    v_exp_f32 v81, v81 clamp
    v_exp_f32 v82, v82 clamp
    v_exp_f32 v83, v83 clamp
    v_exp_f32 v84, v84 clamp
    v_exp_f32 v85, v85 clamp
    v_exp_f32 v86, v86 clamp
    v_exp_f32 v87, v87 clamp
    v_maximum3_f32 v132, v132, 0, 0
    v_maximum3_f32 v133, v133, 0, 0
    v_maximum3_f32 v134, v134, 0, 0
    v_maximum3_f32 v135, v135, 0, 0
    v_maximum3_f32 v148, v148, 0, 0
    v_maximum3_f32 v149, v149, 0, 0
    v_maximum3_f32 v150, v150, 0, 0
    v_maximum3_f32 v151, v151, 0, 0
    v_pk_add_f32 v[80:81], v[80:81], v[22:23] op_sel:[0,1] op_sel_hi:[1,1]
    v_pk_add_f32 v[82:83], v[82:83], v[22:23] op_sel:[0,1] op_sel_hi:[1,1]
    v_pk_add_f32 v[84:85], v[84:85], v[22:23] op_sel:[0,1] op_sel_hi:[1,1]
    v_pk_add_f32 v[86:87], v[86:87], v[22:23] op_sel:[0,1] op_sel_hi:[1,1]
    v_pk_add_f32 v[132:133], v[132:133], v[80:81]
    v_pk_add_f32 v[134:135], v[134:135], v[82:83]
    v_pk_add_f32 v[148:149], v[148:149], v[84:85]
    v_pk_add_f32 v[150:151], v[150:151], v[86:87]
    v_cvt_pk_bf16_f32 v36, v132, v133
    v_cvt_pk_bf16_f32 v37, v134, v135
    v_cvt_pk_bf16_f32 v38, v148, v149
    v_cvt_pk_bf16_f32 v39, v150, v151
    v_cvt_pk_bf16_f32 v44, v140, v141
    v_cvt_pk_bf16_f32 v45, v142, v143
    v_cvt_pk_bf16_f32 v46, v156, v157
    v_cvt_pk_bf16_f32 v47, v158, v159
    s_nop 1
    v_mfma_f32_16x16x32_bf16 v[56:59], v[32:35], v[40:43], 0
    v_mfma_f32_16x16x32_bf16 v[60:63], v[36:39], v[40:43], 0
    v_mfma_f32_16x16x32_bf16 v[64:67], v[32:35], v[44:47], 0
    v_mfma_f32_16x16x32_bf16 v[68:71], v[36:39], v[44:47], 0
    v_mfma_f32_16x16x32_bf16 v[72:75], v[48:51], v[32:35], 0
    v_mfma_f32_16x16x32_bf16 v[76:79], v[48:51], v[36:39], 0
    v_cvt_pk_bf16_f32 v80, v160, v161
    v_cvt_pk_bf16_f32 v81, v162, v163
    v_cvt_pk_bf16_f32 v82, v176, v177
    v_cvt_pk_bf16_f32 v83, v178, v179
    v_lshlrev_b32 v160, 16, v80
    v_and_b32 v161, s48, v80
    v_lshlrev_b32 v162, 16, v81
    v_and_b32 v163, s48, v81
    v_lshlrev_b32 v176, 16, v82
    v_and_b32 v177, s48, v82
    v_lshlrev_b32 v178, 16, v83
    v_and_b32 v179, s48, v83
    v_pk_mul_f32 v[80:81], v[160:161], v[22:23] op_sel_hi:[1,0]
    v_pk_mul_f32 v[82:83], v[162:163], v[22:23] op_sel_hi:[1,0]
    v_pk_mul_f32 v[84:85], v[176:177], v[22:23] op_sel_hi:[1,0]
    v_pk_mul_f32 v[86:87], v[178:179], v[22:23] op_sel_hi:[1,0]
    v_exp_f32 v80, v80 clamp
    v_exp_f32 v81, v81 clamp
    v_exp_f32 v82, v82 clamp
    v_exp_f32 v83, v83 clamp
    v_exp_f32 v84, v84 clamp
    v_exp_f32 v85, v85 clamp
    v_exp_f32 v86, v86 clamp
    v_exp_f32 v87, v87 clamp
    v_maximum3_f32 v160, v160, 0, 0
    v_maximum3_f32 v161, v161, 0, 0
    v_maximum3_f32 v162, v162, 0, 0
    v_maximum3_f32 v163, v163, 0, 0
    v_maximum3_f32 v176, v176, 0, 0
    v_maximum3_f32 v177, v177, 0, 0
    v_maximum3_f32 v178, v178, 0, 0
    v_maximum3_f32 v179, v179, 0, 0
    v_pk_add_f32 v[80:81], v[80:81], v[22:23] op_sel:[0,1] op_sel_hi:[1,1]
    v_pk_add_f32 v[82:83], v[82:83], v[22:23] op_sel:[0,1] op_sel_hi:[1,1]
    v_pk_add_f32 v[84:85], v[84:85], v[22:23] op_sel:[0,1] op_sel_hi:[1,1]
    v_pk_add_f32 v[86:87], v[86:87], v[22:23] op_sel:[0,1] op_sel_hi:[1,1]
    v_pk_add_f32 v[160:161], v[160:161], v[80:81]
    v_pk_add_f32 v[162:163], v[162:163], v[82:83]
    v_pk_add_f32 v[176:177], v[176:177], v[84:85]
    v_pk_add_f32 v[178:179], v[178:179], v[86:87]
    v_cvt_pk_bf16_f32 v32, v160, v161
    v_cvt_pk_bf16_f32 v33, v162, v163
    v_cvt_pk_bf16_f32 v34, v176, v177
    v_cvt_pk_bf16_f32 v35, v178, v179
    v_cvt_pk_bf16_f32 v40, v168, v169
    v_cvt_pk_bf16_f32 v41, v170, v171
    v_cvt_pk_bf16_f32 v42, v184, v185
    v_cvt_pk_bf16_f32 v43, v186, v187
    v_cvt_pk_bf16_f32 v80, v164, v165
    v_cvt_pk_bf16_f32 v81, v166, v167
    v_cvt_pk_bf16_f32 v82, v180, v181
    v_cvt_pk_bf16_f32 v83, v182, v183
    v_lshlrev_b32 v164, 16, v80
    v_and_b32 v165, s48, v80
    v_lshlrev_b32 v166, 16, v81
    v_and_b32 v167, s48, v81
    v_lshlrev_b32 v180, 16, v82
    v_and_b32 v181, s48, v82
    v_lshlrev_b32 v182, 16, v83
    v_and_b32 v183, s48, v83
    v_pk_mul_f32 v[80:81], v[164:165], v[22:23] op_sel_hi:[1,0]
    v_pk_mul_f32 v[82:83], v[166:167], v[22:23] op_sel_hi:[1,0]
    v_pk_mul_f32 v[84:85], v[180:181], v[22:23] op_sel_hi:[1,0]
    v_pk_mul_f32 v[86:87], v[182:183], v[22:23] op_sel_hi:[1,0]
    v_exp_f32 v80, v80 clamp
    v_exp_f32 v81, v81 clamp
    v_exp_f32 v82, v82 clamp
    v_exp_f32 v83, v83 clamp
    v_exp_f32 v84, v84 clamp
    v_exp_f32 v85, v85 clamp
    v_exp_f32 v86, v86 clamp
    v_exp_f32 v87, v87 clamp
    v_maximum3_f32 v164, v164, 0, 0
    v_maximum3_f32 v165, v165, 0, 0
    v_maximum3_f32 v166, v166, 0, 0
    v_maximum3_f32 v167, v167, 0, 0
    v_maximum3_f32 v180, v180, 0, 0
    v_maximum3_f32 v181, v181, 0, 0
    v_maximum3_f32 v182, v182, 0, 0
    v_maximum3_f32 v183, v183, 0, 0
    v_pk_add_f32 v[80:81], v[80:81], v[22:23] op_sel:[0,1] op_sel_hi:[1,1]
    v_pk_add_f32 v[82:83], v[82:83], v[22:23] op_sel:[0,1] op_sel_hi:[1,1]
    v_pk_add_f32 v[84:85], v[84:85], v[22:23] op_sel:[0,1] op_sel_hi:[1,1]
    v_pk_add_f32 v[86:87], v[86:87], v[22:23] op_sel:[0,1] op_sel_hi:[1,1]
    v_pk_add_f32 v[164:165], v[164:165], v[80:81]
    v_pk_add_f32 v[166:167], v[166:167], v[82:83]
    v_pk_add_f32 v[180:181], v[180:181], v[84:85]
    v_pk_add_f32 v[182:183], v[182:183], v[86:87]
    v_cvt_pk_bf16_f32 v36, v164, v165
    v_cvt_pk_bf16_f32 v37, v166, v167
    v_cvt_pk_bf16_f32 v38, v180, v181
    v_cvt_pk_bf16_f32 v39, v182, v183
    v_cvt_pk_bf16_f32 v44, v172, v173
    v_cvt_pk_bf16_f32 v45, v174, v175
    v_cvt_pk_bf16_f32 v46, v188, v189
    v_cvt_pk_bf16_f32 v47, v190, v191
    s_nop 1
    v_mfma_f32_16x16x32_bf16 v[56:59], v[32:35], v[40:43], v[56:59]
    v_mfma_f32_16x16x32_bf16 v[60:63], v[36:39], v[40:43], v[60:63]
    v_mfma_f32_16x16x32_bf16 v[64:67], v[32:35], v[44:47], v[64:67]
    v_mfma_f32_16x16x32_bf16 v[68:71], v[36:39], v[44:47], v[68:71]
    v_mfma_f32_16x16x32_bf16 v[72:75], v[48:51], v[32:35], v[72:75]
    v_mfma_f32_16x16x32_bf16 v[76:79], v[48:51], v[36:39], v[76:79]
    v_cvt_pk_bf16_f32 v80, v192, v193
    v_cvt_pk_bf16_f32 v81, v194, v195
    v_cvt_pk_bf16_f32 v82, v208, v209
    v_cvt_pk_bf16_f32 v83, v210, v211
    v_lshlrev_b32 v192, 16, v80
    v_and_b32 v193, s48, v80
    v_lshlrev_b32 v194, 16, v81
    v_and_b32 v195, s48, v81
    v_lshlrev_b32 v208, 16, v82
    v_and_b32 v209, s48, v82
    v_lshlrev_b32 v210, 16, v83
    v_and_b32 v211, s48, v83
    v_pk_mul_f32 v[80:81], v[192:193], v[22:23] op_sel_hi:[1,0]
    v_pk_mul_f32 v[82:83], v[194:195], v[22:23] op_sel_hi:[1,0]
    v_pk_mul_f32 v[84:85], v[208:209], v[22:23] op_sel_hi:[1,0]
    v_pk_mul_f32 v[86:87], v[210:211], v[22:23] op_sel_hi:[1,0]
    v_exp_f32 v80, v80 clamp
    v_exp_f32 v81, v81 clamp
    v_exp_f32 v82, v82 clamp
    v_exp_f32 v83, v83 clamp
    v_exp_f32 v84, v84 clamp
    v_exp_f32 v85, v85 clamp
    v_exp_f32 v86, v86 clamp
    v_exp_f32 v87, v87 clamp
    v_maximum3_f32 v192, v192, 0, 0
    v_maximum3_f32 v193, v193, 0, 0
    v_maximum3_f32 v194, v194, 0, 0
    v_maximum3_f32 v195, v195, 0, 0
    v_maximum3_f32 v208, v208, 0, 0
    v_maximum3_f32 v209, v209, 0, 0
    v_maximum3_f32 v210, v210, 0, 0
    v_maximum3_f32 v211, v211, 0, 0
    v_pk_add_f32 v[80:81], v[80:81], v[22:23] op_sel:[0,1] op_sel_hi:[1,1]
    v_pk_add_f32 v[82:83], v[82:83], v[22:23] op_sel:[0,1] op_sel_hi:[1,1]
    v_pk_add_f32 v[84:85], v[84:85], v[22:23] op_sel:[0,1] op_sel_hi:[1,1]
    v_pk_add_f32 v[86:87], v[86:87], v[22:23] op_sel:[0,1] op_sel_hi:[1,1]
    v_pk_add_f32 v[192:193], v[192:193], v[80:81]
    v_pk_add_f32 v[194:195], v[194:195], v[82:83]
    v_pk_add_f32 v[208:209], v[208:209], v[84:85]
    v_pk_add_f32 v[210:211], v[210:211], v[86:87]
    v_cvt_pk_bf16_f32 v32, v192, v193
    v_cvt_pk_bf16_f32 v33, v194, v195
    v_cvt_pk_bf16_f32 v34, v208, v209
    v_cvt_pk_bf16_f32 v35, v210, v211
    v_cvt_pk_bf16_f32 v40, v200, v201
    v_cvt_pk_bf16_f32 v41, v202, v203
    v_cvt_pk_bf16_f32 v42, v216, v217
    v_cvt_pk_bf16_f32 v43, v218, v219
    v_cvt_pk_bf16_f32 v80, v196, v197
    v_cvt_pk_bf16_f32 v81, v198, v199
    v_cvt_pk_bf16_f32 v82, v212, v213
    v_cvt_pk_bf16_f32 v83, v214, v215
    v_lshlrev_b32 v196, 16, v80
    v_and_b32 v197, s48, v80
    v_lshlrev_b32 v198, 16, v81
    v_and_b32 v199, s48, v81
    v_lshlrev_b32 v212, 16, v82
    v_and_b32 v213, s48, v82
    v_lshlrev_b32 v214, 16, v83
    v_and_b32 v215, s48, v83
    v_pk_mul_f32 v[80:81], v[196:197], v[22:23] op_sel_hi:[1,0]
    v_pk_mul_f32 v[82:83], v[198:199], v[22:23] op_sel_hi:[1,0]
    v_pk_mul_f32 v[84:85], v[212:213], v[22:23] op_sel_hi:[1,0]
    v_pk_mul_f32 v[86:87], v[214:215], v[22:23] op_sel_hi:[1,0]
    v_exp_f32 v80, v80 clamp
    v_exp_f32 v81, v81 clamp
    v_exp_f32 v82, v82 clamp
    v_exp_f32 v83, v83 clamp
    v_exp_f32 v84, v84 clamp
    v_exp_f32 v85, v85 clamp
    v_exp_f32 v86, v86 clamp
    v_exp_f32 v87, v87 clamp
    v_maximum3_f32 v196, v196, 0, 0
    v_maximum3_f32 v197, v197, 0, 0
    v_maximum3_f32 v198, v198, 0, 0
    v_maximum3_f32 v199, v199, 0, 0
    v_maximum3_f32 v212, v212, 0, 0
    v_maximum3_f32 v213, v213, 0, 0
    v_maximum3_f32 v214, v214, 0, 0
    v_maximum3_f32 v215, v215, 0, 0
    v_pk_add_f32 v[80:81], v[80:81], v[22:23] op_sel:[0,1] op_sel_hi:[1,1]
    v_pk_add_f32 v[82:83], v[82:83], v[22:23] op_sel:[0,1] op_sel_hi:[1,1]
    v_pk_add_f32 v[84:85], v[84:85], v[22:23] op_sel:[0,1] op_sel_hi:[1,1]
    v_pk_add_f32 v[86:87], v[86:87], v[22:23] op_sel:[0,1] op_sel_hi:[1,1]
    v_pk_add_f32 v[196:197], v[196:197], v[80:81]
    v_pk_add_f32 v[198:199], v[198:199], v[82:83]
    v_pk_add_f32 v[212:213], v[212:213], v[84:85]
    v_pk_add_f32 v[214:215], v[214:215], v[86:87]
    v_cvt_pk_bf16_f32 v36, v196, v197
    v_cvt_pk_bf16_f32 v37, v198, v199
    v_cvt_pk_bf16_f32 v38, v212, v213
    v_cvt_pk_bf16_f32 v39, v214, v215
    v_cvt_pk_bf16_f32 v44, v204, v205
    v_cvt_pk_bf16_f32 v45, v206, v207
    v_cvt_pk_bf16_f32 v46, v220, v221
    v_cvt_pk_bf16_f32 v47, v222, v223
    s_nop 1
    v_mfma_f32_16x16x32_bf16 v[56:59], v[32:35], v[40:43], v[56:59]
    v_mfma_f32_16x16x32_bf16 v[60:63], v[36:39], v[40:43], v[60:63]
    v_mfma_f32_16x16x32_bf16 v[64:67], v[32:35], v[44:47], v[64:67]
    v_mfma_f32_16x16x32_bf16 v[68:71], v[36:39], v[44:47], v[68:71]
    v_mfma_f32_16x16x32_bf16 v[72:75], v[48:51], v[32:35], v[72:75]
    v_mfma_f32_16x16x32_bf16 v[76:79], v[48:51], v[36:39], v[76:79]
    v_cvt_pk_bf16_f32 v80, v224, v225
    v_cvt_pk_bf16_f32 v81, v226, v227
    v_cvt_pk_bf16_f32 v82, v240, v241
    v_cvt_pk_bf16_f32 v83, v242, v243
    v_lshlrev_b32 v224, 16, v80
    v_and_b32 v225, s48, v80
    v_lshlrev_b32 v226, 16, v81
    v_and_b32 v227, s48, v81
    v_lshlrev_b32 v240, 16, v82
    v_and_b32 v241, s48, v82
    v_lshlrev_b32 v242, 16, v83
    v_and_b32 v243, s48, v83
    v_pk_mul_f32 v[80:81], v[224:225], v[22:23] op_sel_hi:[1,0]
    v_pk_mul_f32 v[82:83], v[226:227], v[22:23] op_sel_hi:[1,0]
    v_pk_mul_f32 v[84:85], v[240:241], v[22:23] op_sel_hi:[1,0]
    v_pk_mul_f32 v[86:87], v[242:243], v[22:23] op_sel_hi:[1,0]
    v_exp_f32 v80, v80 clamp
    v_exp_f32 v81, v81 clamp
    v_exp_f32 v82, v82 clamp
    v_exp_f32 v83, v83 clamp
    v_exp_f32 v84, v84 clamp
    v_exp_f32 v85, v85 clamp
    v_exp_f32 v86, v86 clamp
    v_exp_f32 v87, v87 clamp
    v_maximum3_f32 v224, v224, 0, 0
    v_maximum3_f32 v225, v225, 0, 0
    v_maximum3_f32 v226, v226, 0, 0
    v_maximum3_f32 v227, v227, 0, 0
    v_maximum3_f32 v240, v240, 0, 0
    v_maximum3_f32 v241, v241, 0, 0
    v_maximum3_f32 v242, v242, 0, 0
    v_maximum3_f32 v243, v243, 0, 0
    v_pk_add_f32 v[80:81], v[80:81], v[22:23] op_sel:[0,1] op_sel_hi:[1,1]
    v_pk_add_f32 v[82:83], v[82:83], v[22:23] op_sel:[0,1] op_sel_hi:[1,1]
    v_pk_add_f32 v[84:85], v[84:85], v[22:23] op_sel:[0,1] op_sel_hi:[1,1]
    v_pk_add_f32 v[86:87], v[86:87], v[22:23] op_sel:[0,1] op_sel_hi:[1,1]
    v_pk_add_f32 v[224:225], v[224:225], v[80:81]
    v_pk_add_f32 v[226:227], v[226:227], v[82:83]
    v_pk_add_f32 v[240:241], v[240:241], v[84:85]
    v_pk_add_f32 v[242:243], v[242:243], v[86:87]
    v_cvt_pk_bf16_f32 v32, v224, v225
    v_cvt_pk_bf16_f32 v33, v226, v227
    v_cvt_pk_bf16_f32 v34, v240, v241
    v_cvt_pk_bf16_f32 v35, v242, v243
    v_cvt_pk_bf16_f32 v40, v232, v233
    v_cvt_pk_bf16_f32 v41, v234, v235
    v_cvt_pk_bf16_f32 v42, v248, v249
    v_cvt_pk_bf16_f32 v43, v250, v251
    v_cvt_pk_bf16_f32 v80, v228, v229
    v_cvt_pk_bf16_f32 v81, v230, v231
    v_cvt_pk_bf16_f32 v82, v244, v245
    v_cvt_pk_bf16_f32 v83, v246, v247
    v_lshlrev_b32 v228, 16, v80
    v_and_b32 v229, s48, v80
    v_lshlrev_b32 v230, 16, v81
    v_and_b32 v231, s48, v81
    v_lshlrev_b32 v244, 16, v82
    v_and_b32 v245, s48, v82
    v_lshlrev_b32 v246, 16, v83
    v_and_b32 v247, s48, v83
    v_pk_mul_f32 v[80:81], v[228:229], v[22:23] op_sel_hi:[1,0]
    v_pk_mul_f32 v[82:83], v[230:231], v[22:23] op_sel_hi:[1,0]
    v_pk_mul_f32 v[84:85], v[244:245], v[22:23] op_sel_hi:[1,0]
    v_pk_mul_f32 v[86:87], v[246:247], v[22:23] op_sel_hi:[1,0]
    v_exp_f32 v80, v80 clamp
    v_exp_f32 v81, v81 clamp
    v_exp_f32 v82, v82 clamp
    v_exp_f32 v83, v83 clamp
    v_exp_f32 v84, v84 clamp
    v_exp_f32 v85, v85 clamp
    v_exp_f32 v86, v86 clamp
    v_exp_f32 v87, v87 clamp
    v_maximum3_f32 v228, v228, 0, 0
    v_maximum3_f32 v229, v229, 0, 0
    v_maximum3_f32 v230, v230, 0, 0
    v_maximum3_f32 v231, v231, 0, 0
    v_maximum3_f32 v244, v244, 0, 0
    v_maximum3_f32 v245, v245, 0, 0
    v_maximum3_f32 v246, v246, 0, 0
    v_maximum3_f32 v247, v247, 0, 0
    v_pk_add_f32 v[80:81], v[80:81], v[22:23] op_sel:[0,1] op_sel_hi:[1,1]
    v_pk_add_f32 v[82:83], v[82:83], v[22:23] op_sel:[0,1] op_sel_hi:[1,1]
    v_pk_add_f32 v[84:85], v[84:85], v[22:23] op_sel:[0,1] op_sel_hi:[1,1]
    v_pk_add_f32 v[86:87], v[86:87], v[22:23] op_sel:[0,1] op_sel_hi:[1,1]
    v_pk_add_f32 v[228:229], v[228:229], v[80:81]
    v_pk_add_f32 v[230:231], v[230:231], v[82:83]
    v_pk_add_f32 v[244:245], v[244:245], v[84:85]
    v_pk_add_f32 v[246:247], v[246:247], v[86:87]
    v_cvt_pk_bf16_f32 v36, v228, v229
    v_cvt_pk_bf16_f32 v37, v230, v231
    v_cvt_pk_bf16_f32 v38, v244, v245
    v_cvt_pk_bf16_f32 v39, v246, v247
    v_cvt_pk_bf16_f32 v44, v236, v237
    v_cvt_pk_bf16_f32 v45, v238, v239
    v_cvt_pk_bf16_f32 v46, v252, v253
    v_cvt_pk_bf16_f32 v47, v254, v255
    s_nop 1
    v_mfma_f32_16x16x32_bf16 v[56:59], v[32:35], v[40:43], v[56:59]
    v_mfma_f32_16x16x32_bf16 v[60:63], v[36:39], v[40:43], v[60:63]
    v_mfma_f32_16x16x32_bf16 v[64:67], v[32:35], v[44:47], v[64:67]
    v_mfma_f32_16x16x32_bf16 v[68:71], v[36:39], v[44:47], v[68:71]
    v_mfma_f32_16x16x32_bf16 v[72:75], v[48:51], v[32:35], v[72:75]
    v_mfma_f32_16x16x32_bf16 v[76:79], v[48:51], v[36:39], v[76:79]
    v_lshlrev_b32 v7, 2, v2
    s_add_u32 s38, s42, s45
    s_lshl_b32 s38, s38, 14
    s_add_u32 s38, s38, 80216064
    s_bfe_u32 s3, s38, 0x10015
    s_lshl_b32 s3, s3, 13
    s_xor_b32 s3, s3, s79
    s_xor_b32 s3, s3, 8192
    s_add_u32 s38, s38, s3
    s_add_u32 s39, s38, 4096
    s_nop 4
    buffer_atomic_add_f32 v56, v7, s[8:11], s38 offen offset:0 sc1
    buffer_atomic_add_f32 v57, v7, s[8:11], s38 offen offset:256 sc1
    buffer_atomic_add_f32 v58, v7, s[8:11], s38 offen offset:512 sc1
    buffer_atomic_add_f32 v59, v7, s[8:11], s38 offen offset:768 sc1
    buffer_atomic_add_f32 v60, v7, s[8:11], s38 offen offset:1024 sc1
    buffer_atomic_add_f32 v61, v7, s[8:11], s38 offen offset:1280 sc1
    buffer_atomic_add_f32 v62, v7, s[8:11], s38 offen offset:1536 sc1
    buffer_atomic_add_f32 v63, v7, s[8:11], s38 offen offset:1792 sc1
    buffer_atomic_add_f32 v64, v7, s[8:11], s38 offen offset:2048 sc1
    buffer_atomic_add_f32 v65, v7, s[8:11], s38 offen offset:2304 sc1
    buffer_atomic_add_f32 v66, v7, s[8:11], s38 offen offset:2560 sc1
    buffer_atomic_add_f32 v67, v7, s[8:11], s38 offen offset:2816 sc1
    buffer_atomic_add_f32 v68, v7, s[8:11], s38 offen offset:3072 sc1
    buffer_atomic_add_f32 v69, v7, s[8:11], s38 offen offset:3328 sc1
    buffer_atomic_add_f32 v70, v7, s[8:11], s38 offen offset:3584 sc1
    buffer_atomic_add_f32 v71, v7, s[8:11], s38 offen offset:3840 sc1
    s_mov_b64 exec, 0xffff
    buffer_atomic_add_f32 v72, v7, s[8:11], s39 offen offset:0 sc1
    buffer_atomic_add_f32 v76, v7, s[8:11], s39 offen offset:64 sc1
    s_mov_b64 exec, -1
    s_lshr_b32 s40, s43, 0
    s_lshl_b32 s40, s40, 7
    s_add_u32 s40, s40, 79724544
    s_waitcnt vmcnt(0)
    s_barrier
    s_cmp_lg_u32 s26, 1
    s_cbranch_scc1 sg_179
    v_mov_b32 v4, s40
    v_mov_b32 v5, 1
    s_mov_b64 exec, 1
    buffer_atomic_add v5, v4, s[8:11], 0 offen sc1
    s_mov_b64 exec, -1
sg_179:
    s_cmp_eq_u32 s6, 0
    s_cbranch_scc1 D_pre
    s_mov_b32 s6, 0
    s_branch D_main
LP_AQ:
    s_mov_b32 s34, 13
    s_mov_b32 s27, 0
    s_waitcnt vmcnt(8)
    s_barrier
    ds_read_b64_tr_b16 v[64:65], v18 offset:32768
    ds_read_b64_tr_b16 v[66:67], v18 offset:34816
    ds_read_b64_tr_b16 v[68:69], v19 offset:32768
    ds_read_b64_tr_b16 v[70:71], v19 offset:34816
    ds_read_b64_tr_b16 v[72:73], v20 offset:32768
    ds_read_b64_tr_b16 v[74:75], v20 offset:34816
    ds_read_b64_tr_b16 v[76:77], v21 offset:32768
    ds_read_b64_tr_b16 v[78:79], v21 offset:34816
    ds_read_b128 v[32:35], v16 offset:0
    ds_read_b128 v[36:39], v16 offset:2048
    ds_read_b128 v[40:43], v16 offset:4096
    ds_read_b128 v[44:47], v16 offset:6144
    ds_read_b128 v[48:51], v16 offset:8192
    ds_read_b128 v[52:55], v16 offset:10240
    ds_read_b128 v[56:59], v16 offset:12288
    ds_read_b128 v[60:63], v16 offset:14336
    s_waitcnt lgkmcnt(0)
    v_mfma_f32_16x16x32_bf16 v[128:131], v[64:67], v[32:35], 0
    ds_read_b64_tr_b16 v[112:113], v18 offset:49152
    v_mfma_f32_16x16x32_bf16 v[132:135], v[68:71], v[32:35], 0
    ds_read_b64_tr_b16 v[114:115], v18 offset:51200
    v_mfma_f32_16x16x32_bf16 v[136:139], v[72:75], v[32:35], 0
    ds_read_b64_tr_b16 v[116:117], v19 offset:49152
    v_mfma_f32_16x16x32_bf16 v[140:143], v[76:79], v[32:35], 0
    ds_read_b64_tr_b16 v[118:119], v19 offset:51200
    v_mfma_f32_16x16x32_bf16 v[144:147], v[64:67], v[36:39], 0
    ds_read_b64_tr_b16 v[120:121], v20 offset:49152
    v_mfma_f32_16x16x32_bf16 v[148:151], v[68:71], v[36:39], 0
    ds_read_b64_tr_b16 v[122:123], v20 offset:51200
    v_mfma_f32_16x16x32_bf16 v[152:155], v[72:75], v[36:39], 0
    ds_read_b64_tr_b16 v[124:125], v21 offset:49152
    v_mfma_f32_16x16x32_bf16 v[156:159], v[76:79], v[36:39], 0
    ds_read_b64_tr_b16 v[126:127], v21 offset:51200
    v_mfma_f32_16x16x32_bf16 v[160:163], v[64:67], v[40:43], 0
    ds_read_b128 v[80:83], v17 offset:0
    v_mfma_f32_16x16x32_bf16 v[164:167], v[68:71], v[40:43], 0
    ds_read_b128 v[84:87], v17 offset:2048
    v_mfma_f32_16x16x32_bf16 v[168:171], v[72:75], v[40:43], 0
    ds_read_b128 v[88:91], v17 offset:4096
    v_mfma_f32_16x16x32_bf16 v[172:175], v[76:79], v[40:43], 0
    ds_read_b128 v[92:95], v17 offset:6144
    v_mfma_f32_16x16x32_bf16 v[176:179], v[64:67], v[44:47], 0
    ds_read_b128 v[96:99], v17 offset:8192
    v_mfma_f32_16x16x32_bf16 v[180:183], v[68:71], v[44:47], 0
    ds_read_b128 v[100:103], v17 offset:10240
    v_mfma_f32_16x16x32_bf16 v[184:187], v[72:75], v[44:47], 0
    ds_read_b128 v[104:107], v17 offset:12288
    v_mfma_f32_16x16x32_bf16 v[188:191], v[76:79], v[44:47], 0
    ds_read_b128 v[108:111], v17 offset:14336
    v_mfma_f32_16x16x32_bf16 v[192:195], v[64:67], v[48:51], 0
    v_xor_b32 v16, 65536, v16
    v_mfma_f32_16x16x32_bf16 v[196:199], v[68:71], v[48:51], 0
    v_xor_b32 v17, 65536, v17
    v_mfma_f32_16x16x32_bf16 v[200:203], v[72:75], v[48:51], 0
    v_xor_b32 v18, 65536, v18
    v_mfma_f32_16x16x32_bf16 v[204:207], v[76:79], v[48:51], 0
    v_xor_b32 v19, 65536, v19
    v_mfma_f32_16x16x32_bf16 v[208:211], v[64:67], v[52:55], 0
    v_xor_b32 v20, 65536, v20
    v_mfma_f32_16x16x32_bf16 v[212:215], v[68:71], v[52:55], 0
    v_xor_b32 v21, 65536, v21
    v_mfma_f32_16x16x32_bf16 v[216:219], v[72:75], v[52:55], 0
    v_mfma_f32_16x16x32_bf16 v[220:223], v[76:79], v[52:55], 0
    v_mfma_f32_16x16x32_bf16 v[224:227], v[64:67], v[56:59], 0
    v_mfma_f32_16x16x32_bf16 v[228:231], v[68:71], v[56:59], 0
    v_mfma_f32_16x16x32_bf16 v[232:235], v[72:75], v[56:59], 0
    v_mfma_f32_16x16x32_bf16 v[236:239], v[76:79], v[56:59], 0
    v_mfma_f32_16x16x32_bf16 v[240:243], v[64:67], v[60:63], 0
    v_mfma_f32_16x16x32_bf16 v[244:247], v[68:71], v[60:63], 0
    v_mfma_f32_16x16x32_bf16 v[248:251], v[72:75], v[60:63], 0
    v_mfma_f32_16x16x32_bf16 v[252:255], v[76:79], v[60:63], 0
    s_waitcnt vmcnt(0) lgkmcnt(0)
    s_barrier
    v_mfma_f32_16x16x32_bf16 v[128:131], v[112:115], v[80:83], v[128:131]
    s_mov_b32 m0, s35
    s_xor_b32 s35, s35, 65536
    v_mfma_f32_16x16x32_bf16 v[132:135], v[116:119], v[80:83], v[132:135]
    ds_read_b64_tr_b16 v[64:65], v18 offset:32768
    v_mfma_f32_16x16x32_bf16 v[136:139], v[120:123], v[80:83], v[136:139]
    buffer_load_dwordx4 v8, s[12:15], s31 offen offset:0  lds
    v_mfma_f32_16x16x32_bf16 v[140:143], v[124:127], v[80:83], v[140:143]
    ds_read_b64_tr_b16 v[66:67], v18 offset:34816
    v_mfma_f32_16x16x32_bf16 v[144:147], v[112:115], v[84:87], v[144:147]
    buffer_load_dwordx4 v9, s[12:15], s31 offen offset:1024  lds
    v_mfma_f32_16x16x32_bf16 v[148:151], v[116:119], v[84:87], v[148:151]
    ds_read_b64_tr_b16 v[68:69], v19 offset:32768
    v_mfma_f32_16x16x32_bf16 v[152:155], v[120:123], v[84:87], v[152:155]
    buffer_load_dwordx4 v10, s[12:15], s31 offen offset:2048  lds
    v_mfma_f32_16x16x32_bf16 v[156:159], v[124:127], v[84:87], v[156:159]
    ds_read_b64_tr_b16 v[70:71], v19 offset:34816
    v_mfma_f32_16x16x32_bf16 v[160:163], v[112:115], v[88:91], v[160:163]
    buffer_load_dwordx4 v11, s[12:15], s31 offen offset:3072  lds
    v_mfma_f32_16x16x32_bf16 v[164:167], v[116:119], v[88:91], v[164:167]
    ds_read_b64_tr_b16 v[72:73], v20 offset:32768
    v_mfma_f32_16x16x32_bf16 v[168:171], v[120:123], v[88:91], v[168:171]
    s_mov_b32 m0, s36
    s_add_u32 s31, s31, 128
    s_xor_b32 s36, s36, 65536
    v_mfma_f32_16x16x32_bf16 v[172:175], v[124:127], v[88:91], v[172:175]
    ds_read_b64_tr_b16 v[74:75], v20 offset:34816
    v_mfma_f32_16x16x32_bf16 v[176:179], v[112:115], v[92:95], v[176:179]
    buffer_load_dwordx4 v12, s[16:19], s32 offen offset:0  lds
    v_mfma_f32_16x16x32_bf16 v[180:183], v[116:119], v[92:95], v[180:183]
    ds_read_b64_tr_b16 v[76:77], v21 offset:32768
    v_mfma_f32_16x16x32_bf16 v[184:187], v[120:123], v[92:95], v[184:187]
    buffer_load_dwordx4 v13, s[16:19], s32 offen offset:1024  lds
    v_mfma_f32_16x16x32_bf16 v[188:191], v[124:127], v[92:95], v[188:191]
    ds_read_b64_tr_b16 v[78:79], v21 offset:34816
    v_mfma_f32_16x16x32_bf16 v[192:195], v[112:115], v[96:99], v[192:195]
    buffer_load_dwordx4 v14, s[16:19], s32 offen offset:2048  lds
    v_mfma_f32_16x16x32_bf16 v[196:199], v[116:119], v[96:99], v[196:199]
    ds_read_b128 v[32:35], v16 offset:0
    v_mfma_f32_16x16x32_bf16 v[200:203], v[120:123], v[96:99], v[200:203]
    buffer_load_dwordx4 v15, s[16:19], s32 offen offset:3072  lds
    v_mfma_f32_16x16x32_bf16 v[204:207], v[124:127], v[96:99], v[204:207]
    ds_read_b128 v[36:39], v16 offset:2048
    v_mfma_f32_16x16x32_bf16 v[208:211], v[112:115], v[100:103], v[208:211]
    s_add_u32 s32, s32, s33
    v_mfma_f32_16x16x32_bf16 v[212:215], v[116:119], v[100:103], v[212:215]
    ds_read_b128 v[40:43], v16 offset:4096
    v_mfma_f32_16x16x32_bf16 v[216:219], v[120:123], v[100:103], v[216:219]
    ds_read_b128 v[44:47], v16 offset:6144
    v_mfma_f32_16x16x32_bf16 v[220:223], v[124:127], v[100:103], v[220:223]
    ds_read_b128 v[48:51], v16 offset:8192
    v_mfma_f32_16x16x32_bf16 v[224:227], v[112:115], v[104:107], v[224:227]
    ds_read_b128 v[52:55], v16 offset:10240
    v_mfma_f32_16x16x32_bf16 v[228:231], v[116:119], v[104:107], v[228:231]
    ds_read_b128 v[56:59], v16 offset:12288
    v_mfma_f32_16x16x32_bf16 v[232:235], v[120:123], v[104:107], v[232:235]
    ds_read_b128 v[60:63], v16 offset:14336
    v_mfma_f32_16x16x32_bf16 v[236:239], v[124:127], v[104:107], v[236:239]
    v_mfma_f32_16x16x32_bf16 v[240:243], v[112:115], v[108:111], v[240:243]
    v_mfma_f32_16x16x32_bf16 v[244:247], v[116:119], v[108:111], v[244:247]
    v_mfma_f32_16x16x32_bf16 v[248:251], v[120:123], v[108:111], v[248:251]
    v_mfma_f32_16x16x32_bf16 v[252:255], v[124:127], v[108:111], v[252:255]
gl_180:
    s_waitcnt lgkmcnt(0)
    v_mfma_f32_16x16x32_bf16 v[128:131], v[64:67], v[32:35], v[128:131]
    ds_read_b64_tr_b16 v[112:113], v18 offset:49152
    v_mfma_f32_16x16x32_bf16 v[132:135], v[68:71], v[32:35], v[132:135]
    ds_read_b64_tr_b16 v[114:115], v18 offset:51200
    v_mfma_f32_16x16x32_bf16 v[136:139], v[72:75], v[32:35], v[136:139]
    ds_read_b64_tr_b16 v[116:117], v19 offset:49152
    v_mfma_f32_16x16x32_bf16 v[140:143], v[76:79], v[32:35], v[140:143]
    ds_read_b64_tr_b16 v[118:119], v19 offset:51200
    v_mfma_f32_16x16x32_bf16 v[144:147], v[64:67], v[36:39], v[144:147]
    ds_read_b64_tr_b16 v[120:121], v20 offset:49152
    v_mfma_f32_16x16x32_bf16 v[148:151], v[68:71], v[36:39], v[148:151]
    ds_read_b64_tr_b16 v[122:123], v20 offset:51200
    v_mfma_f32_16x16x32_bf16 v[152:155], v[72:75], v[36:39], v[152:155]
    ds_read_b64_tr_b16 v[124:125], v21 offset:49152
    v_mfma_f32_16x16x32_bf16 v[156:159], v[76:79], v[36:39], v[156:159]
    ds_read_b64_tr_b16 v[126:127], v21 offset:51200
    v_mfma_f32_16x16x32_bf16 v[160:163], v[64:67], v[40:43], v[160:163]
    ds_read_b128 v[80:83], v17 offset:0
    v_mfma_f32_16x16x32_bf16 v[164:167], v[68:71], v[40:43], v[164:167]
    ds_read_b128 v[84:87], v17 offset:2048
    v_mfma_f32_16x16x32_bf16 v[168:171], v[72:75], v[40:43], v[168:171]
    ds_read_b128 v[88:91], v17 offset:4096
    v_mfma_f32_16x16x32_bf16 v[172:175], v[76:79], v[40:43], v[172:175]
    ds_read_b128 v[92:95], v17 offset:6144
    v_mfma_f32_16x16x32_bf16 v[176:179], v[64:67], v[44:47], v[176:179]
    ds_read_b128 v[96:99], v17 offset:8192
    v_mfma_f32_16x16x32_bf16 v[180:183], v[68:71], v[44:47], v[180:183]
    ds_read_b128 v[100:103], v17 offset:10240
    v_mfma_f32_16x16x32_bf16 v[184:187], v[72:75], v[44:47], v[184:187]
    ds_read_b128 v[104:107], v17 offset:12288
    v_mfma_f32_16x16x32_bf16 v[188:191], v[76:79], v[44:47], v[188:191]
    ds_read_b128 v[108:111], v17 offset:14336
    v_mfma_f32_16x16x32_bf16 v[192:195], v[64:67], v[48:51], v[192:195]
    v_xor_b32 v16, 65536, v16
    v_mfma_f32_16x16x32_bf16 v[196:199], v[68:71], v[48:51], v[196:199]
    v_xor_b32 v17, 65536, v17
    v_mfma_f32_16x16x32_bf16 v[200:203], v[72:75], v[48:51], v[200:203]
    v_xor_b32 v18, 65536, v18
    v_mfma_f32_16x16x32_bf16 v[204:207], v[76:79], v[48:51], v[204:207]
    v_xor_b32 v19, 65536, v19
    v_mfma_f32_16x16x32_bf16 v[208:211], v[64:67], v[52:55], v[208:211]
    v_xor_b32 v20, 65536, v20
    v_mfma_f32_16x16x32_bf16 v[212:215], v[68:71], v[52:55], v[212:215]
    v_xor_b32 v21, 65536, v21
    v_mfma_f32_16x16x32_bf16 v[216:219], v[72:75], v[52:55], v[216:219]
    v_mfma_f32_16x16x32_bf16 v[220:223], v[76:79], v[52:55], v[220:223]
    v_mfma_f32_16x16x32_bf16 v[224:227], v[64:67], v[56:59], v[224:227]
    v_mfma_f32_16x16x32_bf16 v[228:231], v[68:71], v[56:59], v[228:231]
    v_mfma_f32_16x16x32_bf16 v[232:235], v[72:75], v[56:59], v[232:235]
    v_mfma_f32_16x16x32_bf16 v[236:239], v[76:79], v[56:59], v[236:239]
    v_mfma_f32_16x16x32_bf16 v[240:243], v[64:67], v[60:63], v[240:243]
    v_mfma_f32_16x16x32_bf16 v[244:247], v[68:71], v[60:63], v[244:247]
    v_mfma_f32_16x16x32_bf16 v[248:251], v[72:75], v[60:63], v[248:251]
    v_mfma_f32_16x16x32_bf16 v[252:255], v[76:79], v[60:63], v[252:255]
    s_waitcnt vmcnt(0) lgkmcnt(0)
    s_barrier
    v_mfma_f32_16x16x32_bf16 v[128:131], v[112:115], v[80:83], v[128:131]
    s_mov_b32 m0, s35
    s_xor_b32 s35, s35, 65536
    v_mfma_f32_16x16x32_bf16 v[132:135], v[116:119], v[80:83], v[132:135]
    ds_read_b64_tr_b16 v[64:65], v18 offset:32768
    v_mfma_f32_16x16x32_bf16 v[136:139], v[120:123], v[80:83], v[136:139]
    buffer_load_dwordx4 v8, s[12:15], s31 offen offset:0  lds
    v_mfma_f32_16x16x32_bf16 v[140:143], v[124:127], v[80:83], v[140:143]
    ds_read_b64_tr_b16 v[66:67], v18 offset:34816
    v_mfma_f32_16x16x32_bf16 v[144:147], v[112:115], v[84:87], v[144:147]
    buffer_load_dwordx4 v9, s[12:15], s31 offen offset:1024  lds
    v_mfma_f32_16x16x32_bf16 v[148:151], v[116:119], v[84:87], v[148:151]
    ds_read_b64_tr_b16 v[68:69], v19 offset:32768
    v_mfma_f32_16x16x32_bf16 v[152:155], v[120:123], v[84:87], v[152:155]
    buffer_load_dwordx4 v10, s[12:15], s31 offen offset:2048  lds
    v_mfma_f32_16x16x32_bf16 v[156:159], v[124:127], v[84:87], v[156:159]
    ds_read_b64_tr_b16 v[70:71], v19 offset:34816
    v_mfma_f32_16x16x32_bf16 v[160:163], v[112:115], v[88:91], v[160:163]
    buffer_load_dwordx4 v11, s[12:15], s31 offen offset:3072  lds
    v_mfma_f32_16x16x32_bf16 v[164:167], v[116:119], v[88:91], v[164:167]
    ds_read_b64_tr_b16 v[72:73], v20 offset:32768
    v_mfma_f32_16x16x32_bf16 v[168:171], v[120:123], v[88:91], v[168:171]
    s_mov_b32 m0, s36
    s_add_u32 s31, s31, 128
    s_xor_b32 s36, s36, 65536
    v_mfma_f32_16x16x32_bf16 v[172:175], v[124:127], v[88:91], v[172:175]
    ds_read_b64_tr_b16 v[74:75], v20 offset:34816
    v_mfma_f32_16x16x32_bf16 v[176:179], v[112:115], v[92:95], v[176:179]
    buffer_load_dwordx4 v12, s[16:19], s32 offen offset:0  lds
    v_mfma_f32_16x16x32_bf16 v[180:183], v[116:119], v[92:95], v[180:183]
    ds_read_b64_tr_b16 v[76:77], v21 offset:32768
    v_mfma_f32_16x16x32_bf16 v[184:187], v[120:123], v[92:95], v[184:187]
    buffer_load_dwordx4 v13, s[16:19], s32 offen offset:1024  lds
    v_mfma_f32_16x16x32_bf16 v[188:191], v[124:127], v[92:95], v[188:191]
    ds_read_b64_tr_b16 v[78:79], v21 offset:34816
    v_mfma_f32_16x16x32_bf16 v[192:195], v[112:115], v[96:99], v[192:195]
    buffer_load_dwordx4 v14, s[16:19], s32 offen offset:2048  lds
    v_mfma_f32_16x16x32_bf16 v[196:199], v[116:119], v[96:99], v[196:199]
    ds_read_b128 v[32:35], v16 offset:0
    v_mfma_f32_16x16x32_bf16 v[200:203], v[120:123], v[96:99], v[200:203]
    buffer_load_dwordx4 v15, s[16:19], s32 offen offset:3072  lds
    v_mfma_f32_16x16x32_bf16 v[204:207], v[124:127], v[96:99], v[204:207]
    ds_read_b128 v[36:39], v16 offset:2048
    v_mfma_f32_16x16x32_bf16 v[208:211], v[112:115], v[100:103], v[208:211]
    s_add_u32 s32, s32, s33
    v_mfma_f32_16x16x32_bf16 v[212:215], v[116:119], v[100:103], v[212:215]
    ds_read_b128 v[40:43], v16 offset:4096
    v_mfma_f32_16x16x32_bf16 v[216:219], v[120:123], v[100:103], v[216:219]
    ds_read_b128 v[44:47], v16 offset:6144
    v_mfma_f32_16x16x32_bf16 v[220:223], v[124:127], v[100:103], v[220:223]
    ds_read_b128 v[48:51], v16 offset:8192
    v_mfma_f32_16x16x32_bf16 v[224:227], v[112:115], v[104:107], v[224:227]
    ds_read_b128 v[52:55], v16 offset:10240
    v_mfma_f32_16x16x32_bf16 v[228:231], v[116:119], v[104:107], v[228:231]
    ds_read_b128 v[56:59], v16 offset:12288
    v_mfma_f32_16x16x32_bf16 v[232:235], v[120:123], v[104:107], v[232:235]
    ds_read_b128 v[60:63], v16 offset:14336
    v_mfma_f32_16x16x32_bf16 v[236:239], v[124:127], v[104:107], v[236:239]
    v_mfma_f32_16x16x32_bf16 v[240:243], v[112:115], v[108:111], v[240:243]
    v_mfma_f32_16x16x32_bf16 v[244:247], v[116:119], v[108:111], v[244:247]
    v_mfma_f32_16x16x32_bf16 v[248:251], v[120:123], v[108:111], v[248:251]
    v_mfma_f32_16x16x32_bf16 v[252:255], v[124:127], v[108:111], v[252:255]
    s_sub_u32 s34, s34, 1
    s_cmp_lg_u32 s34, 0
    s_cbranch_scc1 gl_180
    s_cmp_lg_u32 s26, 0
    s_cbranch_scc1 ti_181
    s_lshl_b32 s3, s43, 2
    s_add_u32 s3, s3, 16
    v_mov_b32 v27, s3
    v_mov_b32 v28, 1
    s_mov_b64 exec, 1
    buffer_atomic_add v28, v27, s[20:23], 0 offen sc0 sc1
    s_mov_b64 exec, -1
ti_181:
    s_waitcnt lgkmcnt(0)
    v_mfma_f32_16x16x32_bf16 v[128:131], v[64:67], v[32:35], v[128:131]
    ds_read_b64_tr_b16 v[112:113], v18 offset:49152
    v_mfma_f32_16x16x32_bf16 v[132:135], v[68:71], v[32:35], v[132:135]
    ds_read_b64_tr_b16 v[114:115], v18 offset:51200
    v_mfma_f32_16x16x32_bf16 v[136:139], v[72:75], v[32:35], v[136:139]
    ds_read_b64_tr_b16 v[116:117], v19 offset:49152
    v_mfma_f32_16x16x32_bf16 v[140:143], v[76:79], v[32:35], v[140:143]
    ds_read_b64_tr_b16 v[118:119], v19 offset:51200
    v_mfma_f32_16x16x32_bf16 v[144:147], v[64:67], v[36:39], v[144:147]
    ds_read_b64_tr_b16 v[120:121], v20 offset:49152
    v_mfma_f32_16x16x32_bf16 v[148:151], v[68:71], v[36:39], v[148:151]
    ds_read_b64_tr_b16 v[122:123], v20 offset:51200
    v_mfma_f32_16x16x32_bf16 v[152:155], v[72:75], v[36:39], v[152:155]
    ds_read_b64_tr_b16 v[124:125], v21 offset:49152
    v_mfma_f32_16x16x32_bf16 v[156:159], v[76:79], v[36:39], v[156:159]
    ds_read_b64_tr_b16 v[126:127], v21 offset:51200
    v_mfma_f32_16x16x32_bf16 v[160:163], v[64:67], v[40:43], v[160:163]
    ds_read_b128 v[80:83], v17 offset:0
    v_mfma_f32_16x16x32_bf16 v[164:167], v[68:71], v[40:43], v[164:167]
    ds_read_b128 v[84:87], v17 offset:2048
    v_mfma_f32_16x16x32_bf16 v[168:171], v[72:75], v[40:43], v[168:171]
    ds_read_b128 v[88:91], v17 offset:4096
    v_mfma_f32_16x16x32_bf16 v[172:175], v[76:79], v[40:43], v[172:175]
    ds_read_b128 v[92:95], v17 offset:6144
    v_mfma_f32_16x16x32_bf16 v[176:179], v[64:67], v[44:47], v[176:179]
    ds_read_b128 v[96:99], v17 offset:8192
    v_mfma_f32_16x16x32_bf16 v[180:183], v[68:71], v[44:47], v[180:183]
    ds_read_b128 v[100:103], v17 offset:10240
    v_mfma_f32_16x16x32_bf16 v[184:187], v[72:75], v[44:47], v[184:187]
    ds_read_b128 v[104:107], v17 offset:12288
    v_mfma_f32_16x16x32_bf16 v[188:191], v[76:79], v[44:47], v[188:191]
    ds_read_b128 v[108:111], v17 offset:14336
    v_mfma_f32_16x16x32_bf16 v[192:195], v[64:67], v[48:51], v[192:195]
    v_xor_b32 v16, 65536, v16
    v_mfma_f32_16x16x32_bf16 v[196:199], v[68:71], v[48:51], v[196:199]
    v_xor_b32 v17, 65536, v17
    v_mfma_f32_16x16x32_bf16 v[200:203], v[72:75], v[48:51], v[200:203]
    v_xor_b32 v18, 65536, v18
    v_mfma_f32_16x16x32_bf16 v[204:207], v[76:79], v[48:51], v[204:207]
    v_xor_b32 v19, 65536, v19
    v_mfma_f32_16x16x32_bf16 v[208:211], v[64:67], v[52:55], v[208:211]
    v_xor_b32 v20, 65536, v20
    v_mfma_f32_16x16x32_bf16 v[212:215], v[68:71], v[52:55], v[212:215]
    v_xor_b32 v21, 65536, v21
    v_mfma_f32_16x16x32_bf16 v[216:219], v[72:75], v[52:55], v[216:219]
    v_mfma_f32_16x16x32_bf16 v[220:223], v[76:79], v[52:55], v[220:223]
    v_mfma_f32_16x16x32_bf16 v[224:227], v[64:67], v[56:59], v[224:227]
    v_mfma_f32_16x16x32_bf16 v[228:231], v[68:71], v[56:59], v[228:231]
    v_mfma_f32_16x16x32_bf16 v[232:235], v[72:75], v[56:59], v[232:235]
    v_mfma_f32_16x16x32_bf16 v[236:239], v[76:79], v[56:59], v[236:239]
    v_mfma_f32_16x16x32_bf16 v[240:243], v[64:67], v[60:63], v[240:243]
    v_mfma_f32_16x16x32_bf16 v[244:247], v[68:71], v[60:63], v[244:247]
    v_mfma_f32_16x16x32_bf16 v[248:251], v[72:75], v[60:63], v[248:251]
    v_mfma_f32_16x16x32_bf16 v[252:255], v[76:79], v[60:63], v[252:255]
    s_waitcnt vmcnt(0) lgkmcnt(0)
    s_barrier
    v_mfma_f32_16x16x32_bf16 v[128:131], v[112:115], v[80:83], v[128:131]
    ds_read_b64_tr_b16 v[64:65], v18 offset:32768
    v_mfma_f32_16x16x32_bf16 v[132:135], v[116:119], v[80:83], v[132:135]
    ds_read_b64_tr_b16 v[66:67], v18 offset:34816
    v_mfma_f32_16x16x32_bf16 v[136:139], v[120:123], v[80:83], v[136:139]
    ds_read_b64_tr_b16 v[68:69], v19 offset:32768
    v_mfma_f32_16x16x32_bf16 v[140:143], v[124:127], v[80:83], v[140:143]
    ds_read_b64_tr_b16 v[70:71], v19 offset:34816
    v_mfma_f32_16x16x32_bf16 v[144:147], v[112:115], v[84:87], v[144:147]
    ds_read_b64_tr_b16 v[72:73], v20 offset:32768
    v_mfma_f32_16x16x32_bf16 v[148:151], v[116:119], v[84:87], v[148:151]
    ds_read_b64_tr_b16 v[74:75], v20 offset:34816
    v_mfma_f32_16x16x32_bf16 v[152:155], v[120:123], v[84:87], v[152:155]
    ds_read_b64_tr_b16 v[76:77], v21 offset:32768
    v_mfma_f32_16x16x32_bf16 v[156:159], v[124:127], v[84:87], v[156:159]
    ds_read_b64_tr_b16 v[78:79], v21 offset:34816
    v_mfma_f32_16x16x32_bf16 v[160:163], v[112:115], v[88:91], v[160:163]
    ds_read_b128 v[32:35], v16 offset:0
    v_mfma_f32_16x16x32_bf16 v[164:167], v[116:119], v[88:91], v[164:167]
    ds_read_b128 v[36:39], v16 offset:2048
    v_mfma_f32_16x16x32_bf16 v[168:171], v[120:123], v[88:91], v[168:171]
    ds_read_b128 v[40:43], v16 offset:4096
    v_mfma_f32_16x16x32_bf16 v[172:175], v[124:127], v[88:91], v[172:175]
    ds_read_b128 v[44:47], v16 offset:6144
    v_mfma_f32_16x16x32_bf16 v[176:179], v[112:115], v[92:95], v[176:179]
    ds_read_b128 v[48:51], v16 offset:8192
    v_mfma_f32_16x16x32_bf16 v[180:183], v[116:119], v[92:95], v[180:183]
    ds_read_b128 v[52:55], v16 offset:10240
    v_mfma_f32_16x16x32_bf16 v[184:187], v[120:123], v[92:95], v[184:187]
    ds_read_b128 v[56:59], v16 offset:12288
    v_mfma_f32_16x16x32_bf16 v[188:191], v[124:127], v[92:95], v[188:191]
    ds_read_b128 v[60:63], v16 offset:14336
    v_mfma_f32_16x16x32_bf16 v[192:195], v[112:115], v[96:99], v[192:195]
    v_mfma_f32_16x16x32_bf16 v[196:199], v[116:119], v[96:99], v[196:199]
    v_mfma_f32_16x16x32_bf16 v[200:203], v[120:123], v[96:99], v[200:203]
    v_mfma_f32_16x16x32_bf16 v[204:207], v[124:127], v[96:99], v[204:207]
    v_mfma_f32_16x16x32_bf16 v[208:211], v[112:115], v[100:103], v[208:211]
    v_mfma_f32_16x16x32_bf16 v[212:215], v[116:119], v[100:103], v[212:215]
    v_mfma_f32_16x16x32_bf16 v[216:219], v[120:123], v[100:103], v[216:219]
    v_mfma_f32_16x16x32_bf16 v[220:223], v[124:127], v[100:103], v[220:223]
    v_mfma_f32_16x16x32_bf16 v[224:227], v[112:115], v[104:107], v[224:227]
    v_mfma_f32_16x16x32_bf16 v[228:231], v[116:119], v[104:107], v[228:231]
    v_mfma_f32_16x16x32_bf16 v[232:235], v[120:123], v[104:107], v[232:235]
    v_mfma_f32_16x16x32_bf16 v[236:239], v[124:127], v[104:107], v[236:239]
    v_mfma_f32_16x16x32_bf16 v[240:243], v[112:115], v[108:111], v[240:243]
    v_mfma_f32_16x16x32_bf16 v[244:247], v[116:119], v[108:111], v[244:247]
    v_mfma_f32_16x16x32_bf16 v[248:251], v[120:123], v[108:111], v[248:251]
    v_mfma_f32_16x16x32_bf16 v[252:255], v[124:127], v[108:111], v[252:255]
    s_waitcnt lgkmcnt(0)
    v_mfma_f32_16x16x32_bf16 v[128:131], v[64:67], v[32:35], v[128:131]
    ds_read_b64_tr_b16 v[112:113], v18 offset:49152
    v_mfma_f32_16x16x32_bf16 v[132:135], v[68:71], v[32:35], v[132:135]
    ds_read_b64_tr_b16 v[114:115], v18 offset:51200
    v_mfma_f32_16x16x32_bf16 v[136:139], v[72:75], v[32:35], v[136:139]
    ds_read_b64_tr_b16 v[116:117], v19 offset:49152
    v_mfma_f32_16x16x32_bf16 v[140:143], v[76:79], v[32:35], v[140:143]
    ds_read_b64_tr_b16 v[118:119], v19 offset:51200
    v_mfma_f32_16x16x32_bf16 v[144:147], v[64:67], v[36:39], v[144:147]
    ds_read_b64_tr_b16 v[120:121], v20 offset:49152
    v_mfma_f32_16x16x32_bf16 v[148:151], v[68:71], v[36:39], v[148:151]
    ds_read_b64_tr_b16 v[122:123], v20 offset:51200
    v_mfma_f32_16x16x32_bf16 v[152:155], v[72:75], v[36:39], v[152:155]
    ds_read_b64_tr_b16 v[124:125], v21 offset:49152
    v_mfma_f32_16x16x32_bf16 v[156:159], v[76:79], v[36:39], v[156:159]
    ds_read_b64_tr_b16 v[126:127], v21 offset:51200
    v_mfma_f32_16x16x32_bf16 v[160:163], v[64:67], v[40:43], v[160:163]
    ds_read_b128 v[80:83], v17 offset:0
    v_mfma_f32_16x16x32_bf16 v[164:167], v[68:71], v[40:43], v[164:167]
    ds_read_b128 v[84:87], v17 offset:2048
    v_mfma_f32_16x16x32_bf16 v[168:171], v[72:75], v[40:43], v[168:171]
    ds_read_b128 v[88:91], v17 offset:4096
    v_mfma_f32_16x16x32_bf16 v[172:175], v[76:79], v[40:43], v[172:175]
    ds_read_b128 v[92:95], v17 offset:6144
    v_mfma_f32_16x16x32_bf16 v[176:179], v[64:67], v[44:47], v[176:179]
    ds_read_b128 v[96:99], v17 offset:8192
    v_mfma_f32_16x16x32_bf16 v[180:183], v[68:71], v[44:47], v[180:183]
    ds_read_b128 v[100:103], v17 offset:10240
    v_mfma_f32_16x16x32_bf16 v[184:187], v[72:75], v[44:47], v[184:187]
    ds_read_b128 v[104:107], v17 offset:12288
    v_mfma_f32_16x16x32_bf16 v[188:191], v[76:79], v[44:47], v[188:191]
    ds_read_b128 v[108:111], v17 offset:14336
    v_mfma_f32_16x16x32_bf16 v[192:195], v[64:67], v[48:51], v[192:195]
    v_xor_b32 v16, 65536, v16
    v_mfma_f32_16x16x32_bf16 v[196:199], v[68:71], v[48:51], v[196:199]
    v_xor_b32 v17, 65536, v17
    v_mfma_f32_16x16x32_bf16 v[200:203], v[72:75], v[48:51], v[200:203]
    v_xor_b32 v18, 65536, v18
    v_mfma_f32_16x16x32_bf16 v[204:207], v[76:79], v[48:51], v[204:207]
    v_xor_b32 v19, 65536, v19
    v_mfma_f32_16x16x32_bf16 v[208:211], v[64:67], v[52:55], v[208:211]
    v_xor_b32 v20, 65536, v20
    v_mfma_f32_16x16x32_bf16 v[212:215], v[68:71], v[52:55], v[212:215]
    v_xor_b32 v21, 65536, v21
    v_mfma_f32_16x16x32_bf16 v[216:219], v[72:75], v[52:55], v[216:219]
    v_mfma_f32_16x16x32_bf16 v[220:223], v[76:79], v[52:55], v[220:223]
    v_mfma_f32_16x16x32_bf16 v[224:227], v[64:67], v[56:59], v[224:227]
    v_mfma_f32_16x16x32_bf16 v[228:231], v[68:71], v[56:59], v[228:231]
    v_mfma_f32_16x16x32_bf16 v[232:235], v[72:75], v[56:59], v[232:235]
    v_mfma_f32_16x16x32_bf16 v[236:239], v[76:79], v[56:59], v[236:239]
    v_mfma_f32_16x16x32_bf16 v[240:243], v[64:67], v[60:63], v[240:243]
    v_mfma_f32_16x16x32_bf16 v[244:247], v[68:71], v[60:63], v[244:247]
    v_mfma_f32_16x16x32_bf16 v[248:251], v[72:75], v[60:63], v[248:251]
    v_mfma_f32_16x16x32_bf16 v[252:255], v[76:79], v[60:63], v[252:255]
    s_waitcnt lgkmcnt(0)
    v_mfma_f32_16x16x32_bf16 v[128:131], v[112:115], v[80:83], v[128:131]
    v_mfma_f32_16x16x32_bf16 v[132:135], v[116:119], v[80:83], v[132:135]
    v_mfma_f32_16x16x32_bf16 v[136:139], v[120:123], v[80:83], v[136:139]
    v_mfma_f32_16x16x32_bf16 v[140:143], v[124:127], v[80:83], v[140:143]
    v_mfma_f32_16x16x32_bf16 v[144:147], v[112:115], v[84:87], v[144:147]
    v_mfma_f32_16x16x32_bf16 v[148:151], v[116:119], v[84:87], v[148:151]
    v_mfma_f32_16x16x32_bf16 v[152:155], v[120:123], v[84:87], v[152:155]
    v_mfma_f32_16x16x32_bf16 v[156:159], v[124:127], v[84:87], v[156:159]
    v_mfma_f32_16x16x32_bf16 v[160:163], v[112:115], v[88:91], v[160:163]
    v_mfma_f32_16x16x32_bf16 v[164:167], v[116:119], v[88:91], v[164:167]
    v_mfma_f32_16x16x32_bf16 v[168:171], v[120:123], v[88:91], v[168:171]
    v_mfma_f32_16x16x32_bf16 v[172:175], v[124:127], v[88:91], v[172:175]
    v_mfma_f32_16x16x32_bf16 v[176:179], v[112:115], v[92:95], v[176:179]
    v_mfma_f32_16x16x32_bf16 v[180:183], v[116:119], v[92:95], v[180:183]
    v_mfma_f32_16x16x32_bf16 v[184:187], v[120:123], v[92:95], v[184:187]
    v_mfma_f32_16x16x32_bf16 v[188:191], v[124:127], v[92:95], v[188:191]
    v_mfma_f32_16x16x32_bf16 v[192:195], v[112:115], v[96:99], v[192:195]
    v_mfma_f32_16x16x32_bf16 v[196:199], v[116:119], v[96:99], v[196:199]
    v_mfma_f32_16x16x32_bf16 v[200:203], v[120:123], v[96:99], v[200:203]
    v_mfma_f32_16x16x32_bf16 v[204:207], v[124:127], v[96:99], v[204:207]
    v_mfma_f32_16x16x32_bf16 v[208:211], v[112:115], v[100:103], v[208:211]
    v_mfma_f32_16x16x32_bf16 v[212:215], v[116:119], v[100:103], v[212:215]
    v_mfma_f32_16x16x32_bf16 v[216:219], v[120:123], v[100:103], v[216:219]
    v_mfma_f32_16x16x32_bf16 v[220:223], v[124:127], v[100:103], v[220:223]
    v_mfma_f32_16x16x32_bf16 v[224:227], v[112:115], v[104:107], v[224:227]
    v_mfma_f32_16x16x32_bf16 v[228:231], v[116:119], v[104:107], v[228:231]
    v_mfma_f32_16x16x32_bf16 v[232:235], v[120:123], v[104:107], v[232:235]
    v_mfma_f32_16x16x32_bf16 v[236:239], v[124:127], v[104:107], v[236:239]
    v_mfma_f32_16x16x32_bf16 v[240:243], v[112:115], v[108:111], v[240:243]
    v_mfma_f32_16x16x32_bf16 v[244:247], v[116:119], v[108:111], v[244:247]
    v_mfma_f32_16x16x32_bf16 v[248:251], v[120:123], v[108:111], v[248:251]
    v_mfma_f32_16x16x32_bf16 v[252:255], v[124:127], v[108:111], v[252:255]
    s_nop 7
LE_AQ:
    v_mov_b32 v3, 163584
    s_cmp_lg_u32 s26, 0
    s_cbranch_scc1 tt_182
    s_waitcnt vmcnt(0)
    s_mov_b64 exec, 1
    ds_write_b32 v3, v28
    s_waitcnt lgkmcnt(0)
    s_mov_b64 exec, -1
tt_182:
    s_barrier
    ds_read_b32 v5, v3
    s_waitcnt lgkmcnt(0)
    v_readfirstlane_b32 s25, v5
    s_nop 3
    s_min_u32 s3, s25, 204
    s_lshl_b32 s3, s3, 2
    s_load_dword s7, s[50:51], s3
    s_waitcnt lgkmcnt(0)
E_AQ:
    s_mov_b32 s46, 0x3fb8aa3b
    s_mov_b32 s47, 0x358637bd
    s_mov_b32 s48, 0xffff0000
    v_mov_b32 v22, s46
    v_mov_b32 v23, s47
    v_cvt_pk_bf16_f32 v24, v128, v129
    v_cvt_pk_bf16_f32 v25, v130, v131
    v_cvt_pk_bf16_f32 v26, v132, v133
    v_cvt_pk_bf16_f32 v27, v134, v135
    v_lshlrev_b32 v128, 16, v24
    v_and_b32 v129, s48, v24
    v_lshlrev_b32 v130, 16, v25
    v_and_b32 v131, s48, v25
    v_lshlrev_b32 v132, 16, v26
    v_and_b32 v133, s48, v26
    v_lshlrev_b32 v134, 16, v27
    v_and_b32 v135, s48, v27
    v_pk_mul_f32 v[24:25], v[128:129], v[22:23] op_sel_hi:[1,0]
    v_pk_mul_f32 v[26:27], v[130:131], v[22:23] op_sel_hi:[1,0]
    v_pk_mul_f32 v[28:29], v[132:133], v[22:23] op_sel_hi:[1,0]
    v_pk_mul_f32 v[30:31], v[134:135], v[22:23] op_sel_hi:[1,0]
    v_exp_f32 v24, v24 clamp
    v_exp_f32 v25, v25 clamp
    v_exp_f32 v26, v26 clamp
    v_exp_f32 v27, v27 clamp
    v_exp_f32 v28, v28 clamp
    v_exp_f32 v29, v29 clamp
    v_exp_f32 v30, v30 clamp
    v_exp_f32 v31, v31 clamp
    v_maximum3_f32 v128, v128, 0, 0
    v_maximum3_f32 v129, v129, 0, 0
    v_maximum3_f32 v130, v130, 0, 0
    v_maximum3_f32 v131, v131, 0, 0
    v_maximum3_f32 v132, v132, 0, 0
    v_maximum3_f32 v133, v133, 0, 0
    v_maximum3_f32 v134, v134, 0, 0
    v_maximum3_f32 v135, v135, 0, 0
    v_pk_add_f32 v[24:25], v[24:25], v[22:23] op_sel:[0,1] op_sel_hi:[1,1]
    v_pk_add_f32 v[26:27], v[26:27], v[22:23] op_sel:[0,1] op_sel_hi:[1,1]
    v_pk_add_f32 v[28:29], v[28:29], v[22:23] op_sel:[0,1] op_sel_hi:[1,1]
    v_pk_add_f32 v[30:31], v[30:31], v[22:23] op_sel:[0,1] op_sel_hi:[1,1]
    v_pk_add_f32 v[128:129], v[128:129], v[24:25]
    v_pk_add_f32 v[130:131], v[130:131], v[26:27]
    v_pk_add_f32 v[132:133], v[132:133], v[28:29]
    v_pk_add_f32 v[134:135], v[134:135], v[30:31]
    v_cvt_pk_bf16_f32 v64, v128, v129
    v_cvt_pk_bf16_f32 v65, v130, v131
    v_cvt_pk_bf16_f32 v66, v132, v133
    v_cvt_pk_bf16_f32 v67, v134, v135
    v_cvt_pk_bf16_f32 v24, v136, v137
    v_cvt_pk_bf16_f32 v25, v138, v139
    v_cvt_pk_bf16_f32 v26, v140, v141
    v_cvt_pk_bf16_f32 v27, v142, v143
    v_lshlrev_b32 v136, 16, v24
    v_and_b32 v137, s48, v24
    v_lshlrev_b32 v138, 16, v25
    v_and_b32 v139, s48, v25
    v_lshlrev_b32 v140, 16, v26
    v_and_b32 v141, s48, v26
    v_lshlrev_b32 v142, 16, v27
    v_and_b32 v143, s48, v27
    v_pk_mul_f32 v[24:25], v[136:137], v[22:23] op_sel_hi:[1,0]
    v_pk_mul_f32 v[26:27], v[138:139], v[22:23] op_sel_hi:[1,0]
    v_pk_mul_f32 v[28:29], v[140:141], v[22:23] op_sel_hi:[1,0]
    v_pk_mul_f32 v[30:31], v[142:143], v[22:23] op_sel_hi:[1,0]
    v_exp_f32 v24, v24 clamp
    v_exp_f32 v25, v25 clamp
    v_exp_f32 v26, v26 clamp
    v_exp_f32 v27, v27 clamp
    v_exp_f32 v28, v28 clamp
    v_exp_f32 v29, v29 clamp
    v_exp_f32 v30, v30 clamp
    v_exp_f32 v31, v31 clamp
    v_maximum3_f32 v136, v136, 0, 0
    v_maximum3_f32 v137, v137, 0, 0
    v_maximum3_f32 v138, v138, 0, 0
    v_maximum3_f32 v139, v139, 0, 0
    v_maximum3_f32 v140, v140, 0, 0
    v_maximum3_f32 v141, v141, 0, 0
    v_maximum3_f32 v142, v142, 0, 0
    v_maximum3_f32 v143, v143, 0, 0
    v_pk_add_f32 v[24:25], v[24:25], v[22:23] op_sel:[0,1] op_sel_hi:[1,1]
    v_pk_add_f32 v[26:27], v[26:27], v[22:23] op_sel:[0,1] op_sel_hi:[1,1]
    v_pk_add_f32 v[28:29], v[28:29], v[22:23] op_sel:[0,1] op_sel_hi:[1,1]
    v_pk_add_f32 v[30:31], v[30:31], v[22:23] op_sel:[0,1] op_sel_hi:[1,1]
    v_pk_add_f32 v[136:137], v[136:137], v[24:25]
    v_pk_add_f32 v[138:139], v[138:139], v[26:27]
    v_pk_add_f32 v[140:141], v[140:141], v[28:29]
    v_pk_add_f32 v[142:143], v[142:143], v[30:31]
    v_cvt_pk_bf16_f32 v68, v136, v137
    v_cvt_pk_bf16_f32 v69, v138, v139
    v_cvt_pk_bf16_f32 v70, v140, v141
    v_cvt_pk_bf16_f32 v71, v142, v143
    v_cvt_pk_bf16_f32 v24, v144, v145
    v_cvt_pk_bf16_f32 v25, v146, v147
    v_cvt_pk_bf16_f32 v26, v148, v149
    v_cvt_pk_bf16_f32 v27, v150, v151
    v_lshlrev_b32 v144, 16, v24
    v_and_b32 v145, s48, v24
    v_lshlrev_b32 v146, 16, v25
    v_and_b32 v147, s48, v25
    v_lshlrev_b32 v148, 16, v26
    v_and_b32 v149, s48, v26
    v_lshlrev_b32 v150, 16, v27
    v_and_b32 v151, s48, v27
    v_pk_mul_f32 v[24:25], v[144:145], v[22:23] op_sel_hi:[1,0]
    v_pk_mul_f32 v[26:27], v[146:147], v[22:23] op_sel_hi:[1,0]
    v_pk_mul_f32 v[28:29], v[148:149], v[22:23] op_sel_hi:[1,0]
    v_pk_mul_f32 v[30:31], v[150:151], v[22:23] op_sel_hi:[1,0]
    v_exp_f32 v24, v24 clamp
    v_exp_f32 v25, v25 clamp
    v_exp_f32 v26, v26 clamp
    v_exp_f32 v27, v27 clamp
    v_exp_f32 v28, v28 clamp
    v_exp_f32 v29, v29 clamp
    v_exp_f32 v30, v30 clamp
    v_exp_f32 v31, v31 clamp
    v_maximum3_f32 v144, v144, 0, 0
    v_maximum3_f32 v145, v145, 0, 0
    v_maximum3_f32 v146, v146, 0, 0
    v_maximum3_f32 v147, v147, 0, 0
    v_maximum3_f32 v148, v148, 0, 0
    v_maximum3_f32 v149, v149, 0, 0
    v_maximum3_f32 v150, v150, 0, 0
    v_maximum3_f32 v151, v151, 0, 0
    v_pk_add_f32 v[24:25], v[24:25], v[22:23] op_sel:[0,1] op_sel_hi:[1,1]
    v_pk_add_f32 v[26:27], v[26:27], v[22:23] op_sel:[0,1] op_sel_hi:[1,1]
    v_pk_add_f32 v[28:29], v[28:29], v[22:23] op_sel:[0,1] op_sel_hi:[1,1]
    v_pk_add_f32 v[30:31], v[30:31], v[22:23] op_sel:[0,1] op_sel_hi:[1,1]
    v_pk_add_f32 v[144:145], v[144:145], v[24:25]
    v_pk_add_f32 v[146:147], v[146:147], v[26:27]
    v_pk_add_f32 v[148:149], v[148:149], v[28:29]
    v_pk_add_f32 v[150:151], v[150:151], v[30:31]
    v_cvt_pk_bf16_f32 v72, v144, v145
    v_cvt_pk_bf16_f32 v73, v146, v147
    v_cvt_pk_bf16_f32 v74, v148, v149
    v_cvt_pk_bf16_f32 v75, v150, v151
    v_cvt_pk_bf16_f32 v24, v152, v153
    v_cvt_pk_bf16_f32 v25, v154, v155
    v_cvt_pk_bf16_f32 v26, v156, v157
    v_cvt_pk_bf16_f32 v27, v158, v159
    v_lshlrev_b32 v152, 16, v24
    v_and_b32 v153, s48, v24
    v_lshlrev_b32 v154, 16, v25
    v_and_b32 v155, s48, v25
    v_lshlrev_b32 v156, 16, v26
    v_and_b32 v157, s48, v26
    v_lshlrev_b32 v158, 16, v27
    v_and_b32 v159, s48, v27
    v_pk_mul_f32 v[24:25], v[152:153], v[22:23] op_sel_hi:[1,0]
    v_pk_mul_f32 v[26:27], v[154:155], v[22:23] op_sel_hi:[1,0]
    v_pk_mul_f32 v[28:29], v[156:157], v[22:23] op_sel_hi:[1,0]
    v_pk_mul_f32 v[30:31], v[158:159], v[22:23] op_sel_hi:[1,0]
    v_exp_f32 v24, v24 clamp
    v_exp_f32 v25, v25 clamp
    v_exp_f32 v26, v26 clamp
    v_exp_f32 v27, v27 clamp
    v_exp_f32 v28, v28 clamp
    v_exp_f32 v29, v29 clamp
    v_exp_f32 v30, v30 clamp
    v_exp_f32 v31, v31 clamp
    v_maximum3_f32 v152, v152, 0, 0
    v_maximum3_f32 v153, v153, 0, 0
    v_maximum3_f32 v154, v154, 0, 0
    v_maximum3_f32 v155, v155, 0, 0
    v_maximum3_f32 v156, v156, 0, 0
    v_maximum3_f32 v157, v157, 0, 0
    v_maximum3_f32 v158, v158, 0, 0
    v_maximum3_f32 v159, v159, 0, 0
    v_pk_add_f32 v[24:25], v[24:25], v[22:23] op_sel:[0,1] op_sel_hi:[1,1]
    v_pk_add_f32 v[26:27], v[26:27], v[22:23] op_sel:[0,1] op_sel_hi:[1,1]
    v_pk_add_f32 v[28:29], v[28:29], v[22:23] op_sel:[0,1] op_sel_hi:[1,1]
    v_pk_add_f32 v[30:31], v[30:31], v[22:23] op_sel:[0,1] op_sel_hi:[1,1]
    v_pk_add_f32 v[152:153], v[152:153], v[24:25]
    v_pk_add_f32 v[154:155], v[154:155], v[26:27]
    v_pk_add_f32 v[156:157], v[156:157], v[28:29]
    v_pk_add_f32 v[158:159], v[158:159], v[30:31]
    v_cvt_pk_bf16_f32 v76, v152, v153
    v_cvt_pk_bf16_f32 v77, v154, v155
    v_cvt_pk_bf16_f32 v78, v156, v157
    v_cvt_pk_bf16_f32 v79, v158, v159
    v_cvt_pk_bf16_f32 v24, v160, v161
    v_cvt_pk_bf16_f32 v25, v162, v163
    v_cvt_pk_bf16_f32 v26, v164, v165
    v_cvt_pk_bf16_f32 v27, v166, v167
    v_lshlrev_b32 v160, 16, v24
    v_and_b32 v161, s48, v24
    v_lshlrev_b32 v162, 16, v25
    v_and_b32 v163, s48, v25
    v_lshlrev_b32 v164, 16, v26
    v_and_b32 v165, s48, v26
    v_lshlrev_b32 v166, 16, v27
    v_and_b32 v167, s48, v27
    v_pk_mul_f32 v[24:25], v[160:161], v[22:23] op_sel_hi:[1,0]
    v_pk_mul_f32 v[26:27], v[162:163], v[22:23] op_sel_hi:[1,0]
    v_pk_mul_f32 v[28:29], v[164:165], v[22:23] op_sel_hi:[1,0]
    v_pk_mul_f32 v[30:31], v[166:167], v[22:23] op_sel_hi:[1,0]
    v_exp_f32 v24, v24 clamp
    v_exp_f32 v25, v25 clamp
    v_exp_f32 v26, v26 clamp
    v_exp_f32 v27, v27 clamp
    v_exp_f32 v28, v28 clamp
    v_exp_f32 v29, v29 clamp
    v_exp_f32 v30, v30 clamp
    v_exp_f32 v31, v31 clamp
    v_maximum3_f32 v160, v160, 0, 0
    v_maximum3_f32 v161, v161, 0, 0
    v_maximum3_f32 v162, v162, 0, 0
    v_maximum3_f32 v163, v163, 0, 0
    v_maximum3_f32 v164, v164, 0, 0
    v_maximum3_f32 v165, v165, 0, 0
    v_maximum3_f32 v166, v166, 0, 0
    v_maximum3_f32 v167, v167, 0, 0
    v_pk_add_f32 v[24:25], v[24:25], v[22:23] op_sel:[0,1] op_sel_hi:[1,1]
    v_pk_add_f32 v[26:27], v[26:27], v[22:23] op_sel:[0,1] op_sel_hi:[1,1]
    v_pk_add_f32 v[28:29], v[28:29], v[22:23] op_sel:[0,1] op_sel_hi:[1,1]
    v_pk_add_f32 v[30:31], v[30:31], v[22:23] op_sel:[0,1] op_sel_hi:[1,1]
    v_pk_add_f32 v[160:161], v[160:161], v[24:25]
    v_pk_add_f32 v[162:163], v[162:163], v[26:27]
    v_pk_add_f32 v[164:165], v[164:165], v[28:29]
    v_pk_add_f32 v[166:167], v[166:167], v[30:31]
    v_cvt_pk_bf16_f32 v80, v160, v161
    v_cvt_pk_bf16_f32 v81, v162, v163
    v_cvt_pk_bf16_f32 v82, v164, v165
    v_cvt_pk_bf16_f32 v83, v166, v167
    v_cvt_pk_bf16_f32 v24, v168, v169
    v_cvt_pk_bf16_f32 v25, v170, v171
    v_cvt_pk_bf16_f32 v26, v172, v173
    v_cvt_pk_bf16_f32 v27, v174, v175
    v_lshlrev_b32 v168, 16, v24
    v_and_b32 v169, s48, v24
    v_lshlrev_b32 v170, 16, v25
    v_and_b32 v171, s48, v25
    v_lshlrev_b32 v172, 16, v26
    v_and_b32 v173, s48, v26
    v_lshlrev_b32 v174, 16, v27
    v_and_b32 v175, s48, v27
    v_pk_mul_f32 v[24:25], v[168:169], v[22:23] op_sel_hi:[1,0]
    v_pk_mul_f32 v[26:27], v[170:171], v[22:23] op_sel_hi:[1,0]
    v_pk_mul_f32 v[28:29], v[172:173], v[22:23] op_sel_hi:[1,0]
    v_pk_mul_f32 v[30:31], v[174:175], v[22:23] op_sel_hi:[1,0]
    v_exp_f32 v24, v24 clamp
    v_exp_f32 v25, v25 clamp
    v_exp_f32 v26, v26 clamp
    v_exp_f32 v27, v27 clamp
    v_exp_f32 v28, v28 clamp
    v_exp_f32 v29, v29 clamp
    v_exp_f32 v30, v30 clamp
    v_exp_f32 v31, v31 clamp
    v_maximum3_f32 v168, v168, 0, 0
    v_maximum3_f32 v169, v169, 0, 0
    v_maximum3_f32 v170, v170, 0, 0
    v_maximum3_f32 v171, v171, 0, 0
    v_maximum3_f32 v172, v172, 0, 0
    v_maximum3_f32 v173, v173, 0, 0
    v_maximum3_f32 v174, v174, 0, 0
    v_maximum3_f32 v175, v175, 0, 0
    v_pk_add_f32 v[24:25], v[24:25], v[22:23] op_sel:[0,1] op_sel_hi:[1,1]
    v_pk_add_f32 v[26:27], v[26:27], v[22:23] op_sel:[0,1] op_sel_hi:[1,1]
    v_pk_add_f32 v[28:29], v[28:29], v[22:23] op_sel:[0,1] op_sel_hi:[1,1]
    v_pk_add_f32 v[30:31], v[30:31], v[22:23] op_sel:[0,1] op_sel_hi:[1,1]
    v_pk_add_f32 v[168:169], v[168:169], v[24:25]
    v_pk_add_f32 v[170:171], v[170:171], v[26:27]
    v_pk_add_f32 v[172:173], v[172:173], v[28:29]
    v_pk_add_f32 v[174:175], v[174:175], v[30:31]
    v_cvt_pk_bf16_f32 v84, v168, v169
    v_cvt_pk_bf16_f32 v85, v170, v171
    v_cvt_pk_bf16_f32 v86, v172, v173
    v_cvt_pk_bf16_f32 v87, v174, v175
    v_cvt_pk_bf16_f32 v24, v176, v177
    v_cvt_pk_bf16_f32 v25, v178, v179
    v_cvt_pk_bf16_f32 v26, v180, v181
    v_cvt_pk_bf16_f32 v27, v182, v183
    v_lshlrev_b32 v176, 16, v24
    v_and_b32 v177, s48, v24
    v_lshlrev_b32 v178, 16, v25
    v_and_b32 v179, s48, v25
    v_lshlrev_b32 v180, 16, v26
    v_and_b32 v181, s48, v26
    v_lshlrev_b32 v182, 16, v27
    v_and_b32 v183, s48, v27
    v_pk_mul_f32 v[24:25], v[176:177], v[22:23] op_sel_hi:[1,0]
    v_pk_mul_f32 v[26:27], v[178:179], v[22:23] op_sel_hi:[1,0]
    v_pk_mul_f32 v[28:29], v[180:181], v[22:23] op_sel_hi:[1,0]
    v_pk_mul_f32 v[30:31], v[182:183], v[22:23] op_sel_hi:[1,0]
    v_exp_f32 v24, v24 clamp
    v_exp_f32 v25, v25 clamp
    v_exp_f32 v26, v26 clamp
    v_exp_f32 v27, v27 clamp
    v_exp_f32 v28, v28 clamp
    v_exp_f32 v29, v29 clamp
    v_exp_f32 v30, v30 clamp
    v_exp_f32 v31, v31 clamp
    v_maximum3_f32 v176, v176, 0, 0
    v_maximum3_f32 v177, v177, 0, 0
    v_maximum3_f32 v178, v178, 0, 0
    v_maximum3_f32 v179, v179, 0, 0
    v_maximum3_f32 v180, v180, 0, 0
    v_maximum3_f32 v181, v181, 0, 0
    v_maximum3_f32 v182, v182, 0, 0
    v_maximum3_f32 v183, v183, 0, 0
    v_pk_add_f32 v[24:25], v[24:25], v[22:23] op_sel:[0,1] op_sel_hi:[1,1]
    v_pk_add_f32 v[26:27], v[26:27], v[22:23] op_sel:[0,1] op_sel_hi:[1,1]
    v_pk_add_f32 v[28:29], v[28:29], v[22:23] op_sel:[0,1] op_sel_hi:[1,1]
    v_pk_add_f32 v[30:31], v[30:31], v[22:23] op_sel:[0,1] op_sel_hi:[1,1]
    v_pk_add_f32 v[176:177], v[176:177], v[24:25]
    v_pk_add_f32 v[178:179], v[178:179], v[26:27]
    v_pk_add_f32 v[180:181], v[180:181], v[28:29]
    v_pk_add_f32 v[182:183], v[182:183], v[30:31]
    v_cvt_pk_bf16_f32 v88, v176, v177
    v_cvt_pk_bf16_f32 v89, v178, v179
    v_cvt_pk_bf16_f32 v90, v180, v181
    v_cvt_pk_bf16_f32 v91, v182, v183
    v_cvt_pk_bf16_f32 v24, v184, v185
    v_cvt_pk_bf16_f32 v25, v186, v187
    v_cvt_pk_bf16_f32 v26, v188, v189
    v_cvt_pk_bf16_f32 v27, v190, v191
    v_lshlrev_b32 v184, 16, v24
    v_and_b32 v185, s48, v24
    v_lshlrev_b32 v186, 16, v25
    v_and_b32 v187, s48, v25
    v_lshlrev_b32 v188, 16, v26
    v_and_b32 v189, s48, v26
    v_lshlrev_b32 v190, 16, v27
    v_and_b32 v191, s48, v27
    v_pk_mul_f32 v[24:25], v[184:185], v[22:23] op_sel_hi:[1,0]
    v_pk_mul_f32 v[26:27], v[186:187], v[22:23] op_sel_hi:[1,0]
    v_pk_mul_f32 v[28:29], v[188:189], v[22:23] op_sel_hi:[1,0]
    v_pk_mul_f32 v[30:31], v[190:191], v[22:23] op_sel_hi:[1,0]
    v_exp_f32 v24, v24 clamp
    v_exp_f32 v25, v25 clamp
    v_exp_f32 v26, v26 clamp
    v_exp_f32 v27, v27 clamp
    v_exp_f32 v28, v28 clamp
    v_exp_f32 v29, v29 clamp
    v_exp_f32 v30, v30 clamp
    v_exp_f32 v31, v31 clamp
    v_maximum3_f32 v184, v184, 0, 0
    v_maximum3_f32 v185, v185, 0, 0
    v_maximum3_f32 v186, v186, 0, 0
    v_maximum3_f32 v187, v187, 0, 0
    v_maximum3_f32 v188, v188, 0, 0
    v_maximum3_f32 v189, v189, 0, 0
    v_maximum3_f32 v190, v190, 0, 0
    v_maximum3_f32 v191, v191, 0, 0
    v_pk_add_f32 v[24:25], v[24:25], v[22:23] op_sel:[0,1] op_sel_hi:[1,1]
    v_pk_add_f32 v[26:27], v[26:27], v[22:23] op_sel:[0,1] op_sel_hi:[1,1]
    v_pk_add_f32 v[28:29], v[28:29], v[22:23] op_sel:[0,1] op_sel_hi:[1,1]
    v_pk_add_f32 v[30:31], v[30:31], v[22:23] op_sel:[0,1] op_sel_hi:[1,1]
    v_pk_add_f32 v[184:185], v[184:185], v[24:25]
    v_pk_add_f32 v[186:187], v[186:187], v[26:27]
    v_pk_add_f32 v[188:189], v[188:189], v[28:29]
    v_pk_add_f32 v[190:191], v[190:191], v[30:31]
    v_cvt_pk_bf16_f32 v92, v184, v185
    v_cvt_pk_bf16_f32 v93, v186, v187
    v_cvt_pk_bf16_f32 v94, v188, v189
    v_cvt_pk_bf16_f32 v95, v190, v191
    v_cvt_pk_bf16_f32 v24, v192, v193
    v_cvt_pk_bf16_f32 v25, v194, v195
    v_cvt_pk_bf16_f32 v26, v196, v197
    v_cvt_pk_bf16_f32 v27, v198, v199
    v_lshlrev_b32 v192, 16, v24
    v_and_b32 v193, s48, v24
    v_lshlrev_b32 v194, 16, v25
    v_and_b32 v195, s48, v25
    v_lshlrev_b32 v196, 16, v26
    v_and_b32 v197, s48, v26
    v_lshlrev_b32 v198, 16, v27
    v_and_b32 v199, s48, v27
    v_pk_mul_f32 v[24:25], v[192:193], v[22:23] op_sel_hi:[1,0]
    v_pk_mul_f32 v[26:27], v[194:195], v[22:23] op_sel_hi:[1,0]
    v_pk_mul_f32 v[28:29], v[196:197], v[22:23] op_sel_hi:[1,0]
    v_pk_mul_f32 v[30:31], v[198:199], v[22:23] op_sel_hi:[1,0]
    v_exp_f32 v24, v24 clamp
    v_exp_f32 v25, v25 clamp
    v_exp_f32 v26, v26 clamp
    v_exp_f32 v27, v27 clamp
    v_exp_f32 v28, v28 clamp
    v_exp_f32 v29, v29 clamp
    v_exp_f32 v30, v30 clamp
    v_exp_f32 v31, v31 clamp
    v_maximum3_f32 v192, v192, 0, 0
    v_maximum3_f32 v193, v193, 0, 0
    v_maximum3_f32 v194, v194, 0, 0
    v_maximum3_f32 v195, v195, 0, 0
    v_maximum3_f32 v196, v196, 0, 0
    v_maximum3_f32 v197, v197, 0, 0
    v_maximum3_f32 v198, v198, 0, 0
    v_maximum3_f32 v199, v199, 0, 0
    v_pk_add_f32 v[24:25], v[24:25], v[22:23] op_sel:[0,1] op_sel_hi:[1,1]
    v_pk_add_f32 v[26:27], v[26:27], v[22:23] op_sel:[0,1] op_sel_hi:[1,1]
    v_pk_add_f32 v[28:29], v[28:29], v[22:23] op_sel:[0,1] op_sel_hi:[1,1]
    v_pk_add_f32 v[30:31], v[30:31], v[22:23] op_sel:[0,1] op_sel_hi:[1,1]
    v_pk_add_f32 v[192:193], v[192:193], v[24:25]
    v_pk_add_f32 v[194:195], v[194:195], v[26:27]
    v_pk_add_f32 v[196:197], v[196:197], v[28:29]
    v_pk_add_f32 v[198:199], v[198:199], v[30:31]
    v_cvt_pk_bf16_f32 v96, v192, v193
    v_cvt_pk_bf16_f32 v97, v194, v195
    v_cvt_pk_bf16_f32 v98, v196, v197
    v_cvt_pk_bf16_f32 v99, v198, v199
    v_cvt_pk_bf16_f32 v24, v200, v201
    v_cvt_pk_bf16_f32 v25, v202, v203
    v_cvt_pk_bf16_f32 v26, v204, v205
    v_cvt_pk_bf16_f32 v27, v206, v207
    v_lshlrev_b32 v200, 16, v24
    v_and_b32 v201, s48, v24
    v_lshlrev_b32 v202, 16, v25
    v_and_b32 v203, s48, v25
    v_lshlrev_b32 v204, 16, v26
    v_and_b32 v205, s48, v26
    v_lshlrev_b32 v206, 16, v27
    v_and_b32 v207, s48, v27
    v_pk_mul_f32 v[24:25], v[200:201], v[22:23] op_sel_hi:[1,0]
    v_pk_mul_f32 v[26:27], v[202:203], v[22:23] op_sel_hi:[1,0]
    v_pk_mul_f32 v[28:29], v[204:205], v[22:23] op_sel_hi:[1,0]
    v_pk_mul_f32 v[30:31], v[206:207], v[22:23] op_sel_hi:[1,0]
    v_exp_f32 v24, v24 clamp
    v_exp_f32 v25, v25 clamp
    v_exp_f32 v26, v26 clamp
    v_exp_f32 v27, v27 clamp
    v_exp_f32 v28, v28 clamp
    v_exp_f32 v29, v29 clamp
    v_exp_f32 v30, v30 clamp
    v_exp_f32 v31, v31 clamp
    v_maximum3_f32 v200, v200, 0, 0
    v_maximum3_f32 v201, v201, 0, 0
    v_maximum3_f32 v202, v202, 0, 0
    v_maximum3_f32 v203, v203, 0, 0
    v_maximum3_f32 v204, v204, 0, 0
    v_maximum3_f32 v205, v205, 0, 0
    v_maximum3_f32 v206, v206, 0, 0
    v_maximum3_f32 v207, v207, 0, 0
    v_pk_add_f32 v[24:25], v[24:25], v[22:23] op_sel:[0,1] op_sel_hi:[1,1]
    v_pk_add_f32 v[26:27], v[26:27], v[22:23] op_sel:[0,1] op_sel_hi:[1,1]
    v_pk_add_f32 v[28:29], v[28:29], v[22:23] op_sel:[0,1] op_sel_hi:[1,1]
    v_pk_add_f32 v[30:31], v[30:31], v[22:23] op_sel:[0,1] op_sel_hi:[1,1]
    v_pk_add_f32 v[200:201], v[200:201], v[24:25]
    v_pk_add_f32 v[202:203], v[202:203], v[26:27]
    v_pk_add_f32 v[204:205], v[204:205], v[28:29]
    v_pk_add_f32 v[206:207], v[206:207], v[30:31]
    v_cvt_pk_bf16_f32 v100, v200, v201
    v_cvt_pk_bf16_f32 v101, v202, v203
    v_cvt_pk_bf16_f32 v102, v204, v205
    v_cvt_pk_bf16_f32 v103, v206, v207
    v_cvt_pk_bf16_f32 v24, v208, v209
    v_cvt_pk_bf16_f32 v25, v210, v211
    v_cvt_pk_bf16_f32 v26, v212, v213
    v_cvt_pk_bf16_f32 v27, v214, v215
    v_lshlrev_b32 v208, 16, v24
    v_and_b32 v209, s48, v24
    v_lshlrev_b32 v210, 16, v25
    v_and_b32 v211, s48, v25
    v_lshlrev_b32 v212, 16, v26
    v_and_b32 v213, s48, v26
    v_lshlrev_b32 v214, 16, v27
    v_and_b32 v215, s48, v27
    v_pk_mul_f32 v[24:25], v[208:209], v[22:23] op_sel_hi:[1,0]
    v_pk_mul_f32 v[26:27], v[210:211], v[22:23] op_sel_hi:[1,0]
    v_pk_mul_f32 v[28:29], v[212:213], v[22:23] op_sel_hi:[1,0]
    v_pk_mul_f32 v[30:31], v[214:215], v[22:23] op_sel_hi:[1,0]
    v_exp_f32 v24, v24 clamp
    v_exp_f32 v25, v25 clamp
    v_exp_f32 v26, v26 clamp
    v_exp_f32 v27, v27 clamp
    v_exp_f32 v28, v28 clamp
    v_exp_f32 v29, v29 clamp
    v_exp_f32 v30, v30 clamp
    v_exp_f32 v31, v31 clamp
    v_maximum3_f32 v208, v208, 0, 0
    v_maximum3_f32 v209, v209, 0, 0
    v_maximum3_f32 v210, v210, 0, 0
    v_maximum3_f32 v211, v211, 0, 0
    v_maximum3_f32 v212, v212, 0, 0
    v_maximum3_f32 v213, v213, 0, 0
    v_maximum3_f32 v214, v214, 0, 0
    v_maximum3_f32 v215, v215, 0, 0
    v_pk_add_f32 v[24:25], v[24:25], v[22:23] op_sel:[0,1] op_sel_hi:[1,1]
    v_pk_add_f32 v[26:27], v[26:27], v[22:23] op_sel:[0,1] op_sel_hi:[1,1]
    v_pk_add_f32 v[28:29], v[28:29], v[22:23] op_sel:[0,1] op_sel_hi:[1,1]
    v_pk_add_f32 v[30:31], v[30:31], v[22:23] op_sel:[0,1] op_sel_hi:[1,1]
    v_pk_add_f32 v[208:209], v[208:209], v[24:25]
    v_pk_add_f32 v[210:211], v[210:211], v[26:27]
    v_pk_add_f32 v[212:213], v[212:213], v[28:29]
    v_pk_add_f32 v[214:215], v[214:215], v[30:31]
    v_cvt_pk_bf16_f32 v104, v208, v209
    v_cvt_pk_bf16_f32 v105, v210, v211
    v_cvt_pk_bf16_f32 v106, v212, v213
    v_cvt_pk_bf16_f32 v107, v214, v215
    v_cvt_pk_bf16_f32 v24, v216, v217
    v_cvt_pk_bf16_f32 v25, v218, v219
    v_cvt_pk_bf16_f32 v26, v220, v221
    v_cvt_pk_bf16_f32 v27, v222, v223
    v_lshlrev_b32 v216, 16, v24
    v_and_b32 v217, s48, v24
    v_lshlrev_b32 v218, 16, v25
    v_and_b32 v219, s48, v25
    v_lshlrev_b32 v220, 16, v26
    v_and_b32 v221, s48, v26
    v_lshlrev_b32 v222, 16, v27
    v_and_b32 v223, s48, v27
    v_pk_mul_f32 v[24:25], v[216:217], v[22:23] op_sel_hi:[1,0]
    v_pk_mul_f32 v[26:27], v[218:219], v[22:23] op_sel_hi:[1,0]
    v_pk_mul_f32 v[28:29], v[220:221], v[22:23] op_sel_hi:[1,0]
    v_pk_mul_f32 v[30:31], v[222:223], v[22:23] op_sel_hi:[1,0]
    v_exp_f32 v24, v24 clamp
    v_exp_f32 v25, v25 clamp
    v_exp_f32 v26, v26 clamp
    v_exp_f32 v27, v27 clamp
    v_exp_f32 v28, v28 clamp
    v_exp_f32 v29, v29 clamp
    v_exp_f32 v30, v30 clamp
    v_exp_f32 v31, v31 clamp
    v_maximum3_f32 v216, v216, 0, 0
    v_maximum3_f32 v217, v217, 0, 0
    v_maximum3_f32 v218, v218, 0, 0
    v_maximum3_f32 v219, v219, 0, 0
    v_maximum3_f32 v220, v220, 0, 0
    v_maximum3_f32 v221, v221, 0, 0
    v_maximum3_f32 v222, v222, 0, 0
    v_maximum3_f32 v223, v223, 0, 0
    v_pk_add_f32 v[24:25], v[24:25], v[22:23] op_sel:[0,1] op_sel_hi:[1,1]
    v_pk_add_f32 v[26:27], v[26:27], v[22:23] op_sel:[0,1] op_sel_hi:[1,1]
    v_pk_add_f32 v[28:29], v[28:29], v[22:23] op_sel:[0,1] op_sel_hi:[1,1]
    v_pk_add_f32 v[30:31], v[30:31], v[22:23] op_sel:[0,1] op_sel_hi:[1,1]
    v_pk_add_f32 v[216:217], v[216:217], v[24:25]
    v_pk_add_f32 v[218:219], v[218:219], v[26:27]
    v_pk_add_f32 v[220:221], v[220:221], v[28:29]
    v_pk_add_f32 v[222:223], v[222:223], v[30:31]
    v_cvt_pk_bf16_f32 v108, v216, v217
    v_cvt_pk_bf16_f32 v109, v218, v219
    v_cvt_pk_bf16_f32 v110, v220, v221
    v_cvt_pk_bf16_f32 v111, v222, v223
    v_cvt_pk_bf16_f32 v24, v224, v225
    v_cvt_pk_bf16_f32 v25, v226, v227
    v_cvt_pk_bf16_f32 v26, v228, v229
    v_cvt_pk_bf16_f32 v27, v230, v231
    v_lshlrev_b32 v224, 16, v24
    v_and_b32 v225, s48, v24
    v_lshlrev_b32 v226, 16, v25
    v_and_b32 v227, s48, v25
    v_lshlrev_b32 v228, 16, v26
    v_and_b32 v229, s48, v26
    v_lshlrev_b32 v230, 16, v27
    v_and_b32 v231, s48, v27
    v_pk_mul_f32 v[24:25], v[224:225], v[22:23] op_sel_hi:[1,0]
    v_pk_mul_f32 v[26:27], v[226:227], v[22:23] op_sel_hi:[1,0]
    v_pk_mul_f32 v[28:29], v[228:229], v[22:23] op_sel_hi:[1,0]
    v_pk_mul_f32 v[30:31], v[230:231], v[22:23] op_sel_hi:[1,0]
    v_exp_f32 v24, v24 clamp
    v_exp_f32 v25, v25 clamp
    v_exp_f32 v26, v26 clamp
    v_exp_f32 v27, v27 clamp
    v_exp_f32 v28, v28 clamp
    v_exp_f32 v29, v29 clamp
    v_exp_f32 v30, v30 clamp
    v_exp_f32 v31, v31 clamp
    v_maximum3_f32 v224, v224, 0, 0
    v_maximum3_f32 v225, v225, 0, 0
    v_maximum3_f32 v226, v226, 0, 0
    v_maximum3_f32 v227, v227, 0, 0
    v_maximum3_f32 v228, v228, 0, 0
    v_maximum3_f32 v229, v229, 0, 0
    v_maximum3_f32 v230, v230, 0, 0
    v_maximum3_f32 v231, v231, 0, 0
    v_pk_add_f32 v[24:25], v[24:25], v[22:23] op_sel:[0,1] op_sel_hi:[1,1]
    v_pk_add_f32 v[26:27], v[26:27], v[22:23] op_sel:[0,1] op_sel_hi:[1,1]
    v_pk_add_f32 v[28:29], v[28:29], v[22:23] op_sel:[0,1] op_sel_hi:[1,1]
    v_pk_add_f32 v[30:31], v[30:31], v[22:23] op_sel:[0,1] op_sel_hi:[1,1]
    v_pk_add_f32 v[224:225], v[224:225], v[24:25]
    v_pk_add_f32 v[226:227], v[226:227], v[26:27]
    v_pk_add_f32 v[228:229], v[228:229], v[28:29]
    v_pk_add_f32 v[230:231], v[230:231], v[30:31]
    v_cvt_pk_bf16_f32 v112, v224, v225
    v_cvt_pk_bf16_f32 v113, v226, v227
    v_cvt_pk_bf16_f32 v114, v228, v229
    v_cvt_pk_bf16_f32 v115, v230, v231
    v_cvt_pk_bf16_f32 v24, v232, v233
    v_cvt_pk_bf16_f32 v25, v234, v235
    v_cvt_pk_bf16_f32 v26, v236, v237
    v_cvt_pk_bf16_f32 v27, v238, v239
    v_lshlrev_b32 v232, 16, v24
    v_and_b32 v233, s48, v24
    v_lshlrev_b32 v234, 16, v25
    v_and_b32 v235, s48, v25
    v_lshlrev_b32 v236, 16, v26
    v_and_b32 v237, s48, v26
    v_lshlrev_b32 v238, 16, v27
    v_and_b32 v239, s48, v27
    v_pk_mul_f32 v[24:25], v[232:233], v[22:23] op_sel_hi:[1,0]
    v_pk_mul_f32 v[26:27], v[234:235], v[22:23] op_sel_hi:[1,0]
    v_pk_mul_f32 v[28:29], v[236:237], v[22:23] op_sel_hi:[1,0]
    v_pk_mul_f32 v[30:31], v[238:239], v[22:23] op_sel_hi:[1,0]
    v_exp_f32 v24, v24 clamp
    v_exp_f32 v25, v25 clamp
    v_exp_f32 v26, v26 clamp
    v_exp_f32 v27, v27 clamp
    v_exp_f32 v28, v28 clamp
    v_exp_f32 v29, v29 clamp
    v_exp_f32 v30, v30 clamp
    v_exp_f32 v31, v31 clamp
    v_maximum3_f32 v232, v232, 0, 0
    v_maximum3_f32 v233, v233, 0, 0
    v_maximum3_f32 v234, v234, 0, 0
    v_maximum3_f32 v235, v235, 0, 0
    v_maximum3_f32 v236, v236, 0, 0
    v_maximum3_f32 v237, v237, 0, 0
    v_maximum3_f32 v238, v238, 0, 0
    v_maximum3_f32 v239, v239, 0, 0
    v_pk_add_f32 v[24:25], v[24:25], v[22:23] op_sel:[0,1] op_sel_hi:[1,1]
    v_pk_add_f32 v[26:27], v[26:27], v[22:23] op_sel:[0,1] op_sel_hi:[1,1]
    v_pk_add_f32 v[28:29], v[28:29], v[22:23] op_sel:[0,1] op_sel_hi:[1,1]
    v_pk_add_f32 v[30:31], v[30:31], v[22:23] op_sel:[0,1] op_sel_hi:[1,1]
    v_pk_add_f32 v[232:233], v[232:233], v[24:25]
    v_pk_add_f32 v[234:235], v[234:235], v[26:27]
    v_pk_add_f32 v[236:237], v[236:237], v[28:29]
    v_pk_add_f32 v[238:239], v[238:239], v[30:31]
    v_cvt_pk_bf16_f32 v116, v232, v233
    v_cvt_pk_bf16_f32 v117, v234, v235
    v_cvt_pk_bf16_f32 v118, v236, v237
    v_cvt_pk_bf16_f32 v119, v238, v239
    v_cvt_pk_bf16_f32 v24, v240, v241
    v_cvt_pk_bf16_f32 v25, v242, v243
    v_cvt_pk_bf16_f32 v26, v244, v245
    v_cvt_pk_bf16_f32 v27, v246, v247
    v_lshlrev_b32 v240, 16, v24
    v_and_b32 v241, s48, v24
    v_lshlrev_b32 v242, 16, v25
    v_and_b32 v243, s48, v25
    v_lshlrev_b32 v244, 16, v26
    v_and_b32 v245, s48, v26
    v_lshlrev_b32 v246, 16, v27
    v_and_b32 v247, s48, v27
    v_pk_mul_f32 v[24:25], v[240:241], v[22:23] op_sel_hi:[1,0]
    v_pk_mul_f32 v[26:27], v[242:243], v[22:23] op_sel_hi:[1,0]
    v_pk_mul_f32 v[28:29], v[244:245], v[22:23] op_sel_hi:[1,0]
    v_pk_mul_f32 v[30:31], v[246:247], v[22:23] op_sel_hi:[1,0]
    v_exp_f32 v24, v24 clamp
    v_exp_f32 v25, v25 clamp
    v_exp_f32 v26, v26 clamp
    v_exp_f32 v27, v27 clamp
    v_exp_f32 v28, v28 clamp
    v_exp_f32 v29, v29 clamp
    v_exp_f32 v30, v30 clamp
    v_exp_f32 v31, v31 clamp
    v_maximum3_f32 v240, v240, 0, 0
    v_maximum3_f32 v241, v241, 0, 0
    v_maximum3_f32 v242, v242, 0, 0
    v_maximum3_f32 v243, v243, 0, 0
    v_maximum3_f32 v244, v244, 0, 0
    v_maximum3_f32 v245, v245, 0, 0
    v_maximum3_f32 v246, v246, 0, 0
    v_maximum3_f32 v247, v247, 0, 0
    v_pk_add_f32 v[24:25], v[24:25], v[22:23] op_sel:[0,1] op_sel_hi:[1,1]
    v_pk_add_f32 v[26:27], v[26:27], v[22:23] op_sel:[0,1] op_sel_hi:[1,1]
    v_pk_add_f32 v[28:29], v[28:29], v[22:23] op_sel:[0,1] op_sel_hi:[1,1]
    v_pk_add_f32 v[30:31], v[30:31], v[22:23] op_sel:[0,1] op_sel_hi:[1,1]
    v_pk_add_f32 v[240:241], v[240:241], v[24:25]
    v_pk_add_f32 v[242:243], v[242:243], v[26:27]
    v_pk_add_f32 v[244:245], v[244:245], v[28:29]
    v_pk_add_f32 v[246:247], v[246:247], v[30:31]
    v_cvt_pk_bf16_f32 v120, v240, v241
    v_cvt_pk_bf16_f32 v121, v242, v243
    v_cvt_pk_bf16_f32 v122, v244, v245
    v_cvt_pk_bf16_f32 v123, v246, v247
    v_cvt_pk_bf16_f32 v24, v248, v249
    v_cvt_pk_bf16_f32 v25, v250, v251
    v_cvt_pk_bf16_f32 v26, v252, v253
    v_cvt_pk_bf16_f32 v27, v254, v255
    v_lshlrev_b32 v248, 16, v24
    v_and_b32 v249, s48, v24
    v_lshlrev_b32 v250, 16, v25
    v_and_b32 v251, s48, v25
    v_lshlrev_b32 v252, 16, v26
    v_and_b32 v253, s48, v26
    v_lshlrev_b32 v254, 16, v27
    v_and_b32 v255, s48, v27
    v_pk_mul_f32 v[24:25], v[248:249], v[22:23] op_sel_hi:[1,0]
    v_pk_mul_f32 v[26:27], v[250:251], v[22:23] op_sel_hi:[1,0]
    v_pk_mul_f32 v[28:29], v[252:253], v[22:23] op_sel_hi:[1,0]
    v_pk_mul_f32 v[30:31], v[254:255], v[22:23] op_sel_hi:[1,0]
    v_exp_f32 v24, v24 clamp
    v_exp_f32 v25, v25 clamp
    v_exp_f32 v26, v26 clamp
    v_exp_f32 v27, v27 clamp
    v_exp_f32 v28, v28 clamp
    v_exp_f32 v29, v29 clamp
    v_exp_f32 v30, v30 clamp
    v_exp_f32 v31, v31 clamp
    v_maximum3_f32 v248, v248, 0, 0
    v_maximum3_f32 v249, v249, 0, 0
    v_maximum3_f32 v250, v250, 0, 0
    v_maximum3_f32 v251, v251, 0, 0
    v_maximum3_f32 v252, v252, 0, 0
    v_maximum3_f32 v253, v253, 0, 0
    v_maximum3_f32 v254, v254, 0, 0
    v_maximum3_f32 v255, v255, 0, 0
    v_pk_add_f32 v[24:25], v[24:25], v[22:23] op_sel:[0,1] op_sel_hi:[1,1]
    v_pk_add_f32 v[26:27], v[26:27], v[22:23] op_sel:[0,1] op_sel_hi:[1,1]
    v_pk_add_f32 v[28:29], v[28:29], v[22:23] op_sel:[0,1] op_sel_hi:[1,1]
    v_pk_add_f32 v[30:31], v[30:31], v[22:23] op_sel:[0,1] op_sel_hi:[1,1]
    v_pk_add_f32 v[248:249], v[248:249], v[24:25]
    v_pk_add_f32 v[250:251], v[250:251], v[26:27]
    v_pk_add_f32 v[252:253], v[252:253], v[28:29]
    v_pk_add_f32 v[254:255], v[254:255], v[30:31]
    v_cvt_pk_bf16_f32 v124, v248, v249
    v_cvt_pk_bf16_f32 v125, v250, v251
    v_cvt_pk_bf16_f32 v126, v252, v253
    v_cvt_pk_bf16_f32 v127, v254, v255
    s_cmp_lg_u32 s79, -1
    s_cbranch_scc1 hp_183
ht_184:
    s_sub_u32 s30, s30, 1
    s_cbranch_scc1 L_end
    v_mov_b32 v30, 128
    buffer_load_dword v31, v30, s[20:23], 0 offen sc1
hc_185:
    s_waitcnt vmcnt(0)
    v_readfirstlane_b32 s3, v31
    s_nop 3
    s_and_b32 s40, s3, 0xffff
    s_cmp_lt_u32 s40, 128
    s_cbranch_scc1 ht_184
    s_add_u32 s3, s3, 4128768
    s_lshr_b32 s3, s3, 10
    s_and_b32 s79, s3, 8192
hp_183:
    s_lshr_b32 s40, s43, 0
    s_lshl_b32 s40, s40, 7
    s_add_u32 s40, s40, 79724544
    s_cmp_lg_u32 s26, 0
    s_cbranch_scc1 wf_186
    v_mov_b32 v3, s40
wt_187:
    buffer_load_dword v4, v3, s[8:11], 0 offen sc1
    s_sub_u32 s30, s30, 1
    s_cbranch_scc1 L_end
    s_waitcnt vmcnt(0)
    v_cmp_gt_u32 vcc, 16, v4
    s_cbranch_vccz wf_186
    s_sleep 8
    s_branch wt_187
wf_186:
    s_barrier
    v_lshlrev_b32 v6, 2, v2
    v_lshrrev_b32 v5, 4, v2
    v_lshlrev_b32 v5, 4, v5
    v_lshlrev_b32 v7, 4, v2
    s_lshr_b32 s40, s42, 5
    s_mul_i32 s39, s45, 2
    s_add_u32 s40, s40, s39
    s_lshl_b32 s38, s40, 14
    s_add_u32 s38, s38, 80216064
    s_bfe_u32 s3, s38, 0x10015
    s_lshl_b32 s3, s3, 13
    s_xor_b32 s3, s3, s79
    s_xor_b32 s3, s3, 8192
    s_add_u32 s38, s38, s3
    s_add_u32 s39, s38, 4096
    buffer_load_dword v128, v6, s[8:11], s38 offen offset:0 sc1
    buffer_load_dword v129, v6, s[8:11], s38 offen offset:256 sc1
    buffer_load_dword v130, v6, s[8:11], s38 offen offset:512 sc1
    buffer_load_dword v131, v6, s[8:11], s38 offen offset:768 sc1
    buffer_load_dword v132, v6, s[8:11], s38 offen offset:1024 sc1
    buffer_load_dword v133, v6, s[8:11], s38 offen offset:1280 sc1
    buffer_load_dword v134, v6, s[8:11], s38 offen offset:1536 sc1
    buffer_load_dword v135, v6, s[8:11], s38 offen offset:1792 sc1
    buffer_load_dword v136, v6, s[8:11], s38 offen offset:2048 sc1
    buffer_load_dword v137, v6, s[8:11], s38 offen offset:2304 sc1
    buffer_load_dword v138, v6, s[8:11], s38 offen offset:2560 sc1
    buffer_load_dword v139, v6, s[8:11], s38 offen offset:2816 sc1
    buffer_load_dword v140, v6, s[8:11], s38 offen offset:3072 sc1
    buffer_load_dword v141, v6, s[8:11], s38 offen offset:3328 sc1
    buffer_load_dword v142, v6, s[8:11], s38 offen offset:3584 sc1
    buffer_load_dword v143, v6, s[8:11], s38 offen offset:3840 sc1
    buffer_load_dwordx4 v[144:147], v5, s[8:11], s39 offen offset:0 sc1
    buffer_load_dwordx4 v[148:151], v5, s[8:11], s39 offen offset:64 sc1
    s_add_u32 s38, s38, 16384
    s_add_u32 s39, s38, 4096
    buffer_load_dword v152, v6, s[8:11], s38 offen offset:0 sc1
    buffer_load_dword v153, v6, s[8:11], s38 offen offset:256 sc1
    buffer_load_dword v154, v6, s[8:11], s38 offen offset:512 sc1
    buffer_load_dword v155, v6, s[8:11], s38 offen offset:768 sc1
    buffer_load_dword v156, v6, s[8:11], s38 offen offset:1024 sc1
    buffer_load_dword v157, v6, s[8:11], s38 offen offset:1280 sc1
    buffer_load_dword v158, v6, s[8:11], s38 offen offset:1536 sc1
    buffer_load_dword v159, v6, s[8:11], s38 offen offset:1792 sc1
    buffer_load_dword v160, v6, s[8:11], s38 offen offset:2048 sc1
    buffer_load_dword v161, v6, s[8:11], s38 offen offset:2304 sc1
    buffer_load_dword v162, v6, s[8:11], s38 offen offset:2560 sc1
    buffer_load_dword v163, v6, s[8:11], s38 offen offset:2816 sc1
    buffer_load_dword v164, v6, s[8:11], s38 offen offset:3072 sc1
    buffer_load_dword v165, v6, s[8:11], s38 offen offset:3328 sc1
    buffer_load_dword v166, v6, s[8:11], s38 offen offset:3584 sc1
    buffer_load_dword v167, v6, s[8:11], s38 offen offset:3840 sc1
    buffer_load_dwordx4 v[168:171], v5, s[8:11], s39 offen offset:0 sc1
    buffer_load_dwordx4 v[172:175], v5, s[8:11], s39 offen offset:64 sc1
    s_add_u32 s38, s38, 16384
    s_lshr_b32 s38, s41, 4
    s_mul_i32 s39, s44, 8
    s_add_u32 s38, s38, s39
    s_lshl_b32 s38, s38, 16
    s_lshr_b32 s39, s40, 3
    s_lshl_b32 s39, s39, 14
    s_add_u32 s38, s38, s39
    s_and_b32 s39, s40, 7
    s_lshl_b32 s39, s39, 10
    s_add_u32 s38, s38, s39
    s_add_u32 s38, s38, 234881024
    s_bfe_u32 s3, s41, 0x10009
    s_lshl_b32 s3, s3, 13
    s_xor_b32 s3, s3, s79
    s_xor_b32 s3, s3, 8192
    s_add_u32 s38, s38, s3
    s_waitcnt vmcnt(0)
    v_cvt_pk_bf16_f32 v32, v128, v129
    v_cvt_pk_bf16_f32 v33, v130, v131
    v_cvt_pk_bf16_f32 v34, v132, v133
    v_cvt_pk_bf16_f32 v35, v134, v135
    v_cvt_pk_bf16_f32 v36, v136, v137
    v_cvt_pk_bf16_f32 v37, v138, v139
    v_cvt_pk_bf16_f32 v38, v140, v141
    v_cvt_pk_bf16_f32 v39, v142, v143
    v_cvt_pk_bf16_f32 v40, v144, v145
    v_cvt_pk_bf16_f32 v41, v146, v147
    v_cvt_pk_bf16_f32 v42, v148, v149
    v_cvt_pk_bf16_f32 v43, v150, v151
    v_cvt_pk_bf16_f32 v44, v152, v153
    v_cvt_pk_bf16_f32 v45, v154, v155
    v_cvt_pk_bf16_f32 v46, v156, v157
    v_cvt_pk_bf16_f32 v47, v158, v159
    v_cvt_pk_bf16_f32 v48, v160, v161
    v_cvt_pk_bf16_f32 v49, v162, v163
    v_cvt_pk_bf16_f32 v50, v164, v165
    v_cvt_pk_bf16_f32 v51, v166, v167
    v_cvt_pk_bf16_f32 v52, v168, v169
    v_cvt_pk_bf16_f32 v53, v170, v171
    v_cvt_pk_bf16_f32 v54, v172, v173
    v_cvt_pk_bf16_f32 v55, v174, v175
    s_nop 1
    v_mfma_f32_16x16x32_bf16 v[128:131], v[32:35], v[64:67], 0
    v_mfma_f32_16x16x32_bf16 v[132:135], v[36:39], v[64:67], 0
    v_mfma_f32_16x16x32_bf16 v[136:139], v[40:43], v[64:67], 0
    v_mfma_f32_16x16x32_bf16 v[140:143], v[44:47], v[68:71], 0
    v_mfma_f32_16x16x32_bf16 v[144:147], v[48:51], v[68:71], 0
    v_mfma_f32_16x16x32_bf16 v[148:151], v[52:55], v[68:71], 0
    v_mfma_f32_16x16x32_bf16 v[152:155], v[32:35], v[72:75], 0
    v_mfma_f32_16x16x32_bf16 v[156:159], v[36:39], v[72:75], 0
    v_mfma_f32_16x16x32_bf16 v[160:163], v[40:43], v[72:75], 0
    v_mfma_f32_16x16x32_bf16 v[164:167], v[44:47], v[76:79], 0
    v_mfma_f32_16x16x32_bf16 v[168:171], v[48:51], v[76:79], 0
    v_mfma_f32_16x16x32_bf16 v[172:175], v[52:55], v[76:79], 0
    v_mfma_f32_16x16x32_bf16 v[176:179], v[32:35], v[80:83], 0
    v_mfma_f32_16x16x32_bf16 v[180:183], v[36:39], v[80:83], 0
    v_mfma_f32_16x16x32_bf16 v[184:187], v[40:43], v[80:83], 0
    v_add_f32 v136, s47, v136
    v_rcp_f32 v136, v136
    s_nop 0
    v_mul_f32 v128, v128, v136
    v_mul_f32 v129, v129, v136
    v_mul_f32 v130, v130, v136
    v_mul_f32 v131, v131, v136
    v_mul_f32 v132, v132, v136
    v_mul_f32 v133, v133, v136
    v_mul_f32 v134, v134, v136
    v_mul_f32 v135, v135, v136
    v_cvt_pk_bf16_f32 v224, v128, v132
    v_cvt_pk_bf16_f32 v225, v129, v133
    v_cvt_pk_bf16_f32 v226, v130, v134
    v_cvt_pk_bf16_f32 v227, v131, v135
    buffer_store_dwordx4 v[224:227], v7, s[8:11], s38 offen offset:0 sc1
    v_mfma_f32_16x16x32_bf16 v[188:191], v[44:47], v[84:87], 0
    v_mfma_f32_16x16x32_bf16 v[192:195], v[48:51], v[84:87], 0
    v_mfma_f32_16x16x32_bf16 v[196:199], v[52:55], v[84:87], 0
    v_add_f32 v148, s47, v148
    v_rcp_f32 v148, v148
    s_nop 0
    v_mul_f32 v140, v140, v148
    v_mul_f32 v141, v141, v148
    v_mul_f32 v142, v142, v148
    v_mul_f32 v143, v143, v148
    v_mul_f32 v144, v144, v148
    v_mul_f32 v145, v145, v148
    v_mul_f32 v146, v146, v148
    v_mul_f32 v147, v147, v148
    v_cvt_pk_bf16_f32 v228, v140, v144
    v_cvt_pk_bf16_f32 v229, v141, v145
    v_cvt_pk_bf16_f32 v230, v142, v146
    v_cvt_pk_bf16_f32 v231, v143, v147
    buffer_store_dwordx4 v[228:231], v7, s[8:11], s38 offen offset:1024 sc1
    s_add_u32 s38, s38, 65536
    v_mfma_f32_16x16x32_bf16 v[200:203], v[32:35], v[88:91], 0
    v_mfma_f32_16x16x32_bf16 v[204:207], v[36:39], v[88:91], 0
    v_mfma_f32_16x16x32_bf16 v[208:211], v[40:43], v[88:91], 0
    v_add_f32 v160, s47, v160
    v_rcp_f32 v160, v160
    s_nop 0
    v_mul_f32 v152, v152, v160
    v_mul_f32 v153, v153, v160
    v_mul_f32 v154, v154, v160
    v_mul_f32 v155, v155, v160
    v_mul_f32 v156, v156, v160
    v_mul_f32 v157, v157, v160
    v_mul_f32 v158, v158, v160
    v_mul_f32 v159, v159, v160
    v_cvt_pk_bf16_f32 v232, v152, v156
    v_cvt_pk_bf16_f32 v233, v153, v157
    v_cvt_pk_bf16_f32 v234, v154, v158
    v_cvt_pk_bf16_f32 v235, v155, v159
    buffer_store_dwordx4 v[232:235], v7, s[8:11], s38 offen offset:0 sc1
    v_mfma_f32_16x16x32_bf16 v[212:215], v[44:47], v[92:95], 0
    v_mfma_f32_16x16x32_bf16 v[216:219], v[48:51], v[92:95], 0
    v_mfma_f32_16x16x32_bf16 v[220:223], v[52:55], v[92:95], 0
    v_add_f32 v172, s47, v172
    v_rcp_f32 v172, v172
    s_nop 0
    v_mul_f32 v164, v164, v172
    v_mul_f32 v165, v165, v172
    v_mul_f32 v166, v166, v172
    v_mul_f32 v167, v167, v172
    v_mul_f32 v168, v168, v172
    v_mul_f32 v169, v169, v172
    v_mul_f32 v170, v170, v172
    v_mul_f32 v171, v171, v172
    v_cvt_pk_bf16_f32 v236, v164, v168
    v_cvt_pk_bf16_f32 v237, v165, v169
    v_cvt_pk_bf16_f32 v238, v166, v170
    v_cvt_pk_bf16_f32 v239, v167, v171
    buffer_store_dwordx4 v[236:239], v7, s[8:11], s38 offen offset:1024 sc1
    s_add_u32 s38, s38, 65536
    v_mfma_f32_16x16x32_bf16 v[128:131], v[32:35], v[96:99], 0
    v_mfma_f32_16x16x32_bf16 v[132:135], v[36:39], v[96:99], 0
    v_mfma_f32_16x16x32_bf16 v[136:139], v[40:43], v[96:99], 0
    v_add_f32 v184, s47, v184
    v_rcp_f32 v184, v184
    s_nop 0
    v_mul_f32 v176, v176, v184
    v_mul_f32 v177, v177, v184
    v_mul_f32 v178, v178, v184
    v_mul_f32 v179, v179, v184
    v_mul_f32 v180, v180, v184
    v_mul_f32 v181, v181, v184
    v_mul_f32 v182, v182, v184
    v_mul_f32 v183, v183, v184
    v_cvt_pk_bf16_f32 v240, v176, v180
    v_cvt_pk_bf16_f32 v241, v177, v181
    v_cvt_pk_bf16_f32 v242, v178, v182
    v_cvt_pk_bf16_f32 v243, v179, v183
    buffer_store_dwordx4 v[240:243], v7, s[8:11], s38 offen offset:0 sc1
    v_mfma_f32_16x16x32_bf16 v[140:143], v[44:47], v[100:103], 0
    v_mfma_f32_16x16x32_bf16 v[144:147], v[48:51], v[100:103], 0
    v_mfma_f32_16x16x32_bf16 v[148:151], v[52:55], v[100:103], 0
    v_add_f32 v196, s47, v196
    v_rcp_f32 v196, v196
    s_nop 0
    v_mul_f32 v188, v188, v196
    v_mul_f32 v189, v189, v196
    v_mul_f32 v190, v190, v196
    v_mul_f32 v191, v191, v196
    v_mul_f32 v192, v192, v196
    v_mul_f32 v193, v193, v196
    v_mul_f32 v194, v194, v196
    v_mul_f32 v195, v195, v196
    v_cvt_pk_bf16_f32 v244, v188, v192
    v_cvt_pk_bf16_f32 v245, v189, v193
    v_cvt_pk_bf16_f32 v246, v190, v194
    v_cvt_pk_bf16_f32 v247, v191, v195
    buffer_store_dwordx4 v[244:247], v7, s[8:11], s38 offen offset:1024 sc1
    s_add_u32 s38, s38, 65536
    v_mfma_f32_16x16x32_bf16 v[152:155], v[32:35], v[104:107], 0
    v_mfma_f32_16x16x32_bf16 v[156:159], v[36:39], v[104:107], 0
    v_mfma_f32_16x16x32_bf16 v[160:163], v[40:43], v[104:107], 0
    v_add_f32 v208, s47, v208
    v_rcp_f32 v208, v208
    s_nop 0
    v_mul_f32 v200, v200, v208
    v_mul_f32 v201, v201, v208
    v_mul_f32 v202, v202, v208
    v_mul_f32 v203, v203, v208
    v_mul_f32 v204, v204, v208
    v_mul_f32 v205, v205, v208
    v_mul_f32 v206, v206, v208
    v_mul_f32 v207, v207, v208
    v_cvt_pk_bf16_f32 v248, v200, v204
    v_cvt_pk_bf16_f32 v249, v201, v205
    v_cvt_pk_bf16_f32 v250, v202, v206
    v_cvt_pk_bf16_f32 v251, v203, v207
    buffer_store_dwordx4 v[248:251], v7, s[8:11], s38 offen offset:0 sc1
    v_mfma_f32_16x16x32_bf16 v[164:167], v[44:47], v[108:111], 0
    v_mfma_f32_16x16x32_bf16 v[168:171], v[48:51], v[108:111], 0
    v_mfma_f32_16x16x32_bf16 v[172:175], v[52:55], v[108:111], 0
    v_add_f32 v220, s47, v220
    v_rcp_f32 v220, v220
    s_nop 0
    v_mul_f32 v212, v212, v220
    v_mul_f32 v213, v213, v220
    v_mul_f32 v214, v214, v220
    v_mul_f32 v215, v215, v220
    v_mul_f32 v216, v216, v220
    v_mul_f32 v217, v217, v220
    v_mul_f32 v218, v218, v220
    v_mul_f32 v219, v219, v220
    v_cvt_pk_bf16_f32 v252, v212, v216
    v_cvt_pk_bf16_f32 v253, v213, v217
    v_cvt_pk_bf16_f32 v254, v214, v218
    v_cvt_pk_bf16_f32 v255, v215, v219
    buffer_store_dwordx4 v[252:255], v7, s[8:11], s38 offen offset:1024 sc1
    s_add_u32 s38, s38, 65536
    v_mfma_f32_16x16x32_bf16 v[176:179], v[32:35], v[112:115], 0
    v_mfma_f32_16x16x32_bf16 v[180:183], v[36:39], v[112:115], 0
    v_mfma_f32_16x16x32_bf16 v[184:187], v[40:43], v[112:115], 0
    v_add_f32 v136, s47, v136
    v_rcp_f32 v136, v136
    s_nop 0
    v_mul_f32 v128, v128, v136
    v_mul_f32 v129, v129, v136
    v_mul_f32 v130, v130, v136
    v_mul_f32 v131, v131, v136
    v_mul_f32 v132, v132, v136
    v_mul_f32 v133, v133, v136
    v_mul_f32 v134, v134, v136
    v_mul_f32 v135, v135, v136
    v_cvt_pk_bf16_f32 v224, v128, v132
    v_cvt_pk_bf16_f32 v225, v129, v133
    v_cvt_pk_bf16_f32 v226, v130, v134
    v_cvt_pk_bf16_f32 v227, v131, v135
    buffer_store_dwordx4 v[224:227], v7, s[8:11], s38 offen offset:0 sc1
    v_mfma_f32_16x16x32_bf16 v[188:191], v[44:47], v[116:119], 0
    v_mfma_f32_16x16x32_bf16 v[192:195], v[48:51], v[116:119], 0
    v_mfma_f32_16x16x32_bf16 v[196:199], v[52:55], v[116:119], 0
    v_add_f32 v148, s47, v148
    v_rcp_f32 v148, v148
    s_nop 0
    v_mul_f32 v140, v140, v148
    v_mul_f32 v141, v141, v148
    v_mul_f32 v142, v142, v148
    v_mul_f32 v143, v143, v148
    v_mul_f32 v144, v144, v148
    v_mul_f32 v145, v145, v148
    v_mul_f32 v146, v146, v148
    v_mul_f32 v147, v147, v148
    v_cvt_pk_bf16_f32 v228, v140, v144
    v_cvt_pk_bf16_f32 v229, v141, v145
    v_cvt_pk_bf16_f32 v230, v142, v146
    v_cvt_pk_bf16_f32 v231, v143, v147
    buffer_store_dwordx4 v[228:231], v7, s[8:11], s38 offen offset:1024 sc1
    s_add_u32 s38, s38, 65536
    v_mfma_f32_16x16x32_bf16 v[200:203], v[32:35], v[120:123], 0
    v_mfma_f32_16x16x32_bf16 v[204:207], v[36:39], v[120:123], 0
    v_mfma_f32_16x16x32_bf16 v[208:211], v[40:43], v[120:123], 0
    v_add_f32 v160, s47, v160
    v_rcp_f32 v160, v160
    s_nop 0
    v_mul_f32 v152, v152, v160
    v_mul_f32 v153, v153, v160
    v_mul_f32 v154, v154, v160
    v_mul_f32 v155, v155, v160
    v_mul_f32 v156, v156, v160
    v_mul_f32 v157, v157, v160
    v_mul_f32 v158, v158, v160
    v_mul_f32 v159, v159, v160
    v_cvt_pk_bf16_f32 v232, v152, v156
    v_cvt_pk_bf16_f32 v233, v153, v157
    v_cvt_pk_bf16_f32 v234, v154, v158
    v_cvt_pk_bf16_f32 v235, v155, v159
    buffer_store_dwordx4 v[232:235], v7, s[8:11], s38 offen offset:0 sc1
    v_mfma_f32_16x16x32_bf16 v[212:215], v[44:47], v[124:127], 0
    v_mfma_f32_16x16x32_bf16 v[216:219], v[48:51], v[124:127], 0
    v_mfma_f32_16x16x32_bf16 v[220:223], v[52:55], v[124:127], 0
    v_add_f32 v172, s47, v172
    v_rcp_f32 v172, v172
    s_nop 0
    v_mul_f32 v164, v164, v172
    v_mul_f32 v165, v165, v172
    v_mul_f32 v166, v166, v172
    v_mul_f32 v167, v167, v172
    v_mul_f32 v168, v168, v172
    v_mul_f32 v169, v169, v172
    v_mul_f32 v170, v170, v172
    v_mul_f32 v171, v171, v172
    v_cvt_pk_bf16_f32 v236, v164, v168
    v_cvt_pk_bf16_f32 v237, v165, v169
    v_cvt_pk_bf16_f32 v238, v166, v170
    v_cvt_pk_bf16_f32 v239, v167, v171
    buffer_store_dwordx4 v[236:239], v7, s[8:11], s38 offen offset:1024 sc1
    s_add_u32 s38, s38, 65536
    v_add_f32 v184, s47, v184
    v_rcp_f32 v184, v184
    s_nop 0
    v_mul_f32 v176, v176, v184
    v_mul_f32 v177, v177, v184
    v_mul_f32 v178, v178, v184
    v_mul_f32 v179, v179, v184
    v_mul_f32 v180, v180, v184
    v_mul_f32 v181, v181, v184
    v_mul_f32 v182, v182, v184
    v_mul_f32 v183, v183, v184
    v_cvt_pk_bf16_f32 v240, v176, v180
    v_cvt_pk_bf16_f32 v241, v177, v181
    v_cvt_pk_bf16_f32 v242, v178, v182
    v_cvt_pk_bf16_f32 v243, v179, v183
    buffer_store_dwordx4 v[240:243], v7, s[8:11], s38 offen offset:0 sc1
    v_add_f32 v196, s47, v196
    v_rcp_f32 v196, v196
    s_nop 0
    v_mul_f32 v188, v188, v196
    v_mul_f32 v189, v189, v196
    v_mul_f32 v190, v190, v196
    v_mul_f32 v191, v191, v196
    v_mul_f32 v192, v192, v196
    v_mul_f32 v193, v193, v196
    v_mul_f32 v194, v194, v196
    v_mul_f32 v195, v195, v196
    v_cvt_pk_bf16_f32 v244, v188, v192
    v_cvt_pk_bf16_f32 v245, v189, v193
    v_cvt_pk_bf16_f32 v246, v190, v194
    v_cvt_pk_bf16_f32 v247, v191, v195
    buffer_store_dwordx4 v[244:247], v7, s[8:11], s38 offen offset:1024 sc1
    s_add_u32 s38, s38, 65536
    v_add_f32 v208, s47, v208
    v_rcp_f32 v208, v208
    s_nop 0
    v_mul_f32 v200, v200, v208
    v_mul_f32 v201, v201, v208
    v_mul_f32 v202, v202, v208
    v_mul_f32 v203, v203, v208
    v_mul_f32 v204, v204, v208
    v_mul_f32 v205, v205, v208
    v_mul_f32 v206, v206, v208
    v_mul_f32 v207, v207, v208
    v_cvt_pk_bf16_f32 v248, v200, v204
    v_cvt_pk_bf16_f32 v249, v201, v205
    v_cvt_pk_bf16_f32 v250, v202, v206
    v_cvt_pk_bf16_f32 v251, v203, v207
    buffer_store_dwordx4 v[248:251], v7, s[8:11], s38 offen offset:0 sc1
    v_add_f32 v220, s47, v220
    v_rcp_f32 v220, v220
    s_nop 0
    v_mul_f32 v212, v212, v220
    v_mul_f32 v213, v213, v220
    v_mul_f32 v214, v214, v220
    v_mul_f32 v215, v215, v220
    v_mul_f32 v216, v216, v220
    v_mul_f32 v217, v217, v220
    v_mul_f32 v218, v218, v220
    v_mul_f32 v219, v219, v220
    v_cvt_pk_bf16_f32 v252, v212, v216
    v_cvt_pk_bf16_f32 v253, v213, v217
    v_cvt_pk_bf16_f32 v254, v214, v218
    v_cvt_pk_bf16_f32 v255, v215, v219
    buffer_store_dwordx4 v[252:255], v7, s[8:11], s38 offen offset:1024 sc1
    s_add_u32 s38, s38, 65536
    s_lshr_b32 s40, s41, 8
    s_lshl_b32 s40, s40, 7
    s_add_u32 s40, s40, 79725568
    s_waitcnt vmcnt(0)
    s_barrier
    s_cmp_lg_u32 s26, 1
    s_cbranch_scc1 sg_188
    v_mov_b32 v4, s40
    v_mov_b32 v5, 1
    s_mov_b64 exec, 1
    buffer_atomic_add v5, v4, s[8:11], 0 offen sc1
    s_mov_b64 exec, -1
sg_188:
    s_cmp_eq_u32 s6, 0
    s_cbranch_scc1 D_pre
    s_mov_b32 s6, 0
    s_branch D_main
LP_T4:
    s_mov_b32 s34, 59
    s_mov_b32 s27, 0
    s_mov_b32 s29, 32768
    s_waitcnt vmcnt(12)
    s_barrier
    ds_read_b64_tr_b16 v[48:49], v18 offset:16384
    ds_read_b64_tr_b16 v[50:51], v18 offset:17408
    ds_read_b64_tr_b16 v[52:53], v19 offset:16384
    ds_read_b64_tr_b16 v[54:55], v19 offset:17408
    ds_read_b128 v[32:35], v16 offset:0
    ds_read_b128 v[36:39], v16 offset:2048
    ds_read_b128 v[40:43], v16 offset:4096
    ds_read_b128 v[44:47], v16 offset:6144
    s_waitcnt lgkmcnt(0)
    v_mfma_f32_16x16x32_bf16 v[128:131], v[48:51], v[32:35], 0
    ds_read_b64_tr_b16 v[96:97], v18 offset:24576
    ds_read_b64_tr_b16 v[98:99], v18 offset:25600
    v_mfma_f32_16x16x32_bf16 v[132:135], v[52:55], v[32:35], 0
    ds_read_b64_tr_b16 v[100:101], v19 offset:24576
    ds_read_b64_tr_b16 v[102:103], v19 offset:25600
    v_mfma_f32_16x16x32_bf16 v[136:139], v[48:51], v[36:39], 0
    ds_read_b128 v[80:83], v17 offset:0
    v_mfma_f32_16x16x32_bf16 v[140:143], v[52:55], v[36:39], 0
    ds_read_b128 v[84:87], v17 offset:2048
    ds_read_b128 v[88:91], v17 offset:4096
    v_mfma_f32_16x16x32_bf16 v[144:147], v[48:51], v[40:43], 0
    ds_read_b128 v[92:95], v17 offset:6144
    s_add_u32 s27, s27, 1
    s_cmp_eq_u32 s27, 4
    s_cselect_b32 s28, -98304, s29
    s_cselect_b32 s27, 0, s27
    v_mfma_f32_16x16x32_bf16 v[148:151], v[52:55], v[40:43], 0
    v_add_u32 v16, s28, v16
    v_mfma_f32_16x16x32_bf16 v[152:155], v[48:51], v[44:47], 0
    v_add_u32 v17, s28, v17
    v_add_u32 v18, s28, v18
    v_mfma_f32_16x16x32_bf16 v[156:159], v[52:55], v[44:47], 0
    v_add_u32 v19, s28, v19
    s_waitcnt vmcnt(8) lgkmcnt(0)
    s_barrier
    v_mfma_f32_16x16x32_bf16 v[128:131], v[96:99], v[80:83], v[128:131]
    ds_read_b64_tr_b16 v[48:49], v18 offset:16384
    ds_read_b64_tr_b16 v[50:51], v18 offset:17408
    v_mfma_f32_16x16x32_bf16 v[132:135], v[100:103], v[80:83], v[132:135]
    ds_read_b64_tr_b16 v[52:53], v19 offset:16384
    ds_read_b64_tr_b16 v[54:55], v19 offset:17408
    v_mfma_f32_16x16x32_bf16 v[136:139], v[96:99], v[84:87], v[136:139]
    ds_read_b128 v[32:35], v16 offset:0
    ds_read_b128 v[36:39], v16 offset:2048
    v_mfma_f32_16x16x32_bf16 v[140:143], v[100:103], v[84:87], v[140:143]
    ds_read_b128 v[40:43], v16 offset:4096
    ds_read_b128 v[44:47], v16 offset:6144
    v_mfma_f32_16x16x32_bf16 v[144:147], v[96:99], v[88:91], v[144:147]
    s_mov_b32 m0, s35
    s_add_u32 s35, s35, 32768
    s_cmp_ge_u32 s35, 131072
    s_cselect_b32 s40, 131072, 0
    s_sub_u32 s35, s35, s40
    buffer_load_dwordx4 v8, s[12:15], s31 offen offset:0 sc1 lds
    v_mfma_f32_16x16x32_bf16 v[148:151], v[100:103], v[88:91], v[148:151]
    buffer_load_dwordx4 v9, s[12:15], s31 offen offset:1024 sc1 lds
    s_mov_b32 m0, s36
    s_add_u32 s31, s31, 2048
    s_and_b32 s40, s31, 0x1fff
    s_cselect_b32 s40, 0, 0x2000
    s_add_u32 s31, s31, s40
    s_add_u32 s36, s36, 32768
    s_cmp_ge_u32 s36, 131072
    s_cselect_b32 s40, 131072, 0
    s_sub_u32 s36, s36, s40
    v_mfma_f32_16x16x32_bf16 v[152:155], v[96:99], v[92:95], v[152:155]
    buffer_load_dwordx4 v12, s[16:19], s32 offen offset:0  lds
    buffer_load_dwordx4 v13, s[16:19], s32 offen offset:1024  lds
    v_mfma_f32_16x16x32_bf16 v[156:159], v[100:103], v[92:95], v[156:159]
    s_add_u32 s32, s32, s33
gl_197:
    s_waitcnt lgkmcnt(0)
    v_mfma_f32_16x16x32_bf16 v[128:131], v[48:51], v[32:35], v[128:131]
    ds_read_b64_tr_b16 v[96:97], v18 offset:24576
    ds_read_b64_tr_b16 v[98:99], v18 offset:25600
    v_mfma_f32_16x16x32_bf16 v[132:135], v[52:55], v[32:35], v[132:135]
    ds_read_b64_tr_b16 v[100:101], v19 offset:24576
    ds_read_b64_tr_b16 v[102:103], v19 offset:25600
    v_mfma_f32_16x16x32_bf16 v[136:139], v[48:51], v[36:39], v[136:139]
    ds_read_b128 v[80:83], v17 offset:0
    v_mfma_f32_16x16x32_bf16 v[140:143], v[52:55], v[36:39], v[140:143]
    ds_read_b128 v[84:87], v17 offset:2048
    ds_read_b128 v[88:91], v17 offset:4096
    v_mfma_f32_16x16x32_bf16 v[144:147], v[48:51], v[40:43], v[144:147]
    ds_read_b128 v[92:95], v17 offset:6144
    s_add_u32 s27, s27, 1
    s_cmp_eq_u32 s27, 4
    s_cselect_b32 s28, -98304, s29
    s_cselect_b32 s27, 0, s27
    v_mfma_f32_16x16x32_bf16 v[148:151], v[52:55], v[40:43], v[148:151]
    v_add_u32 v16, s28, v16
    v_mfma_f32_16x16x32_bf16 v[152:155], v[48:51], v[44:47], v[152:155]
    v_add_u32 v17, s28, v17
    v_add_u32 v18, s28, v18
    v_mfma_f32_16x16x32_bf16 v[156:159], v[52:55], v[44:47], v[156:159]
    v_add_u32 v19, s28, v19
    s_waitcnt vmcnt(8) lgkmcnt(0)
    s_barrier
    v_mfma_f32_16x16x32_bf16 v[128:131], v[96:99], v[80:83], v[128:131]
    ds_read_b64_tr_b16 v[48:49], v18 offset:16384
    ds_read_b64_tr_b16 v[50:51], v18 offset:17408
    v_mfma_f32_16x16x32_bf16 v[132:135], v[100:103], v[80:83], v[132:135]
    ds_read_b64_tr_b16 v[52:53], v19 offset:16384
    ds_read_b64_tr_b16 v[54:55], v19 offset:17408
    v_mfma_f32_16x16x32_bf16 v[136:139], v[96:99], v[84:87], v[136:139]
    ds_read_b128 v[32:35], v16 offset:0
    ds_read_b128 v[36:39], v16 offset:2048
    v_mfma_f32_16x16x32_bf16 v[140:143], v[100:103], v[84:87], v[140:143]
    ds_read_b128 v[40:43], v16 offset:4096
    ds_read_b128 v[44:47], v16 offset:6144
    v_mfma_f32_16x16x32_bf16 v[144:147], v[96:99], v[88:91], v[144:147]
    s_mov_b32 m0, s35
    s_add_u32 s35, s35, 32768
    s_cmp_ge_u32 s35, 131072
    s_cselect_b32 s40, 131072, 0
    s_sub_u32 s35, s35, s40
    buffer_load_dwordx4 v8, s[12:15], s31 offen offset:0 sc1 lds
    v_mfma_f32_16x16x32_bf16 v[148:151], v[100:103], v[88:91], v[148:151]
    buffer_load_dwordx4 v9, s[12:15], s31 offen offset:1024 sc1 lds
    s_mov_b32 m0, s36
    s_add_u32 s31, s31, 2048
    s_and_b32 s40, s31, 0x1fff
    s_cselect_b32 s40, 0, 0x2000
    s_add_u32 s31, s31, s40
    s_add_u32 s36, s36, 32768
    s_cmp_ge_u32 s36, 131072
    s_cselect_b32 s40, 131072, 0
    s_sub_u32 s36, s36, s40
    v_mfma_f32_16x16x32_bf16 v[152:155], v[96:99], v[92:95], v[152:155]
    buffer_load_dwordx4 v12, s[16:19], s32 offen offset:0  lds
    buffer_load_dwordx4 v13, s[16:19], s32 offen offset:1024  lds
    v_mfma_f32_16x16x32_bf16 v[156:159], v[100:103], v[92:95], v[156:159]
    s_add_u32 s32, s32, s33
    s_sub_u32 s34, s34, 1
    s_cmp_lg_u32 s34, 0
    s_cbranch_scc1 gl_197
    s_cmp_lg_u32 s26, 0
    s_cbranch_scc1 ti_198
    s_lshl_b32 s3, s43, 2
    s_add_u32 s3, s3, 16
    v_mov_b32 v27, s3
    v_mov_b32 v28, 1
    s_mov_b64 exec, 1
    buffer_atomic_add v28, v27, s[20:23], 0 offen sc0 sc1
    s_mov_b64 exec, -1
ti_198:
    s_waitcnt lgkmcnt(0)
    v_mfma_f32_16x16x32_bf16 v[128:131], v[48:51], v[32:35], v[128:131]
    ds_read_b64_tr_b16 v[96:97], v18 offset:24576
    ds_read_b64_tr_b16 v[98:99], v18 offset:25600
    v_mfma_f32_16x16x32_bf16 v[132:135], v[52:55], v[32:35], v[132:135]
    ds_read_b64_tr_b16 v[100:101], v19 offset:24576
    ds_read_b64_tr_b16 v[102:103], v19 offset:25600
    v_mfma_f32_16x16x32_bf16 v[136:139], v[48:51], v[36:39], v[136:139]
    ds_read_b128 v[80:83], v17 offset:0
    v_mfma_f32_16x16x32_bf16 v[140:143], v[52:55], v[36:39], v[140:143]
    ds_read_b128 v[84:87], v17 offset:2048
    ds_read_b128 v[88:91], v17 offset:4096
    v_mfma_f32_16x16x32_bf16 v[144:147], v[48:51], v[40:43], v[144:147]
    ds_read_b128 v[92:95], v17 offset:6144
    s_add_u32 s27, s27, 1
    s_cmp_eq_u32 s27, 4
    s_cselect_b32 s28, -98304, s29
    s_cselect_b32 s27, 0, s27
    v_mfma_f32_16x16x32_bf16 v[148:151], v[52:55], v[40:43], v[148:151]
    v_add_u32 v16, s28, v16
    v_mfma_f32_16x16x32_bf16 v[152:155], v[48:51], v[44:47], v[152:155]
    v_add_u32 v17, s28, v17
    v_add_u32 v18, s28, v18
    v_mfma_f32_16x16x32_bf16 v[156:159], v[52:55], v[44:47], v[156:159]
    v_add_u32 v19, s28, v19
    s_waitcnt vmcnt(8) lgkmcnt(0)
    s_barrier
    v_mfma_f32_16x16x32_bf16 v[128:131], v[96:99], v[80:83], v[128:131]
    ds_read_b64_tr_b16 v[48:49], v18 offset:16384
    v_mfma_f32_16x16x32_bf16 v[132:135], v[100:103], v[80:83], v[132:135]
    ds_read_b64_tr_b16 v[50:51], v18 offset:17408
    v_mfma_f32_16x16x32_bf16 v[136:139], v[96:99], v[84:87], v[136:139]
    ds_read_b64_tr_b16 v[52:53], v19 offset:16384
    v_mfma_f32_16x16x32_bf16 v[140:143], v[100:103], v[84:87], v[140:143]
    ds_read_b64_tr_b16 v[54:55], v19 offset:17408
    v_mfma_f32_16x16x32_bf16 v[144:147], v[96:99], v[88:91], v[144:147]
    ds_read_b128 v[32:35], v16 offset:0
    v_mfma_f32_16x16x32_bf16 v[148:151], v[100:103], v[88:91], v[148:151]
    ds_read_b128 v[36:39], v16 offset:2048
    v_mfma_f32_16x16x32_bf16 v[152:155], v[96:99], v[92:95], v[152:155]
    ds_read_b128 v[40:43], v16 offset:4096
    v_mfma_f32_16x16x32_bf16 v[156:159], v[100:103], v[92:95], v[156:159]
    ds_read_b128 v[44:47], v16 offset:6144
    s_waitcnt lgkmcnt(0)
    v_mfma_f32_16x16x32_bf16 v[128:131], v[48:51], v[32:35], v[128:131]
    ds_read_b64_tr_b16 v[96:97], v18 offset:24576
    ds_read_b64_tr_b16 v[98:99], v18 offset:25600
    v_mfma_f32_16x16x32_bf16 v[132:135], v[52:55], v[32:35], v[132:135]
    ds_read_b64_tr_b16 v[100:101], v19 offset:24576
    ds_read_b64_tr_b16 v[102:103], v19 offset:25600
    v_mfma_f32_16x16x32_bf16 v[136:139], v[48:51], v[36:39], v[136:139]
    ds_read_b128 v[80:83], v17 offset:0
    v_mfma_f32_16x16x32_bf16 v[140:143], v[52:55], v[36:39], v[140:143]
    ds_read_b128 v[84:87], v17 offset:2048
    ds_read_b128 v[88:91], v17 offset:4096
    v_mfma_f32_16x16x32_bf16 v[144:147], v[48:51], v[40:43], v[144:147]
    ds_read_b128 v[92:95], v17 offset:6144
    s_add_u32 s27, s27, 1
    s_cmp_eq_u32 s27, 4
    s_cselect_b32 s28, -98304, s29
    s_cselect_b32 s27, 0, s27
    v_mfma_f32_16x16x32_bf16 v[148:151], v[52:55], v[40:43], v[148:151]
    v_add_u32 v16, s28, v16
    v_mfma_f32_16x16x32_bf16 v[152:155], v[48:51], v[44:47], v[152:155]
    v_add_u32 v17, s28, v17
    v_add_u32 v18, s28, v18
    v_mfma_f32_16x16x32_bf16 v[156:159], v[52:55], v[44:47], v[156:159]
    v_add_u32 v19, s28, v19
    s_waitcnt vmcnt(4) lgkmcnt(0)
    s_barrier
    v_mfma_f32_16x16x32_bf16 v[128:131], v[96:99], v[80:83], v[128:131]
    ds_read_b64_tr_b16 v[48:49], v18 offset:16384
    v_mfma_f32_16x16x32_bf16 v[132:135], v[100:103], v[80:83], v[132:135]
    ds_read_b64_tr_b16 v[50:51], v18 offset:17408
    v_mfma_f32_16x16x32_bf16 v[136:139], v[96:99], v[84:87], v[136:139]
    ds_read_b64_tr_b16 v[52:53], v19 offset:16384
    v_mfma_f32_16x16x32_bf16 v[140:143], v[100:103], v[84:87], v[140:143]
    ds_read_b64_tr_b16 v[54:55], v19 offset:17408
    v_mfma_f32_16x16x32_bf16 v[144:147], v[96:99], v[88:91], v[144:147]
    ds_read_b128 v[32:35], v16 offset:0
    v_mfma_f32_16x16x32_bf16 v[148:151], v[100:103], v[88:91], v[148:151]
    ds_read_b128 v[36:39], v16 offset:2048
    v_mfma_f32_16x16x32_bf16 v[152:155], v[96:99], v[92:95], v[152:155]
    ds_read_b128 v[40:43], v16 offset:4096
    v_mfma_f32_16x16x32_bf16 v[156:159], v[100:103], v[92:95], v[156:159]
    ds_read_b128 v[44:47], v16 offset:6144
    s_waitcnt lgkmcnt(0)
    v_mfma_f32_16x16x32_bf16 v[128:131], v[48:51], v[32:35], v[128:131]
    ds_read_b64_tr_b16 v[96:97], v18 offset:24576
    ds_read_b64_tr_b16 v[98:99], v18 offset:25600
    v_mfma_f32_16x16x32_bf16 v[132:135], v[52:55], v[32:35], v[132:135]
    ds_read_b64_tr_b16 v[100:101], v19 offset:24576
    ds_read_b64_tr_b16 v[102:103], v19 offset:25600
    v_mfma_f32_16x16x32_bf16 v[136:139], v[48:51], v[36:39], v[136:139]
    ds_read_b128 v[80:83], v17 offset:0
    v_mfma_f32_16x16x32_bf16 v[140:143], v[52:55], v[36:39], v[140:143]
    ds_read_b128 v[84:87], v17 offset:2048
    ds_read_b128 v[88:91], v17 offset:4096
    v_mfma_f32_16x16x32_bf16 v[144:147], v[48:51], v[40:43], v[144:147]
    ds_read_b128 v[92:95], v17 offset:6144
    s_add_u32 s27, s27, 1
    s_cmp_eq_u32 s27, 4
    s_cselect_b32 s28, -98304, s29
    s_cselect_b32 s27, 0, s27
    v_mfma_f32_16x16x32_bf16 v[148:151], v[52:55], v[40:43], v[148:151]
    v_add_u32 v16, s28, v16
    v_mfma_f32_16x16x32_bf16 v[152:155], v[48:51], v[44:47], v[152:155]
    v_add_u32 v17, s28, v17
    v_add_u32 v18, s28, v18
    v_mfma_f32_16x16x32_bf16 v[156:159], v[52:55], v[44:47], v[156:159]
    v_add_u32 v19, s28, v19
    s_waitcnt vmcnt(0) lgkmcnt(0)
    s_barrier
    v_mfma_f32_16x16x32_bf16 v[128:131], v[96:99], v[80:83], v[128:131]
    ds_read_b64_tr_b16 v[48:49], v18 offset:16384
    v_mfma_f32_16x16x32_bf16 v[132:135], v[100:103], v[80:83], v[132:135]
    ds_read_b64_tr_b16 v[50:51], v18 offset:17408
    v_mfma_f32_16x16x32_bf16 v[136:139], v[96:99], v[84:87], v[136:139]
    ds_read_b64_tr_b16 v[52:53], v19 offset:16384
    v_mfma_f32_16x16x32_bf16 v[140:143], v[100:103], v[84:87], v[140:143]
    ds_read_b64_tr_b16 v[54:55], v19 offset:17408
    v_mfma_f32_16x16x32_bf16 v[144:147], v[96:99], v[88:91], v[144:147]
    ds_read_b128 v[32:35], v16 offset:0
    v_mfma_f32_16x16x32_bf16 v[148:151], v[100:103], v[88:91], v[148:151]
    ds_read_b128 v[36:39], v16 offset:2048
    v_mfma_f32_16x16x32_bf16 v[152:155], v[96:99], v[92:95], v[152:155]
    ds_read_b128 v[40:43], v16 offset:4096
    v_mfma_f32_16x16x32_bf16 v[156:159], v[100:103], v[92:95], v[156:159]
    ds_read_b128 v[44:47], v16 offset:6144
    s_waitcnt lgkmcnt(0)
    v_mfma_f32_16x16x32_bf16 v[128:131], v[48:51], v[32:35], v[128:131]
    ds_read_b64_tr_b16 v[96:97], v18 offset:24576
    ds_read_b64_tr_b16 v[98:99], v18 offset:25600
    v_mfma_f32_16x16x32_bf16 v[132:135], v[52:55], v[32:35], v[132:135]
    ds_read_b64_tr_b16 v[100:101], v19 offset:24576
    ds_read_b64_tr_b16 v[102:103], v19 offset:25600
    v_mfma_f32_16x16x32_bf16 v[136:139], v[48:51], v[36:39], v[136:139]
    ds_read_b128 v[80:83], v17 offset:0
    v_mfma_f32_16x16x32_bf16 v[140:143], v[52:55], v[36:39], v[140:143]
    ds_read_b128 v[84:87], v17 offset:2048
    ds_read_b128 v[88:91], v17 offset:4096
    v_mfma_f32_16x16x32_bf16 v[144:147], v[48:51], v[40:43], v[144:147]
    ds_read_b128 v[92:95], v17 offset:6144
    s_add_u32 s27, s27, 1
    s_cmp_eq_u32 s27, 4
    s_cselect_b32 s28, -98304, s29
    s_cselect_b32 s27, 0, s27
    v_mfma_f32_16x16x32_bf16 v[148:151], v[52:55], v[40:43], v[148:151]
    v_add_u32 v16, s28, v16
    v_mfma_f32_16x16x32_bf16 v[152:155], v[48:51], v[44:47], v[152:155]
    v_add_u32 v17, s28, v17
    v_add_u32 v18, s28, v18
    v_mfma_f32_16x16x32_bf16 v[156:159], v[52:55], v[44:47], v[156:159]
    v_add_u32 v19, s28, v19
    s_waitcnt lgkmcnt(0)
    v_mfma_f32_16x16x32_bf16 v[128:131], v[96:99], v[80:83], v[128:131]
    v_mfma_f32_16x16x32_bf16 v[132:135], v[100:103], v[80:83], v[132:135]
    v_mfma_f32_16x16x32_bf16 v[136:139], v[96:99], v[84:87], v[136:139]
    v_mfma_f32_16x16x32_bf16 v[140:143], v[100:103], v[84:87], v[140:143]
    v_mfma_f32_16x16x32_bf16 v[144:147], v[96:99], v[88:91], v[144:147]
    v_mfma_f32_16x16x32_bf16 v[148:151], v[100:103], v[88:91], v[148:151]
    v_mfma_f32_16x16x32_bf16 v[152:155], v[96:99], v[92:95], v[152:155]
    v_mfma_f32_16x16x32_bf16 v[156:159], v[100:103], v[92:95], v[156:159]
    s_nop 7
LE_T4:
    v_mov_b32 v3, 163584
    s_cmp_lg_u32 s26, 0
    s_cbranch_scc1 tt_199
    s_waitcnt vmcnt(0)
    s_mov_b64 exec, 1
    ds_write_b32 v3, v28
    s_waitcnt lgkmcnt(0)
    s_mov_b64 exec, -1
tt_199:
    s_barrier
    ds_read_b32 v5, v3
    s_waitcnt lgkmcnt(0)
    v_readfirstlane_b32 s25, v5
    s_nop 3
    s_min_u32 s3, s25, 204
    s_lshl_b32 s3, s3, 2
    s_load_dword s7, s[50:51], s3
    s_waitcnt lgkmcnt(0)
E_T4:
    v_and_b32 v3, 15, v2
    v_lshrrev_b32 v4, 4, v2
    v_mul_u32_u24 v3, 4096, v3
    v_lshl_add_u32 v7, v4, 4, v3
    s_mul_i32 s38, s44, 64
    s_add_u32 s38, s38, s41
    s_mul_i32 s38, s38, 4096
    s_mul_i32 s39, s45, 32
    s_add_u32 s39, s39, s42
    s_lshl_b32 s39, s39, 1
    s_add_u32 s38, s38, s39
    s_add_u32 s38, s38, 2048
    v_cvt_pk_bf16_f32 v32, v128, v129
    v_cvt_pk_bf16_f32 v33, v130, v131
    v_cvt_pk_bf16_f32 v34, v132, v133
    v_cvt_pk_bf16_f32 v35, v134, v135
    buffer_store_dwordx4 v[32:35], v7, s[64:67], s38 offen offset:0
    s_add_u32 s38, s38, 65536
    v_cvt_pk_bf16_f32 v36, v136, v137
    v_cvt_pk_bf16_f32 v37, v138, v139
    v_cvt_pk_bf16_f32 v38, v140, v141
    v_cvt_pk_bf16_f32 v39, v142, v143
    buffer_store_dwordx4 v[36:39], v7, s[64:67], s38 offen offset:0
    s_add_u32 s38, s38, 65536
    v_cvt_pk_bf16_f32 v40, v144, v145
    v_cvt_pk_bf16_f32 v41, v146, v147
    v_cvt_pk_bf16_f32 v42, v148, v149
    v_cvt_pk_bf16_f32 v43, v150, v151
    buffer_store_dwordx4 v[40:43], v7, s[64:67], s38 offen offset:0
    s_add_u32 s38, s38, 65536
    v_cvt_pk_bf16_f32 v44, v152, v153
    v_cvt_pk_bf16_f32 v45, v154, v155
    v_cvt_pk_bf16_f32 v46, v156, v157
    v_cvt_pk_bf16_f32 v47, v158, v159
    buffer_store_dwordx4 v[44:47], v7, s[64:67], s38 offen offset:0
    s_add_u32 s38, s38, 65536
    s_waitcnt vmcnt(63)
    s_cmp_lg_u32 s26, 1
    s_cbranch_scc1 sg_200
    s_mov_b64 exec, -1
sg_200:
    s_cmp_eq_u32 s6, 0
    s_cbranch_scc1 D_pre
    s_mov_b32 s6, 0
    s_branch D_main
LP_T4S:
    s_mov_b32 s34, 58
    s_mov_b32 s27, 0
    s_mov_b32 s29, 24576
    s_waitcnt vmcnt(12)
    s_barrier
    ds_read_b64_tr_b16 v[40:41], v18 offset:8192
    ds_read_b64_tr_b16 v[42:43], v18 offset:9216
    ds_read_b64_tr_b16 v[44:45], v19 offset:8192
    ds_read_b64_tr_b16 v[46:47], v19 offset:9216
    ds_read_b128 v[32:35], v16 offset:0
    ds_read_b128 v[36:39], v16 offset:2048
    s_waitcnt lgkmcnt(0)
    v_mfma_f32_16x16x32_bf16 v[128:131], v[40:43], v[32:35], 0
    ds_read_b64_tr_b16 v[88:89], v18 offset:16384
    ds_read_b64_tr_b16 v[90:91], v18 offset:17408
    ds_read_b64_tr_b16 v[92:93], v19 offset:16384
    v_mfma_f32_16x16x32_bf16 v[132:135], v[44:47], v[32:35], 0
    ds_read_b64_tr_b16 v[94:95], v19 offset:17408
    ds_read_b128 v[80:83], v17 offset:0
    ds_read_b128 v[84:87], v17 offset:2048
    v_mfma_f32_16x16x32_bf16 v[136:139], v[40:43], v[36:39], 0
    s_add_u32 s27, s27, 1
    s_cmp_eq_u32 s27, 5
    s_cselect_b32 s28, -98304, s29
    s_cselect_b32 s27, 0, s27
    v_add_u32 v16, s28, v16
    v_add_u32 v17, s28, v17
    v_mfma_f32_16x16x32_bf16 v[140:143], v[44:47], v[36:39], 0
    v_add_u32 v18, s28, v18
    v_add_u32 v19, s28, v19
    s_waitcnt vmcnt(9) lgkmcnt(0)
    s_barrier
    v_mfma_f32_16x16x32_bf16 v[128:131], v[88:91], v[80:83], v[128:131]
    ds_read_b64_tr_b16 v[40:41], v18 offset:8192
    ds_read_b64_tr_b16 v[42:43], v18 offset:9216
    ds_read_b64_tr_b16 v[44:45], v19 offset:8192
    v_mfma_f32_16x16x32_bf16 v[132:135], v[92:95], v[80:83], v[132:135]
    ds_read_b64_tr_b16 v[46:47], v19 offset:9216
    ds_read_b128 v[32:35], v16 offset:0
    ds_read_b128 v[36:39], v16 offset:2048
    v_mfma_f32_16x16x32_bf16 v[136:139], v[88:91], v[84:87], v[136:139]
    s_mov_b32 m0, s35
    s_add_u32 s35, s35, 24576
    s_cmp_ge_u32 s35, 122880
    s_cselect_b32 s40, 122880, 0
    s_sub_u32 s35, s35, s40
    buffer_load_dwordx4 v8, s[12:15], s31 offen offset:0 sc1 lds
    s_mov_b32 m0, s36
    s_add_u32 s31, s31, 2048
    s_and_b32 s40, s31, 0x1fff
    s_cselect_b32 s40, 0, 0x2000
    s_add_u32 s31, s31, s40
    s_add_u32 s36, s36, 24576
    s_cmp_ge_u32 s36, 122880
    s_cselect_b32 s40, 122880, 0
    s_sub_u32 s36, s36, s40
    v_mfma_f32_16x16x32_bf16 v[140:143], v[92:95], v[84:87], v[140:143]
    buffer_load_dwordx4 v12, s[16:19], s32 offen offset:0  lds
    buffer_load_dwordx4 v13, s[16:19], s32 offen offset:1024  lds
    s_add_u32 s32, s32, s33
gl_209:
    s_waitcnt lgkmcnt(0)
    v_mfma_f32_16x16x32_bf16 v[128:131], v[40:43], v[32:35], v[128:131]
    ds_read_b64_tr_b16 v[88:89], v18 offset:16384
    ds_read_b64_tr_b16 v[90:91], v18 offset:17408
    ds_read_b64_tr_b16 v[92:93], v19 offset:16384
    v_mfma_f32_16x16x32_bf16 v[132:135], v[44:47], v[32:35], v[132:135]
    ds_read_b64_tr_b16 v[94:95], v19 offset:17408
    ds_read_b128 v[80:83], v17 offset:0
    ds_read_b128 v[84:87], v17 offset:2048
    v_mfma_f32_16x16x32_bf16 v[136:139], v[40:43], v[36:39], v[136:139]
    s_add_u32 s27, s27, 1
    s_cmp_eq_u32 s27, 5
    s_cselect_b32 s28, -98304, s29
    s_cselect_b32 s27, 0, s27
    v_add_u32 v16, s28, v16
    v_add_u32 v17, s28, v17
    v_mfma_f32_16x16x32_bf16 v[140:143], v[44:47], v[36:39], v[140:143]
    v_add_u32 v18, s28, v18
    v_add_u32 v19, s28, v19
    s_waitcnt vmcnt(9) lgkmcnt(0)
    s_barrier
    v_mfma_f32_16x16x32_bf16 v[128:131], v[88:91], v[80:83], v[128:131]
    ds_read_b64_tr_b16 v[40:41], v18 offset:8192
    ds_read_b64_tr_b16 v[42:43], v18 offset:9216
    ds_read_b64_tr_b16 v[44:45], v19 offset:8192
    v_mfma_f32_16x16x32_bf16 v[132:135], v[92:95], v[80:83], v[132:135]
    ds_read_b64_tr_b16 v[46:47], v19 offset:9216
    ds_read_b128 v[32:35], v16 offset:0
    ds_read_b128 v[36:39], v16 offset:2048
    v_mfma_f32_16x16x32_bf16 v[136:139], v[88:91], v[84:87], v[136:139]
    s_mov_b32 m0, s35
    s_add_u32 s35, s35, 24576
    s_cmp_ge_u32 s35, 122880
    s_cselect_b32 s40, 122880, 0
    s_sub_u32 s35, s35, s40
    buffer_load_dwordx4 v8, s[12:15], s31 offen offset:0 sc1 lds
    s_mov_b32 m0, s36
    s_add_u32 s31, s31, 2048
    s_and_b32 s40, s31, 0x1fff
    s_cselect_b32 s40, 0, 0x2000
    s_add_u32 s31, s31, s40
    s_add_u32 s36, s36, 24576
    s_cmp_ge_u32 s36, 122880
    s_cselect_b32 s40, 122880, 0
    s_sub_u32 s36, s36, s40
    v_mfma_f32_16x16x32_bf16 v[140:143], v[92:95], v[84:87], v[140:143]
    buffer_load_dwordx4 v12, s[16:19], s32 offen offset:0  lds
    buffer_load_dwordx4 v13, s[16:19], s32 offen offset:1024  lds
    s_add_u32 s32, s32, s33
    s_sub_u32 s34, s34, 1
    s_cmp_lg_u32 s34, 0
    s_cbranch_scc1 gl_209
    s_cmp_lg_u32 s26, 0
    s_cbranch_scc1 ti_210
    s_lshl_b32 s3, s43, 2
    s_add_u32 s3, s3, 16
    v_mov_b32 v27, s3
    v_mov_b32 v28, 1
    s_mov_b64 exec, 1
    buffer_atomic_add v28, v27, s[20:23], 0 offen sc0 sc1
    s_mov_b64 exec, -1
ti_210:
    s_waitcnt lgkmcnt(0)
    v_mfma_f32_16x16x32_bf16 v[128:131], v[40:43], v[32:35], v[128:131]
    ds_read_b64_tr_b16 v[88:89], v18 offset:16384
    ds_read_b64_tr_b16 v[90:91], v18 offset:17408
    ds_read_b64_tr_b16 v[92:93], v19 offset:16384
    v_mfma_f32_16x16x32_bf16 v[132:135], v[44:47], v[32:35], v[132:135]
    ds_read_b64_tr_b16 v[94:95], v19 offset:17408
    ds_read_b128 v[80:83], v17 offset:0
    ds_read_b128 v[84:87], v17 offset:2048
    v_mfma_f32_16x16x32_bf16 v[136:139], v[40:43], v[36:39], v[136:139]
    s_add_u32 s27, s27, 1
    s_cmp_eq_u32 s27, 5
    s_cselect_b32 s28, -98304, s29
    s_cselect_b32 s27, 0, s27
    v_add_u32 v16, s28, v16
    v_add_u32 v17, s28, v17
    v_mfma_f32_16x16x32_bf16 v[140:143], v[44:47], v[36:39], v[140:143]
    v_add_u32 v18, s28, v18
    v_add_u32 v19, s28, v19
    s_waitcnt vmcnt(9) lgkmcnt(0)
    s_barrier
    v_mfma_f32_16x16x32_bf16 v[128:131], v[88:91], v[80:83], v[128:131]
    ds_read_b64_tr_b16 v[40:41], v18 offset:8192
    ds_read_b64_tr_b16 v[42:43], v18 offset:9216
    v_mfma_f32_16x16x32_bf16 v[132:135], v[92:95], v[80:83], v[132:135]
    ds_read_b64_tr_b16 v[44:45], v19 offset:8192
    v_mfma_f32_16x16x32_bf16 v[136:139], v[88:91], v[84:87], v[136:139]
    ds_read_b64_tr_b16 v[46:47], v19 offset:9216
    ds_read_b128 v[32:35], v16 offset:0
    v_mfma_f32_16x16x32_bf16 v[140:143], v[92:95], v[84:87], v[140:143]
    ds_read_b128 v[36:39], v16 offset:2048
    s_waitcnt lgkmcnt(0)
    v_mfma_f32_16x16x32_bf16 v[128:131], v[40:43], v[32:35], v[128:131]
    ds_read_b64_tr_b16 v[88:89], v18 offset:16384
    ds_read_b64_tr_b16 v[90:91], v18 offset:17408
    ds_read_b64_tr_b16 v[92:93], v19 offset:16384
    v_mfma_f32_16x16x32_bf16 v[132:135], v[44:47], v[32:35], v[132:135]
    ds_read_b64_tr_b16 v[94:95], v19 offset:17408
    ds_read_b128 v[80:83], v17 offset:0
    ds_read_b128 v[84:87], v17 offset:2048
    v_mfma_f32_16x16x32_bf16 v[136:139], v[40:43], v[36:39], v[136:139]
    s_add_u32 s27, s27, 1
    s_cmp_eq_u32 s27, 5
    s_cselect_b32 s28, -98304, s29
    s_cselect_b32 s27, 0, s27
    v_add_u32 v16, s28, v16
    v_add_u32 v17, s28, v17
    v_mfma_f32_16x16x32_bf16 v[140:143], v[44:47], v[36:39], v[140:143]
    v_add_u32 v18, s28, v18
    v_add_u32 v19, s28, v19
    s_waitcnt vmcnt(6) lgkmcnt(0)
    s_barrier
    v_mfma_f32_16x16x32_bf16 v[128:131], v[88:91], v[80:83], v[128:131]
    ds_read_b64_tr_b16 v[40:41], v18 offset:8192
    ds_read_b64_tr_b16 v[42:43], v18 offset:9216
    v_mfma_f32_16x16x32_bf16 v[132:135], v[92:95], v[80:83], v[132:135]
    ds_read_b64_tr_b16 v[44:45], v19 offset:8192
    v_mfma_f32_16x16x32_bf16 v[136:139], v[88:91], v[84:87], v[136:139]
    ds_read_b64_tr_b16 v[46:47], v19 offset:9216
    ds_read_b128 v[32:35], v16 offset:0
    v_mfma_f32_16x16x32_bf16 v[140:143], v[92:95], v[84:87], v[140:143]
    ds_read_b128 v[36:39], v16 offset:2048
    s_waitcnt lgkmcnt(0)
    v_mfma_f32_16x16x32_bf16 v[128:131], v[40:43], v[32:35], v[128:131]
    ds_read_b64_tr_b16 v[88:89], v18 offset:16384
    ds_read_b64_tr_b16 v[90:91], v18 offset:17408
    ds_read_b64_tr_b16 v[92:93], v19 offset:16384
    v_mfma_f32_16x16x32_bf16 v[132:135], v[44:47], v[32:35], v[132:135]
    ds_read_b64_tr_b16 v[94:95], v19 offset:17408
    ds_read_b128 v[80:83], v17 offset:0
    ds_read_b128 v[84:87], v17 offset:2048
    v_mfma_f32_16x16x32_bf16 v[136:139], v[40:43], v[36:39], v[136:139]
    s_add_u32 s27, s27, 1
    s_cmp_eq_u32 s27, 5
    s_cselect_b32 s28, -98304, s29
    s_cselect_b32 s27, 0, s27
    v_add_u32 v16, s28, v16
    v_add_u32 v17, s28, v17
    v_mfma_f32_16x16x32_bf16 v[140:143], v[44:47], v[36:39], v[140:143]
    v_add_u32 v18, s28, v18
    v_add_u32 v19, s28, v19
    s_waitcnt vmcnt(3) lgkmcnt(0)
    s_barrier
    v_mfma_f32_16x16x32_bf16 v[128:131], v[88:91], v[80:83], v[128:131]
    ds_read_b64_tr_b16 v[40:41], v18 offset:8192
    ds_read_b64_tr_b16 v[42:43], v18 offset:9216
    v_mfma_f32_16x16x32_bf16 v[132:135], v[92:95], v[80:83], v[132:135]
    ds_read_b64_tr_b16 v[44:45], v19 offset:8192
    v_mfma_f32_16x16x32_bf16 v[136:139], v[88:91], v[84:87], v[136:139]
    ds_read_b64_tr_b16 v[46:47], v19 offset:9216
    ds_read_b128 v[32:35], v16 offset:0
    v_mfma_f32_16x16x32_bf16 v[140:143], v[92:95], v[84:87], v[140:143]
    ds_read_b128 v[36:39], v16 offset:2048
    s_waitcnt lgkmcnt(0)
    v_mfma_f32_16x16x32_bf16 v[128:131], v[40:43], v[32:35], v[128:131]
    ds_read_b64_tr_b16 v[88:89], v18 offset:16384
    ds_read_b64_tr_b16 v[90:91], v18 offset:17408
    ds_read_b64_tr_b16 v[92:93], v19 offset:16384
    v_mfma_f32_16x16x32_bf16 v[132:135], v[44:47], v[32:35], v[132:135]
    ds_read_b64_tr_b16 v[94:95], v19 offset:17408
    ds_read_b128 v[80:83], v17 offset:0
    ds_read_b128 v[84:87], v17 offset:2048
    v_mfma_f32_16x16x32_bf16 v[136:139], v[40:43], v[36:39], v[136:139]
    s_add_u32 s27, s27, 1
    s_cmp_eq_u32 s27, 5
    s_cselect_b32 s28, -98304, s29
    s_cselect_b32 s27, 0, s27
    v_add_u32 v16, s28, v16
    v_add_u32 v17, s28, v17
    v_mfma_f32_16x16x32_bf16 v[140:143], v[44:47], v[36:39], v[140:143]
    v_add_u32 v18, s28, v18
    v_add_u32 v19, s28, v19
    s_waitcnt vmcnt(0) lgkmcnt(0)
    s_barrier
    v_mfma_f32_16x16x32_bf16 v[128:131], v[88:91], v[80:83], v[128:131]
    ds_read_b64_tr_b16 v[40:41], v18 offset:8192
    ds_read_b64_tr_b16 v[42:43], v18 offset:9216
    v_mfma_f32_16x16x32_bf16 v[132:135], v[92:95], v[80:83], v[132:135]
    ds_read_b64_tr_b16 v[44:45], v19 offset:8192
    v_mfma_f32_16x16x32_bf16 v[136:139], v[88:91], v[84:87], v[136:139]
    ds_read_b64_tr_b16 v[46:47], v19 offset:9216
    ds_read_b128 v[32:35], v16 offset:0
    v_mfma_f32_16x16x32_bf16 v[140:143], v[92:95], v[84:87], v[140:143]
    ds_read_b128 v[36:39], v16 offset:2048
    s_waitcnt lgkmcnt(0)
    v_mfma_f32_16x16x32_bf16 v[128:131], v[40:43], v[32:35], v[128:131]
    ds_read_b64_tr_b16 v[88:89], v18 offset:16384
    ds_read_b64_tr_b16 v[90:91], v18 offset:17408
    ds_read_b64_tr_b16 v[92:93], v19 offset:16384
    v_mfma_f32_16x16x32_bf16 v[132:135], v[44:47], v[32:35], v[132:135]
    ds_read_b64_tr_b16 v[94:95], v19 offset:17408
    ds_read_b128 v[80:83], v17 offset:0
    ds_read_b128 v[84:87], v17 offset:2048
    v_mfma_f32_16x16x32_bf16 v[136:139], v[40:43], v[36:39], v[136:139]
    s_add_u32 s27, s27, 1
    s_cmp_eq_u32 s27, 5
    s_cselect_b32 s28, -98304, s29
    s_cselect_b32 s27, 0, s27
    v_add_u32 v16, s28, v16
    v_add_u32 v17, s28, v17
    v_mfma_f32_16x16x32_bf16 v[140:143], v[44:47], v[36:39], v[140:143]
    v_add_u32 v18, s28, v18
    v_add_u32 v19, s28, v19
    s_waitcnt lgkmcnt(0)
    v_mfma_f32_16x16x32_bf16 v[128:131], v[88:91], v[80:83], v[128:131]
    v_mfma_f32_16x16x32_bf16 v[132:135], v[92:95], v[80:83], v[132:135]
    v_mfma_f32_16x16x32_bf16 v[136:139], v[88:91], v[84:87], v[136:139]
    v_mfma_f32_16x16x32_bf16 v[140:143], v[92:95], v[84:87], v[140:143]
    s_nop 7
LE_T4S:
    v_mov_b32 v3, 163584
    s_cmp_lg_u32 s26, 0
    s_cbranch_scc1 tt_211
    s_waitcnt vmcnt(0)
    s_mov_b64 exec, 1
    ds_write_b32 v3, v28
    s_waitcnt lgkmcnt(0)
    s_mov_b64 exec, -1
tt_211:
    s_barrier
    ds_read_b32 v5, v3
    s_waitcnt lgkmcnt(0)
    v_readfirstlane_b32 s25, v5
    s_nop 3
    s_min_u32 s3, s25, 204
    s_lshl_b32 s3, s3, 2
    s_load_dword s7, s[50:51], s3
    s_waitcnt lgkmcnt(0)
E_T4S:
    v_and_b32 v3, 15, v2
    v_lshrrev_b32 v4, 4, v2
    v_mul_u32_u24 v3, 4096, v3
    v_lshl_add_u32 v7, v4, 4, v3
    s_mul_i32 s38, s44, 32
    s_add_u32 s38, s38, s41
    s_mul_i32 s38, s38, 4096
    s_mul_i32 s39, s45, 32
    s_add_u32 s39, s39, s42
    s_lshl_b32 s39, s39, 1
    s_add_u32 s38, s38, s39
    s_add_u32 s38, s38, 2048
    v_cvt_pk_bf16_f32 v32, v128, v129
    v_cvt_pk_bf16_f32 v33, v130, v131
    v_cvt_pk_bf16_f32 v34, v132, v133
    v_cvt_pk_bf16_f32 v35, v134, v135
    buffer_store_dwordx4 v[32:35], v7, s[64:67], s38 offen offset:0
    s_add_u32 s38, s38, 65536
    v_cvt_pk_bf16_f32 v36, v136, v137
    v_cvt_pk_bf16_f32 v37, v138, v139
    v_cvt_pk_bf16_f32 v38, v140, v141
    v_cvt_pk_bf16_f32 v39, v142, v143
    buffer_store_dwordx4 v[36:39], v7, s[64:67], s38 offen offset:0
    s_add_u32 s38, s38, 65536
    s_waitcnt vmcnt(63)
    s_cmp_lg_u32 s26, 1
    s_cbranch_scc1 sg_212
    s_mov_b64 exec, -1
sg_212:
    s_cmp_eq_u32 s6, 0
    s_cbranch_scc1 D_pre
    s_mov_b32 s6, 0
    s_branch D_main
LP_T4W:
    s_mov_b32 s34, 60
    s_mov_b32 s27, 0
    s_mov_b32 s29, 49152
    s_waitcnt vmcnt(12)
    s_barrier
    ds_read_b64_tr_b16 v[48:49], v18 offset:16384
    ds_read_b64_tr_b16 v[50:51], v18 offset:18432
    ds_read_b64_tr_b16 v[52:53], v19 offset:16384
    ds_read_b64_tr_b16 v[54:55], v19 offset:18432
    ds_read_b64_tr_b16 v[56:57], v20 offset:16384
    ds_read_b64_tr_b16 v[58:59], v20 offset:18432
    ds_read_b64_tr_b16 v[60:61], v21 offset:16384
    ds_read_b64_tr_b16 v[62:63], v21 offset:18432
    ds_read_b128 v[32:35], v16 offset:0
    ds_read_b128 v[36:39], v16 offset:2048
    ds_read_b128 v[40:43], v16 offset:4096
    ds_read_b128 v[44:47], v16 offset:6144
    s_waitcnt lgkmcnt(0)
    v_mfma_f32_16x16x32_bf16 v[128:131], v[48:51], v[32:35], 0
    ds_read_b64_tr_b16 v[96:97], v18 offset:32768
    ds_read_b64_tr_b16 v[98:99], v18 offset:34816
    v_mfma_f32_16x16x32_bf16 v[132:135], v[52:55], v[32:35], 0
    ds_read_b64_tr_b16 v[100:101], v19 offset:32768
    v_mfma_f32_16x16x32_bf16 v[136:139], v[56:59], v[32:35], 0
    ds_read_b64_tr_b16 v[102:103], v19 offset:34816
    v_mfma_f32_16x16x32_bf16 v[140:143], v[60:63], v[32:35], 0
    ds_read_b64_tr_b16 v[104:105], v20 offset:32768
    v_mfma_f32_16x16x32_bf16 v[144:147], v[48:51], v[36:39], 0
    ds_read_b64_tr_b16 v[106:107], v20 offset:34816
    v_mfma_f32_16x16x32_bf16 v[148:151], v[52:55], v[36:39], 0
    ds_read_b64_tr_b16 v[108:109], v21 offset:32768
    ds_read_b64_tr_b16 v[110:111], v21 offset:34816
    v_mfma_f32_16x16x32_bf16 v[152:155], v[56:59], v[36:39], 0
    ds_read_b128 v[80:83], v17 offset:0
    v_mfma_f32_16x16x32_bf16 v[156:159], v[60:63], v[36:39], 0
    ds_read_b128 v[84:87], v17 offset:2048
    v_mfma_f32_16x16x32_bf16 v[160:163], v[48:51], v[40:43], 0
    ds_read_b128 v[88:91], v17 offset:4096
    v_mfma_f32_16x16x32_bf16 v[164:167], v[52:55], v[40:43], 0
    ds_read_b128 v[92:95], v17 offset:6144
    v_mfma_f32_16x16x32_bf16 v[168:171], v[56:59], v[40:43], 0
    s_add_u32 s27, s27, 1
    s_cmp_eq_u32 s27, 3
    s_cselect_b32 s28, -98304, s29
    s_cselect_b32 s27, 0, s27
    v_add_u32 v16, s28, v16
    v_mfma_f32_16x16x32_bf16 v[172:175], v[60:63], v[40:43], 0
    v_add_u32 v17, s28, v17
    v_mfma_f32_16x16x32_bf16 v[176:179], v[48:51], v[44:47], 0
    v_add_u32 v18, s28, v18
    v_mfma_f32_16x16x32_bf16 v[180:183], v[52:55], v[44:47], 0
    v_add_u32 v19, s28, v19
    v_mfma_f32_16x16x32_bf16 v[184:187], v[56:59], v[44:47], 0
    v_add_u32 v20, s28, v20
    v_mfma_f32_16x16x32_bf16 v[188:191], v[60:63], v[44:47], 0
    v_add_u32 v21, s28, v21
    s_waitcnt vmcnt(6) lgkmcnt(0)
    s_barrier
    v_mfma_f32_16x16x32_bf16 v[128:131], v[96:99], v[80:83], v[128:131]
    ds_read_b64_tr_b16 v[48:49], v18 offset:16384
    ds_read_b64_tr_b16 v[50:51], v18 offset:18432
    v_mfma_f32_16x16x32_bf16 v[132:135], v[100:103], v[80:83], v[132:135]
    ds_read_b64_tr_b16 v[52:53], v19 offset:16384
    v_mfma_f32_16x16x32_bf16 v[136:139], v[104:107], v[80:83], v[136:139]
    ds_read_b64_tr_b16 v[54:55], v19 offset:18432
    v_mfma_f32_16x16x32_bf16 v[140:143], v[108:111], v[80:83], v[140:143]
    ds_read_b64_tr_b16 v[56:57], v20 offset:16384
    ds_read_b64_tr_b16 v[58:59], v20 offset:18432
    v_mfma_f32_16x16x32_bf16 v[144:147], v[96:99], v[84:87], v[144:147]
    ds_read_b64_tr_b16 v[60:61], v21 offset:16384
    v_mfma_f32_16x16x32_bf16 v[148:151], v[100:103], v[84:87], v[148:151]
    ds_read_b64_tr_b16 v[62:63], v21 offset:18432
    v_mfma_f32_16x16x32_bf16 v[152:155], v[104:107], v[84:87], v[152:155]
    ds_read_b128 v[32:35], v16 offset:0
    ds_read_b128 v[36:39], v16 offset:2048
    v_mfma_f32_16x16x32_bf16 v[156:159], v[108:111], v[84:87], v[156:159]
    ds_read_b128 v[40:43], v16 offset:4096
    v_mfma_f32_16x16x32_bf16 v[160:163], v[96:99], v[88:91], v[160:163]
    ds_read_b128 v[44:47], v16 offset:6144
    v_mfma_f32_16x16x32_bf16 v[164:167], v[100:103], v[88:91], v[164:167]
    s_mov_b32 m0, s35
    s_add_u32 s35, s35, 49152
    s_cmp_ge_u32 s35, 147456
    s_cselect_b32 s40, 147456, 0
    s_sub_u32 s35, s35, s40
    buffer_load_dwordx4 v8, s[12:15], s31 offen offset:0 sc1 lds
    v_mfma_f32_16x16x32_bf16 v[168:171], v[104:107], v[88:91], v[168:171]
    buffer_load_dwordx4 v9, s[12:15], s31 offen offset:1024 sc1 lds
    v_mfma_f32_16x16x32_bf16 v[172:175], v[108:111], v[88:91], v[172:175]
    s_mov_b32 m0, s36
    s_add_u32 s31, s31, 2048
    s_and_b32 s40, s31, 0x1fff
    s_cselect_b32 s40, 0, 0x2000
    s_add_u32 s31, s31, s40
    s_add_u32 s36, s36, 49152
    s_cmp_ge_u32 s36, 147456
    s_cselect_b32 s40, 147456, 0
    s_sub_u32 s36, s36, s40
    v_mfma_f32_16x16x32_bf16 v[176:179], v[96:99], v[92:95], v[176:179]
    buffer_load_dwordx4 v12, s[16:19], s32 offen offset:0  lds
    buffer_load_dwordx4 v13, s[16:19], s32 offen offset:1024  lds
    v_mfma_f32_16x16x32_bf16 v[180:183], v[100:103], v[92:95], v[180:183]
    buffer_load_dwordx4 v14, s[16:19], s32 offen offset:2048  lds
    v_mfma_f32_16x16x32_bf16 v[184:187], v[104:107], v[92:95], v[184:187]
    buffer_load_dwordx4 v15, s[16:19], s32 offen offset:3072  lds
    v_mfma_f32_16x16x32_bf16 v[188:191], v[108:111], v[92:95], v[188:191]
    s_add_u32 s32, s32, s33
gl_221:
    s_waitcnt lgkmcnt(0)
    v_mfma_f32_16x16x32_bf16 v[128:131], v[48:51], v[32:35], v[128:131]
    ds_read_b64_tr_b16 v[96:97], v18 offset:32768
    ds_read_b64_tr_b16 v[98:99], v18 offset:34816
    v_mfma_f32_16x16x32_bf16 v[132:135], v[52:55], v[32:35], v[132:135]
    ds_read_b64_tr_b16 v[100:101], v19 offset:32768
    v_mfma_f32_16x16x32_bf16 v[136:139], v[56:59], v[32:35], v[136:139]
    ds_read_b64_tr_b16 v[102:103], v19 offset:34816
    v_mfma_f32_16x16x32_bf16 v[140:143], v[60:63], v[32:35], v[140:143]
    ds_read_b64_tr_b16 v[104:105], v20 offset:32768
    v_mfma_f32_16x16x32_bf16 v[144:147], v[48:51], v[36:39], v[144:147]
    ds_read_b64_tr_b16 v[106:107], v20 offset:34816
    v_mfma_f32_16x16x32_bf16 v[148:151], v[52:55], v[36:39], v[148:151]
    ds_read_b64_tr_b16 v[108:109], v21 offset:32768
    ds_read_b64_tr_b16 v[110:111], v21 offset:34816
    v_mfma_f32_16x16x32_bf16 v[152:155], v[56:59], v[36:39], v[152:155]
    ds_read_b128 v[80:83], v17 offset:0
    v_mfma_f32_16x16x32_bf16 v[156:159], v[60:63], v[36:39], v[156:159]
    ds_read_b128 v[84:87], v17 offset:2048
    v_mfma_f32_16x16x32_bf16 v[160:163], v[48:51], v[40:43], v[160:163]
    ds_read_b128 v[88:91], v17 offset:4096
    v_mfma_f32_16x16x32_bf16 v[164:167], v[52:55], v[40:43], v[164:167]
    ds_read_b128 v[92:95], v17 offset:6144
    v_mfma_f32_16x16x32_bf16 v[168:171], v[56:59], v[40:43], v[168:171]
    s_add_u32 s27, s27, 1
    s_cmp_eq_u32 s27, 3
    s_cselect_b32 s28, -98304, s29
    s_cselect_b32 s27, 0, s27
    v_add_u32 v16, s28, v16
    v_mfma_f32_16x16x32_bf16 v[172:175], v[60:63], v[40:43], v[172:175]
    v_add_u32 v17, s28, v17
    v_mfma_f32_16x16x32_bf16 v[176:179], v[48:51], v[44:47], v[176:179]
    v_add_u32 v18, s28, v18
    v_mfma_f32_16x16x32_bf16 v[180:183], v[52:55], v[44:47], v[180:183]
    v_add_u32 v19, s28, v19
    v_mfma_f32_16x16x32_bf16 v[184:187], v[56:59], v[44:47], v[184:187]
    v_add_u32 v20, s28, v20
    v_mfma_f32_16x16x32_bf16 v[188:191], v[60:63], v[44:47], v[188:191]
    v_add_u32 v21, s28, v21
    s_waitcnt vmcnt(6) lgkmcnt(0)
    s_barrier
    v_mfma_f32_16x16x32_bf16 v[128:131], v[96:99], v[80:83], v[128:131]
    ds_read_b64_tr_b16 v[48:49], v18 offset:16384
    ds_read_b64_tr_b16 v[50:51], v18 offset:18432
    v_mfma_f32_16x16x32_bf16 v[132:135], v[100:103], v[80:83], v[132:135]
    ds_read_b64_tr_b16 v[52:53], v19 offset:16384
    v_mfma_f32_16x16x32_bf16 v[136:139], v[104:107], v[80:83], v[136:139]
    ds_read_b64_tr_b16 v[54:55], v19 offset:18432
    v_mfma_f32_16x16x32_bf16 v[140:143], v[108:111], v[80:83], v[140:143]
    ds_read_b64_tr_b16 v[56:57], v20 offset:16384
    ds_read_b64_tr_b16 v[58:59], v20 offset:18432
    v_mfma_f32_16x16x32_bf16 v[144:147], v[96:99], v[84:87], v[144:147]
    ds_read_b64_tr_b16 v[60:61], v21 offset:16384
    v_mfma_f32_16x16x32_bf16 v[148:151], v[100:103], v[84:87], v[148:151]
    ds_read_b64_tr_b16 v[62:63], v21 offset:18432
    v_mfma_f32_16x16x32_bf16 v[152:155], v[104:107], v[84:87], v[152:155]
    ds_read_b128 v[32:35], v16 offset:0
    ds_read_b128 v[36:39], v16 offset:2048
    v_mfma_f32_16x16x32_bf16 v[156:159], v[108:111], v[84:87], v[156:159]
    ds_read_b128 v[40:43], v16 offset:4096
    v_mfma_f32_16x16x32_bf16 v[160:163], v[96:99], v[88:91], v[160:163]
    ds_read_b128 v[44:47], v16 offset:6144
    v_mfma_f32_16x16x32_bf16 v[164:167], v[100:103], v[88:91], v[164:167]
    s_mov_b32 m0, s35
    s_add_u32 s35, s35, 49152
    s_cmp_ge_u32 s35, 147456
    s_cselect_b32 s40, 147456, 0
    s_sub_u32 s35, s35, s40
    buffer_load_dwordx4 v8, s[12:15], s31 offen offset:0 sc1 lds
    v_mfma_f32_16x16x32_bf16 v[168:171], v[104:107], v[88:91], v[168:171]
    buffer_load_dwordx4 v9, s[12:15], s31 offen offset:1024 sc1 lds
    v_mfma_f32_16x16x32_bf16 v[172:175], v[108:111], v[88:91], v[172:175]
    s_mov_b32 m0, s36
    s_add_u32 s31, s31, 2048
    s_and_b32 s40, s31, 0x1fff
    s_cselect_b32 s40, 0, 0x2000
    s_add_u32 s31, s31, s40
    s_add_u32 s36, s36, 49152
    s_cmp_ge_u32 s36, 147456
    s_cselect_b32 s40, 147456, 0
    s_sub_u32 s36, s36, s40
    v_mfma_f32_16x16x32_bf16 v[176:179], v[96:99], v[92:95], v[176:179]
    buffer_load_dwordx4 v12, s[16:19], s32 offen offset:0  lds
    buffer_load_dwordx4 v13, s[16:19], s32 offen offset:1024  lds
    v_mfma_f32_16x16x32_bf16 v[180:183], v[100:103], v[92:95], v[180:183]
    buffer_load_dwordx4 v14, s[16:19], s32 offen offset:2048  lds
    v_mfma_f32_16x16x32_bf16 v[184:187], v[104:107], v[92:95], v[184:187]
    buffer_load_dwordx4 v15, s[16:19], s32 offen offset:3072  lds
    v_mfma_f32_16x16x32_bf16 v[188:191], v[108:111], v[92:95], v[188:191]
    s_add_u32 s32, s32, s33
    s_sub_u32 s34, s34, 1
    s_cmp_lg_u32 s34, 0
    s_cbranch_scc1 gl_221
    s_cmp_lg_u32 s26, 0
    s_cbranch_scc1 ti_222
    s_lshl_b32 s3, s43, 2
    s_add_u32 s3, s3, 16
    v_mov_b32 v27, s3
    v_mov_b32 v28, 1
    s_mov_b64 exec, 1
    buffer_atomic_add v28, v27, s[20:23], 0 offen sc0 sc1
    s_mov_b64 exec, -1
ti_222:
    s_waitcnt lgkmcnt(0)
    v_mfma_f32_16x16x32_bf16 v[128:131], v[48:51], v[32:35], v[128:131]
    ds_read_b64_tr_b16 v[96:97], v18 offset:32768
    ds_read_b64_tr_b16 v[98:99], v18 offset:34816
    v_mfma_f32_16x16x32_bf16 v[132:135], v[52:55], v[32:35], v[132:135]
    ds_read_b64_tr_b16 v[100:101], v19 offset:32768
    v_mfma_f32_16x16x32_bf16 v[136:139], v[56:59], v[32:35], v[136:139]
    ds_read_b64_tr_b16 v[102:103], v19 offset:34816
    v_mfma_f32_16x16x32_bf16 v[140:143], v[60:63], v[32:35], v[140:143]
    ds_read_b64_tr_b16 v[104:105], v20 offset:32768
    v_mfma_f32_16x16x32_bf16 v[144:147], v[48:51], v[36:39], v[144:147]
    ds_read_b64_tr_b16 v[106:107], v20 offset:34816
    v_mfma_f32_16x16x32_bf16 v[148:151], v[52:55], v[36:39], v[148:151]
    ds_read_b64_tr_b16 v[108:109], v21 offset:32768
    ds_read_b64_tr_b16 v[110:111], v21 offset:34816
    v_mfma_f32_16x16x32_bf16 v[152:155], v[56:59], v[36:39], v[152:155]
    ds_read_b128 v[80:83], v17 offset:0
    v_mfma_f32_16x16x32_bf16 v[156:159], v[60:63], v[36:39], v[156:159]
    ds_read_b128 v[84:87], v17 offset:2048
    v_mfma_f32_16x16x32_bf16 v[160:163], v[48:51], v[40:43], v[160:163]
    ds_read_b128 v[88:91], v17 offset:4096
    v_mfma_f32_16x16x32_bf16 v[164:167], v[52:55], v[40:43], v[164:167]
    ds_read_b128 v[92:95], v17 offset:6144
    v_mfma_f32_16x16x32_bf16 v[168:171], v[56:59], v[40:43], v[168:171]
    s_add_u32 s27, s27, 1
    s_cmp_eq_u32 s27, 3
    s_cselect_b32 s28, -98304, s29
    s_cselect_b32 s27, 0, s27
    v_add_u32 v16, s28, v16
    v_mfma_f32_16x16x32_bf16 v[172:175], v[60:63], v[40:43], v[172:175]
    v_add_u32 v17, s28, v17
    v_mfma_f32_16x16x32_bf16 v[176:179], v[48:51], v[44:47], v[176:179]
    v_add_u32 v18, s28, v18
    v_mfma_f32_16x16x32_bf16 v[180:183], v[52:55], v[44:47], v[180:183]
    v_add_u32 v19, s28, v19
    v_mfma_f32_16x16x32_bf16 v[184:187], v[56:59], v[44:47], v[184:187]
    v_add_u32 v20, s28, v20
    v_mfma_f32_16x16x32_bf16 v[188:191], v[60:63], v[44:47], v[188:191]
    v_add_u32 v21, s28, v21
    s_waitcnt vmcnt(6) lgkmcnt(0)
    s_barrier
    v_mfma_f32_16x16x32_bf16 v[128:131], v[96:99], v[80:83], v[128:131]
    ds_read_b64_tr_b16 v[48:49], v18 offset:16384
    v_mfma_f32_16x16x32_bf16 v[132:135], v[100:103], v[80:83], v[132:135]
    ds_read_b64_tr_b16 v[50:51], v18 offset:18432
    v_mfma_f32_16x16x32_bf16 v[136:139], v[104:107], v[80:83], v[136:139]
    ds_read_b64_tr_b16 v[52:53], v19 offset:16384
    v_mfma_f32_16x16x32_bf16 v[140:143], v[108:111], v[80:83], v[140:143]
    v_mfma_f32_16x16x32_bf16 v[144:147], v[96:99], v[84:87], v[144:147]
    ds_read_b64_tr_b16 v[54:55], v19 offset:18432
    v_mfma_f32_16x16x32_bf16 v[148:151], v[100:103], v[84:87], v[148:151]
    ds_read_b64_tr_b16 v[56:57], v20 offset:16384
    v_mfma_f32_16x16x32_bf16 v[152:155], v[104:107], v[84:87], v[152:155]
    ds_read_b64_tr_b16 v[58:59], v20 offset:18432
    v_mfma_f32_16x16x32_bf16 v[156:159], v[108:111], v[84:87], v[156:159]
    v_mfma_f32_16x16x32_bf16 v[160:163], v[96:99], v[88:91], v[160:163]
    ds_read_b64_tr_b16 v[60:61], v21 offset:16384
    v_mfma_f32_16x16x32_bf16 v[164:167], v[100:103], v[88:91], v[164:167]
    ds_read_b64_tr_b16 v[62:63], v21 offset:18432
    v_mfma_f32_16x16x32_bf16 v[168:171], v[104:107], v[88:91], v[168:171]
    ds_read_b128 v[32:35], v16 offset:0
    v_mfma_f32_16x16x32_bf16 v[172:175], v[108:111], v[88:91], v[172:175]
    v_mfma_f32_16x16x32_bf16 v[176:179], v[96:99], v[92:95], v[176:179]
    ds_read_b128 v[36:39], v16 offset:2048
    v_mfma_f32_16x16x32_bf16 v[180:183], v[100:103], v[92:95], v[180:183]
    ds_read_b128 v[40:43], v16 offset:4096
    v_mfma_f32_16x16x32_bf16 v[184:187], v[104:107], v[92:95], v[184:187]
    ds_read_b128 v[44:47], v16 offset:6144
    v_mfma_f32_16x16x32_bf16 v[188:191], v[108:111], v[92:95], v[188:191]
    s_waitcnt lgkmcnt(0)
    v_mfma_f32_16x16x32_bf16 v[128:131], v[48:51], v[32:35], v[128:131]
    ds_read_b64_tr_b16 v[96:97], v18 offset:32768
    ds_read_b64_tr_b16 v[98:99], v18 offset:34816
    v_mfma_f32_16x16x32_bf16 v[132:135], v[52:55], v[32:35], v[132:135]
    ds_read_b64_tr_b16 v[100:101], v19 offset:32768
    v_mfma_f32_16x16x32_bf16 v[136:139], v[56:59], v[32:35], v[136:139]
    ds_read_b64_tr_b16 v[102:103], v19 offset:34816
    v_mfma_f32_16x16x32_bf16 v[140:143], v[60:63], v[32:35], v[140:143]
    ds_read_b64_tr_b16 v[104:105], v20 offset:32768
    v_mfma_f32_16x16x32_bf16 v[144:147], v[48:51], v[36:39], v[144:147]
    ds_read_b64_tr_b16 v[106:107], v20 offset:34816
    v_mfma_f32_16x16x32_bf16 v[148:151], v[52:55], v[36:39], v[148:151]
    ds_read_b64_tr_b16 v[108:109], v21 offset:32768
    ds_read_b64_tr_b16 v[110:111], v21 offset:34816
    v_mfma_f32_16x16x32_bf16 v[152:155], v[56:59], v[36:39], v[152:155]
    ds_read_b128 v[80:83], v17 offset:0
    v_mfma_f32_16x16x32_bf16 v[156:159], v[60:63], v[36:39], v[156:159]
    ds_read_b128 v[84:87], v17 offset:2048
    v_mfma_f32_16x16x32_bf16 v[160:163], v[48:51], v[40:43], v[160:163]
    ds_read_b128 v[88:91], v17 offset:4096
    v_mfma_f32_16x16x32_bf16 v[164:167], v[52:55], v[40:43], v[164:167]
    ds_read_b128 v[92:95], v17 offset:6144
    v_mfma_f32_16x16x32_bf16 v[168:171], v[56:59], v[40:43], v[168:171]
    s_add_u32 s27, s27, 1
    s_cmp_eq_u32 s27, 3
    s_cselect_b32 s28, -98304, s29
    s_cselect_b32 s27, 0, s27
    v_add_u32 v16, s28, v16
    v_mfma_f32_16x16x32_bf16 v[172:175], v[60:63], v[40:43], v[172:175]
    v_add_u32 v17, s28, v17
    v_mfma_f32_16x16x32_bf16 v[176:179], v[48:51], v[44:47], v[176:179]
    v_add_u32 v18, s28, v18
    v_mfma_f32_16x16x32_bf16 v[180:183], v[52:55], v[44:47], v[180:183]
    v_add_u32 v19, s28, v19
    v_mfma_f32_16x16x32_bf16 v[184:187], v[56:59], v[44:47], v[184:187]
    v_add_u32 v20, s28, v20
    v_mfma_f32_16x16x32_bf16 v[188:191], v[60:63], v[44:47], v[188:191]
    v_add_u32 v21, s28, v21
    s_waitcnt vmcnt(0) lgkmcnt(0)
    s_barrier
    v_mfma_f32_16x16x32_bf16 v[128:131], v[96:99], v[80:83], v[128:131]
    ds_read_b64_tr_b16 v[48:49], v18 offset:16384
    v_mfma_f32_16x16x32_bf16 v[132:135], v[100:103], v[80:83], v[132:135]
    ds_read_b64_tr_b16 v[50:51], v18 offset:18432
    v_mfma_f32_16x16x32_bf16 v[136:139], v[104:107], v[80:83], v[136:139]
    ds_read_b64_tr_b16 v[52:53], v19 offset:16384
    v_mfma_f32_16x16x32_bf16 v[140:143], v[108:111], v[80:83], v[140:143]
    v_mfma_f32_16x16x32_bf16 v[144:147], v[96:99], v[84:87], v[144:147]
    ds_read_b64_tr_b16 v[54:55], v19 offset:18432
    v_mfma_f32_16x16x32_bf16 v[148:151], v[100:103], v[84:87], v[148:151]
    ds_read_b64_tr_b16 v[56:57], v20 offset:16384
    v_mfma_f32_16x16x32_bf16 v[152:155], v[104:107], v[84:87], v[152:155]
    ds_read_b64_tr_b16 v[58:59], v20 offset:18432
    v_mfma_f32_16x16x32_bf16 v[156:159], v[108:111], v[84:87], v[156:159]
    v_mfma_f32_16x16x32_bf16 v[160:163], v[96:99], v[88:91], v[160:163]
    ds_read_b64_tr_b16 v[60:61], v21 offset:16384
    v_mfma_f32_16x16x32_bf16 v[164:167], v[100:103], v[88:91], v[164:167]
    ds_read_b64_tr_b16 v[62:63], v21 offset:18432
    v_mfma_f32_16x16x32_bf16 v[168:171], v[104:107], v[88:91], v[168:171]
    ds_read_b128 v[32:35], v16 offset:0
    v_mfma_f32_16x16x32_bf16 v[172:175], v[108:111], v[88:91], v[172:175]
    v_mfma_f32_16x16x32_bf16 v[176:179], v[96:99], v[92:95], v[176:179]
    ds_read_b128 v[36:39], v16 offset:2048
    v_mfma_f32_16x16x32_bf16 v[180:183], v[100:103], v[92:95], v[180:183]
    ds_read_b128 v[40:43], v16 offset:4096
    v_mfma_f32_16x16x32_bf16 v[184:187], v[104:107], v[92:95], v[184:187]
    ds_read_b128 v[44:47], v16 offset:6144
    v_mfma_f32_16x16x32_bf16 v[188:191], v[108:111], v[92:95], v[188:191]
    s_waitcnt lgkmcnt(0)
    v_mfma_f32_16x16x32_bf16 v[128:131], v[48:51], v[32:35], v[128:131]
    ds_read_b64_tr_b16 v[96:97], v18 offset:32768
    ds_read_b64_tr_b16 v[98:99], v18 offset:34816
    v_mfma_f32_16x16x32_bf16 v[132:135], v[52:55], v[32:35], v[132:135]
    ds_read_b64_tr_b16 v[100:101], v19 offset:32768
    v_mfma_f32_16x16x32_bf16 v[136:139], v[56:59], v[32:35], v[136:139]
    ds_read_b64_tr_b16 v[102:103], v19 offset:34816
    v_mfma_f32_16x16x32_bf16 v[140:143], v[60:63], v[32:35], v[140:143]
    ds_read_b64_tr_b16 v[104:105], v20 offset:32768
    v_mfma_f32_16x16x32_bf16 v[144:147], v[48:51], v[36:39], v[144:147]
    ds_read_b64_tr_b16 v[106:107], v20 offset:34816
    v_mfma_f32_16x16x32_bf16 v[148:151], v[52:55], v[36:39], v[148:151]
    ds_read_b64_tr_b16 v[108:109], v21 offset:32768
    ds_read_b64_tr_b16 v[110:111], v21 offset:34816
    v_mfma_f32_16x16x32_bf16 v[152:155], v[56:59], v[36:39], v[152:155]
    ds_read_b128 v[80:83], v17 offset:0
    v_mfma_f32_16x16x32_bf16 v[156:159], v[60:63], v[36:39], v[156:159]
    ds_read_b128 v[84:87], v17 offset:2048
    v_mfma_f32_16x16x32_bf16 v[160:163], v[48:51], v[40:43], v[160:163]
    ds_read_b128 v[88:91], v17 offset:4096
    v_mfma_f32_16x16x32_bf16 v[164:167], v[52:55], v[40:43], v[164:167]
    ds_read_b128 v[92:95], v17 offset:6144
    v_mfma_f32_16x16x32_bf16 v[168:171], v[56:59], v[40:43], v[168:171]
    s_add_u32 s27, s27, 1
    s_cmp_eq_u32 s27, 3
    s_cselect_b32 s28, -98304, s29
    s_cselect_b32 s27, 0, s27
    v_add_u32 v16, s28, v16
    v_mfma_f32_16x16x32_bf16 v[172:175], v[60:63], v[40:43], v[172:175]
    v_add_u32 v17, s28, v17
    v_mfma_f32_16x16x32_bf16 v[176:179], v[48:51], v[44:47], v[176:179]
    v_add_u32 v18, s28, v18
    v_mfma_f32_16x16x32_bf16 v[180:183], v[52:55], v[44:47], v[180:183]
    v_add_u32 v19, s28, v19
    v_mfma_f32_16x16x32_bf16 v[184:187], v[56:59], v[44:47], v[184:187]
    v_add_u32 v20, s28, v20
    v_mfma_f32_16x16x32_bf16 v[188:191], v[60:63], v[44:47], v[188:191]
    v_add_u32 v21, s28, v21
    s_waitcnt lgkmcnt(0)
    v_mfma_f32_16x16x32_bf16 v[128:131], v[96:99], v[80:83], v[128:131]
    v_mfma_f32_16x16x32_bf16 v[132:135], v[100:103], v[80:83], v[132:135]
    v_mfma_f32_16x16x32_bf16 v[136:139], v[104:107], v[80:83], v[136:139]
    v_mfma_f32_16x16x32_bf16 v[140:143], v[108:111], v[80:83], v[140:143]
    v_mfma_f32_16x16x32_bf16 v[144:147], v[96:99], v[84:87], v[144:147]
    v_mfma_f32_16x16x32_bf16 v[148:151], v[100:103], v[84:87], v[148:151]
    v_mfma_f32_16x16x32_bf16 v[152:155], v[104:107], v[84:87], v[152:155]
    v_mfma_f32_16x16x32_bf16 v[156:159], v[108:111], v[84:87], v[156:159]
    v_mfma_f32_16x16x32_bf16 v[160:163], v[96:99], v[88:91], v[160:163]
    v_mfma_f32_16x16x32_bf16 v[164:167], v[100:103], v[88:91], v[164:167]
    v_mfma_f32_16x16x32_bf16 v[168:171], v[104:107], v[88:91], v[168:171]
    v_mfma_f32_16x16x32_bf16 v[172:175], v[108:111], v[88:91], v[172:175]
    v_mfma_f32_16x16x32_bf16 v[176:179], v[96:99], v[92:95], v[176:179]
    v_mfma_f32_16x16x32_bf16 v[180:183], v[100:103], v[92:95], v[180:183]
    v_mfma_f32_16x16x32_bf16 v[184:187], v[104:107], v[92:95], v[184:187]
    v_mfma_f32_16x16x32_bf16 v[188:191], v[108:111], v[92:95], v[188:191]
    s_nop 7
LE_T4W:
    v_mov_b32 v3, 163584
    s_cmp_lg_u32 s26, 0
    s_cbranch_scc1 tt_223
    s_waitcnt vmcnt(0)
    s_mov_b64 exec, 1
    ds_write_b32 v3, v28
    s_waitcnt lgkmcnt(0)
    s_mov_b64 exec, -1
tt_223:
    s_barrier
    ds_read_b32 v5, v3
    s_waitcnt lgkmcnt(0)
    v_readfirstlane_b32 s25, v5
    s_nop 3
    s_min_u32 s3, s25, 204
    s_lshl_b32 s3, s3, 2
    s_load_dword s7, s[50:51], s3
    s_waitcnt lgkmcnt(0)
E_T4W:
    v_and_b32 v3, 15, v2
    v_lshrrev_b32 v4, 4, v2
    v_mul_u32_u24 v3, 4096, v3
    v_lshl_add_u32 v7, v4, 4, v3
    s_mul_i32 s38, s44, 64
    s_add_u32 s38, s38, s41
    s_mul_i32 s38, s38, 4096
    s_mul_i32 s39, s45, 64
    s_add_u32 s39, s39, s42
    s_lshl_b32 s39, s39, 1
    s_add_u32 s38, s38, s39
    s_add_u32 s38, s38, 2048
    v_cvt_pk_bf16_f32 v32, v128, v129
    v_cvt_pk_bf16_f32 v33, v130, v131
    v_cvt_pk_bf16_f32 v34, v132, v133
    v_cvt_pk_bf16_f32 v35, v134, v135
    buffer_store_dwordx4 v[32:35], v7, s[64:67], s38 offen offset:0
    v_cvt_pk_bf16_f32 v36, v136, v137
    v_cvt_pk_bf16_f32 v37, v138, v139
    v_cvt_pk_bf16_f32 v38, v140, v141
    v_cvt_pk_bf16_f32 v39, v142, v143
    buffer_store_dwordx4 v[36:39], v7, s[64:67], s38 offen offset:64
    s_add_u32 s38, s38, 65536
    v_cvt_pk_bf16_f32 v40, v144, v145
    v_cvt_pk_bf16_f32 v41, v146, v147
    v_cvt_pk_bf16_f32 v42, v148, v149
    v_cvt_pk_bf16_f32 v43, v150, v151
    buffer_store_dwordx4 v[40:43], v7, s[64:67], s38 offen offset:0
    v_cvt_pk_bf16_f32 v44, v152, v153
    v_cvt_pk_bf16_f32 v45, v154, v155
    v_cvt_pk_bf16_f32 v46, v156, v157
    v_cvt_pk_bf16_f32 v47, v158, v159
    buffer_store_dwordx4 v[44:47], v7, s[64:67], s38 offen offset:64
    s_add_u32 s38, s38, 65536
    v_cvt_pk_bf16_f32 v48, v160, v161
    v_cvt_pk_bf16_f32 v49, v162, v163
    v_cvt_pk_bf16_f32 v50, v164, v165
    v_cvt_pk_bf16_f32 v51, v166, v167
    buffer_store_dwordx4 v[48:51], v7, s[64:67], s38 offen offset:0
    v_cvt_pk_bf16_f32 v52, v168, v169
    v_cvt_pk_bf16_f32 v53, v170, v171
    v_cvt_pk_bf16_f32 v54, v172, v173
    v_cvt_pk_bf16_f32 v55, v174, v175
    buffer_store_dwordx4 v[52:55], v7, s[64:67], s38 offen offset:64
    s_add_u32 s38, s38, 65536
    v_cvt_pk_bf16_f32 v56, v176, v177
    v_cvt_pk_bf16_f32 v57, v178, v179
    v_cvt_pk_bf16_f32 v58, v180, v181
    v_cvt_pk_bf16_f32 v59, v182, v183
    buffer_store_dwordx4 v[56:59], v7, s[64:67], s38 offen offset:0
    v_cvt_pk_bf16_f32 v60, v184, v185
    v_cvt_pk_bf16_f32 v61, v186, v187
    v_cvt_pk_bf16_f32 v62, v188, v189
    v_cvt_pk_bf16_f32 v63, v190, v191
    buffer_store_dwordx4 v[60:63], v7, s[64:67], s38 offen offset:64
    s_add_u32 s38, s38, 65536
    s_waitcnt vmcnt(63)
    s_cmp_lg_u32 s26, 1
    s_cbranch_scc1 sg_224
    s_mov_b64 exec, -1
sg_224:
    s_cmp_eq_u32 s6, 0
    s_cbranch_scc1 D_pre
    s_mov_b32 s6, 0
    s_branch D_main
LP_T4Q:
    s_mov_b32 s34, 10
    s_mov_b32 s27, 0
    s_mov_b32 s29, 24576
    s_waitcnt vmcnt(12)
    s_barrier
    ds_read_b64_tr_b16 v[40:41], v18 offset:8192
    ds_read_b64_tr_b16 v[42:43], v18 offset:9216
    ds_read_b64_tr_b16 v[44:45], v19 offset:8192
    ds_read_b64_tr_b16 v[46:47], v19 offset:9216
    ds_read_b128 v[32:35], v16 offset:0
    ds_read_b128 v[36:39], v16 offset:2048
    s_waitcnt lgkmcnt(0)
    v_mfma_f32_16x16x32_bf16 v[128:131], v[40:43], v[32:35], 0
    ds_read_b64_tr_b16 v[88:89], v18 offset:16384
    ds_read_b64_tr_b16 v[90:91], v18 offset:17408
    ds_read_b64_tr_b16 v[92:93], v19 offset:16384
    v_mfma_f32_16x16x32_bf16 v[132:135], v[44:47], v[32:35], 0
    ds_read_b64_tr_b16 v[94:95], v19 offset:17408
    ds_read_b128 v[80:83], v17 offset:0
    ds_read_b128 v[84:87], v17 offset:2048
    v_mfma_f32_16x16x32_bf16 v[136:139], v[40:43], v[36:39], 0
    s_add_u32 s27, s27, 1
    s_cmp_eq_u32 s27, 5
    s_cselect_b32 s28, -98304, s29
    s_cselect_b32 s27, 0, s27
    v_add_u32 v16, s28, v16
    v_add_u32 v17, s28, v17
    v_mfma_f32_16x16x32_bf16 v[140:143], v[44:47], v[36:39], 0
    v_add_u32 v18, s28, v18
    v_add_u32 v19, s28, v19
    s_waitcnt vmcnt(9) lgkmcnt(0)
    s_barrier
    v_mfma_f32_16x16x32_bf16 v[128:131], v[88:91], v[80:83], v[128:131]
    ds_read_b64_tr_b16 v[40:41], v18 offset:8192
    ds_read_b64_tr_b16 v[42:43], v18 offset:9216
    ds_read_b64_tr_b16 v[44:45], v19 offset:8192
    v_mfma_f32_16x16x32_bf16 v[132:135], v[92:95], v[80:83], v[132:135]
    ds_read_b64_tr_b16 v[46:47], v19 offset:9216
    ds_read_b128 v[32:35], v16 offset:0
    ds_read_b128 v[36:39], v16 offset:2048
    v_mfma_f32_16x16x32_bf16 v[136:139], v[88:91], v[84:87], v[136:139]
    s_mov_b32 m0, s35
    s_add_u32 s35, s35, 24576
    s_cmp_ge_u32 s35, 122880
    s_cselect_b32 s40, 122880, 0
    s_sub_u32 s35, s35, s40
    buffer_load_dwordx4 v8, s[12:15], s31 offen offset:0 sc1 lds
    s_mov_b32 m0, s36
    s_add_u32 s31, s31, 2048
    s_and_b32 s40, s31, 0x1fff
    s_cselect_b32 s40, 0, 0x2000
    s_add_u32 s31, s31, s40
    s_add_u32 s36, s36, 24576
    s_cmp_ge_u32 s36, 122880
    s_cselect_b32 s40, 122880, 0
    s_sub_u32 s36, s36, s40
    v_mfma_f32_16x16x32_bf16 v[140:143], v[92:95], v[84:87], v[140:143]
    buffer_load_dwordx4 v12, s[16:19], s32 offen offset:0  lds
    buffer_load_dwordx4 v13, s[16:19], s32 offen offset:1024  lds
    s_add_u32 s32, s32, s33
gl_233:
    s_waitcnt lgkmcnt(0)
    v_mfma_f32_16x16x32_bf16 v[128:131], v[40:43], v[32:35], v[128:131]
    ds_read_b64_tr_b16 v[88:89], v18 offset:16384
    ds_read_b64_tr_b16 v[90:91], v18 offset:17408
    ds_read_b64_tr_b16 v[92:93], v19 offset:16384
    v_mfma_f32_16x16x32_bf16 v[132:135], v[44:47], v[32:35], v[132:135]
    ds_read_b64_tr_b16 v[94:95], v19 offset:17408
    ds_read_b128 v[80:83], v17 offset:0
    ds_read_b128 v[84:87], v17 offset:2048
    v_mfma_f32_16x16x32_bf16 v[136:139], v[40:43], v[36:39], v[136:139]
    s_add_u32 s27, s27, 1
    s_cmp_eq_u32 s27, 5
    s_cselect_b32 s28, -98304, s29
    s_cselect_b32 s27, 0, s27
    v_add_u32 v16, s28, v16
    v_add_u32 v17, s28, v17
    v_mfma_f32_16x16x32_bf16 v[140:143], v[44:47], v[36:39], v[140:143]
    v_add_u32 v18, s28, v18
    v_add_u32 v19, s28, v19
    s_waitcnt vmcnt(9) lgkmcnt(0)
    s_barrier
    v_mfma_f32_16x16x32_bf16 v[128:131], v[88:91], v[80:83], v[128:131]
    ds_read_b64_tr_b16 v[40:41], v18 offset:8192
    ds_read_b64_tr_b16 v[42:43], v18 offset:9216
    ds_read_b64_tr_b16 v[44:45], v19 offset:8192
    v_mfma_f32_16x16x32_bf16 v[132:135], v[92:95], v[80:83], v[132:135]
    ds_read_b64_tr_b16 v[46:47], v19 offset:9216
    ds_read_b128 v[32:35], v16 offset:0
    ds_read_b128 v[36:39], v16 offset:2048
    v_mfma_f32_16x16x32_bf16 v[136:139], v[88:91], v[84:87], v[136:139]
    s_mov_b32 m0, s35
    s_add_u32 s35, s35, 24576
    s_cmp_ge_u32 s35, 122880
    s_cselect_b32 s40, 122880, 0
    s_sub_u32 s35, s35, s40
    buffer_load_dwordx4 v8, s[12:15], s31 offen offset:0 sc1 lds
    s_mov_b32 m0, s36
    s_add_u32 s31, s31, 2048
    s_and_b32 s40, s31, 0x1fff
    s_cselect_b32 s40, 0, 0x2000
    s_add_u32 s31, s31, s40
    s_add_u32 s36, s36, 24576
    s_cmp_ge_u32 s36, 122880
    s_cselect_b32 s40, 122880, 0
    s_sub_u32 s36, s36, s40
    v_mfma_f32_16x16x32_bf16 v[140:143], v[92:95], v[84:87], v[140:143]
    buffer_load_dwordx4 v12, s[16:19], s32 offen offset:0  lds
    buffer_load_dwordx4 v13, s[16:19], s32 offen offset:1024  lds
    s_add_u32 s32, s32, s33
    s_sub_u32 s34, s34, 1
    s_cmp_lg_u32 s34, 0
    s_cbranch_scc1 gl_233
    s_cmp_lg_u32 s26, 0
    s_cbranch_scc1 ti_234
    s_lshl_b32 s3, s43, 2
    s_add_u32 s3, s3, 16
    v_mov_b32 v27, s3
    v_mov_b32 v28, 1
    s_mov_b64 exec, 1
    buffer_atomic_add v28, v27, s[20:23], 0 offen sc0 sc1
    s_mov_b64 exec, -1
ti_234:
    s_waitcnt lgkmcnt(0)
    v_mfma_f32_16x16x32_bf16 v[128:131], v[40:43], v[32:35], v[128:131]
    ds_read_b64_tr_b16 v[88:89], v18 offset:16384
    ds_read_b64_tr_b16 v[90:91], v18 offset:17408
    ds_read_b64_tr_b16 v[92:93], v19 offset:16384
    v_mfma_f32_16x16x32_bf16 v[132:135], v[44:47], v[32:35], v[132:135]
    ds_read_b64_tr_b16 v[94:95], v19 offset:17408
    ds_read_b128 v[80:83], v17 offset:0
    ds_read_b128 v[84:87], v17 offset:2048
    v_mfma_f32_16x16x32_bf16 v[136:139], v[40:43], v[36:39], v[136:139]
    s_add_u32 s27, s27, 1
    s_cmp_eq_u32 s27, 5
    s_cselect_b32 s28, -98304, s29
    s_cselect_b32 s27, 0, s27
    v_add_u32 v16, s28, v16
    v_add_u32 v17, s28, v17
    v_mfma_f32_16x16x32_bf16 v[140:143], v[44:47], v[36:39], v[140:143]
    v_add_u32 v18, s28, v18
    v_add_u32 v19, s28, v19
    s_waitcnt vmcnt(9) lgkmcnt(0)
    s_barrier
    v_mfma_f32_16x16x32_bf16 v[128:131], v[88:91], v[80:83], v[128:131]
    ds_read_b64_tr_b16 v[40:41], v18 offset:8192
    ds_read_b64_tr_b16 v[42:43], v18 offset:9216
    v_mfma_f32_16x16x32_bf16 v[132:135], v[92:95], v[80:83], v[132:135]
    ds_read_b64_tr_b16 v[44:45], v19 offset:8192
    v_mfma_f32_16x16x32_bf16 v[136:139], v[88:91], v[84:87], v[136:139]
    ds_read_b64_tr_b16 v[46:47], v19 offset:9216
    ds_read_b128 v[32:35], v16 offset:0
    v_mfma_f32_16x16x32_bf16 v[140:143], v[92:95], v[84:87], v[140:143]
    ds_read_b128 v[36:39], v16 offset:2048
    s_waitcnt lgkmcnt(0)
    v_mfma_f32_16x16x32_bf16 v[128:131], v[40:43], v[32:35], v[128:131]
    ds_read_b64_tr_b16 v[88:89], v18 offset:16384
    ds_read_b64_tr_b16 v[90:91], v18 offset:17408
    ds_read_b64_tr_b16 v[92:93], v19 offset:16384
    v_mfma_f32_16x16x32_bf16 v[132:135], v[44:47], v[32:35], v[132:135]
    ds_read_b64_tr_b16 v[94:95], v19 offset:17408
    ds_read_b128 v[80:83], v17 offset:0
    ds_read_b128 v[84:87], v17 offset:2048
    v_mfma_f32_16x16x32_bf16 v[136:139], v[40:43], v[36:39], v[136:139]
    s_add_u32 s27, s27, 1
    s_cmp_eq_u32 s27, 5
    s_cselect_b32 s28, -98304, s29
    s_cselect_b32 s27, 0, s27
    v_add_u32 v16, s28, v16
    v_add_u32 v17, s28, v17
    v_mfma_f32_16x16x32_bf16 v[140:143], v[44:47], v[36:39], v[140:143]
    v_add_u32 v18, s28, v18
    v_add_u32 v19, s28, v19
    s_waitcnt vmcnt(6) lgkmcnt(0)
    s_barrier
    v_mfma_f32_16x16x32_bf16 v[128:131], v[88:91], v[80:83], v[128:131]
    ds_read_b64_tr_b16 v[40:41], v18 offset:8192
    ds_read_b64_tr_b16 v[42:43], v18 offset:9216
    v_mfma_f32_16x16x32_bf16 v[132:135], v[92:95], v[80:83], v[132:135]
    ds_read_b64_tr_b16 v[44:45], v19 offset:8192
    v_mfma_f32_16x16x32_bf16 v[136:139], v[88:91], v[84:87], v[136:139]
    ds_read_b64_tr_b16 v[46:47], v19 offset:9216
    ds_read_b128 v[32:35], v16 offset:0
    v_mfma_f32_16x16x32_bf16 v[140:143], v[92:95], v[84:87], v[140:143]
    ds_read_b128 v[36:39], v16 offset:2048
    s_waitcnt lgkmcnt(0)
    v_mfma_f32_16x16x32_bf16 v[128:131], v[40:43], v[32:35], v[128:131]
    ds_read_b64_tr_b16 v[88:89], v18 offset:16384
    ds_read_b64_tr_b16 v[90:91], v18 offset:17408
    ds_read_b64_tr_b16 v[92:93], v19 offset:16384
    v_mfma_f32_16x16x32_bf16 v[132:135], v[44:47], v[32:35], v[132:135]
    ds_read_b64_tr_b16 v[94:95], v19 offset:17408
    ds_read_b128 v[80:83], v17 offset:0
    ds_read_b128 v[84:87], v17 offset:2048
    v_mfma_f32_16x16x32_bf16 v[136:139], v[40:43], v[36:39], v[136:139]
    s_add_u32 s27, s27, 1
    s_cmp_eq_u32 s27, 5
    s_cselect_b32 s28, -98304, s29
    s_cselect_b32 s27, 0, s27
    v_add_u32 v16, s28, v16
    v_add_u32 v17, s28, v17
    v_mfma_f32_16x16x32_bf16 v[140:143], v[44:47], v[36:39], v[140:143]
    v_add_u32 v18, s28, v18
    v_add_u32 v19, s28, v19
    s_waitcnt vmcnt(3) lgkmcnt(0)
    s_barrier
    v_mfma_f32_16x16x32_bf16 v[128:131], v[88:91], v[80:83], v[128:131]
    ds_read_b64_tr_b16 v[40:41], v18 offset:8192
    ds_read_b64_tr_b16 v[42:43], v18 offset:9216
    v_mfma_f32_16x16x32_bf16 v[132:135], v[92:95], v[80:83], v[132:135]
    ds_read_b64_tr_b16 v[44:45], v19 offset:8192
    v_mfma_f32_16x16x32_bf16 v[136:139], v[88:91], v[84:87], v[136:139]
    ds_read_b64_tr_b16 v[46:47], v19 offset:9216
    ds_read_b128 v[32:35], v16 offset:0
    v_mfma_f32_16x16x32_bf16 v[140:143], v[92:95], v[84:87], v[140:143]
    ds_read_b128 v[36:39], v16 offset:2048
    s_waitcnt lgkmcnt(0)
    v_mfma_f32_16x16x32_bf16 v[128:131], v[40:43], v[32:35], v[128:131]
    ds_read_b64_tr_b16 v[88:89], v18 offset:16384
    ds_read_b64_tr_b16 v[90:91], v18 offset:17408
    ds_read_b64_tr_b16 v[92:93], v19 offset:16384
    v_mfma_f32_16x16x32_bf16 v[132:135], v[44:47], v[32:35], v[132:135]
    ds_read_b64_tr_b16 v[94:95], v19 offset:17408
    ds_read_b128 v[80:83], v17 offset:0
    ds_read_b128 v[84:87], v17 offset:2048
    v_mfma_f32_16x16x32_bf16 v[136:139], v[40:43], v[36:39], v[136:139]
    s_add_u32 s27, s27, 1
    s_cmp_eq_u32 s27, 5
    s_cselect_b32 s28, -98304, s29
    s_cselect_b32 s27, 0, s27
    v_add_u32 v16, s28, v16
    v_add_u32 v17, s28, v17
    v_mfma_f32_16x16x32_bf16 v[140:143], v[44:47], v[36:39], v[140:143]
    v_add_u32 v18, s28, v18
    v_add_u32 v19, s28, v19
    s_waitcnt vmcnt(0) lgkmcnt(0)
    s_barrier
    v_mfma_f32_16x16x32_bf16 v[128:131], v[88:91], v[80:83], v[128:131]
    ds_read_b64_tr_b16 v[40:41], v18 offset:8192
    ds_read_b64_tr_b16 v[42:43], v18 offset:9216
    v_mfma_f32_16x16x32_bf16 v[132:135], v[92:95], v[80:83], v[132:135]
    ds_read_b64_tr_b16 v[44:45], v19 offset:8192
    v_mfma_f32_16x16x32_bf16 v[136:139], v[88:91], v[84:87], v[136:139]
    ds_read_b64_tr_b16 v[46:47], v19 offset:9216
    ds_read_b128 v[32:35], v16 offset:0
    v_mfma_f32_16x16x32_bf16 v[140:143], v[92:95], v[84:87], v[140:143]
    ds_read_b128 v[36:39], v16 offset:2048
    s_waitcnt lgkmcnt(0)
    v_mfma_f32_16x16x32_bf16 v[128:131], v[40:43], v[32:35], v[128:131]
    ds_read_b64_tr_b16 v[88:89], v18 offset:16384
    ds_read_b64_tr_b16 v[90:91], v18 offset:17408
    ds_read_b64_tr_b16 v[92:93], v19 offset:16384
    v_mfma_f32_16x16x32_bf16 v[132:135], v[44:47], v[32:35], v[132:135]
    ds_read_b64_tr_b16 v[94:95], v19 offset:17408
    ds_read_b128 v[80:83], v17 offset:0
    ds_read_b128 v[84:87], v17 offset:2048
    v_mfma_f32_16x16x32_bf16 v[136:139], v[40:43], v[36:39], v[136:139]
    s_add_u32 s27, s27, 1
    s_cmp_eq_u32 s27, 5
    s_cselect_b32 s28, -98304, s29
    s_cselect_b32 s27, 0, s27
    v_add_u32 v16, s28, v16
    v_add_u32 v17, s28, v17
    v_mfma_f32_16x16x32_bf16 v[140:143], v[44:47], v[36:39], v[140:143]
    v_add_u32 v18, s28, v18
    v_add_u32 v19, s28, v19
    s_waitcnt lgkmcnt(0)
    v_mfma_f32_16x16x32_bf16 v[128:131], v[88:91], v[80:83], v[128:131]
    v_mfma_f32_16x16x32_bf16 v[132:135], v[92:95], v[80:83], v[132:135]
    v_mfma_f32_16x16x32_bf16 v[136:139], v[88:91], v[84:87], v[136:139]
    v_mfma_f32_16x16x32_bf16 v[140:143], v[92:95], v[84:87], v[140:143]
    s_nop 7
LE_T4Q:
    v_mov_b32 v3, 163584
    s_cmp_lg_u32 s26, 0
    s_cbranch_scc1 tt_235
    s_waitcnt vmcnt(0)
    s_mov_b64 exec, 1
    ds_write_b32 v3, v28
    s_waitcnt lgkmcnt(0)
    s_mov_b64 exec, -1
tt_235:
    s_barrier
    ds_read_b32 v5, v3
    s_waitcnt lgkmcnt(0)
    v_readfirstlane_b32 s25, v5
    s_nop 3
    s_min_u32 s3, s25, 204
    s_lshl_b32 s3, s3, 2
    s_load_dword s7, s[50:51], s3
    s_waitcnt lgkmcnt(0)
E_T4Q:
    s_sub_u32 s27, s41, 1408
    s_lshr_b32 s27, s27, 3
    s_lshr_b32 s3, s42, 7
    s_add_u32 s27, s27, s3
    s_lshl_b32 s28, s27, 18
    s_lshr_b32 s3, s26, 1
    s_lshl_b32 s3, s3, 14
    s_add_u32 s28, s28, s3
    s_and_b32 s3, s26, 1
    s_lshl_b32 s3, s3, 12
    s_add_u32 s28, s28, s3
    s_add_u32 s28, s28, 243269632
    s_bfe_u32 s3, s27, 0x10003
    s_lshl_b32 s3, s3, 13
    s_xor_b32 s3, s3, s79
    s_xor_b32 s3, s3, 8192
    s_add_u32 s28, s28, s3
    v_lshlrev_b32 v7, 4, v2
    s_lshl_b32 s38, s43, 16
    s_add_u32 s38, s38, s28
    buffer_store_dwordx4 v[128:131], v7, s[8:11], s38 offen offset:0 sc1
    buffer_store_dwordx4 v[132:135], v7, s[8:11], s38 offen offset:1024 sc1
    buffer_store_dwordx4 v[136:139], v7, s[8:11], s38 offen offset:2048 sc1
    buffer_store_dwordx4 v[140:143], v7, s[8:11], s38 offen offset:3072 sc1
    s_lshl_b32 s40, s27, 7
    s_add_u32 s40, s40, 79726592
    s_waitcnt vmcnt(0)
    s_barrier
    s_cmp_lg_u32 s26, 0
    s_cbranch_scc1 pq_236
    v_mov_b32 v4, s40
    v_mov_b32 v5, 1
    s_mov_b64 exec, 1
    buffer_atomic_add v5, v4, s[8:11], 0 offen sc1
    s_mov_b64 exec, -1
pq_236:
    s_cmp_lg_u32 s26, 0
    s_cbranch_scc1 wf_237
    v_mov_b32 v3, s40
wt_238:
    buffer_load_dword v4, v3, s[8:11], 0 offen sc1
    s_sub_u32 s30, s30, 1
    s_cbranch_scc1 L_end
    s_waitcnt vmcnt(0)
    v_cmp_gt_u32 vcc, 4, v4
    s_cbranch_vccz wf_237
    s_sleep 1
    s_branch wt_238
wf_237:
    s_barrier
    s_lshr_b32 s3, s43, 1
    s_cmp_lg_u32 s3, s44
    s_cbranch_scc1 pe_239
    s_and_b32 s3, s43, 1
    s_lshl_b32 s3, s3, 11
    s_add_u32 s38, s28, s3
    buffer_load_dwordx4 v[48:51], v7, s[8:11], s38 offen offset:0 sc1
    buffer_load_dwordx4 v[52:55], v7, s[8:11], s38 offen offset:1024 sc1
    s_add_u32 s38, s38, 65536
    buffer_load_dwordx4 v[56:59], v7, s[8:11], s38 offen offset:0 sc1
    buffer_load_dwordx4 v[60:63], v7, s[8:11], s38 offen offset:1024 sc1
    s_add_u32 s38, s38, 65536
    buffer_load_dwordx4 v[64:67], v7, s[8:11], s38 offen offset:0 sc1
    buffer_load_dwordx4 v[68:71], v7, s[8:11], s38 offen offset:1024 sc1
    s_add_u32 s38, s38, 65536
    buffer_load_dwordx4 v[72:75], v7, s[8:11], s38 offen offset:0 sc1
    buffer_load_dwordx4 v[76:79], v7, s[8:11], s38 offen offset:1024 sc1
    s_add_u32 s38, s38, 65536
    v_and_b32 v3, 15, v2
    v_lshrrev_b32 v4, 4, v2
    v_lshlrev_b32 v3, 12, v3
    v_lshl_add_u32 v3, v4, 4, v3
    s_lshl_b32 s38, s43, 4
    s_add_u32 s38, s38, s41
    s_lshl_b32 s38, s38, 12
    s_lshl_b32 s3, s45, 5
    s_add_u32 s3, s3, s42
    s_lshl_b32 s3, s3, 1
    s_add_u32 s38, s38, s3
    s_add_u32 s38, s38, 2048
    s_waitcnt vmcnt(0)
    v_pk_add_f32 v[48:49], v[48:49], v[56:57]
    v_pk_add_f32 v[64:65], v[64:65], v[72:73]
    v_pk_add_f32 v[50:51], v[50:51], v[58:59]
    v_pk_add_f32 v[66:67], v[66:67], v[74:75]
    v_pk_add_f32 v[52:53], v[52:53], v[60:61]
    v_pk_add_f32 v[68:69], v[68:69], v[76:77]
    v_pk_add_f32 v[54:55], v[54:55], v[62:63]
    v_pk_add_f32 v[70:71], v[70:71], v[78:79]
    v_pk_add_f32 v[48:49], v[48:49], v[64:65]
    v_pk_add_f32 v[50:51], v[50:51], v[66:67]
    v_pk_add_f32 v[52:53], v[52:53], v[68:69]
    v_pk_add_f32 v[54:55], v[54:55], v[70:71]
    v_cvt_pk_bf16_f32 v40, v48, v49
    v_cvt_pk_bf16_f32 v41, v50, v51
    v_cvt_pk_bf16_f32 v42, v52, v53
    v_cvt_pk_bf16_f32 v43, v54, v55
    buffer_store_dwordx4 v[40:43], v3, s[64:67], s38 offen
pe_239:
    s_waitcnt vmcnt(63)
    s_cmp_lg_u32 s26, 1
    s_cbranch_scc1 sg_240
    s_mov_b64 exec, -1
sg_240:
    s_cmp_eq_u32 s6, 0
    s_cbranch_scc1 D_pre
    s_mov_b32 s6, 0
    s_branch D_main
LP_T7:
    s_mov_b32 s34, 13
    s_mov_b32 s27, 0
    s_waitcnt vmcnt(8)
    s_barrier
    ds_read_b64_tr_b16 v[64:65], v18 offset:32768
    ds_read_b64_tr_b16 v[66:67], v18 offset:34816
    ds_read_b64_tr_b16 v[68:69], v19 offset:32768
    ds_read_b64_tr_b16 v[70:71], v19 offset:34816
    ds_read_b64_tr_b16 v[72:73], v20 offset:32768
    ds_read_b64_tr_b16 v[74:75], v20 offset:34816
    ds_read_b64_tr_b16 v[76:77], v21 offset:32768
    ds_read_b64_tr_b16 v[78:79], v21 offset:34816
    ds_read_b128 v[32:35], v16 offset:0
    ds_read_b128 v[36:39], v16 offset:2048
    ds_read_b128 v[40:43], v16 offset:4096
    ds_read_b128 v[44:47], v16 offset:6144
    ds_read_b128 v[48:51], v16 offset:8192
    ds_read_b128 v[52:55], v16 offset:10240
    ds_read_b128 v[56:59], v16 offset:12288
    ds_read_b128 v[60:63], v16 offset:14336
    s_waitcnt lgkmcnt(0)
    v_mfma_f32_16x16x32_bf16 v[128:131], v[64:67], v[32:35], 0
    ds_read_b64_tr_b16 v[112:113], v18 offset:49152
    v_mfma_f32_16x16x32_bf16 v[132:135], v[68:71], v[32:35], 0
    ds_read_b64_tr_b16 v[114:115], v18 offset:51200
    v_mfma_f32_16x16x32_bf16 v[136:139], v[72:75], v[32:35], 0
    ds_read_b64_tr_b16 v[116:117], v19 offset:49152
    v_mfma_f32_16x16x32_bf16 v[140:143], v[76:79], v[32:35], 0
    ds_read_b64_tr_b16 v[118:119], v19 offset:51200
    v_mfma_f32_16x16x32_bf16 v[144:147], v[64:67], v[36:39], 0
    ds_read_b64_tr_b16 v[120:121], v20 offset:49152
    v_mfma_f32_16x16x32_bf16 v[148:151], v[68:71], v[36:39], 0
    ds_read_b64_tr_b16 v[122:123], v20 offset:51200
    v_mfma_f32_16x16x32_bf16 v[152:155], v[72:75], v[36:39], 0
    ds_read_b64_tr_b16 v[124:125], v21 offset:49152
    v_mfma_f32_16x16x32_bf16 v[156:159], v[76:79], v[36:39], 0
    ds_read_b64_tr_b16 v[126:127], v21 offset:51200
    v_mfma_f32_16x16x32_bf16 v[160:163], v[64:67], v[40:43], 0
    ds_read_b128 v[80:83], v17 offset:0
    v_mfma_f32_16x16x32_bf16 v[164:167], v[68:71], v[40:43], 0
    ds_read_b128 v[84:87], v17 offset:2048
    v_mfma_f32_16x16x32_bf16 v[168:171], v[72:75], v[40:43], 0
    ds_read_b128 v[88:91], v17 offset:4096
    v_mfma_f32_16x16x32_bf16 v[172:175], v[76:79], v[40:43], 0
    ds_read_b128 v[92:95], v17 offset:6144
    v_mfma_f32_16x16x32_bf16 v[176:179], v[64:67], v[44:47], 0
    ds_read_b128 v[96:99], v17 offset:8192
    v_mfma_f32_16x16x32_bf16 v[180:183], v[68:71], v[44:47], 0
    ds_read_b128 v[100:103], v17 offset:10240
    v_mfma_f32_16x16x32_bf16 v[184:187], v[72:75], v[44:47], 0
    ds_read_b128 v[104:107], v17 offset:12288
    v_mfma_f32_16x16x32_bf16 v[188:191], v[76:79], v[44:47], 0
    ds_read_b128 v[108:111], v17 offset:14336
    v_mfma_f32_16x16x32_bf16 v[192:195], v[64:67], v[48:51], 0
    v_xor_b32 v16, 65536, v16
    v_mfma_f32_16x16x32_bf16 v[196:199], v[68:71], v[48:51], 0
    v_xor_b32 v17, 65536, v17
    v_mfma_f32_16x16x32_bf16 v[200:203], v[72:75], v[48:51], 0
    v_xor_b32 v18, 65536, v18
    v_mfma_f32_16x16x32_bf16 v[204:207], v[76:79], v[48:51], 0
    v_xor_b32 v19, 65536, v19
    v_mfma_f32_16x16x32_bf16 v[208:211], v[64:67], v[52:55], 0
    v_xor_b32 v20, 65536, v20
    v_mfma_f32_16x16x32_bf16 v[212:215], v[68:71], v[52:55], 0
    v_xor_b32 v21, 65536, v21
    v_mfma_f32_16x16x32_bf16 v[216:219], v[72:75], v[52:55], 0
    v_mfma_f32_16x16x32_bf16 v[220:223], v[76:79], v[52:55], 0
    v_mfma_f32_16x16x32_bf16 v[224:227], v[64:67], v[56:59], 0
    v_mfma_f32_16x16x32_bf16 v[228:231], v[68:71], v[56:59], 0
    v_mfma_f32_16x16x32_bf16 v[232:235], v[72:75], v[56:59], 0
    v_mfma_f32_16x16x32_bf16 v[236:239], v[76:79], v[56:59], 0
    v_mfma_f32_16x16x32_bf16 v[240:243], v[64:67], v[60:63], 0
    v_mfma_f32_16x16x32_bf16 v[244:247], v[68:71], v[60:63], 0
    v_mfma_f32_16x16x32_bf16 v[248:251], v[72:75], v[60:63], 0
    v_mfma_f32_16x16x32_bf16 v[252:255], v[76:79], v[60:63], 0
    s_waitcnt vmcnt(0) lgkmcnt(0)
    s_barrier
    v_mfma_f32_16x16x32_bf16 v[128:131], v[112:115], v[80:83], v[128:131]
    s_mov_b32 m0, s35
    s_xor_b32 s35, s35, 65536
    v_mfma_f32_16x16x32_bf16 v[132:135], v[116:119], v[80:83], v[132:135]
    ds_read_b64_tr_b16 v[64:65], v18 offset:32768
    v_mfma_f32_16x16x32_bf16 v[136:139], v[120:123], v[80:83], v[136:139]
    buffer_load_dwordx4 v8, s[12:15], s31 offen offset:0 sc1 lds
    v_mfma_f32_16x16x32_bf16 v[140:143], v[124:127], v[80:83], v[140:143]
    ds_read_b64_tr_b16 v[66:67], v18 offset:34816
    v_mfma_f32_16x16x32_bf16 v[144:147], v[112:115], v[84:87], v[144:147]
    buffer_load_dwordx4 v9, s[12:15], s31 offen offset:1024 sc1 lds
    v_mfma_f32_16x16x32_bf16 v[148:151], v[116:119], v[84:87], v[148:151]
    ds_read_b64_tr_b16 v[68:69], v19 offset:32768
    v_mfma_f32_16x16x32_bf16 v[152:155], v[120:123], v[84:87], v[152:155]
    buffer_load_dwordx4 v10, s[12:15], s31 offen offset:2048 sc1 lds
    v_mfma_f32_16x16x32_bf16 v[156:159], v[124:127], v[84:87], v[156:159]
    ds_read_b64_tr_b16 v[70:71], v19 offset:34816
    v_mfma_f32_16x16x32_bf16 v[160:163], v[112:115], v[88:91], v[160:163]
    buffer_load_dwordx4 v11, s[12:15], s31 offen offset:3072 sc1 lds
    v_mfma_f32_16x16x32_bf16 v[164:167], v[116:119], v[88:91], v[164:167]
    ds_read_b64_tr_b16 v[72:73], v20 offset:32768
    v_mfma_f32_16x16x32_bf16 v[168:171], v[120:123], v[88:91], v[168:171]
    s_mov_b32 m0, s36
    s_add_u32 s31, s31, 2048
    s_and_b32 s40, s31, 0x1fff
    s_cselect_b32 s40, 0, 0x2000
    s_add_u32 s31, s31, s40
    s_xor_b32 s36, s36, 65536
    v_mfma_f32_16x16x32_bf16 v[172:175], v[124:127], v[88:91], v[172:175]
    ds_read_b64_tr_b16 v[74:75], v20 offset:34816
    v_mfma_f32_16x16x32_bf16 v[176:179], v[112:115], v[92:95], v[176:179]
    buffer_load_dwordx4 v12, s[16:19], s32 offen offset:0  lds
    v_mfma_f32_16x16x32_bf16 v[180:183], v[116:119], v[92:95], v[180:183]
    ds_read_b64_tr_b16 v[76:77], v21 offset:32768
    v_mfma_f32_16x16x32_bf16 v[184:187], v[120:123], v[92:95], v[184:187]
    buffer_load_dwordx4 v13, s[16:19], s32 offen offset:1024  lds
    v_mfma_f32_16x16x32_bf16 v[188:191], v[124:127], v[92:95], v[188:191]
    ds_read_b64_tr_b16 v[78:79], v21 offset:34816
    v_mfma_f32_16x16x32_bf16 v[192:195], v[112:115], v[96:99], v[192:195]
    buffer_load_dwordx4 v14, s[16:19], s32 offen offset:2048  lds
    v_mfma_f32_16x16x32_bf16 v[196:199], v[116:119], v[96:99], v[196:199]
    ds_read_b128 v[32:35], v16 offset:0
    v_mfma_f32_16x16x32_bf16 v[200:203], v[120:123], v[96:99], v[200:203]
    buffer_load_dwordx4 v15, s[16:19], s32 offen offset:3072  lds
    v_mfma_f32_16x16x32_bf16 v[204:207], v[124:127], v[96:99], v[204:207]
    ds_read_b128 v[36:39], v16 offset:2048
    v_mfma_f32_16x16x32_bf16 v[208:211], v[112:115], v[100:103], v[208:211]
    s_add_u32 s32, s32, s33
    v_mfma_f32_16x16x32_bf16 v[212:215], v[116:119], v[100:103], v[212:215]
    ds_read_b128 v[40:43], v16 offset:4096
    v_mfma_f32_16x16x32_bf16 v[216:219], v[120:123], v[100:103], v[216:219]
    ds_read_b128 v[44:47], v16 offset:6144
    v_mfma_f32_16x16x32_bf16 v[220:223], v[124:127], v[100:103], v[220:223]
    ds_read_b128 v[48:51], v16 offset:8192
    v_mfma_f32_16x16x32_bf16 v[224:227], v[112:115], v[104:107], v[224:227]
    ds_read_b128 v[52:55], v16 offset:10240
    v_mfma_f32_16x16x32_bf16 v[228:231], v[116:119], v[104:107], v[228:231]
    ds_read_b128 v[56:59], v16 offset:12288
    v_mfma_f32_16x16x32_bf16 v[232:235], v[120:123], v[104:107], v[232:235]
    ds_read_b128 v[60:63], v16 offset:14336
    v_mfma_f32_16x16x32_bf16 v[236:239], v[124:127], v[104:107], v[236:239]
    v_mfma_f32_16x16x32_bf16 v[240:243], v[112:115], v[108:111], v[240:243]
    v_mfma_f32_16x16x32_bf16 v[244:247], v[116:119], v[108:111], v[244:247]
    v_mfma_f32_16x16x32_bf16 v[248:251], v[120:123], v[108:111], v[248:251]
    v_mfma_f32_16x16x32_bf16 v[252:255], v[124:127], v[108:111], v[252:255]
gl_249:
    s_waitcnt lgkmcnt(0)
    v_mfma_f32_16x16x32_bf16 v[128:131], v[64:67], v[32:35], v[128:131]
    ds_read_b64_tr_b16 v[112:113], v18 offset:49152
    v_mfma_f32_16x16x32_bf16 v[132:135], v[68:71], v[32:35], v[132:135]
    ds_read_b64_tr_b16 v[114:115], v18 offset:51200
    v_mfma_f32_16x16x32_bf16 v[136:139], v[72:75], v[32:35], v[136:139]
    ds_read_b64_tr_b16 v[116:117], v19 offset:49152
    v_mfma_f32_16x16x32_bf16 v[140:143], v[76:79], v[32:35], v[140:143]
    ds_read_b64_tr_b16 v[118:119], v19 offset:51200
    v_mfma_f32_16x16x32_bf16 v[144:147], v[64:67], v[36:39], v[144:147]
    ds_read_b64_tr_b16 v[120:121], v20 offset:49152
    v_mfma_f32_16x16x32_bf16 v[148:151], v[68:71], v[36:39], v[148:151]
    ds_read_b64_tr_b16 v[122:123], v20 offset:51200
    v_mfma_f32_16x16x32_bf16 v[152:155], v[72:75], v[36:39], v[152:155]
    ds_read_b64_tr_b16 v[124:125], v21 offset:49152
    v_mfma_f32_16x16x32_bf16 v[156:159], v[76:79], v[36:39], v[156:159]
    ds_read_b64_tr_b16 v[126:127], v21 offset:51200
    v_mfma_f32_16x16x32_bf16 v[160:163], v[64:67], v[40:43], v[160:163]
    ds_read_b128 v[80:83], v17 offset:0
    v_mfma_f32_16x16x32_bf16 v[164:167], v[68:71], v[40:43], v[164:167]
    ds_read_b128 v[84:87], v17 offset:2048
    v_mfma_f32_16x16x32_bf16 v[168:171], v[72:75], v[40:43], v[168:171]
    ds_read_b128 v[88:91], v17 offset:4096
    v_mfma_f32_16x16x32_bf16 v[172:175], v[76:79], v[40:43], v[172:175]
    ds_read_b128 v[92:95], v17 offset:6144
    v_mfma_f32_16x16x32_bf16 v[176:179], v[64:67], v[44:47], v[176:179]
    ds_read_b128 v[96:99], v17 offset:8192
    v_mfma_f32_16x16x32_bf16 v[180:183], v[68:71], v[44:47], v[180:183]
    ds_read_b128 v[100:103], v17 offset:10240
    v_mfma_f32_16x16x32_bf16 v[184:187], v[72:75], v[44:47], v[184:187]
    ds_read_b128 v[104:107], v17 offset:12288
    v_mfma_f32_16x16x32_bf16 v[188:191], v[76:79], v[44:47], v[188:191]
    ds_read_b128 v[108:111], v17 offset:14336
    v_mfma_f32_16x16x32_bf16 v[192:195], v[64:67], v[48:51], v[192:195]
    v_xor_b32 v16, 65536, v16
    v_mfma_f32_16x16x32_bf16 v[196:199], v[68:71], v[48:51], v[196:199]
    v_xor_b32 v17, 65536, v17
    v_mfma_f32_16x16x32_bf16 v[200:203], v[72:75], v[48:51], v[200:203]
    v_xor_b32 v18, 65536, v18
    v_mfma_f32_16x16x32_bf16 v[204:207], v[76:79], v[48:51], v[204:207]
    v_xor_b32 v19, 65536, v19
    v_mfma_f32_16x16x32_bf16 v[208:211], v[64:67], v[52:55], v[208:211]
    v_xor_b32 v20, 65536, v20
    v_mfma_f32_16x16x32_bf16 v[212:215], v[68:71], v[52:55], v[212:215]
    v_xor_b32 v21, 65536, v21
    v_mfma_f32_16x16x32_bf16 v[216:219], v[72:75], v[52:55], v[216:219]
    v_mfma_f32_16x16x32_bf16 v[220:223], v[76:79], v[52:55], v[220:223]
    v_mfma_f32_16x16x32_bf16 v[224:227], v[64:67], v[56:59], v[224:227]
    v_mfma_f32_16x16x32_bf16 v[228:231], v[68:71], v[56:59], v[228:231]
    v_mfma_f32_16x16x32_bf16 v[232:235], v[72:75], v[56:59], v[232:235]
    v_mfma_f32_16x16x32_bf16 v[236:239], v[76:79], v[56:59], v[236:239]
    v_mfma_f32_16x16x32_bf16 v[240:243], v[64:67], v[60:63], v[240:243]
    v_mfma_f32_16x16x32_bf16 v[244:247], v[68:71], v[60:63], v[244:247]
    v_mfma_f32_16x16x32_bf16 v[248:251], v[72:75], v[60:63], v[248:251]
    v_mfma_f32_16x16x32_bf16 v[252:255], v[76:79], v[60:63], v[252:255]
    s_waitcnt vmcnt(0) lgkmcnt(0)
    s_barrier
    v_mfma_f32_16x16x32_bf16 v[128:131], v[112:115], v[80:83], v[128:131]
    s_mov_b32 m0, s35
    s_xor_b32 s35, s35, 65536
    v_mfma_f32_16x16x32_bf16 v[132:135], v[116:119], v[80:83], v[132:135]
    ds_read_b64_tr_b16 v[64:65], v18 offset:32768
    v_mfma_f32_16x16x32_bf16 v[136:139], v[120:123], v[80:83], v[136:139]
    buffer_load_dwordx4 v8, s[12:15], s31 offen offset:0 sc1 lds
    v_mfma_f32_16x16x32_bf16 v[140:143], v[124:127], v[80:83], v[140:143]
    ds_read_b64_tr_b16 v[66:67], v18 offset:34816
    v_mfma_f32_16x16x32_bf16 v[144:147], v[112:115], v[84:87], v[144:147]
    buffer_load_dwordx4 v9, s[12:15], s31 offen offset:1024 sc1 lds
    v_mfma_f32_16x16x32_bf16 v[148:151], v[116:119], v[84:87], v[148:151]
    ds_read_b64_tr_b16 v[68:69], v19 offset:32768
    v_mfma_f32_16x16x32_bf16 v[152:155], v[120:123], v[84:87], v[152:155]
    buffer_load_dwordx4 v10, s[12:15], s31 offen offset:2048 sc1 lds
    v_mfma_f32_16x16x32_bf16 v[156:159], v[124:127], v[84:87], v[156:159]
    ds_read_b64_tr_b16 v[70:71], v19 offset:34816
    v_mfma_f32_16x16x32_bf16 v[160:163], v[112:115], v[88:91], v[160:163]
    buffer_load_dwordx4 v11, s[12:15], s31 offen offset:3072 sc1 lds
    v_mfma_f32_16x16x32_bf16 v[164:167], v[116:119], v[88:91], v[164:167]
    ds_read_b64_tr_b16 v[72:73], v20 offset:32768
    v_mfma_f32_16x16x32_bf16 v[168:171], v[120:123], v[88:91], v[168:171]
    s_mov_b32 m0, s36
    s_add_u32 s31, s31, 2048
    s_and_b32 s40, s31, 0x1fff
    s_cselect_b32 s40, 0, 0x2000
    s_add_u32 s31, s31, s40
    s_xor_b32 s36, s36, 65536
    v_mfma_f32_16x16x32_bf16 v[172:175], v[124:127], v[88:91], v[172:175]
    ds_read_b64_tr_b16 v[74:75], v20 offset:34816
    v_mfma_f32_16x16x32_bf16 v[176:179], v[112:115], v[92:95], v[176:179]
    buffer_load_dwordx4 v12, s[16:19], s32 offen offset:0  lds
    v_mfma_f32_16x16x32_bf16 v[180:183], v[116:119], v[92:95], v[180:183]
    ds_read_b64_tr_b16 v[76:77], v21 offset:32768
    v_mfma_f32_16x16x32_bf16 v[184:187], v[120:123], v[92:95], v[184:187]
    buffer_load_dwordx4 v13, s[16:19], s32 offen offset:1024  lds
    v_mfma_f32_16x16x32_bf16 v[188:191], v[124:127], v[92:95], v[188:191]
    ds_read_b64_tr_b16 v[78:79], v21 offset:34816
    v_mfma_f32_16x16x32_bf16 v[192:195], v[112:115], v[96:99], v[192:195]
    buffer_load_dwordx4 v14, s[16:19], s32 offen offset:2048  lds
    v_mfma_f32_16x16x32_bf16 v[196:199], v[116:119], v[96:99], v[196:199]
    ds_read_b128 v[32:35], v16 offset:0
    v_mfma_f32_16x16x32_bf16 v[200:203], v[120:123], v[96:99], v[200:203]
    buffer_load_dwordx4 v15, s[16:19], s32 offen offset:3072  lds
    v_mfma_f32_16x16x32_bf16 v[204:207], v[124:127], v[96:99], v[204:207]
    ds_read_b128 v[36:39], v16 offset:2048
    v_mfma_f32_16x16x32_bf16 v[208:211], v[112:115], v[100:103], v[208:211]
    s_add_u32 s32, s32, s33
    v_mfma_f32_16x16x32_bf16 v[212:215], v[116:119], v[100:103], v[212:215]
    ds_read_b128 v[40:43], v16 offset:4096
    v_mfma_f32_16x16x32_bf16 v[216:219], v[120:123], v[100:103], v[216:219]
    ds_read_b128 v[44:47], v16 offset:6144
    v_mfma_f32_16x16x32_bf16 v[220:223], v[124:127], v[100:103], v[220:223]
    ds_read_b128 v[48:51], v16 offset:8192
    v_mfma_f32_16x16x32_bf16 v[224:227], v[112:115], v[104:107], v[224:227]
    ds_read_b128 v[52:55], v16 offset:10240
    v_mfma_f32_16x16x32_bf16 v[228:231], v[116:119], v[104:107], v[228:231]
    ds_read_b128 v[56:59], v16 offset:12288
    v_mfma_f32_16x16x32_bf16 v[232:235], v[120:123], v[104:107], v[232:235]
    ds_read_b128 v[60:63], v16 offset:14336
    v_mfma_f32_16x16x32_bf16 v[236:239], v[124:127], v[104:107], v[236:239]
    v_mfma_f32_16x16x32_bf16 v[240:243], v[112:115], v[108:111], v[240:243]
    v_mfma_f32_16x16x32_bf16 v[244:247], v[116:119], v[108:111], v[244:247]
    v_mfma_f32_16x16x32_bf16 v[248:251], v[120:123], v[108:111], v[248:251]
    v_mfma_f32_16x16x32_bf16 v[252:255], v[124:127], v[108:111], v[252:255]
    s_sub_u32 s34, s34, 1
    s_cmp_lg_u32 s34, 0
    s_cbranch_scc1 gl_249
    s_cmp_lg_u32 s26, 0
    s_cbranch_scc1 ti_250
    s_lshl_b32 s3, s43, 2
    s_add_u32 s3, s3, 16
    v_mov_b32 v27, s3
    v_mov_b32 v28, 1
    s_mov_b64 exec, 1
    buffer_atomic_add v28, v27, s[20:23], 0 offen sc0 sc1
    s_mov_b64 exec, -1
ti_250:
    s_waitcnt lgkmcnt(0)
    v_mfma_f32_16x16x32_bf16 v[128:131], v[64:67], v[32:35], v[128:131]
    ds_read_b64_tr_b16 v[112:113], v18 offset:49152
    v_mfma_f32_16x16x32_bf16 v[132:135], v[68:71], v[32:35], v[132:135]
    ds_read_b64_tr_b16 v[114:115], v18 offset:51200
    v_mfma_f32_16x16x32_bf16 v[136:139], v[72:75], v[32:35], v[136:139]
    ds_read_b64_tr_b16 v[116:117], v19 offset:49152
    v_mfma_f32_16x16x32_bf16 v[140:143], v[76:79], v[32:35], v[140:143]
    ds_read_b64_tr_b16 v[118:119], v19 offset:51200
    v_mfma_f32_16x16x32_bf16 v[144:147], v[64:67], v[36:39], v[144:147]
    ds_read_b64_tr_b16 v[120:121], v20 offset:49152
    v_mfma_f32_16x16x32_bf16 v[148:151], v[68:71], v[36:39], v[148:151]
    ds_read_b64_tr_b16 v[122:123], v20 offset:51200
    v_mfma_f32_16x16x32_bf16 v[152:155], v[72:75], v[36:39], v[152:155]
    ds_read_b64_tr_b16 v[124:125], v21 offset:49152
    v_mfma_f32_16x16x32_bf16 v[156:159], v[76:79], v[36:39], v[156:159]
    ds_read_b64_tr_b16 v[126:127], v21 offset:51200
    v_mfma_f32_16x16x32_bf16 v[160:163], v[64:67], v[40:43], v[160:163]
    ds_read_b128 v[80:83], v17 offset:0
    v_mfma_f32_16x16x32_bf16 v[164:167], v[68:71], v[40:43], v[164:167]
    ds_read_b128 v[84:87], v17 offset:2048
    v_mfma_f32_16x16x32_bf16 v[168:171], v[72:75], v[40:43], v[168:171]
    ds_read_b128 v[88:91], v17 offset:4096
    v_mfma_f32_16x16x32_bf16 v[172:175], v[76:79], v[40:43], v[172:175]
    ds_read_b128 v[92:95], v17 offset:6144
    v_mfma_f32_16x16x32_bf16 v[176:179], v[64:67], v[44:47], v[176:179]
    ds_read_b128 v[96:99], v17 offset:8192
    v_mfma_f32_16x16x32_bf16 v[180:183], v[68:71], v[44:47], v[180:183]
    ds_read_b128 v[100:103], v17 offset:10240
    v_mfma_f32_16x16x32_bf16 v[184:187], v[72:75], v[44:47], v[184:187]
    ds_read_b128 v[104:107], v17 offset:12288
    v_mfma_f32_16x16x32_bf16 v[188:191], v[76:79], v[44:47], v[188:191]
    ds_read_b128 v[108:111], v17 offset:14336
    v_mfma_f32_16x16x32_bf16 v[192:195], v[64:67], v[48:51], v[192:195]
    v_xor_b32 v16, 65536, v16
    v_mfma_f32_16x16x32_bf16 v[196:199], v[68:71], v[48:51], v[196:199]
    v_xor_b32 v17, 65536, v17
    v_mfma_f32_16x16x32_bf16 v[200:203], v[72:75], v[48:51], v[200:203]
    v_xor_b32 v18, 65536, v18
    v_mfma_f32_16x16x32_bf16 v[204:207], v[76:79], v[48:51], v[204:207]
    v_xor_b32 v19, 65536, v19
    v_mfma_f32_16x16x32_bf16 v[208:211], v[64:67], v[52:55], v[208:211]
    v_xor_b32 v20, 65536, v20
    v_mfma_f32_16x16x32_bf16 v[212:215], v[68:71], v[52:55], v[212:215]
    v_xor_b32 v21, 65536, v21
    v_mfma_f32_16x16x32_bf16 v[216:219], v[72:75], v[52:55], v[216:219]
    v_mfma_f32_16x16x32_bf16 v[220:223], v[76:79], v[52:55], v[220:223]
    v_mfma_f32_16x16x32_bf16 v[224:227], v[64:67], v[56:59], v[224:227]
    v_mfma_f32_16x16x32_bf16 v[228:231], v[68:71], v[56:59], v[228:231]
    v_mfma_f32_16x16x32_bf16 v[232:235], v[72:75], v[56:59], v[232:235]
    v_mfma_f32_16x16x32_bf16 v[236:239], v[76:79], v[56:59], v[236:239]
    v_mfma_f32_16x16x32_bf16 v[240:243], v[64:67], v[60:63], v[240:243]
    v_mfma_f32_16x16x32_bf16 v[244:247], v[68:71], v[60:63], v[244:247]
    v_mfma_f32_16x16x32_bf16 v[248:251], v[72:75], v[60:63], v[248:251]
    v_mfma_f32_16x16x32_bf16 v[252:255], v[76:79], v[60:63], v[252:255]
    s_waitcnt vmcnt(0) lgkmcnt(0)
    s_barrier
    v_mfma_f32_16x16x32_bf16 v[128:131], v[112:115], v[80:83], v[128:131]
    ds_read_b64_tr_b16 v[64:65], v18 offset:32768
    v_mfma_f32_16x16x32_bf16 v[132:135], v[116:119], v[80:83], v[132:135]
    ds_read_b64_tr_b16 v[66:67], v18 offset:34816
    v_mfma_f32_16x16x32_bf16 v[136:139], v[120:123], v[80:83], v[136:139]
    ds_read_b64_tr_b16 v[68:69], v19 offset:32768
    v_mfma_f32_16x16x32_bf16 v[140:143], v[124:127], v[80:83], v[140:143]
    ds_read_b64_tr_b16 v[70:71], v19 offset:34816
    v_mfma_f32_16x16x32_bf16 v[144:147], v[112:115], v[84:87], v[144:147]
    ds_read_b64_tr_b16 v[72:73], v20 offset:32768
    v_mfma_f32_16x16x32_bf16 v[148:151], v[116:119], v[84:87], v[148:151]
    ds_read_b64_tr_b16 v[74:75], v20 offset:34816
    v_mfma_f32_16x16x32_bf16 v[152:155], v[120:123], v[84:87], v[152:155]
    ds_read_b64_tr_b16 v[76:77], v21 offset:32768
    v_mfma_f32_16x16x32_bf16 v[156:159], v[124:127], v[84:87], v[156:159]
    ds_read_b64_tr_b16 v[78:79], v21 offset:34816
    v_mfma_f32_16x16x32_bf16 v[160:163], v[112:115], v[88:91], v[160:163]
    ds_read_b128 v[32:35], v16 offset:0
    v_mfma_f32_16x16x32_bf16 v[164:167], v[116:119], v[88:91], v[164:167]
    ds_read_b128 v[36:39], v16 offset:2048
    v_mfma_f32_16x16x32_bf16 v[168:171], v[120:123], v[88:91], v[168:171]
    ds_read_b128 v[40:43], v16 offset:4096
    v_mfma_f32_16x16x32_bf16 v[172:175], v[124:127], v[88:91], v[172:175]
    ds_read_b128 v[44:47], v16 offset:6144
    v_mfma_f32_16x16x32_bf16 v[176:179], v[112:115], v[92:95], v[176:179]
    ds_read_b128 v[48:51], v16 offset:8192
    v_mfma_f32_16x16x32_bf16 v[180:183], v[116:119], v[92:95], v[180:183]
    ds_read_b128 v[52:55], v16 offset:10240
    v_mfma_f32_16x16x32_bf16 v[184:187], v[120:123], v[92:95], v[184:187]
    ds_read_b128 v[56:59], v16 offset:12288
    v_mfma_f32_16x16x32_bf16 v[188:191], v[124:127], v[92:95], v[188:191]
    ds_read_b128 v[60:63], v16 offset:14336
    v_mfma_f32_16x16x32_bf16 v[192:195], v[112:115], v[96:99], v[192:195]
    v_mfma_f32_16x16x32_bf16 v[196:199], v[116:119], v[96:99], v[196:199]
    v_mfma_f32_16x16x32_bf16 v[200:203], v[120:123], v[96:99], v[200:203]
    v_mfma_f32_16x16x32_bf16 v[204:207], v[124:127], v[96:99], v[204:207]
    v_mfma_f32_16x16x32_bf16 v[208:211], v[112:115], v[100:103], v[208:211]
    v_mfma_f32_16x16x32_bf16 v[212:215], v[116:119], v[100:103], v[212:215]
    v_mfma_f32_16x16x32_bf16 v[216:219], v[120:123], v[100:103], v[216:219]
    v_mfma_f32_16x16x32_bf16 v[220:223], v[124:127], v[100:103], v[220:223]
    v_mfma_f32_16x16x32_bf16 v[224:227], v[112:115], v[104:107], v[224:227]
    v_mfma_f32_16x16x32_bf16 v[228:231], v[116:119], v[104:107], v[228:231]
    v_mfma_f32_16x16x32_bf16 v[232:235], v[120:123], v[104:107], v[232:235]
    v_mfma_f32_16x16x32_bf16 v[236:239], v[124:127], v[104:107], v[236:239]
    v_mfma_f32_16x16x32_bf16 v[240:243], v[112:115], v[108:111], v[240:243]
    v_mfma_f32_16x16x32_bf16 v[244:247], v[116:119], v[108:111], v[244:247]
    v_mfma_f32_16x16x32_bf16 v[248:251], v[120:123], v[108:111], v[248:251]
    v_mfma_f32_16x16x32_bf16 v[252:255], v[124:127], v[108:111], v[252:255]
    s_waitcnt lgkmcnt(0)
    v_mfma_f32_16x16x32_bf16 v[128:131], v[64:67], v[32:35], v[128:131]
    ds_read_b64_tr_b16 v[112:113], v18 offset:49152
    v_mfma_f32_16x16x32_bf16 v[132:135], v[68:71], v[32:35], v[132:135]
    ds_read_b64_tr_b16 v[114:115], v18 offset:51200
    v_mfma_f32_16x16x32_bf16 v[136:139], v[72:75], v[32:35], v[136:139]
    ds_read_b64_tr_b16 v[116:117], v19 offset:49152
    v_mfma_f32_16x16x32_bf16 v[140:143], v[76:79], v[32:35], v[140:143]
    ds_read_b64_tr_b16 v[118:119], v19 offset:51200
    v_mfma_f32_16x16x32_bf16 v[144:147], v[64:67], v[36:39], v[144:147]
    ds_read_b64_tr_b16 v[120:121], v20 offset:49152
    v_mfma_f32_16x16x32_bf16 v[148:151], v[68:71], v[36:39], v[148:151]
    ds_read_b64_tr_b16 v[122:123], v20 offset:51200
    v_mfma_f32_16x16x32_bf16 v[152:155], v[72:75], v[36:39], v[152:155]
    ds_read_b64_tr_b16 v[124:125], v21 offset:49152
    v_mfma_f32_16x16x32_bf16 v[156:159], v[76:79], v[36:39], v[156:159]
    ds_read_b64_tr_b16 v[126:127], v21 offset:51200
    v_mfma_f32_16x16x32_bf16 v[160:163], v[64:67], v[40:43], v[160:163]
    ds_read_b128 v[80:83], v17 offset:0
    v_mfma_f32_16x16x32_bf16 v[164:167], v[68:71], v[40:43], v[164:167]
    ds_read_b128 v[84:87], v17 offset:2048
    v_mfma_f32_16x16x32_bf16 v[168:171], v[72:75], v[40:43], v[168:171]
    ds_read_b128 v[88:91], v17 offset:4096
    v_mfma_f32_16x16x32_bf16 v[172:175], v[76:79], v[40:43], v[172:175]
    ds_read_b128 v[92:95], v17 offset:6144
    v_mfma_f32_16x16x32_bf16 v[176:179], v[64:67], v[44:47], v[176:179]
    ds_read_b128 v[96:99], v17 offset:8192
    v_mfma_f32_16x16x32_bf16 v[180:183], v[68:71], v[44:47], v[180:183]
    ds_read_b128 v[100:103], v17 offset:10240
    v_mfma_f32_16x16x32_bf16 v[184:187], v[72:75], v[44:47], v[184:187]
    ds_read_b128 v[104:107], v17 offset:12288
    v_mfma_f32_16x16x32_bf16 v[188:191], v[76:79], v[44:47], v[188:191]
    ds_read_b128 v[108:111], v17 offset:14336
    v_mfma_f32_16x16x32_bf16 v[192:195], v[64:67], v[48:51], v[192:195]
    v_xor_b32 v16, 65536, v16
    v_mfma_f32_16x16x32_bf16 v[196:199], v[68:71], v[48:51], v[196:199]
    v_xor_b32 v17, 65536, v17
    v_mfma_f32_16x16x32_bf16 v[200:203], v[72:75], v[48:51], v[200:203]
    v_xor_b32 v18, 65536, v18
    v_mfma_f32_16x16x32_bf16 v[204:207], v[76:79], v[48:51], v[204:207]
    v_xor_b32 v19, 65536, v19
    v_mfma_f32_16x16x32_bf16 v[208:211], v[64:67], v[52:55], v[208:211]
    v_xor_b32 v20, 65536, v20
    v_mfma_f32_16x16x32_bf16 v[212:215], v[68:71], v[52:55], v[212:215]
    v_xor_b32 v21, 65536, v21
    v_mfma_f32_16x16x32_bf16 v[216:219], v[72:75], v[52:55], v[216:219]
    v_mfma_f32_16x16x32_bf16 v[220:223], v[76:79], v[52:55], v[220:223]
    v_mfma_f32_16x16x32_bf16 v[224:227], v[64:67], v[56:59], v[224:227]
    v_mfma_f32_16x16x32_bf16 v[228:231], v[68:71], v[56:59], v[228:231]
    v_mfma_f32_16x16x32_bf16 v[232:235], v[72:75], v[56:59], v[232:235]
    v_mfma_f32_16x16x32_bf16 v[236:239], v[76:79], v[56:59], v[236:239]
    v_mfma_f32_16x16x32_bf16 v[240:243], v[64:67], v[60:63], v[240:243]
    v_mfma_f32_16x16x32_bf16 v[244:247], v[68:71], v[60:63], v[244:247]
    v_mfma_f32_16x16x32_bf16 v[248:251], v[72:75], v[60:63], v[248:251]
    v_mfma_f32_16x16x32_bf16 v[252:255], v[76:79], v[60:63], v[252:255]
    s_waitcnt lgkmcnt(0)
    v_mfma_f32_16x16x32_bf16 v[128:131], v[112:115], v[80:83], v[128:131]
    v_mfma_f32_16x16x32_bf16 v[132:135], v[116:119], v[80:83], v[132:135]
    v_mfma_f32_16x16x32_bf16 v[136:139], v[120:123], v[80:83], v[136:139]
    v_mfma_f32_16x16x32_bf16 v[140:143], v[124:127], v[80:83], v[140:143]
    v_mfma_f32_16x16x32_bf16 v[144:147], v[112:115], v[84:87], v[144:147]
    v_mfma_f32_16x16x32_bf16 v[148:151], v[116:119], v[84:87], v[148:151]
    v_mfma_f32_16x16x32_bf16 v[152:155], v[120:123], v[84:87], v[152:155]
    v_mfma_f32_16x16x32_bf16 v[156:159], v[124:127], v[84:87], v[156:159]
    v_mfma_f32_16x16x32_bf16 v[160:163], v[112:115], v[88:91], v[160:163]
    v_mfma_f32_16x16x32_bf16 v[164:167], v[116:119], v[88:91], v[164:167]
    v_mfma_f32_16x16x32_bf16 v[168:171], v[120:123], v[88:91], v[168:171]
    v_mfma_f32_16x16x32_bf16 v[172:175], v[124:127], v[88:91], v[172:175]
    v_mfma_f32_16x16x32_bf16 v[176:179], v[112:115], v[92:95], v[176:179]
    v_mfma_f32_16x16x32_bf16 v[180:183], v[116:119], v[92:95], v[180:183]
    v_mfma_f32_16x16x32_bf16 v[184:187], v[120:123], v[92:95], v[184:187]
    v_mfma_f32_16x16x32_bf16 v[188:191], v[124:127], v[92:95], v[188:191]
    v_mfma_f32_16x16x32_bf16 v[192:195], v[112:115], v[96:99], v[192:195]
    v_mfma_f32_16x16x32_bf16 v[196:199], v[116:119], v[96:99], v[196:199]
    v_mfma_f32_16x16x32_bf16 v[200:203], v[120:123], v[96:99], v[200:203]
    v_mfma_f32_16x16x32_bf16 v[204:207], v[124:127], v[96:99], v[204:207]
    v_mfma_f32_16x16x32_bf16 v[208:211], v[112:115], v[100:103], v[208:211]
    v_mfma_f32_16x16x32_bf16 v[212:215], v[116:119], v[100:103], v[212:215]
    v_mfma_f32_16x16x32_bf16 v[216:219], v[120:123], v[100:103], v[216:219]
    v_mfma_f32_16x16x32_bf16 v[220:223], v[124:127], v[100:103], v[220:223]
    v_mfma_f32_16x16x32_bf16 v[224:227], v[112:115], v[104:107], v[224:227]
    v_mfma_f32_16x16x32_bf16 v[228:231], v[116:119], v[104:107], v[228:231]
    v_mfma_f32_16x16x32_bf16 v[232:235], v[120:123], v[104:107], v[232:235]
    v_mfma_f32_16x16x32_bf16 v[236:239], v[124:127], v[104:107], v[236:239]
    v_mfma_f32_16x16x32_bf16 v[240:243], v[112:115], v[108:111], v[240:243]
    v_mfma_f32_16x16x32_bf16 v[244:247], v[116:119], v[108:111], v[244:247]
    v_mfma_f32_16x16x32_bf16 v[248:251], v[120:123], v[108:111], v[248:251]
    v_mfma_f32_16x16x32_bf16 v[252:255], v[124:127], v[108:111], v[252:255]
    s_nop 7
LE_T7:
    v_mov_b32 v3, 163584
    s_cmp_lg_u32 s26, 0
    s_cbranch_scc1 tt_251
    s_waitcnt vmcnt(0)
    s_mov_b64 exec, 1
    ds_write_b32 v3, v28
    s_waitcnt lgkmcnt(0)
    s_mov_b64 exec, -1
tt_251:
    s_barrier
    ds_read_b32 v5, v3
    s_waitcnt lgkmcnt(0)
    v_readfirstlane_b32 s25, v5
    s_nop 3
    s_min_u32 s3, s25, 204
    s_lshl_b32 s3, s3, 2
    s_load_dword s7, s[50:51], s3
    s_waitcnt lgkmcnt(0)
E_T7:
    v_and_b32 v3, 15, v2
    v_lshrrev_b32 v4, 4, v2
    v_mul_u32_u24 v3, 4096, v3
    v_lshl_add_u32 v7, v4, 4, v3
    s_mul_i32 s38, s44, 128
    s_add_u32 s38, s38, s41
    s_mul_i32 s38, s38, 4096
    s_mul_i32 s39, s45, 64
    s_add_u32 s39, s39, s42
    s_lshl_b32 s39, s39, 1
    s_add_u32 s38, s38, s39
    s_add_u32 s38, s38, 0
    v_cvt_pk_bf16_f32 v32, v128, v129
    v_cvt_pk_bf16_f32 v33, v130, v131
    v_cvt_pk_bf16_f32 v34, v132, v133
    v_cvt_pk_bf16_f32 v35, v134, v135
    buffer_store_dwordx4 v[32:35], v7, s[64:67], s38 offen offset:0
    v_cvt_pk_bf16_f32 v36, v136, v137
    v_cvt_pk_bf16_f32 v37, v138, v139
    v_cvt_pk_bf16_f32 v38, v140, v141
    v_cvt_pk_bf16_f32 v39, v142, v143
    buffer_store_dwordx4 v[36:39], v7, s[64:67], s38 offen offset:64
    s_add_u32 s38, s38, 65536
    v_cvt_pk_bf16_f32 v40, v144, v145
    v_cvt_pk_bf16_f32 v41, v146, v147
    v_cvt_pk_bf16_f32 v42, v148, v149
    v_cvt_pk_bf16_f32 v43, v150, v151
    buffer_store_dwordx4 v[40:43], v7, s[64:67], s38 offen offset:0
    v_cvt_pk_bf16_f32 v44, v152, v153
    v_cvt_pk_bf16_f32 v45, v154, v155
    v_cvt_pk_bf16_f32 v46, v156, v157
    v_cvt_pk_bf16_f32 v47, v158, v159
    buffer_store_dwordx4 v[44:47], v7, s[64:67], s38 offen offset:64
    s_add_u32 s38, s38, 65536
    v_cvt_pk_bf16_f32 v48, v160, v161
    v_cvt_pk_bf16_f32 v49, v162, v163
    v_cvt_pk_bf16_f32 v50, v164, v165
    v_cvt_pk_bf16_f32 v51, v166, v167
    buffer_store_dwordx4 v[48:51], v7, s[64:67], s38 offen offset:0
    v_cvt_pk_bf16_f32 v52, v168, v169
    v_cvt_pk_bf16_f32 v53, v170, v171
    v_cvt_pk_bf16_f32 v54, v172, v173
    v_cvt_pk_bf16_f32 v55, v174, v175
    buffer_store_dwordx4 v[52:55], v7, s[64:67], s38 offen offset:64
    s_add_u32 s38, s38, 65536
    v_cvt_pk_bf16_f32 v56, v176, v177
    v_cvt_pk_bf16_f32 v57, v178, v179
    v_cvt_pk_bf16_f32 v58, v180, v181
    v_cvt_pk_bf16_f32 v59, v182, v183
    buffer_store_dwordx4 v[56:59], v7, s[64:67], s38 offen offset:0
    v_cvt_pk_bf16_f32 v60, v184, v185
    v_cvt_pk_bf16_f32 v61, v186, v187
    v_cvt_pk_bf16_f32 v62, v188, v189
    v_cvt_pk_bf16_f32 v63, v190, v191
    buffer_store_dwordx4 v[60:63], v7, s[64:67], s38 offen offset:64
    s_add_u32 s38, s38, 65536
    v_cvt_pk_bf16_f32 v32, v192, v193
    v_cvt_pk_bf16_f32 v33, v194, v195
    v_cvt_pk_bf16_f32 v34, v196, v197
    v_cvt_pk_bf16_f32 v35, v198, v199
    buffer_store_dwordx4 v[32:35], v7, s[64:67], s38 offen offset:0
    v_cvt_pk_bf16_f32 v36, v200, v201
    v_cvt_pk_bf16_f32 v37, v202, v203
    v_cvt_pk_bf16_f32 v38, v204, v205
    v_cvt_pk_bf16_f32 v39, v206, v207
    buffer_store_dwordx4 v[36:39], v7, s[64:67], s38 offen offset:64
    s_add_u32 s38, s38, 65536
    v_cvt_pk_bf16_f32 v40, v208, v209
    v_cvt_pk_bf16_f32 v41, v210, v211
    v_cvt_pk_bf16_f32 v42, v212, v213
    v_cvt_pk_bf16_f32 v43, v214, v215
    buffer_store_dwordx4 v[40:43], v7, s[64:67], s38 offen offset:0
    v_cvt_pk_bf16_f32 v44, v216, v217
    v_cvt_pk_bf16_f32 v45, v218, v219
    v_cvt_pk_bf16_f32 v46, v220, v221
    v_cvt_pk_bf16_f32 v47, v222, v223
    buffer_store_dwordx4 v[44:47], v7, s[64:67], s38 offen offset:64
    s_add_u32 s38, s38, 65536
    v_cvt_pk_bf16_f32 v48, v224, v225
    v_cvt_pk_bf16_f32 v49, v226, v227
    v_cvt_pk_bf16_f32 v50, v228, v229
    v_cvt_pk_bf16_f32 v51, v230, v231
    buffer_store_dwordx4 v[48:51], v7, s[64:67], s38 offen offset:0
    v_cvt_pk_bf16_f32 v52, v232, v233
    v_cvt_pk_bf16_f32 v53, v234, v235
    v_cvt_pk_bf16_f32 v54, v236, v237
    v_cvt_pk_bf16_f32 v55, v238, v239
    buffer_store_dwordx4 v[52:55], v7, s[64:67], s38 offen offset:64
    s_add_u32 s38, s38, 65536
    v_cvt_pk_bf16_f32 v56, v240, v241
    v_cvt_pk_bf16_f32 v57, v242, v243
    v_cvt_pk_bf16_f32 v58, v244, v245
    v_cvt_pk_bf16_f32 v59, v246, v247
    buffer_store_dwordx4 v[56:59], v7, s[64:67], s38 offen offset:0
    v_cvt_pk_bf16_f32 v60, v248, v249
    v_cvt_pk_bf16_f32 v61, v250, v251
    v_cvt_pk_bf16_f32 v62, v252, v253
    v_cvt_pk_bf16_f32 v63, v254, v255
    buffer_store_dwordx4 v[60:63], v7, s[64:67], s38 offen offset:64
    s_add_u32 s38, s38, 65536
    s_waitcnt vmcnt(63)
    s_cmp_lg_u32 s26, 1
    s_cbranch_scc1 sg_252
    s_mov_b64 exec, -1
sg_252:
    s_cmp_eq_u32 s6, 0
    s_cbranch_scc1 D_pre
    s_mov_b32 s6, 0
    s_branch D_main
LP_QT:
    s_mov_b32 s34, 13
    s_mov_b32 s27, 0
    s_waitcnt vmcnt(8)
    s_barrier
    ds_read_b64_tr_b16 v[48:49], v18 offset:32768
    ds_read_b64_tr_b16 v[50:51], v18 offset:34816
    ds_read_b64_tr_b16 v[52:53], v19 offset:32768
    ds_read_b64_tr_b16 v[54:55], v19 offset:34816
    ds_read_b64_tr_b16 v[56:57], v20 offset:32768
    ds_read_b64_tr_b16 v[58:59], v20 offset:34816
    ds_read_b64_tr_b16 v[60:61], v21 offset:32768
    ds_read_b64_tr_b16 v[62:63], v21 offset:34816
    ds_read_b64_tr_b16 v[64:65], v22 offset:32768
    ds_read_b64_tr_b16 v[66:67], v22 offset:34816
    ds_read_b64_tr_b16 v[68:69], v23 offset:32768
    ds_read_b64_tr_b16 v[70:71], v23 offset:34816
    ds_read_b64_tr_b16 v[72:73], v24 offset:32768
    ds_read_b64_tr_b16 v[74:75], v24 offset:34816
    ds_read_b64_tr_b16 v[76:77], v25 offset:32768
    ds_read_b64_tr_b16 v[78:79], v25 offset:34816
    ds_read_b128 v[32:35], v16 offset:0
    ds_read_b128 v[36:39], v16 offset:2048
    ds_read_b128 v[40:43], v16 offset:16384
    ds_read_b128 v[44:47], v16 offset:18432
    s_waitcnt lgkmcnt(0)
    v_mfma_f32_16x16x32_bf16 v[128:131], v[48:51], v[32:35], 0
    ds_read_b64_tr_b16 v[96:97], v18 offset:49152
    v_mfma_f32_16x16x32_bf16 v[132:135], v[52:55], v[32:35], 0
    ds_read_b64_tr_b16 v[98:99], v18 offset:51200
    v_mfma_f32_16x16x32_bf16 v[136:139], v[56:59], v[32:35], 0
    ds_read_b64_tr_b16 v[100:101], v19 offset:49152
    v_mfma_f32_16x16x32_bf16 v[140:143], v[60:63], v[32:35], 0
    ds_read_b64_tr_b16 v[102:103], v19 offset:51200
    v_mfma_f32_16x16x32_bf16 v[144:147], v[64:67], v[32:35], 0
    ds_read_b64_tr_b16 v[104:105], v20 offset:49152
    v_mfma_f32_16x16x32_bf16 v[148:151], v[68:71], v[32:35], 0
    ds_read_b64_tr_b16 v[106:107], v20 offset:51200
    v_mfma_f32_16x16x32_bf16 v[152:155], v[72:75], v[32:35], 0
    ds_read_b64_tr_b16 v[108:109], v21 offset:49152
    v_mfma_f32_16x16x32_bf16 v[156:159], v[76:79], v[32:35], 0
    ds_read_b64_tr_b16 v[110:111], v21 offset:51200
    v_mfma_f32_16x16x32_bf16 v[160:163], v[48:51], v[36:39], 0
    ds_read_b64_tr_b16 v[112:113], v22 offset:49152
    v_mfma_f32_16x16x32_bf16 v[164:167], v[52:55], v[36:39], 0
    ds_read_b64_tr_b16 v[114:115], v22 offset:51200
    v_mfma_f32_16x16x32_bf16 v[168:171], v[56:59], v[36:39], 0
    ds_read_b64_tr_b16 v[116:117], v23 offset:49152
    v_mfma_f32_16x16x32_bf16 v[172:175], v[60:63], v[36:39], 0
    ds_read_b64_tr_b16 v[118:119], v23 offset:51200
    v_mfma_f32_16x16x32_bf16 v[176:179], v[64:67], v[36:39], 0
    ds_read_b64_tr_b16 v[120:121], v24 offset:49152
    v_mfma_f32_16x16x32_bf16 v[180:183], v[68:71], v[36:39], 0
    ds_read_b64_tr_b16 v[122:123], v24 offset:51200
    v_mfma_f32_16x16x32_bf16 v[184:187], v[72:75], v[36:39], 0
    ds_read_b64_tr_b16 v[124:125], v25 offset:49152
    v_mfma_f32_16x16x32_bf16 v[188:191], v[76:79], v[36:39], 0
    ds_read_b64_tr_b16 v[126:127], v25 offset:51200
    v_mfma_f32_16x16x32_bf16 v[192:195], v[48:51], v[40:43], 0
    ds_read_b128 v[80:83], v17 offset:0
    v_mfma_f32_16x16x32_bf16 v[196:199], v[52:55], v[40:43], 0
    ds_read_b128 v[84:87], v17 offset:2048
    v_mfma_f32_16x16x32_bf16 v[200:203], v[56:59], v[40:43], 0
    ds_read_b128 v[88:91], v17 offset:16384
    v_mfma_f32_16x16x32_bf16 v[204:207], v[60:63], v[40:43], 0
    ds_read_b128 v[92:95], v17 offset:18432
    v_mfma_f32_16x16x32_bf16 v[208:211], v[64:67], v[40:43], 0
    v_xor_b32 v16, 65536, v16
    v_mfma_f32_16x16x32_bf16 v[212:215], v[68:71], v[40:43], 0
    v_xor_b32 v17, 65536, v17
    v_mfma_f32_16x16x32_bf16 v[216:219], v[72:75], v[40:43], 0
    v_xor_b32 v18, 65536, v18
    v_mfma_f32_16x16x32_bf16 v[220:223], v[76:79], v[40:43], 0
    v_xor_b32 v19, 65536, v19
    v_mfma_f32_16x16x32_bf16 v[224:227], v[48:51], v[44:47], 0
    v_xor_b32 v20, 65536, v20
    v_mfma_f32_16x16x32_bf16 v[228:231], v[52:55], v[44:47], 0
    v_xor_b32 v21, 65536, v21
    v_mfma_f32_16x16x32_bf16 v[232:235], v[56:59], v[44:47], 0
    v_xor_b32 v22, 65536, v22
    v_mfma_f32_16x16x32_bf16 v[236:239], v[60:63], v[44:47], 0
    v_xor_b32 v23, 65536, v23
    v_mfma_f32_16x16x32_bf16 v[240:243], v[64:67], v[44:47], 0
    v_xor_b32 v24, 65536, v24
    v_mfma_f32_16x16x32_bf16 v[244:247], v[68:71], v[44:47], 0
    v_xor_b32 v25, 65536, v25
    v_mfma_f32_16x16x32_bf16 v[248:251], v[72:75], v[44:47], 0
    v_mfma_f32_16x16x32_bf16 v[252:255], v[76:79], v[44:47], 0
    s_waitcnt vmcnt(0) lgkmcnt(0)
    s_barrier
    v_mfma_f32_16x16x32_bf16 v[128:131], v[96:99], v[80:83], v[128:131]
    s_mov_b32 m0, s35
    s_xor_b32 s35, s35, 65536
    v_mfma_f32_16x16x32_bf16 v[132:135], v[100:103], v[80:83], v[132:135]
    ds_read_b64_tr_b16 v[48:49], v18 offset:32768
    v_mfma_f32_16x16x32_bf16 v[136:139], v[104:107], v[80:83], v[136:139]
    buffer_load_dwordx4 v8, s[12:15], s31 offen offset:0  lds
    v_mfma_f32_16x16x32_bf16 v[140:143], v[108:111], v[80:83], v[140:143]
    ds_read_b64_tr_b16 v[50:51], v18 offset:34816
    v_mfma_f32_16x16x32_bf16 v[144:147], v[112:115], v[80:83], v[144:147]
    buffer_load_dwordx4 v9, s[12:15], s31 offen offset:1024  lds
    v_mfma_f32_16x16x32_bf16 v[148:151], v[116:119], v[80:83], v[148:151]
    ds_read_b64_tr_b16 v[52:53], v19 offset:32768
    v_mfma_f32_16x16x32_bf16 v[152:155], v[120:123], v[80:83], v[152:155]
    buffer_load_dwordx4 v10, s[12:15], s31 offen offset:2048  lds
    v_mfma_f32_16x16x32_bf16 v[156:159], v[124:127], v[80:83], v[156:159]
    ds_read_b64_tr_b16 v[54:55], v19 offset:34816
    v_mfma_f32_16x16x32_bf16 v[160:163], v[96:99], v[84:87], v[160:163]
    buffer_load_dwordx4 v11, s[12:15], s31 offen offset:3072  lds
    v_mfma_f32_16x16x32_bf16 v[164:167], v[100:103], v[84:87], v[164:167]
    ds_read_b64_tr_b16 v[56:57], v20 offset:32768
    v_mfma_f32_16x16x32_bf16 v[168:171], v[104:107], v[84:87], v[168:171]
    s_mov_b32 m0, s36
    s_add_u32 s31, s31, 128
    s_xor_b32 s36, s36, 65536
    v_mfma_f32_16x16x32_bf16 v[172:175], v[108:111], v[84:87], v[172:175]
    ds_read_b64_tr_b16 v[58:59], v20 offset:34816
    v_mfma_f32_16x16x32_bf16 v[176:179], v[112:115], v[84:87], v[176:179]
    buffer_load_dwordx4 v12, s[16:19], s32 offen offset:0  lds
    v_mfma_f32_16x16x32_bf16 v[180:183], v[116:119], v[84:87], v[180:183]
    ds_read_b64_tr_b16 v[60:61], v21 offset:32768
    v_mfma_f32_16x16x32_bf16 v[184:187], v[120:123], v[84:87], v[184:187]
    buffer_load_dwordx4 v13, s[16:19], s32 offen offset:1024  lds
    v_mfma_f32_16x16x32_bf16 v[188:191], v[124:127], v[84:87], v[188:191]
    ds_read_b64_tr_b16 v[62:63], v21 offset:34816
    v_mfma_f32_16x16x32_bf16 v[192:195], v[96:99], v[88:91], v[192:195]
    buffer_load_dwordx4 v14, s[16:19], s32 offen offset:2048  lds
    v_mfma_f32_16x16x32_bf16 v[196:199], v[100:103], v[88:91], v[196:199]
    ds_read_b64_tr_b16 v[64:65], v22 offset:32768
    v_mfma_f32_16x16x32_bf16 v[200:203], v[104:107], v[88:91], v[200:203]
    buffer_load_dwordx4 v15, s[16:19], s32 offen offset:3072  lds
    v_mfma_f32_16x16x32_bf16 v[204:207], v[108:111], v[88:91], v[204:207]
    ds_read_b64_tr_b16 v[66:67], v22 offset:34816
    v_mfma_f32_16x16x32_bf16 v[208:211], v[112:115], v[88:91], v[208:211]
    s_add_u32 s32, s32, s33
    v_mfma_f32_16x16x32_bf16 v[212:215], v[116:119], v[88:91], v[212:215]
    ds_read_b64_tr_b16 v[68:69], v23 offset:32768
    v_mfma_f32_16x16x32_bf16 v[216:219], v[120:123], v[88:91], v[216:219]
    ds_read_b64_tr_b16 v[70:71], v23 offset:34816
    v_mfma_f32_16x16x32_bf16 v[220:223], v[124:127], v[88:91], v[220:223]
    ds_read_b64_tr_b16 v[72:73], v24 offset:32768
    v_mfma_f32_16x16x32_bf16 v[224:227], v[96:99], v[92:95], v[224:227]
    ds_read_b64_tr_b16 v[74:75], v24 offset:34816
    v_mfma_f32_16x16x32_bf16 v[228:231], v[100:103], v[92:95], v[228:231]
    ds_read_b64_tr_b16 v[76:77], v25 offset:32768
    v_mfma_f32_16x16x32_bf16 v[232:235], v[104:107], v[92:95], v[232:235]
    ds_read_b64_tr_b16 v[78:79], v25 offset:34816
    v_mfma_f32_16x16x32_bf16 v[236:239], v[108:111], v[92:95], v[236:239]
    ds_read_b128 v[32:35], v16 offset:0
    v_mfma_f32_16x16x32_bf16 v[240:243], v[112:115], v[92:95], v[240:243]
    ds_read_b128 v[36:39], v16 offset:2048
    v_mfma_f32_16x16x32_bf16 v[244:247], v[116:119], v[92:95], v[244:247]
    ds_read_b128 v[40:43], v16 offset:16384
    v_mfma_f32_16x16x32_bf16 v[248:251], v[120:123], v[92:95], v[248:251]
    ds_read_b128 v[44:47], v16 offset:18432
    v_mfma_f32_16x16x32_bf16 v[252:255], v[124:127], v[92:95], v[252:255]
gl_256:
    s_waitcnt lgkmcnt(0)
    v_mfma_f32_16x16x32_bf16 v[128:131], v[48:51], v[32:35], v[128:131]
    ds_read_b64_tr_b16 v[96:97], v18 offset:49152
    v_mfma_f32_16x16x32_bf16 v[132:135], v[52:55], v[32:35], v[132:135]
    ds_read_b64_tr_b16 v[98:99], v18 offset:51200
    v_mfma_f32_16x16x32_bf16 v[136:139], v[56:59], v[32:35], v[136:139]
    ds_read_b64_tr_b16 v[100:101], v19 offset:49152
    v_mfma_f32_16x16x32_bf16 v[140:143], v[60:63], v[32:35], v[140:143]
    ds_read_b64_tr_b16 v[102:103], v19 offset:51200
    v_mfma_f32_16x16x32_bf16 v[144:147], v[64:67], v[32:35], v[144:147]
    ds_read_b64_tr_b16 v[104:105], v20 offset:49152
    v_mfma_f32_16x16x32_bf16 v[148:151], v[68:71], v[32:35], v[148:151]
    ds_read_b64_tr_b16 v[106:107], v20 offset:51200
    v_mfma_f32_16x16x32_bf16 v[152:155], v[72:75], v[32:35], v[152:155]
    ds_read_b64_tr_b16 v[108:109], v21 offset:49152
    v_mfma_f32_16x16x32_bf16 v[156:159], v[76:79], v[32:35], v[156:159]
    ds_read_b64_tr_b16 v[110:111], v21 offset:51200
    v_mfma_f32_16x16x32_bf16 v[160:163], v[48:51], v[36:39], v[160:163]
    ds_read_b64_tr_b16 v[112:113], v22 offset:49152
    v_mfma_f32_16x16x32_bf16 v[164:167], v[52:55], v[36:39], v[164:167]
    ds_read_b64_tr_b16 v[114:115], v22 offset:51200
    v_mfma_f32_16x16x32_bf16 v[168:171], v[56:59], v[36:39], v[168:171]
    ds_read_b64_tr_b16 v[116:117], v23 offset:49152
    v_mfma_f32_16x16x32_bf16 v[172:175], v[60:63], v[36:39], v[172:175]
    ds_read_b64_tr_b16 v[118:119], v23 offset:51200
    v_mfma_f32_16x16x32_bf16 v[176:179], v[64:67], v[36:39], v[176:179]
    ds_read_b64_tr_b16 v[120:121], v24 offset:49152
    v_mfma_f32_16x16x32_bf16 v[180:183], v[68:71], v[36:39], v[180:183]
    ds_read_b64_tr_b16 v[122:123], v24 offset:51200
    v_mfma_f32_16x16x32_bf16 v[184:187], v[72:75], v[36:39], v[184:187]
    ds_read_b64_tr_b16 v[124:125], v25 offset:49152
    v_mfma_f32_16x16x32_bf16 v[188:191], v[76:79], v[36:39], v[188:191]
    ds_read_b64_tr_b16 v[126:127], v25 offset:51200
    v_mfma_f32_16x16x32_bf16 v[192:195], v[48:51], v[40:43], v[192:195]
    ds_read_b128 v[80:83], v17 offset:0
    v_mfma_f32_16x16x32_bf16 v[196:199], v[52:55], v[40:43], v[196:199]
    ds_read_b128 v[84:87], v17 offset:2048
    v_mfma_f32_16x16x32_bf16 v[200:203], v[56:59], v[40:43], v[200:203]
    ds_read_b128 v[88:91], v17 offset:16384
    v_mfma_f32_16x16x32_bf16 v[204:207], v[60:63], v[40:43], v[204:207]
    ds_read_b128 v[92:95], v17 offset:18432
    v_mfma_f32_16x16x32_bf16 v[208:211], v[64:67], v[40:43], v[208:211]
    v_xor_b32 v16, 65536, v16
    v_mfma_f32_16x16x32_bf16 v[212:215], v[68:71], v[40:43], v[212:215]
    v_xor_b32 v17, 65536, v17
    v_mfma_f32_16x16x32_bf16 v[216:219], v[72:75], v[40:43], v[216:219]
    v_xor_b32 v18, 65536, v18
    v_mfma_f32_16x16x32_bf16 v[220:223], v[76:79], v[40:43], v[220:223]
    v_xor_b32 v19, 65536, v19
    v_mfma_f32_16x16x32_bf16 v[224:227], v[48:51], v[44:47], v[224:227]
    v_xor_b32 v20, 65536, v20
    v_mfma_f32_16x16x32_bf16 v[228:231], v[52:55], v[44:47], v[228:231]
    v_xor_b32 v21, 65536, v21
    v_mfma_f32_16x16x32_bf16 v[232:235], v[56:59], v[44:47], v[232:235]
    v_xor_b32 v22, 65536, v22
    v_mfma_f32_16x16x32_bf16 v[236:239], v[60:63], v[44:47], v[236:239]
    v_xor_b32 v23, 65536, v23
    v_mfma_f32_16x16x32_bf16 v[240:243], v[64:67], v[44:47], v[240:243]
    v_xor_b32 v24, 65536, v24
    v_mfma_f32_16x16x32_bf16 v[244:247], v[68:71], v[44:47], v[244:247]
    v_xor_b32 v25, 65536, v25
    v_mfma_f32_16x16x32_bf16 v[248:251], v[72:75], v[44:47], v[248:251]
    v_mfma_f32_16x16x32_bf16 v[252:255], v[76:79], v[44:47], v[252:255]
    s_waitcnt vmcnt(0) lgkmcnt(0)
    s_barrier
    v_mfma_f32_16x16x32_bf16 v[128:131], v[96:99], v[80:83], v[128:131]
    s_mov_b32 m0, s35
    s_xor_b32 s35, s35, 65536
    v_mfma_f32_16x16x32_bf16 v[132:135], v[100:103], v[80:83], v[132:135]
    ds_read_b64_tr_b16 v[48:49], v18 offset:32768
    v_mfma_f32_16x16x32_bf16 v[136:139], v[104:107], v[80:83], v[136:139]
    buffer_load_dwordx4 v8, s[12:15], s31 offen offset:0  lds
    v_mfma_f32_16x16x32_bf16 v[140:143], v[108:111], v[80:83], v[140:143]
    ds_read_b64_tr_b16 v[50:51], v18 offset:34816
    v_mfma_f32_16x16x32_bf16 v[144:147], v[112:115], v[80:83], v[144:147]
    buffer_load_dwordx4 v9, s[12:15], s31 offen offset:1024  lds
    v_mfma_f32_16x16x32_bf16 v[148:151], v[116:119], v[80:83], v[148:151]
    ds_read_b64_tr_b16 v[52:53], v19 offset:32768
    v_mfma_f32_16x16x32_bf16 v[152:155], v[120:123], v[80:83], v[152:155]
    buffer_load_dwordx4 v10, s[12:15], s31 offen offset:2048  lds
    v_mfma_f32_16x16x32_bf16 v[156:159], v[124:127], v[80:83], v[156:159]
    ds_read_b64_tr_b16 v[54:55], v19 offset:34816
    v_mfma_f32_16x16x32_bf16 v[160:163], v[96:99], v[84:87], v[160:163]
    buffer_load_dwordx4 v11, s[12:15], s31 offen offset:3072  lds
    v_mfma_f32_16x16x32_bf16 v[164:167], v[100:103], v[84:87], v[164:167]
    ds_read_b64_tr_b16 v[56:57], v20 offset:32768
    v_mfma_f32_16x16x32_bf16 v[168:171], v[104:107], v[84:87], v[168:171]
    s_mov_b32 m0, s36
    s_add_u32 s31, s31, 128
    s_xor_b32 s36, s36, 65536
    v_mfma_f32_16x16x32_bf16 v[172:175], v[108:111], v[84:87], v[172:175]
    ds_read_b64_tr_b16 v[58:59], v20 offset:34816
    v_mfma_f32_16x16x32_bf16 v[176:179], v[112:115], v[84:87], v[176:179]
    buffer_load_dwordx4 v12, s[16:19], s32 offen offset:0  lds
    v_mfma_f32_16x16x32_bf16 v[180:183], v[116:119], v[84:87], v[180:183]
    ds_read_b64_tr_b16 v[60:61], v21 offset:32768
    v_mfma_f32_16x16x32_bf16 v[184:187], v[120:123], v[84:87], v[184:187]
    buffer_load_dwordx4 v13, s[16:19], s32 offen offset:1024  lds
    v_mfma_f32_16x16x32_bf16 v[188:191], v[124:127], v[84:87], v[188:191]
    ds_read_b64_tr_b16 v[62:63], v21 offset:34816
    v_mfma_f32_16x16x32_bf16 v[192:195], v[96:99], v[88:91], v[192:195]
    buffer_load_dwordx4 v14, s[16:19], s32 offen offset:2048  lds
    v_mfma_f32_16x16x32_bf16 v[196:199], v[100:103], v[88:91], v[196:199]
    ds_read_b64_tr_b16 v[64:65], v22 offset:32768
    v_mfma_f32_16x16x32_bf16 v[200:203], v[104:107], v[88:91], v[200:203]
    buffer_load_dwordx4 v15, s[16:19], s32 offen offset:3072  lds
    v_mfma_f32_16x16x32_bf16 v[204:207], v[108:111], v[88:91], v[204:207]
    ds_read_b64_tr_b16 v[66:67], v22 offset:34816
    v_mfma_f32_16x16x32_bf16 v[208:211], v[112:115], v[88:91], v[208:211]
    s_add_u32 s32, s32, s33
    v_mfma_f32_16x16x32_bf16 v[212:215], v[116:119], v[88:91], v[212:215]
    ds_read_b64_tr_b16 v[68:69], v23 offset:32768
    v_mfma_f32_16x16x32_bf16 v[216:219], v[120:123], v[88:91], v[216:219]
    ds_read_b64_tr_b16 v[70:71], v23 offset:34816
    v_mfma_f32_16x16x32_bf16 v[220:223], v[124:127], v[88:91], v[220:223]
    ds_read_b64_tr_b16 v[72:73], v24 offset:32768
    v_mfma_f32_16x16x32_bf16 v[224:227], v[96:99], v[92:95], v[224:227]
    ds_read_b64_tr_b16 v[74:75], v24 offset:34816
    v_mfma_f32_16x16x32_bf16 v[228:231], v[100:103], v[92:95], v[228:231]
    ds_read_b64_tr_b16 v[76:77], v25 offset:32768
    v_mfma_f32_16x16x32_bf16 v[232:235], v[104:107], v[92:95], v[232:235]
    ds_read_b64_tr_b16 v[78:79], v25 offset:34816
    v_mfma_f32_16x16x32_bf16 v[236:239], v[108:111], v[92:95], v[236:239]
    ds_read_b128 v[32:35], v16 offset:0
    v_mfma_f32_16x16x32_bf16 v[240:243], v[112:115], v[92:95], v[240:243]
    ds_read_b128 v[36:39], v16 offset:2048
    v_mfma_f32_16x16x32_bf16 v[244:247], v[116:119], v[92:95], v[244:247]
    ds_read_b128 v[40:43], v16 offset:16384
    v_mfma_f32_16x16x32_bf16 v[248:251], v[120:123], v[92:95], v[248:251]
    ds_read_b128 v[44:47], v16 offset:18432
    v_mfma_f32_16x16x32_bf16 v[252:255], v[124:127], v[92:95], v[252:255]
    s_sub_u32 s34, s34, 1
    s_cmp_lg_u32 s34, 0
    s_cbranch_scc1 gl_256
qw_257:
    v_cmp_gt_i32 vcc, 32, v29
    s_nop 3
    s_and_b32 s3, vcc_lo, 0xf0
    s_cbranch_scc0 qo_258
    s_sub_u32 s30, s30, 1
    s_cbranch_scc1 L_end
    s_sleep 4
    buffer_load_dword v29, v30, s[8:11], 0 offen sc1
    s_waitcnt vmcnt(0)
    s_branch qw_257
qo_258:
    buffer_load_dword v29, v30, s[8:11], 0 offen sc1
    v_lshlrev_b32 v10, 4, v2
    s_lshl_b32 s63, s26, 13
    v_add_u32 v13, s63, v10
    s_lshl_b32 s60, s81, 7
    s_lshr_b32 s3, s80, 1
    s_add_u32 s60, s60, s3
    s_lshl_b32 s60, s60, 14
    s_and_b32 s3, s80, 1
    s_lshl_b32 s3, s3, 12
    s_add_u32 s60, s60, s3
    s_add_u32 s60, s60, 134217728
    s_bfe_u32 s3, s81, 0x10000
    s_lshl_b32 s3, s3, 13
    s_xor_b32 s3, s3, s79
    s_xor_b32 s3, s3, 8192
    s_add_u32 s60, s60, s3
    s_waitcnt lgkmcnt(0)
    v_mfma_f32_16x16x32_bf16 v[128:131], v[48:51], v[32:35], v[128:131]
    ds_read_b64_tr_b16 v[96:97], v18 offset:49152
    v_mfma_f32_16x16x32_bf16 v[132:135], v[52:55], v[32:35], v[132:135]
    ds_read_b64_tr_b16 v[98:99], v18 offset:51200
    v_mfma_f32_16x16x32_bf16 v[136:139], v[56:59], v[32:35], v[136:139]
    ds_read_b64_tr_b16 v[100:101], v19 offset:49152
    v_mfma_f32_16x16x32_bf16 v[140:143], v[60:63], v[32:35], v[140:143]
    ds_read_b64_tr_b16 v[102:103], v19 offset:51200
    v_mfma_f32_16x16x32_bf16 v[144:147], v[64:67], v[32:35], v[144:147]
    ds_read_b64_tr_b16 v[104:105], v20 offset:49152
    v_mfma_f32_16x16x32_bf16 v[148:151], v[68:71], v[32:35], v[148:151]
    ds_read_b64_tr_b16 v[106:107], v20 offset:51200
    v_mfma_f32_16x16x32_bf16 v[152:155], v[72:75], v[32:35], v[152:155]
    ds_read_b64_tr_b16 v[108:109], v21 offset:49152
    v_mfma_f32_16x16x32_bf16 v[156:159], v[76:79], v[32:35], v[156:159]
    ds_read_b64_tr_b16 v[110:111], v21 offset:51200
    v_mfma_f32_16x16x32_bf16 v[160:163], v[48:51], v[36:39], v[160:163]
    ds_read_b64_tr_b16 v[112:113], v22 offset:49152
    v_mfma_f32_16x16x32_bf16 v[164:167], v[52:55], v[36:39], v[164:167]
    ds_read_b64_tr_b16 v[114:115], v22 offset:51200
    v_mfma_f32_16x16x32_bf16 v[168:171], v[56:59], v[36:39], v[168:171]
    ds_read_b64_tr_b16 v[116:117], v23 offset:49152
    v_mfma_f32_16x16x32_bf16 v[172:175], v[60:63], v[36:39], v[172:175]
    ds_read_b64_tr_b16 v[118:119], v23 offset:51200
    v_mfma_f32_16x16x32_bf16 v[176:179], v[64:67], v[36:39], v[176:179]
    ds_read_b64_tr_b16 v[120:121], v24 offset:49152
    v_mfma_f32_16x16x32_bf16 v[180:183], v[68:71], v[36:39], v[180:183]
    ds_read_b64_tr_b16 v[122:123], v24 offset:51200
    v_mfma_f32_16x16x32_bf16 v[184:187], v[72:75], v[36:39], v[184:187]
    ds_read_b64_tr_b16 v[124:125], v25 offset:49152
    v_mfma_f32_16x16x32_bf16 v[188:191], v[76:79], v[36:39], v[188:191]
    ds_read_b64_tr_b16 v[126:127], v25 offset:51200
    v_mfma_f32_16x16x32_bf16 v[192:195], v[48:51], v[40:43], v[192:195]
    ds_read_b128 v[80:83], v17 offset:0
    v_mfma_f32_16x16x32_bf16 v[196:199], v[52:55], v[40:43], v[196:199]
    ds_read_b128 v[84:87], v17 offset:2048
    v_mfma_f32_16x16x32_bf16 v[200:203], v[56:59], v[40:43], v[200:203]
    ds_read_b128 v[88:91], v17 offset:16384
    v_mfma_f32_16x16x32_bf16 v[204:207], v[60:63], v[40:43], v[204:207]
    ds_read_b128 v[92:95], v17 offset:18432
    v_mfma_f32_16x16x32_bf16 v[208:211], v[64:67], v[40:43], v[208:211]
    v_xor_b32 v16, 65536, v16
    v_mfma_f32_16x16x32_bf16 v[212:215], v[68:71], v[40:43], v[212:215]
    v_xor_b32 v17, 65536, v17
    v_mfma_f32_16x16x32_bf16 v[216:219], v[72:75], v[40:43], v[216:219]
    v_xor_b32 v18, 65536, v18
    v_mfma_f32_16x16x32_bf16 v[220:223], v[76:79], v[40:43], v[220:223]
    v_xor_b32 v19, 65536, v19
    v_mfma_f32_16x16x32_bf16 v[224:227], v[48:51], v[44:47], v[224:227]
    v_xor_b32 v20, 65536, v20
    v_mfma_f32_16x16x32_bf16 v[228:231], v[52:55], v[44:47], v[228:231]
    v_xor_b32 v21, 65536, v21
    v_mfma_f32_16x16x32_bf16 v[232:235], v[56:59], v[44:47], v[232:235]
    v_xor_b32 v22, 65536, v22
    v_mfma_f32_16x16x32_bf16 v[236:239], v[60:63], v[44:47], v[236:239]
    v_xor_b32 v23, 65536, v23
    v_mfma_f32_16x16x32_bf16 v[240:243], v[64:67], v[44:47], v[240:243]
    v_xor_b32 v24, 65536, v24
    v_mfma_f32_16x16x32_bf16 v[244:247], v[68:71], v[44:47], v[244:247]
    v_xor_b32 v25, 65536, v25
    v_mfma_f32_16x16x32_bf16 v[248:251], v[72:75], v[44:47], v[248:251]
    v_mfma_f32_16x16x32_bf16 v[252:255], v[76:79], v[44:47], v[252:255]
    s_waitcnt vmcnt(0) lgkmcnt(0)
    s_barrier
    v_mfma_f32_16x16x32_bf16 v[128:131], v[96:99], v[80:83], v[128:131]
    s_add_u32 m0, s63, 0
    s_add_u32 s38, s60, 0
    buffer_load_dwordx4 v10, s[8:11], s38 offen sc1 lds
    v_mfma_f32_16x16x32_bf16 v[132:135], v[100:103], v[80:83], v[132:135]
    ds_read_b64_tr_b16 v[48:49], v18 offset:32768
    v_mfma_f32_16x16x32_bf16 v[136:139], v[104:107], v[80:83], v[136:139]
    buffer_load_dwordx4 v10, s[8:11], s38 offen offset:1024 sc1 lds
    v_mfma_f32_16x16x32_bf16 v[140:143], v[108:111], v[80:83], v[140:143]
    ds_read_b64_tr_b16 v[50:51], v18 offset:34816
    v_mfma_f32_16x16x32_bf16 v[144:147], v[112:115], v[80:83], v[144:147]
    s_add_u32 m0, s63, 2048
    s_add_u32 s38, s60, 524288
    buffer_load_dwordx4 v10, s[8:11], s38 offen sc1 lds
    v_mfma_f32_16x16x32_bf16 v[148:151], v[116:119], v[80:83], v[148:151]
    ds_read_b64_tr_b16 v[52:53], v19 offset:32768
    v_mfma_f32_16x16x32_bf16 v[152:155], v[120:123], v[80:83], v[152:155]
    buffer_load_dwordx4 v10, s[8:11], s38 offen offset:1024 sc1 lds
    v_mfma_f32_16x16x32_bf16 v[156:159], v[124:127], v[80:83], v[156:159]
    ds_read_b64_tr_b16 v[54:55], v19 offset:34816
    v_mfma_f32_16x16x32_bf16 v[160:163], v[96:99], v[84:87], v[160:163]
    s_add_u32 m0, s63, 4096
    s_add_u32 s38, s60, 1048576
    buffer_load_dwordx4 v10, s[8:11], s38 offen sc1 lds
    v_mfma_f32_16x16x32_bf16 v[164:167], v[100:103], v[84:87], v[164:167]
    ds_read_b64_tr_b16 v[56:57], v20 offset:32768
    v_mfma_f32_16x16x32_bf16 v[168:171], v[104:107], v[84:87], v[168:171]
    buffer_load_dwordx4 v10, s[8:11], s38 offen offset:1024 sc1 lds
    v_mfma_f32_16x16x32_bf16 v[172:175], v[108:111], v[84:87], v[172:175]
    ds_read_b64_tr_b16 v[58:59], v20 offset:34816
    v_mfma_f32_16x16x32_bf16 v[176:179], v[112:115], v[84:87], v[176:179]
    s_add_u32 m0, s63, 6144
    s_add_u32 s38, s60, 1572864
    buffer_load_dwordx4 v10, s[8:11], s38 offen sc1 lds
    v_mfma_f32_16x16x32_bf16 v[180:183], v[116:119], v[84:87], v[180:183]
    ds_read_b64_tr_b16 v[60:61], v21 offset:32768
    v_mfma_f32_16x16x32_bf16 v[184:187], v[120:123], v[84:87], v[184:187]
    buffer_load_dwordx4 v10, s[8:11], s38 offen offset:1024 sc1 lds
    v_mfma_f32_16x16x32_bf16 v[188:191], v[124:127], v[84:87], v[188:191]
    ds_read_b64_tr_b16 v[62:63], v21 offset:34816
    v_mfma_f32_16x16x32_bf16 v[192:195], v[96:99], v[88:91], v[192:195]
    ds_read_b64_tr_b16 v[64:65], v22 offset:32768
    v_mfma_f32_16x16x32_bf16 v[196:199], v[100:103], v[88:91], v[196:199]
    ds_read_b64_tr_b16 v[66:67], v22 offset:34816
    v_mfma_f32_16x16x32_bf16 v[200:203], v[104:107], v[88:91], v[200:203]
    ds_read_b64_tr_b16 v[68:69], v23 offset:32768
    v_mfma_f32_16x16x32_bf16 v[204:207], v[108:111], v[88:91], v[204:207]
    ds_read_b64_tr_b16 v[70:71], v23 offset:34816
    v_mfma_f32_16x16x32_bf16 v[208:211], v[112:115], v[88:91], v[208:211]
    ds_read_b64_tr_b16 v[72:73], v24 offset:32768
    v_mfma_f32_16x16x32_bf16 v[212:215], v[116:119], v[88:91], v[212:215]
    ds_read_b64_tr_b16 v[74:75], v24 offset:34816
    v_mfma_f32_16x16x32_bf16 v[216:219], v[120:123], v[88:91], v[216:219]
    ds_read_b64_tr_b16 v[76:77], v25 offset:32768
    v_mfma_f32_16x16x32_bf16 v[220:223], v[124:127], v[88:91], v[220:223]
    ds_read_b64_tr_b16 v[78:79], v25 offset:34816
    v_mfma_f32_16x16x32_bf16 v[224:227], v[96:99], v[92:95], v[224:227]
    ds_read_b128 v[32:35], v16 offset:0
    v_mfma_f32_16x16x32_bf16 v[228:231], v[100:103], v[92:95], v[228:231]
    ds_read_b128 v[36:39], v16 offset:2048
    v_mfma_f32_16x16x32_bf16 v[232:235], v[104:107], v[92:95], v[232:235]
    ds_read_b128 v[40:43], v16 offset:16384
    v_mfma_f32_16x16x32_bf16 v[236:239], v[108:111], v[92:95], v[236:239]
    ds_read_b128 v[44:47], v16 offset:18432
    v_mfma_f32_16x16x32_bf16 v[240:243], v[112:115], v[92:95], v[240:243]
    v_mfma_f32_16x16x32_bf16 v[244:247], v[116:119], v[92:95], v[244:247]
    v_mfma_f32_16x16x32_bf16 v[248:251], v[120:123], v[92:95], v[248:251]
    v_mfma_f32_16x16x32_bf16 v[252:255], v[124:127], v[92:95], v[252:255]
    s_waitcnt lgkmcnt(0)
    v_mfma_f32_16x16x32_bf16 v[128:131], v[48:51], v[32:35], v[128:131]
    ds_read_b64_tr_b16 v[96:97], v18 offset:49152
    v_mfma_f32_16x16x32_bf16 v[132:135], v[52:55], v[32:35], v[132:135]
    ds_read_b64_tr_b16 v[98:99], v18 offset:51200
    v_mfma_f32_16x16x32_bf16 v[136:139], v[56:59], v[32:35], v[136:139]
    ds_read_b64_tr_b16 v[100:101], v19 offset:49152
    v_mfma_f32_16x16x32_bf16 v[140:143], v[60:63], v[32:35], v[140:143]
    ds_read_b64_tr_b16 v[102:103], v19 offset:51200
    v_mfma_f32_16x16x32_bf16 v[144:147], v[64:67], v[32:35], v[144:147]
    ds_read_b64_tr_b16 v[104:105], v20 offset:49152
    v_mfma_f32_16x16x32_bf16 v[148:151], v[68:71], v[32:35], v[148:151]
    ds_read_b64_tr_b16 v[106:107], v20 offset:51200
    v_mfma_f32_16x16x32_bf16 v[152:155], v[72:75], v[32:35], v[152:155]
    ds_read_b64_tr_b16 v[108:109], v21 offset:49152
    v_mfma_f32_16x16x32_bf16 v[156:159], v[76:79], v[32:35], v[156:159]
    ds_read_b64_tr_b16 v[110:111], v21 offset:51200
    v_mfma_f32_16x16x32_bf16 v[160:163], v[48:51], v[36:39], v[160:163]
    ds_read_b64_tr_b16 v[112:113], v22 offset:49152
    v_mfma_f32_16x16x32_bf16 v[164:167], v[52:55], v[36:39], v[164:167]
    ds_read_b64_tr_b16 v[114:115], v22 offset:51200
    v_mfma_f32_16x16x32_bf16 v[168:171], v[56:59], v[36:39], v[168:171]
    ds_read_b64_tr_b16 v[116:117], v23 offset:49152
    v_mfma_f32_16x16x32_bf16 v[172:175], v[60:63], v[36:39], v[172:175]
    ds_read_b64_tr_b16 v[118:119], v23 offset:51200
    v_mfma_f32_16x16x32_bf16 v[176:179], v[64:67], v[36:39], v[176:179]
    ds_read_b64_tr_b16 v[120:121], v24 offset:49152
    v_mfma_f32_16x16x32_bf16 v[180:183], v[68:71], v[36:39], v[180:183]
    ds_read_b64_tr_b16 v[122:123], v24 offset:51200
    v_mfma_f32_16x16x32_bf16 v[184:187], v[72:75], v[36:39], v[184:187]
    ds_read_b64_tr_b16 v[124:125], v25 offset:49152
    v_mfma_f32_16x16x32_bf16 v[188:191], v[76:79], v[36:39], v[188:191]
    ds_read_b64_tr_b16 v[126:127], v25 offset:51200
    v_mfma_f32_16x16x32_bf16 v[192:195], v[48:51], v[40:43], v[192:195]
    ds_read_b128 v[80:83], v17 offset:0
    v_mfma_f32_16x16x32_bf16 v[196:199], v[52:55], v[40:43], v[196:199]
    ds_read_b128 v[84:87], v17 offset:2048
    v_mfma_f32_16x16x32_bf16 v[200:203], v[56:59], v[40:43], v[200:203]
    ds_read_b128 v[88:91], v17 offset:16384
    v_mfma_f32_16x16x32_bf16 v[204:207], v[60:63], v[40:43], v[204:207]
    ds_read_b128 v[92:95], v17 offset:18432
    v_mfma_f32_16x16x32_bf16 v[208:211], v[64:67], v[40:43], v[208:211]
    v_xor_b32 v16, 65536, v16
    v_mfma_f32_16x16x32_bf16 v[212:215], v[68:71], v[40:43], v[212:215]
    v_xor_b32 v17, 65536, v17
    v_mfma_f32_16x16x32_bf16 v[216:219], v[72:75], v[40:43], v[216:219]
    v_xor_b32 v18, 65536, v18
    v_mfma_f32_16x16x32_bf16 v[220:223], v[76:79], v[40:43], v[220:223]
    v_xor_b32 v19, 65536, v19
    v_mfma_f32_16x16x32_bf16 v[224:227], v[48:51], v[44:47], v[224:227]
    v_xor_b32 v20, 65536, v20
    v_mfma_f32_16x16x32_bf16 v[228:231], v[52:55], v[44:47], v[228:231]
    v_xor_b32 v21, 65536, v21
    v_mfma_f32_16x16x32_bf16 v[232:235], v[56:59], v[44:47], v[232:235]
    v_xor_b32 v22, 65536, v22
    v_mfma_f32_16x16x32_bf16 v[236:239], v[60:63], v[44:47], v[236:239]
    v_xor_b32 v23, 65536, v23
    v_mfma_f32_16x16x32_bf16 v[240:243], v[64:67], v[44:47], v[240:243]
    v_xor_b32 v24, 65536, v24
    v_mfma_f32_16x16x32_bf16 v[244:247], v[68:71], v[44:47], v[244:247]
    v_xor_b32 v25, 65536, v25
    v_mfma_f32_16x16x32_bf16 v[248:251], v[72:75], v[44:47], v[248:251]
    v_mfma_f32_16x16x32_bf16 v[252:255], v[76:79], v[44:47], v[252:255]
    s_waitcnt lgkmcnt(0)
    s_barrier
    v_mfma_f32_16x16x32_bf16 v[128:131], v[96:99], v[80:83], v[128:131]
    s_add_u32 s38, s60, 0
    buffer_load_dwordx4 v[32:35], v10, s[8:11], s38 offen offset:2048 sc1
    v_mfma_f32_16x16x32_bf16 v[132:135], v[100:103], v[80:83], v[132:135]
    buffer_load_dwordx4 v[36:39], v10, s[8:11], s38 offen offset:3072 sc1
    v_mfma_f32_16x16x32_bf16 v[136:139], v[104:107], v[80:83], v[136:139]
    s_add_u32 s38, s60, 524288
    buffer_load_dwordx4 v[40:43], v10, s[8:11], s38 offen offset:2048 sc1
    v_mfma_f32_16x16x32_bf16 v[140:143], v[108:111], v[80:83], v[140:143]
    buffer_load_dwordx4 v[44:47], v10, s[8:11], s38 offen offset:3072 sc1
    v_mfma_f32_16x16x32_bf16 v[144:147], v[112:115], v[80:83], v[144:147]
    s_add_u32 s38, s60, 1048576
    buffer_load_dwordx4 v[48:51], v10, s[8:11], s38 offen offset:2048 sc1
    v_mfma_f32_16x16x32_bf16 v[148:151], v[116:119], v[80:83], v[148:151]
    buffer_load_dwordx4 v[52:55], v10, s[8:11], s38 offen offset:3072 sc1
    v_mfma_f32_16x16x32_bf16 v[152:155], v[120:123], v[80:83], v[152:155]
    s_add_u32 s38, s60, 1572864
    buffer_load_dwordx4 v[56:59], v10, s[8:11], s38 offen offset:2048 sc1
    v_mfma_f32_16x16x32_bf16 v[156:159], v[124:127], v[80:83], v[156:159]
    buffer_load_dwordx4 v[60:63], v10, s[8:11], s38 offen offset:3072 sc1
    v_mfma_f32_16x16x32_bf16 v[160:163], v[96:99], v[84:87], v[160:163]
    s_add_u32 m0, s63, 65536
    s_add_u32 s38, s60, 32768
    buffer_load_dwordx4 v10, s[8:11], s38 offen sc1 lds
    v_mfma_f32_16x16x32_bf16 v[164:167], v[100:103], v[84:87], v[164:167]
    buffer_load_dwordx4 v10, s[8:11], s38 offen offset:1024 sc1 lds
    v_mfma_f32_16x16x32_bf16 v[168:171], v[104:107], v[84:87], v[168:171]
    s_add_u32 m0, s63, 67584
    s_add_u32 s38, s60, 557056
    buffer_load_dwordx4 v10, s[8:11], s38 offen sc1 lds
    v_mfma_f32_16x16x32_bf16 v[172:175], v[108:111], v[84:87], v[172:175]
    buffer_load_dwordx4 v10, s[8:11], s38 offen offset:1024 sc1 lds
    v_mfma_f32_16x16x32_bf16 v[176:179], v[112:115], v[84:87], v[176:179]
    s_add_u32 m0, s63, 69632
    s_add_u32 s38, s60, 1081344
    buffer_load_dwordx4 v10, s[8:11], s38 offen sc1 lds
    v_mfma_f32_16x16x32_bf16 v[180:183], v[116:119], v[84:87], v[180:183]
    buffer_load_dwordx4 v10, s[8:11], s38 offen offset:1024 sc1 lds
    v_mfma_f32_16x16x32_bf16 v[184:187], v[120:123], v[84:87], v[184:187]
    s_add_u32 m0, s63, 71680
    s_add_u32 s38, s60, 1605632
    buffer_load_dwordx4 v10, s[8:11], s38 offen sc1 lds
    v_mfma_f32_16x16x32_bf16 v[188:191], v[124:127], v[84:87], v[188:191]
    buffer_load_dwordx4 v10, s[8:11], s38 offen offset:1024 sc1 lds
    v_mfma_f32_16x16x32_bf16 v[192:195], v[96:99], v[88:91], v[192:195]
    v_mfma_f32_16x16x32_bf16 v[196:199], v[100:103], v[88:91], v[196:199]
    v_mfma_f32_16x16x32_bf16 v[200:203], v[104:107], v[88:91], v[200:203]
    v_mfma_f32_16x16x32_bf16 v[204:207], v[108:111], v[88:91], v[204:207]
    v_mfma_f32_16x16x32_bf16 v[208:211], v[112:115], v[88:91], v[208:211]
    v_mfma_f32_16x16x32_bf16 v[212:215], v[116:119], v[88:91], v[212:215]
    v_mfma_f32_16x16x32_bf16 v[216:219], v[120:123], v[88:91], v[216:219]
    v_mfma_f32_16x16x32_bf16 v[220:223], v[124:127], v[88:91], v[220:223]
    v_mfma_f32_16x16x32_bf16 v[224:227], v[96:99], v[92:95], v[224:227]
    v_mfma_f32_16x16x32_bf16 v[228:231], v[100:103], v[92:95], v[228:231]
    v_mfma_f32_16x16x32_bf16 v[232:235], v[104:107], v[92:95], v[232:235]
    v_mfma_f32_16x16x32_bf16 v[236:239], v[108:111], v[92:95], v[236:239]
    v_mfma_f32_16x16x32_bf16 v[240:243], v[112:115], v[92:95], v[240:243]
    v_mfma_f32_16x16x32_bf16 v[244:247], v[116:119], v[92:95], v[244:247]
    v_mfma_f32_16x16x32_bf16 v[248:251], v[120:123], v[92:95], v[248:251]
    v_mfma_f32_16x16x32_bf16 v[252:255], v[124:127], v[92:95], v[252:255]
    s_nop 7
LE_QT:
E_QT:
    s_waitcnt vmcnt(16)
    ds_read_b128 v[64:67], v13 offset:0
    ds_read_b128 v[68:71], v13 offset:1024
    ds_read_b128 v[72:75], v13 offset:2048
    ds_read_b128 v[76:79], v13 offset:3072
    ds_read_b128 v[80:83], v13 offset:4096
    ds_read_b128 v[84:87], v13 offset:5120
    ds_read_b128 v[88:91], v13 offset:6144
    ds_read_b128 v[92:95], v13 offset:7168
    v_and_b32 v3, 15, v2
    v_lshrrev_b32 v4, 4, v2
    v_add_u32 v18, 65536, v13
    v_and_b32 v5, 7, v3
    v_lshl_add_u32 v11, v4, 3, v5
    v_lshlrev_b32 v11, 4, v11
    v_and_b32 v5, 1, v4
    v_lshlrev_b32 v12, 4, v3
    v_lshl_add_u32 v12, v5, 3, v12
    s_waitcnt lgkmcnt(0)
    s_add_u32 m0, s63, 0
    s_add_u32 s38, s60, 34816
    buffer_load_dwordx4 v10, s[8:11], s38 offen sc1 lds
    buffer_load_dwordx4 v10, s[8:11], s38 offen offset:1024 sc1 lds
    s_add_u32 m0, s63, 2048
    s_add_u32 s38, s60, 559104
    buffer_load_dwordx4 v10, s[8:11], s38 offen sc1 lds
    buffer_load_dwordx4 v10, s[8:11], s38 offen offset:1024 sc1 lds
    s_add_u32 m0, s63, 4096
    s_add_u32 s38, s60, 1083392
    buffer_load_dwordx4 v10, s[8:11], s38 offen sc1 lds
    buffer_load_dwordx4 v10, s[8:11], s38 offen offset:1024 sc1 lds
    s_add_u32 m0, s63, 6144
    s_add_u32 s38, s60, 1607680
    buffer_load_dwordx4 v10, s[8:11], s38 offen sc1 lds
    buffer_load_dwordx4 v10, s[8:11], s38 offen offset:1024 sc1 lds
    v_lshlrev_b32 v5, 2, v4
    v_add_u32 v5, 0, v5
    v_cmp_le_u32 s[68:69], v5, v3
    v_lshlrev_b32 v5, 2, v4
    v_add_u32 v5, 1, v5
    v_cmp_le_u32 s[70:71], v5, v3
    v_lshlrev_b32 v5, 2, v4
    v_add_u32 v5, 2, v5
    v_cmp_le_u32 s[72:73], v5, v3
    v_lshlrev_b32 v5, 2, v4
    v_add_u32 v5, 3, v5
    v_cmp_le_u32 s[74:75], v5, v3
    v_cmp_gt_u32 s[76:77], 2, v4
    s_mov_b32 s78, 0x3e0293ee
    v_mov_b32 v8, 0xceabfb8f
    v_mov_b32 v9, 0xff800000
    s_add_u32 s39, s80, 0
    s_lshl_b32 s61, s39, 18
    s_lshr_b32 s3, s81, 1
    s_lshl_b32 s3, s3, 14
    s_add_u32 s61, s61, s3
    s_and_b32 s3, s81, 1
    s_lshl_b32 s3, s3, 12
    s_add_u32 s61, s61, s3
    s_lshl_b32 s3, s39, 18
    s_add_u32 s62, s61, s3
    s_add_u32 s62, s62, 201326592
    s_bfe_u32 s3, s39, 0x10002
    s_lshl_b32 s3, s3, 13
    s_xor_b32 s3, s3, s79
    s_xor_b32 s3, s3, 8192
    s_add_u32 s62, s62, s3
    s_add_u32 s3, s39, 6
    s_and_b32 s3, s3, 64
    s_lshl_b32 s3, s3, 7
    s_and_b32 s3, s3, 8192
    s_xor_b32 s62, s62, s3
    s_lshl_b32 s3, s39, 10
    s_and_b32 s3, s3, 8192
    s_xor_b32 s3, s3, s79
    s_xor_b32 s3, s3, 0
    s_add_u32 s61, s61, s3
    s_add_u32 s61, s61, 104857600
    s_lshr_b32 s37, s81, 16
    s_add_u32 s3, s80, 1
    v_cmp_gt_i32 vcc, s3, v29
    s_nop 3
    s_and_b32 s40, vcc_lo, 0x0f
    s_cbranch_scc1 qs_259
    buffer_load_dwordx4 v[96:99], v11, s[8:11], s61 offen offset:0 sc1
    buffer_load_dwordx4 v[100:103], v11, s[8:11], s61 offen offset:1024 sc1
    buffer_load_dwordx4 v[104:107], v11, s[8:11], s61 offen offset:2048 sc1
    buffer_load_dwordx4 v[108:111], v11, s[8:11], s61 offen offset:3072 sc1
    buffer_load_dwordx2 v[112:113], v12, s[8:11], s61 offen offset:512 sc1
    buffer_load_dwordx2 v[114:115], v12, s[8:11], s61 offen offset:768 sc1
    buffer_load_dwordx2 v[116:117], v12, s[8:11], s61 offen offset:1536 sc1
    buffer_load_dwordx2 v[118:119], v12, s[8:11], s61 offen offset:1792 sc1
    buffer_load_dwordx2 v[120:121], v12, s[8:11], s61 offen offset:2560 sc1
    buffer_load_dwordx2 v[122:123], v12, s[8:11], s61 offen offset:2816 sc1
    buffer_load_dwordx2 v[124:125], v12, s[8:11], s61 offen offset:3584 sc1
    buffer_load_dwordx2 v[126:127], v12, s[8:11], s61 offen offset:3840 sc1
qs_259:
    v_cvt_pk_bf16_f32 v128, v128, v129
    v_cvt_pk_bf16_f32 v129, v130, v131
    v_cvt_pk_bf16_f32 v130, v132, v133
    v_cvt_pk_bf16_f32 v131, v134, v135
    v_cvt_pk_bf16_f32 v132, v136, v137
    v_cvt_pk_bf16_f32 v133, v138, v139
    v_cvt_pk_bf16_f32 v134, v140, v141
    v_cvt_pk_bf16_f32 v135, v142, v143
    v_cvt_pk_bf16_f32 v136, v144, v145
    v_cvt_pk_bf16_f32 v137, v146, v147
    v_cvt_pk_bf16_f32 v138, v148, v149
    v_cvt_pk_bf16_f32 v139, v150, v151
    v_cvt_pk_bf16_f32 v140, v152, v153
    v_cvt_pk_bf16_f32 v141, v154, v155
    v_cvt_pk_bf16_f32 v142, v156, v157
    v_cvt_pk_bf16_f32 v143, v158, v159
    v_cvt_pk_bf16_f32 v144, v160, v161
    v_cvt_pk_bf16_f32 v145, v162, v163
    v_cvt_pk_bf16_f32 v146, v164, v165
    v_cvt_pk_bf16_f32 v147, v166, v167
    v_cvt_pk_bf16_f32 v148, v168, v169
    v_cvt_pk_bf16_f32 v149, v170, v171
    v_cvt_pk_bf16_f32 v150, v172, v173
    v_cvt_pk_bf16_f32 v151, v174, v175
    v_cvt_pk_bf16_f32 v152, v176, v177
    v_cvt_pk_bf16_f32 v153, v178, v179
    v_cvt_pk_bf16_f32 v154, v180, v181
    v_cvt_pk_bf16_f32 v155, v182, v183
    v_cvt_pk_bf16_f32 v156, v184, v185
    v_cvt_pk_bf16_f32 v157, v186, v187
    v_cvt_pk_bf16_f32 v158, v188, v189
    v_cvt_pk_bf16_f32 v159, v190, v191
    v_cvt_pk_bf16_f32 v160, v192, v193
    v_cvt_pk_bf16_f32 v161, v194, v195
    v_cvt_pk_bf16_f32 v162, v196, v197
    v_cvt_pk_bf16_f32 v163, v198, v199
    v_cvt_pk_bf16_f32 v164, v200, v201
    v_cvt_pk_bf16_f32 v165, v202, v203
    v_cvt_pk_bf16_f32 v166, v204, v205
    v_cvt_pk_bf16_f32 v167, v206, v207
    v_cvt_pk_bf16_f32 v168, v208, v209
    v_cvt_pk_bf16_f32 v169, v210, v211
    v_cvt_pk_bf16_f32 v170, v212, v213
    v_cvt_pk_bf16_f32 v171, v214, v215
    v_cvt_pk_bf16_f32 v172, v216, v217
    v_cvt_pk_bf16_f32 v173, v218, v219
    v_cvt_pk_bf16_f32 v174, v220, v221
    v_cvt_pk_bf16_f32 v175, v222, v223
    v_cvt_pk_bf16_f32 v176, v224, v225
    v_cvt_pk_bf16_f32 v177, v226, v227
    v_cvt_pk_bf16_f32 v178, v228, v229
    v_cvt_pk_bf16_f32 v179, v230, v231
    v_cvt_pk_bf16_f32 v180, v232, v233
    v_cvt_pk_bf16_f32 v181, v234, v235
    v_cvt_pk_bf16_f32 v182, v236, v237
    v_cvt_pk_bf16_f32 v183, v238, v239
    v_cvt_pk_bf16_f32 v184, v240, v241
    v_cvt_pk_bf16_f32 v185, v242, v243
    v_cvt_pk_bf16_f32 v186, v244, v245
    v_cvt_pk_bf16_f32 v187, v246, v247
    v_cvt_pk_bf16_f32 v188, v248, v249
    v_cvt_pk_bf16_f32 v189, v250, v251
    v_cvt_pk_bf16_f32 v190, v252, v253
    v_cvt_pk_bf16_f32 v191, v254, v255
    s_nop 1
    v_mfma_f32_16x16x32_bf16 v[192:195], v[64:67], v[128:131], 0
    v_mfma_f32_16x16x32_bf16 v[204:207], v[64:67], v[144:147], 0
    v_mfma_f32_16x16x32_bf16 v[208:211], v[68:71], v[144:147], 0
    v_mfma_f32_16x16x32_bf16 v[192:195], v[72:75], v[132:135], v[192:195]
    v_mfma_f32_16x16x32_bf16 v[204:207], v[72:75], v[148:151], v[204:207]
    v_mfma_f32_16x16x32_bf16 v[208:211], v[76:79], v[148:151], v[208:211]
    v_mfma_f32_16x16x32_bf16 v[192:195], v[80:83], v[136:139], v[192:195]
    v_mfma_f32_16x16x32_bf16 v[204:207], v[80:83], v[152:155], v[204:207]
    v_mfma_f32_16x16x32_bf16 v[208:211], v[84:87], v[152:155], v[208:211]
    v_mfma_f32_16x16x32_bf16 v[192:195], v[88:91], v[140:143], v[192:195]
    v_mfma_f32_16x16x32_bf16 v[204:207], v[88:91], v[156:159], v[204:207]
    v_mfma_f32_16x16x32_bf16 v[208:211], v[92:95], v[156:159], v[208:211]
    s_cmp_eq_u32 s40, 0
    s_cbranch_scc1 qj_260
qw_261:
    s_add_u32 s3, s80, 1
    v_cmp_gt_i32 vcc, s3, v29
    s_nop 3
    s_and_b32 s3, vcc_lo, 0x0f
    s_cbranch_scc0 qo_262
    s_sub_u32 s30, s30, 1
    s_cbranch_scc1 L_end
    s_sleep 4
    buffer_load_dword v29, v30, s[8:11], 0 offen sc1
    s_waitcnt vmcnt(0)
    s_branch qw_261
qo_262:
    buffer_load_dwordx4 v[96:99], v11, s[8:11], s61 offen offset:0 sc1
    buffer_load_dwordx4 v[100:103], v11, s[8:11], s61 offen offset:1024 sc1
    buffer_load_dwordx4 v[104:107], v11, s[8:11], s61 offen offset:2048 sc1
    buffer_load_dwordx4 v[108:111], v11, s[8:11], s61 offen offset:3072 sc1
    buffer_load_dwordx2 v[112:113], v12, s[8:11], s61 offen offset:512 sc1
    buffer_load_dwordx2 v[114:115], v12, s[8:11], s61 offen offset:768 sc1
    buffer_load_dwordx2 v[116:117], v12, s[8:11], s61 offen offset:1536 sc1
    buffer_load_dwordx2 v[118:119], v12, s[8:11], s61 offen offset:1792 sc1
    buffer_load_dwordx2 v[120:121], v12, s[8:11], s61 offen offset:2560 sc1
    buffer_load_dwordx2 v[122:123], v12, s[8:11], s61 offen offset:2816 sc1
    buffer_load_dwordx2 v[124:125], v12, s[8:11], s61 offen offset:3584 sc1
    buffer_load_dwordx2 v[126:127], v12, s[8:11], s61 offen offset:3840 sc1
qj_260:
    s_waitcnt vmcnt(8)
    v_mfma_f32_16x16x32_bf16 v[200:203], v[96:99], v[128:131], 0
    v_mfma_f32_16x16x32_bf16 v[212:215], v[96:99], v[144:147], 0
    v_mfma_f32_16x16x32_bf16 v[200:203], v[100:103], v[132:135], v[200:203]
    v_mfma_f32_16x16x32_bf16 v[212:215], v[100:103], v[148:151], v[212:215]
    v_mfma_f32_16x16x32_bf16 v[200:203], v[104:107], v[136:139], v[200:203]
    v_mfma_f32_16x16x32_bf16 v[212:215], v[104:107], v[152:155], v[212:215]
    v_mfma_f32_16x16x32_bf16 v[200:203], v[108:111], v[140:143], v[200:203]
    v_mfma_f32_16x16x32_bf16 v[212:215], v[108:111], v[156:159], v[212:215]
    ds_read_b128 v[64:67], v18 offset:0
    ds_read_b128 v[68:71], v18 offset:1024
    ds_read_b128 v[72:75], v18 offset:2048
    ds_read_b128 v[76:79], v18 offset:3072
    ds_read_b128 v[80:83], v18 offset:4096
    ds_read_b128 v[84:87], v18 offset:5120
    ds_read_b128 v[88:91], v18 offset:6144
    ds_read_b128 v[92:95], v18 offset:7168
    v_mul_f32 v192, s78, v192
    v_cndmask_b32 v192, v8, v192, s[68:69]
    v_mul_f32 v193, s78, v193
    v_cndmask_b32 v193, v8, v193, s[70:71]
    v_mul_f32 v194, s78, v194
    v_cndmask_b32 v194, v8, v194, s[72:73]
    v_mul_f32 v195, s78, v195
    v_cndmask_b32 v195, v8, v195, s[74:75]
    v_mov_b32 v196, v8
    v_mov_b32 v197, v8
    v_mov_b32 v198, v8
    v_mov_b32 v199, v8
    v_mul_f32 v200, s78, v200
    v_cndmask_b32 v200, v9, v200, s[76:77]
    v_mul_f32 v201, s78, v201
    v_cndmask_b32 v201, v9, v201, s[76:77]
    v_mul_f32 v202, s78, v202
    v_cndmask_b32 v202, v9, v202, s[76:77]
    v_mul_f32 v203, s78, v203
    v_cndmask_b32 v203, v9, v203, s[76:77]
    v_max3_f32 v16, v192, v193, v194
    v_max3_f32 v16, v16, v195, v196
    v_max3_f32 v16, v16, v197, v198
    v_max3_f32 v16, v16, v199, v200
    v_max3_f32 v16, v16, v201, v202
    v_max_f32 v16, v16, v203
    v_mov_b32 v17, v16
    s_nop 1
    v_permlane16_swap_b32 v16, v17
    v_max_f32 v16, v16, v17
    v_mov_b32 v17, v16
    s_nop 1
    v_permlane32_swap_b32 v16, v17
    v_max_f32 v16, v16, v17
    v_sub_f32 v192, v192, v16
    v_sub_f32 v193, v193, v16
    v_sub_f32 v194, v194, v16
    v_sub_f32 v195, v195, v16
    v_sub_f32 v196, v196, v16
    v_sub_f32 v197, v197, v16
    v_sub_f32 v198, v198, v16
    v_sub_f32 v199, v199, v16
    v_sub_f32 v200, v200, v16
    v_sub_f32 v201, v201, v16
    v_sub_f32 v202, v202, v16
    v_sub_f32 v203, v203, v16
    v_exp_f32 v192, v192
    v_exp_f32 v193, v193
    v_exp_f32 v194, v194
    v_exp_f32 v195, v195
    v_exp_f32 v196, v196
    v_exp_f32 v197, v197
    v_exp_f32 v198, v198
    v_exp_f32 v199, v199
    v_exp_f32 v200, v200
    v_exp_f32 v201, v201
    v_exp_f32 v202, v202
    v_exp_f32 v203, v203
    v_add_f32 v16, v192, v193
    v_add_f32 v16, v16, v194
    v_add_f32 v16, v16, v195
    v_add_f32 v16, v16, v196
    v_add_f32 v16, v16, v197
    v_add_f32 v16, v16, v198
    v_add_f32 v16, v16, v199
    v_add_f32 v16, v16, v200
    v_add_f32 v16, v16, v201
    v_add_f32 v16, v16, v202
    v_add_f32 v16, v16, v203
    v_mov_b32 v17, v16
    s_nop 1
    v_permlane16_swap_b32 v16, v17
    v_add_f32 v16, v16, v17
    v_mov_b32 v17, v16
    s_nop 1
    v_permlane32_swap_b32 v16, v17
    v_add_f32 v16, v16, v17
    v_rcp_f32 v16, v16
    s_nop 0
    v_mul_f32 v192, v192, v16
    v_mul_f32 v193, v193, v16
    v_mul_f32 v194, v194, v16
    v_mul_f32 v195, v195, v16
    v_mul_f32 v196, v196, v16
    v_mul_f32 v197, v197, v16
    v_mul_f32 v198, v198, v16
    v_mul_f32 v199, v199, v16
    v_mul_f32 v200, v200, v16
    v_mul_f32 v201, v201, v16
    v_mul_f32 v202, v202, v16
    v_mul_f32 v203, v203, v16
    v_cvt_pk_bf16_f32 v216, v192, v193
    v_cvt_pk_bf16_f32 v217, v196, v197
    v_cvt_pk_bf16_f32 v218, v194, v195
    v_cvt_pk_bf16_f32 v219, v198, v199
    v_cvt_pk_bf16_f32 v220, v200, v201
    v_cvt_pk_bf16_f32 v221, v202, v203
    v_mul_f32 v204, s78, v204
    v_mul_f32 v205, s78, v205
    v_mul_f32 v206, s78, v206
    v_mul_f32 v207, s78, v207
    v_mul_f32 v208, s78, v208
    v_cndmask_b32 v208, v8, v208, s[68:69]
    v_mul_f32 v209, s78, v209
    v_cndmask_b32 v209, v8, v209, s[70:71]
    v_mul_f32 v210, s78, v210
    v_cndmask_b32 v210, v8, v210, s[72:73]
    v_mul_f32 v211, s78, v211
    v_cndmask_b32 v211, v8, v211, s[74:75]
    v_mul_f32 v212, s78, v212
    v_cndmask_b32 v212, v9, v212, s[76:77]
    v_mul_f32 v213, s78, v213
    v_cndmask_b32 v213, v9, v213, s[76:77]
    v_mul_f32 v214, s78, v214
    v_cndmask_b32 v214, v9, v214, s[76:77]
    v_mul_f32 v215, s78, v215
    v_cndmask_b32 v215, v9, v215, s[76:77]
    v_max3_f32 v16, v204, v205, v206
    v_max3_f32 v16, v16, v207, v208
    v_max3_f32 v16, v16, v209, v210
    v_max3_f32 v16, v16, v211, v212
    v_max3_f32 v16, v16, v213, v214
    v_max_f32 v16, v16, v215
    v_mov_b32 v17, v16
    s_nop 1
    v_permlane16_swap_b32 v16, v17
    v_max_f32 v16, v16, v17
    v_mov_b32 v17, v16
    s_nop 1
    v_permlane32_swap_b32 v16, v17
    v_max_f32 v16, v16, v17
    v_sub_f32 v204, v204, v16
    v_sub_f32 v205, v205, v16
    v_sub_f32 v206, v206, v16
    v_sub_f32 v207, v207, v16
    v_sub_f32 v208, v208, v16
    v_sub_f32 v209, v209, v16
    v_sub_f32 v210, v210, v16
    v_sub_f32 v211, v211, v16
    v_sub_f32 v212, v212, v16
    v_sub_f32 v213, v213, v16
    v_sub_f32 v214, v214, v16
    v_sub_f32 v215, v215, v16
    v_exp_f32 v204, v204
    v_exp_f32 v205, v205
    v_exp_f32 v206, v206
    v_exp_f32 v207, v207
    v_exp_f32 v208, v208
    v_exp_f32 v209, v209
    v_exp_f32 v210, v210
    v_exp_f32 v211, v211
    v_exp_f32 v212, v212
    v_exp_f32 v213, v213
    v_exp_f32 v214, v214
    v_exp_f32 v215, v215
    v_add_f32 v16, v204, v205
    v_add_f32 v16, v16, v206
    v_add_f32 v16, v16, v207
    v_add_f32 v16, v16, v208
    v_add_f32 v16, v16, v209
    v_add_f32 v16, v16, v210
    v_add_f32 v16, v16, v211
    v_add_f32 v16, v16, v212
    v_add_f32 v16, v16, v213
    v_add_f32 v16, v16, v214
    v_add_f32 v16, v16, v215
    v_mov_b32 v17, v16
    s_nop 1
    v_permlane16_swap_b32 v16, v17
    v_add_f32 v16, v16, v17
    v_mov_b32 v17, v16
    s_nop 1
    v_permlane32_swap_b32 v16, v17
    v_add_f32 v16, v16, v17
    v_rcp_f32 v16, v16
    s_nop 0
    v_mul_f32 v204, v204, v16
    v_mul_f32 v205, v205, v16
    v_mul_f32 v206, v206, v16
    v_mul_f32 v207, v207, v16
    v_mul_f32 v208, v208, v16
    v_mul_f32 v209, v209, v16
    v_mul_f32 v210, v210, v16
    v_mul_f32 v211, v211, v16
    v_mul_f32 v212, v212, v16
    v_mul_f32 v213, v213, v16
    v_mul_f32 v214, v214, v16
    v_mul_f32 v215, v215, v16
    v_cvt_pk_bf16_f32 v222, v204, v205
    v_cvt_pk_bf16_f32 v223, v208, v209
    v_cvt_pk_bf16_f32 v224, v206, v207
    v_cvt_pk_bf16_f32 v225, v210, v211
    v_cvt_pk_bf16_f32 v226, v212, v213
    v_cvt_pk_bf16_f32 v227, v214, v215
    s_waitcnt vmcnt(0) lgkmcnt(0)
    s_nop 0
    v_mfma_f32_16x16x32_bf16 v[128:131], v[32:35], v[216:219], 0
    v_mfma_f32_16x16x32_bf16 v[132:135], v[36:39], v[216:219], 0
    v_mfma_f32_16x16x32_bf16 v[136:139], v[40:43], v[216:219], 0
    v_mfma_f32_16x16x32_bf16 v[140:143], v[44:47], v[216:219], 0
    v_mfma_f32_16x16x32_bf16 v[144:147], v[48:51], v[216:219], 0
    v_mfma_f32_16x16x32_bf16 v[148:151], v[52:55], v[216:219], 0
    v_mfma_f32_16x16x32_bf16 v[152:155], v[56:59], v[216:219], 0
    v_mfma_f32_16x16x32_bf16 v[156:159], v[60:63], v[216:219], 0
    v_mfma_f32_16x16x16_bf16 v[128:131], v[112:113], v[220:221], v[128:131]
    v_mfma_f32_16x16x16_bf16 v[132:135], v[114:115], v[220:221], v[132:135]
    v_mfma_f32_16x16x16_bf16 v[136:139], v[116:117], v[220:221], v[136:139]
    v_mfma_f32_16x16x16_bf16 v[140:143], v[118:119], v[220:221], v[140:143]
    v_mfma_f32_16x16x16_bf16 v[144:147], v[120:121], v[220:221], v[144:147]
    v_mfma_f32_16x16x16_bf16 v[148:151], v[122:123], v[220:221], v[148:151]
    v_mfma_f32_16x16x16_bf16 v[152:155], v[124:125], v[220:221], v[152:155]
    v_mfma_f32_16x16x16_bf16 v[156:159], v[126:127], v[220:221], v[156:159]
    s_nop 1
    v_cvt_pk_bf16_f32 v228, v128, v132
    v_cvt_pk_bf16_f32 v229, v129, v133
    v_cvt_pk_bf16_f32 v230, v130, v134
    v_cvt_pk_bf16_f32 v231, v131, v135
    buffer_store_dwordx4 v[228:231], v10, s[8:11], s62 offen offset:0 sc1
    v_cvt_pk_bf16_f32 v232, v136, v140
    v_cvt_pk_bf16_f32 v233, v137, v141
    v_cvt_pk_bf16_f32 v234, v138, v142
    v_cvt_pk_bf16_f32 v235, v139, v143
    buffer_store_dwordx4 v[232:235], v10, s[8:11], s62 offen offset:1024 sc1
    v_cvt_pk_bf16_f32 v236, v144, v148
    v_cvt_pk_bf16_f32 v237, v145, v149
    v_cvt_pk_bf16_f32 v238, v146, v150
    v_cvt_pk_bf16_f32 v239, v147, v151
    buffer_store_dwordx4 v[236:239], v10, s[8:11], s62 offen offset:2048 sc1
    v_cvt_pk_bf16_f32 v240, v152, v156
    v_cvt_pk_bf16_f32 v241, v153, v157
    v_cvt_pk_bf16_f32 v242, v154, v158
    v_cvt_pk_bf16_f32 v243, v155, v159
    buffer_store_dwordx4 v[240:243], v10, s[8:11], s62 offen offset:3072 sc1
    s_add_u32 s62, s62, 262144
    v_mfma_f32_16x16x32_bf16 v[128:131], v[32:35], v[222:225], 0
    v_mfma_f32_16x16x32_bf16 v[132:135], v[36:39], v[222:225], 0
    v_mfma_f32_16x16x32_bf16 v[136:139], v[40:43], v[222:225], 0
    v_mfma_f32_16x16x32_bf16 v[140:143], v[44:47], v[222:225], 0
    v_mfma_f32_16x16x32_bf16 v[144:147], v[48:51], v[222:225], 0
    v_mfma_f32_16x16x32_bf16 v[148:151], v[52:55], v[222:225], 0
    v_mfma_f32_16x16x32_bf16 v[152:155], v[56:59], v[222:225], 0
    v_mfma_f32_16x16x32_bf16 v[156:159], v[60:63], v[222:225], 0
    v_mfma_f32_16x16x16_bf16 v[128:131], v[112:113], v[226:227], v[128:131]
    v_mfma_f32_16x16x16_bf16 v[132:135], v[114:115], v[226:227], v[132:135]
    v_mfma_f32_16x16x16_bf16 v[136:139], v[116:117], v[226:227], v[136:139]
    v_mfma_f32_16x16x16_bf16 v[140:143], v[118:119], v[226:227], v[140:143]
    v_mfma_f32_16x16x16_bf16 v[144:147], v[120:121], v[226:227], v[144:147]
    v_mfma_f32_16x16x16_bf16 v[148:151], v[122:123], v[226:227], v[148:151]
    v_mfma_f32_16x16x16_bf16 v[152:155], v[124:125], v[226:227], v[152:155]
    v_mfma_f32_16x16x16_bf16 v[156:159], v[126:127], v[226:227], v[156:159]
    s_nop 1
    v_cvt_pk_bf16_f32 v192, v128, v132
    v_cvt_pk_bf16_f32 v193, v129, v133
    v_cvt_pk_bf16_f32 v194, v130, v134
    v_cvt_pk_bf16_f32 v195, v131, v135
    buffer_store_dwordx4 v[192:195], v10, s[8:11], s62 offen offset:0 sc1
    v_cvt_pk_bf16_f32 v196, v136, v140
    v_cvt_pk_bf16_f32 v197, v137, v141
    v_cvt_pk_bf16_f32 v198, v138, v142
    v_cvt_pk_bf16_f32 v199, v139, v143
    buffer_store_dwordx4 v[196:199], v10, s[8:11], s62 offen offset:1024 sc1
    v_cvt_pk_bf16_f32 v200, v144, v148
    v_cvt_pk_bf16_f32 v201, v145, v149
    v_cvt_pk_bf16_f32 v202, v146, v150
    v_cvt_pk_bf16_f32 v203, v147, v151
    buffer_store_dwordx4 v[200:203], v10, s[8:11], s62 offen offset:2048 sc1
    v_cvt_pk_bf16_f32 v204, v152, v156
    v_cvt_pk_bf16_f32 v205, v153, v157
    v_cvt_pk_bf16_f32 v206, v154, v158
    v_cvt_pk_bf16_f32 v207, v155, v159
    buffer_store_dwordx4 v[204:207], v10, s[8:11], s62 offen offset:3072 sc1
    s_add_u32 s62, s62, 262144
    ds_read_b128 v[32:35], v13 offset:0
    ds_read_b128 v[36:39], v13 offset:1024
    ds_read_b128 v[40:43], v13 offset:2048
    ds_read_b128 v[44:47], v13 offset:3072
    ds_read_b128 v[48:51], v13 offset:4096
    ds_read_b128 v[52:55], v13 offset:5120
    ds_read_b128 v[56:59], v13 offset:6144
    ds_read_b128 v[60:63], v13 offset:7168
    s_add_u32 s39, s80, 4
    s_lshl_b32 s61, s39, 18
    s_lshr_b32 s3, s81, 1
    s_lshl_b32 s3, s3, 14
    s_add_u32 s61, s61, s3
    s_and_b32 s3, s81, 1
    s_lshl_b32 s3, s3, 12
    s_add_u32 s61, s61, s3
    s_lshl_b32 s3, s39, 18
    s_add_u32 s62, s61, s3
    s_add_u32 s62, s62, 201326592
    s_bfe_u32 s3, s39, 0x10002
    s_lshl_b32 s3, s3, 13
    s_xor_b32 s3, s3, s79
    s_xor_b32 s3, s3, 8192
    s_add_u32 s62, s62, s3
    s_add_u32 s3, s39, 6
    s_and_b32 s3, s3, 64
    s_lshl_b32 s3, s3, 7
    s_and_b32 s3, s3, 8192
    s_xor_b32 s62, s62, s3
    s_lshl_b32 s3, s39, 10
    s_and_b32 s3, s3, 8192
    s_xor_b32 s3, s3, s79
    s_xor_b32 s3, s3, 0
    s_add_u32 s61, s61, s3
    s_add_u32 s61, s61, 104857600
    s_lshr_b32 s37, s81, 16
    s_add_u32 s3, s80, 5
    v_cmp_gt_i32 vcc, s3, v29
    s_nop 3
    s_and_b32 s40, vcc_lo, 0x0f
    s_cbranch_scc1 qs_263
    buffer_load_dwordx4 v[96:99], v11, s[8:11], s61 offen offset:0 sc1
    buffer_load_dwordx4 v[100:103], v11, s[8:11], s61 offen offset:1024 sc1
    buffer_load_dwordx4 v[104:107], v11, s[8:11], s61 offen offset:2048 sc1
    buffer_load_dwordx4 v[108:111], v11, s[8:11], s61 offen offset:3072 sc1
    buffer_load_dwordx2 v[112:113], v12, s[8:11], s61 offen offset:512 sc1
    buffer_load_dwordx2 v[114:115], v12, s[8:11], s61 offen offset:768 sc1
    buffer_load_dwordx2 v[116:117], v12, s[8:11], s61 offen offset:1536 sc1
    buffer_load_dwordx2 v[118:119], v12, s[8:11], s61 offen offset:1792 sc1
    buffer_load_dwordx2 v[120:121], v12, s[8:11], s61 offen offset:2560 sc1
    buffer_load_dwordx2 v[122:123], v12, s[8:11], s61 offen offset:2816 sc1
    buffer_load_dwordx2 v[124:125], v12, s[8:11], s61 offen offset:3584 sc1
    buffer_load_dwordx2 v[126:127], v12, s[8:11], s61 offen offset:3840 sc1
qs_263:
    v_mfma_f32_16x16x32_bf16 v[192:195], v[64:67], v[160:163], 0
    v_mfma_f32_16x16x32_bf16 v[204:207], v[64:67], v[176:179], 0
    v_mfma_f32_16x16x32_bf16 v[208:211], v[68:71], v[176:179], 0
    v_mfma_f32_16x16x32_bf16 v[192:195], v[72:75], v[164:167], v[192:195]
    v_mfma_f32_16x16x32_bf16 v[204:207], v[72:75], v[180:183], v[204:207]
    v_mfma_f32_16x16x32_bf16 v[208:211], v[76:79], v[180:183], v[208:211]
    v_mfma_f32_16x16x32_bf16 v[192:195], v[80:83], v[168:171], v[192:195]
    v_mfma_f32_16x16x32_bf16 v[204:207], v[80:83], v[184:187], v[204:207]
    v_mfma_f32_16x16x32_bf16 v[208:211], v[84:87], v[184:187], v[208:211]
    v_mfma_f32_16x16x32_bf16 v[192:195], v[88:91], v[172:175], v[192:195]
    v_mfma_f32_16x16x32_bf16 v[204:207], v[88:91], v[188:191], v[204:207]
    v_mfma_f32_16x16x32_bf16 v[208:211], v[92:95], v[188:191], v[208:211]
    s_cmp_eq_u32 s40, 0
    s_cbranch_scc1 qj_264
qw_265:
    s_add_u32 s3, s80, 5
    v_cmp_gt_i32 vcc, s3, v29
    s_nop 3
    s_and_b32 s3, vcc_lo, 0x0f
    s_cbranch_scc0 qo_266
    s_cmp_lg_u32 s37, 0
    s_cbranch_scc1 on_267
    s_waitcnt vmcnt(0)
    s_add_u32 s3, s80, 0
    s_lshl_b32 s3, s3, 5
    s_add_u32 s3, s3, s43
    s_lshl_b32 s3, s3, 2
    s_add_u32 s3, s3, 79708160
    v_mov_b32 v14, s3
    v_mov_b32 v15, 1
    s_mov_b64 exec, 1
    buffer_atomic_add v15, v14, s[8:11], 0 offen sc1
    s_mov_b64 exec, -1
    s_add_u32 s37, s37, 1
on_267:
    s_sub_u32 s30, s30, 1
    s_cbranch_scc1 L_end
    s_sleep 4
    buffer_load_dword v29, v30, s[8:11], 0 offen sc1
    s_waitcnt vmcnt(0)
    s_branch qw_265
qo_266:
    buffer_load_dwordx4 v[96:99], v11, s[8:11], s61 offen offset:0 sc1
    buffer_load_dwordx4 v[100:103], v11, s[8:11], s61 offen offset:1024 sc1
    buffer_load_dwordx4 v[104:107], v11, s[8:11], s61 offen offset:2048 sc1
    buffer_load_dwordx4 v[108:111], v11, s[8:11], s61 offen offset:3072 sc1
    buffer_load_dwordx2 v[112:113], v12, s[8:11], s61 offen offset:512 sc1
    buffer_load_dwordx2 v[114:115], v12, s[8:11], s61 offen offset:768 sc1
    buffer_load_dwordx2 v[116:117], v12, s[8:11], s61 offen offset:1536 sc1
    buffer_load_dwordx2 v[118:119], v12, s[8:11], s61 offen offset:1792 sc1
    buffer_load_dwordx2 v[120:121], v12, s[8:11], s61 offen offset:2560 sc1
    buffer_load_dwordx2 v[122:123], v12, s[8:11], s61 offen offset:2816 sc1
    buffer_load_dwordx2 v[124:125], v12, s[8:11], s61 offen offset:3584 sc1
    buffer_load_dwordx2 v[126:127], v12, s[8:11], s61 offen offset:3840 sc1
qj_264:
    s_waitcnt vmcnt(8)
    v_mfma_f32_16x16x32_bf16 v[200:203], v[96:99], v[160:163], 0
    v_mfma_f32_16x16x32_bf16 v[212:215], v[96:99], v[176:179], 0
    v_mfma_f32_16x16x32_bf16 v[200:203], v[100:103], v[164:167], v[200:203]
    v_mfma_f32_16x16x32_bf16 v[212:215], v[100:103], v[180:183], v[212:215]
    v_mfma_f32_16x16x32_bf16 v[200:203], v[104:107], v[168:171], v[200:203]
    v_mfma_f32_16x16x32_bf16 v[212:215], v[104:107], v[184:187], v[212:215]
    v_mfma_f32_16x16x32_bf16 v[200:203], v[108:111], v[172:175], v[200:203]
    v_mfma_f32_16x16x32_bf16 v[212:215], v[108:111], v[188:191], v[212:215]
    s_nop 7
    v_mul_f32 v192, s78, v192
    v_cndmask_b32 v192, v8, v192, s[68:69]
    v_mul_f32 v193, s78, v193
    v_cndmask_b32 v193, v8, v193, s[70:71]
    v_mul_f32 v194, s78, v194
    v_cndmask_b32 v194, v8, v194, s[72:73]
    v_mul_f32 v195, s78, v195
    v_cndmask_b32 v195, v8, v195, s[74:75]
    v_mov_b32 v196, v8
    v_mov_b32 v197, v8
    v_mov_b32 v198, v8
    v_mov_b32 v199, v8
    v_mul_f32 v200, s78, v200
    v_cndmask_b32 v200, v9, v200, s[76:77]
    v_mul_f32 v201, s78, v201
    v_cndmask_b32 v201, v9, v201, s[76:77]
    v_mul_f32 v202, s78, v202
    v_cndmask_b32 v202, v9, v202, s[76:77]
    v_mul_f32 v203, s78, v203
    v_cndmask_b32 v203, v9, v203, s[76:77]
    v_max3_f32 v16, v192, v193, v194
    v_max3_f32 v16, v16, v195, v196
    v_max3_f32 v16, v16, v197, v198
    v_max3_f32 v16, v16, v199, v200
    v_max3_f32 v16, v16, v201, v202
    v_max_f32 v16, v16, v203
    v_mov_b32 v17, v16
    s_nop 1
    v_permlane16_swap_b32 v16, v17
    v_max_f32 v16, v16, v17
    v_mov_b32 v17, v16
    s_nop 1
    v_permlane32_swap_b32 v16, v17
    v_max_f32 v16, v16, v17
    v_sub_f32 v192, v192, v16
    v_sub_f32 v193, v193, v16
    v_sub_f32 v194, v194, v16
    v_sub_f32 v195, v195, v16
    v_sub_f32 v196, v196, v16
    v_sub_f32 v197, v197, v16
    v_sub_f32 v198, v198, v16
    v_sub_f32 v199, v199, v16
    v_sub_f32 v200, v200, v16
    v_sub_f32 v201, v201, v16
    v_sub_f32 v202, v202, v16
    v_sub_f32 v203, v203, v16
    v_exp_f32 v192, v192
    v_exp_f32 v193, v193
    v_exp_f32 v194, v194
    v_exp_f32 v195, v195
    v_exp_f32 v196, v196
    v_exp_f32 v197, v197
    v_exp_f32 v198, v198
    v_exp_f32 v199, v199
    v_exp_f32 v200, v200
    v_exp_f32 v201, v201
    v_exp_f32 v202, v202
    v_exp_f32 v203, v203
    v_add_f32 v16, v192, v193
    v_add_f32 v16, v16, v194
    v_add_f32 v16, v16, v195
    v_add_f32 v16, v16, v196
    v_add_f32 v16, v16, v197
    v_add_f32 v16, v16, v198
    v_add_f32 v16, v16, v199
    v_add_f32 v16, v16, v200
    v_add_f32 v16, v16, v201
    v_add_f32 v16, v16, v202
    v_add_f32 v16, v16, v203
    v_mov_b32 v17, v16
    s_nop 1
    v_permlane16_swap_b32 v16, v17
    v_add_f32 v16, v16, v17
    v_mov_b32 v17, v16
    s_nop 1
    v_permlane32_swap_b32 v16, v17
    v_add_f32 v16, v16, v17
    v_rcp_f32 v16, v16
    s_nop 0
    v_mul_f32 v192, v192, v16
    v_mul_f32 v193, v193, v16
    v_mul_f32 v194, v194, v16
    v_mul_f32 v195, v195, v16
    v_mul_f32 v196, v196, v16
    v_mul_f32 v197, v197, v16
    v_mul_f32 v198, v198, v16
    v_mul_f32 v199, v199, v16
    v_mul_f32 v200, v200, v16
    v_mul_f32 v201, v201, v16
    v_mul_f32 v202, v202, v16
    v_mul_f32 v203, v203, v16
    v_cvt_pk_bf16_f32 v216, v192, v193
    v_cvt_pk_bf16_f32 v217, v196, v197
    v_cvt_pk_bf16_f32 v218, v194, v195
    v_cvt_pk_bf16_f32 v219, v198, v199
    v_cvt_pk_bf16_f32 v220, v200, v201
    v_cvt_pk_bf16_f32 v221, v202, v203
    v_mul_f32 v204, s78, v204
    v_mul_f32 v205, s78, v205
    v_mul_f32 v206, s78, v206
    v_mul_f32 v207, s78, v207
    v_mul_f32 v208, s78, v208
    v_cndmask_b32 v208, v8, v208, s[68:69]
    v_mul_f32 v209, s78, v209
    v_cndmask_b32 v209, v8, v209, s[70:71]
    v_mul_f32 v210, s78, v210
    v_cndmask_b32 v210, v8, v210, s[72:73]
    v_mul_f32 v211, s78, v211
    v_cndmask_b32 v211, v8, v211, s[74:75]
    v_mul_f32 v212, s78, v212
    v_cndmask_b32 v212, v9, v212, s[76:77]
    v_mul_f32 v213, s78, v213
    v_cndmask_b32 v213, v9, v213, s[76:77]
    v_mul_f32 v214, s78, v214
    v_cndmask_b32 v214, v9, v214, s[76:77]
    v_mul_f32 v215, s78, v215
    v_cndmask_b32 v215, v9, v215, s[76:77]
    v_max3_f32 v16, v204, v205, v206
    v_max3_f32 v16, v16, v207, v208
    v_max3_f32 v16, v16, v209, v210
    v_max3_f32 v16, v16, v211, v212
    v_max3_f32 v16, v16, v213, v214
    v_max_f32 v16, v16, v215
    v_mov_b32 v17, v16
    s_nop 1
    v_permlane16_swap_b32 v16, v17
    v_max_f32 v16, v16, v17
    v_mov_b32 v17, v16
    s_nop 1
    v_permlane32_swap_b32 v16, v17
    v_max_f32 v16, v16, v17
    v_sub_f32 v204, v204, v16
    v_sub_f32 v205, v205, v16
    v_sub_f32 v206, v206, v16
    v_sub_f32 v207, v207, v16
    v_sub_f32 v208, v208, v16
    v_sub_f32 v209, v209, v16
    v_sub_f32 v210, v210, v16
    v_sub_f32 v211, v211, v16
    v_sub_f32 v212, v212, v16
    v_sub_f32 v213, v213, v16
    v_sub_f32 v214, v214, v16
    v_sub_f32 v215, v215, v16
    v_exp_f32 v204, v204
    v_exp_f32 v205, v205
    v_exp_f32 v206, v206
    v_exp_f32 v207, v207
    v_exp_f32 v208, v208
    v_exp_f32 v209, v209
    v_exp_f32 v210, v210
    v_exp_f32 v211, v211
    v_exp_f32 v212, v212
    v_exp_f32 v213, v213
    v_exp_f32 v214, v214
    v_exp_f32 v215, v215
    v_add_f32 v16, v204, v205
    v_add_f32 v16, v16, v206
    v_add_f32 v16, v16, v207
    v_add_f32 v16, v16, v208
    v_add_f32 v16, v16, v209
    v_add_f32 v16, v16, v210
    v_add_f32 v16, v16, v211
    v_add_f32 v16, v16, v212
    v_add_f32 v16, v16, v213
    v_add_f32 v16, v16, v214
    v_add_f32 v16, v16, v215
    v_mov_b32 v17, v16
    s_nop 1
    v_permlane16_swap_b32 v16, v17
    v_add_f32 v16, v16, v17
    v_mov_b32 v17, v16
    s_nop 1
    v_permlane32_swap_b32 v16, v17
    v_add_f32 v16, v16, v17
    v_rcp_f32 v16, v16
    s_nop 0
    v_mul_f32 v204, v204, v16
    v_mul_f32 v205, v205, v16
    v_mul_f32 v206, v206, v16
    v_mul_f32 v207, v207, v16
    v_mul_f32 v208, v208, v16
    v_mul_f32 v209, v209, v16
    v_mul_f32 v210, v210, v16
    v_mul_f32 v211, v211, v16
    v_mul_f32 v212, v212, v16
    v_mul_f32 v213, v213, v16
    v_mul_f32 v214, v214, v16
    v_mul_f32 v215, v215, v16
    v_cvt_pk_bf16_f32 v222, v204, v205
    v_cvt_pk_bf16_f32 v223, v208, v209
    v_cvt_pk_bf16_f32 v224, v206, v207
    v_cvt_pk_bf16_f32 v225, v210, v211
    v_cvt_pk_bf16_f32 v226, v212, v213
    v_cvt_pk_bf16_f32 v227, v214, v215
    s_waitcnt vmcnt(0) lgkmcnt(0)
    s_cmp_lg_u32 s37, 0
    s_cbranch_scc1 on_268
    s_waitcnt vmcnt(0)
    s_add_u32 s3, s80, 0
    s_lshl_b32 s3, s3, 5
    s_add_u32 s3, s3, s43
    s_lshl_b32 s3, s3, 2
    s_add_u32 s3, s3, 79708160
    v_mov_b32 v14, s3
    v_mov_b32 v15, 1
    s_mov_b64 exec, 1
    buffer_atomic_add v15, v14, s[8:11], 0 offen sc1
    s_mov_b64 exec, -1
    s_add_u32 s37, s37, 1
on_268:
    s_cmp_lg_u32 s26, 0
    s_cbranch_scc1 ti_269
    s_lshl_b32 s3, s43, 2
    s_add_u32 s3, s3, 16
    v_mov_b32 v27, s3
    v_mov_b32 v28, 1
    s_mov_b64 exec, 1
    buffer_atomic_add v28, v27, s[20:23], 0 offen sc0 sc1
    s_mov_b64 exec, -1
ti_269:
    s_nop 0
    v_mfma_f32_16x16x32_bf16 v[160:163], v[32:35], v[216:219], 0
    v_mfma_f32_16x16x32_bf16 v[164:167], v[36:39], v[216:219], 0
    v_mfma_f32_16x16x32_bf16 v[168:171], v[40:43], v[216:219], 0
    v_mfma_f32_16x16x32_bf16 v[172:175], v[44:47], v[216:219], 0
    v_mfma_f32_16x16x32_bf16 v[176:179], v[48:51], v[216:219], 0
    v_mfma_f32_16x16x32_bf16 v[180:183], v[52:55], v[216:219], 0
    v_mfma_f32_16x16x32_bf16 v[184:187], v[56:59], v[216:219], 0
    v_mfma_f32_16x16x32_bf16 v[188:191], v[60:63], v[216:219], 0
    v_mfma_f32_16x16x16_bf16 v[160:163], v[112:113], v[220:221], v[160:163]
    v_mfma_f32_16x16x16_bf16 v[164:167], v[114:115], v[220:221], v[164:167]
    v_mfma_f32_16x16x16_bf16 v[168:171], v[116:117], v[220:221], v[168:171]
    v_mfma_f32_16x16x16_bf16 v[172:175], v[118:119], v[220:221], v[172:175]
    v_mfma_f32_16x16x16_bf16 v[176:179], v[120:121], v[220:221], v[176:179]
    v_mfma_f32_16x16x16_bf16 v[180:183], v[122:123], v[220:221], v[180:183]
    v_mfma_f32_16x16x16_bf16 v[184:187], v[124:125], v[220:221], v[184:187]
    v_mfma_f32_16x16x16_bf16 v[188:191], v[126:127], v[220:221], v[188:191]
    s_nop 1
    v_cvt_pk_bf16_f32 v228, v160, v164
    v_cvt_pk_bf16_f32 v229, v161, v165
    v_cvt_pk_bf16_f32 v230, v162, v166
    v_cvt_pk_bf16_f32 v231, v163, v167
    buffer_store_dwordx4 v[228:231], v10, s[8:11], s62 offen offset:0 sc1
    v_cvt_pk_bf16_f32 v232, v168, v172
    v_cvt_pk_bf16_f32 v233, v169, v173
    v_cvt_pk_bf16_f32 v234, v170, v174
    v_cvt_pk_bf16_f32 v235, v171, v175
    buffer_store_dwordx4 v[232:235], v10, s[8:11], s62 offen offset:1024 sc1
    v_cvt_pk_bf16_f32 v236, v176, v180
    v_cvt_pk_bf16_f32 v237, v177, v181
    v_cvt_pk_bf16_f32 v238, v178, v182
    v_cvt_pk_bf16_f32 v239, v179, v183
    buffer_store_dwordx4 v[236:239], v10, s[8:11], s62 offen offset:2048 sc1
    v_cvt_pk_bf16_f32 v240, v184, v188
    v_cvt_pk_bf16_f32 v241, v185, v189
    v_cvt_pk_bf16_f32 v242, v186, v190
    v_cvt_pk_bf16_f32 v243, v187, v191
    buffer_store_dwordx4 v[240:243], v10, s[8:11], s62 offen offset:3072 sc1
    s_add_u32 s62, s62, 262144
    v_mfma_f32_16x16x32_bf16 v[160:163], v[32:35], v[222:225], 0
    v_mfma_f32_16x16x32_bf16 v[164:167], v[36:39], v[222:225], 0
    v_mfma_f32_16x16x32_bf16 v[168:171], v[40:43], v[222:225], 0
    v_mfma_f32_16x16x32_bf16 v[172:175], v[44:47], v[222:225], 0
    v_mfma_f32_16x16x32_bf16 v[176:179], v[48:51], v[222:225], 0
    v_mfma_f32_16x16x32_bf16 v[180:183], v[52:55], v[222:225], 0
    v_mfma_f32_16x16x32_bf16 v[184:187], v[56:59], v[222:225], 0
    v_mfma_f32_16x16x32_bf16 v[188:191], v[60:63], v[222:225], 0
    v_mfma_f32_16x16x16_bf16 v[160:163], v[112:113], v[226:227], v[160:163]
    v_mfma_f32_16x16x16_bf16 v[164:167], v[114:115], v[226:227], v[164:167]
    v_mfma_f32_16x16x16_bf16 v[168:171], v[116:117], v[226:227], v[168:171]
    v_mfma_f32_16x16x16_bf16 v[172:175], v[118:119], v[226:227], v[172:175]
    v_mfma_f32_16x16x16_bf16 v[176:179], v[120:121], v[226:227], v[176:179]
    v_mfma_f32_16x16x16_bf16 v[180:183], v[122:123], v[226:227], v[180:183]
    v_mfma_f32_16x16x16_bf16 v[184:187], v[124:125], v[226:227], v[184:187]
    v_mfma_f32_16x16x16_bf16 v[188:191], v[126:127], v[226:227], v[188:191]
    s_nop 1
    v_cvt_pk_bf16_f32 v192, v160, v164
    v_cvt_pk_bf16_f32 v193, v161, v165
    v_cvt_pk_bf16_f32 v194, v162, v166
    v_cvt_pk_bf16_f32 v195, v163, v167
    buffer_store_dwordx4 v[192:195], v10, s[8:11], s62 offen offset:0 sc1
    v_cvt_pk_bf16_f32 v196, v168, v172
    v_cvt_pk_bf16_f32 v197, v169, v173
    v_cvt_pk_bf16_f32 v198, v170, v174
    v_cvt_pk_bf16_f32 v199, v171, v175
    buffer_store_dwordx4 v[196:199], v10, s[8:11], s62 offen offset:1024 sc1
    v_cvt_pk_bf16_f32 v200, v176, v180
    v_cvt_pk_bf16_f32 v201, v177, v181
    v_cvt_pk_bf16_f32 v202, v178, v182
    v_cvt_pk_bf16_f32 v203, v179, v183
    buffer_store_dwordx4 v[200:203], v10, s[8:11], s62 offen offset:2048 sc1
    v_cvt_pk_bf16_f32 v204, v184, v188
    v_cvt_pk_bf16_f32 v205, v185, v189
    v_cvt_pk_bf16_f32 v206, v186, v190
    v_cvt_pk_bf16_f32 v207, v187, v191
    buffer_store_dwordx4 v[204:207], v10, s[8:11], s62 offen offset:3072 sc1
    s_add_u32 s62, s62, 262144
    s_waitcnt vmcnt(0)
    s_add_u32 s3, s80, 4
    s_lshl_b32 s3, s3, 5
    s_add_u32 s3, s3, s43
    s_lshl_b32 s3, s3, 2
    s_add_u32 s3, s3, 79708160
    v_mov_b32 v14, s3
    v_mov_b32 v15, 1
    s_mov_b64 exec, 1
    buffer_atomic_add v15, v14, s[8:11], 0 offen sc1
    s_mov_b64 exec, -1
    s_waitcnt vmcnt(0)
    v_mov_b32 v3, 163584
    s_cmp_lg_u32 s26, 0
    s_cbranch_scc1 tt_270
    s_mov_b64 exec, 1
    ds_write_b32 v3, v28
    s_waitcnt lgkmcnt(0)
    s_mov_b64 exec, -1
tt_270:
    s_barrier
    ds_read_b32 v5, v3
    s_waitcnt lgkmcnt(0)
    v_readfirstlane_b32 s25, v5
    s_nop 3
    s_cmp_lg_u32 s26, 1
    s_cbranch_scc1 sg_271
    s_mov_b64 exec, -1
sg_271:
    s_branch W_dec
L_end:
    s_endpgm
.p2align 2
.type W_table,@object
W_table:
.long 0x4000000
.long 0x5000400
.long 0x6040000
.long 0x7040400
.long 0x8080000
.long 0x9080400
.long 0xa0c0000
.long 0xb0c0400
.long 0xc100000
.long 0xd100400
.long 0xe140000
.long 0xf140400
.long 0x10180000
.long 0x11180400
.long 0x121c0000
.long 0x131c0400
.long 0x14000001
.long 0x15000401
.long 0x16040001
.long 0x17040401
.long 0x18080001
.long 0x19080401
.long 0x1a0c0001
.long 0x1b0c0401
.long 0x1c100001
.long 0x1d100401
.long 0x1e140001
.long 0x1f140401
.long 0x20180001
.long 0x21180401
.long 0x221c0001
.long 0x231c0401
.long 0x24000802
.long 0x26000c02
.long 0x28080802
.long 0x2a080c02
.long 0x2c100802
.long 0x2e100c02
.long 0x30180802
.long 0x32180c02
.long 0x34000803
.long 0x36000c03
.long 0x38080803
.long 0x3a080c03
.long 0x3c100803
.long 0x3e100c03
.long 0x40180803
.long 0x42180c03
.long 0xff001004
.long 0xff081004
.long 0xff101004
.long 0xff181004
.long 0xff001005
.long 0xff081005
.long 0xff101005
.long 0xff181005
.long 0x44001804
.long 0x48081804
.long 0x4c101804
.long 0x50181804
.long 0x54001805
.long 0x58081805
.long 0x5c101805
.long 0x60181805
.long 0x64002004
.long 0x68082004
.long 0x6c102004
.long 0x70182004
.long 0x74002005
.long 0x78082005
.long 0x7c102005
.long 0x80182005
.long 0x84002804
.long 0x88082804
.long 0x8c102804
.long 0x90182804
.long 0x94002805
.long 0x98082805
.long 0x9c102805
.long 0xa0182805
.long 0xff000006
.long 0xff080006
.long 0xff100006
.long 0xff180006
.long 0xff000806
.long 0xff080806
.long 0xff100806
.long 0xff180806
.long 0xa4003004
.long 0xa8083004
.long 0xac103004
.long 0xb0183004
.long 0xb4003005
.long 0xb8083005
.long 0xbc103005
.long 0xc0183005
.long 0xff001006
.long 0xff081006
.long 0xff101006
.long 0xff181006
.long 0xff000007
.long 0xff040007
.long 0xff000807
.long 0xff040807
.long 0xff001007
.long 0xff041007
.long 0xff001807
.long 0xff041807
.long 0xff001806
.long 0xff081806
.long 0xff101806
.long 0xff181806
.long 0xff002007
.long 0xff042007
.long 0xff002807
.long 0xff042807
.long 0xff003007
.long 0xff043007
.long 0xff003807
.long 0xff043807
.long 0xff002006
.long 0xff082006
.long 0xff102006
.long 0xff182006
.long 0xff000008
.long 0xff000808
.long 0xff001008
.long 0xff001808
.long 0xff002008
.long 0xff002808
.long 0xff003008
.long 0xff003808
.long 0xff00000c
.long 0xff00040c
.long 0xff00080c
.long 0xff000c0c
.long 0xc4003804
.long 0xc8083804
.long 0xcc103804
.long 0xd0183804
.long 0xd4003805
.long 0xd8083805
.long 0xdc103805
.long 0xe0183805
.long 0xff002806
.long 0xff082806
.long 0xff102806
.long 0xff182806
.long 0xff00100c
.long 0xff00140c
.long 0xff00180c
.long 0xff001c0c
.long 0xff003006
.long 0xff083006
.long 0xff103006
.long 0xff183006
.long 0xff00200a
.long 0xff04200a
.long 0xff00240a
.long 0xff04240a
.long 0xff003806
.long 0xff083806
.long 0xff103806
.long 0xff183806
.long 0xff00000b
.long 0xff00080b
.long 0xff00100b
.long 0xff00180b
.long 0xff00200b
.long 0xff00280b
.long 0xff00300b
.long 0xff00380b
.long 0xff00280a
.long 0xff04280a
.long 0xff002c0a
.long 0xff042c0a
.long 0xff003009
.long 0xff043009
.long 0xff003209
.long 0xff043209
.long 0xff00340d
.long 0xff04340d
.long 0xff08340d
.long 0xff0c340d
.long 0xff10340d
.long 0xff14340d
.long 0xff18340d
.long 0xff1c340d
.long 0xff00360d
.long 0xff04360d
.long 0xff08360d
.long 0xff0c360d
.long 0xff10360d
.long 0xff14360d
.long 0xff18360d
.long 0xff1c360d
.long 0xff00380d
.long 0xff04380d
.long 0xff08380d
.long 0xff0c380d
.long 0xff10380d
.long 0xff14380d
.long 0xff18380d
.long 0xff1c380d
.long 0xff
.section .rodata,"a"
.p2align 6
.amdhsa_kernel main_kernel
  .amdhsa_next_free_vgpr 256
  .amdhsa_next_free_sgpr 102
  .amdhsa_accum_offset 256
  .amdhsa_group_segment_fixed_size 0
  .amdhsa_kernarg_size 104
  .amdhsa_user_sgpr_count 2
  .amdhsa_user_sgpr_kernarg_segment_ptr 1
  .amdhsa_system_sgpr_workgroup_id_x 1
  .amdhsa_float_denorm_mode_32 3
  .amdhsa_float_denorm_mode_16_64 3
.end_amdhsa_kernel
```
